```python
import torch

def _softmax(x, axis=-1):
    return torch.softmax(x, dim=axis)
def _gelu(x):
    return torch.nn.functional.gelu(x, approximate="tanh")
def _silu(x):
    return torch.nn.functional.silu(x)
def _sigmoid(x):
    return torch.sigmoid(x)
def _layernorm(x, axis=-1, eps=1e-5):
    m = x.mean(dim=axis, keepdim=True)
    v = x.var(dim=axis, keepdim=True, unbiased=False)
    return (x - m) / torch.sqrt(v + eps)
def _scatter_add(tgt, idx, src, axis=0):
    return tgt.clone().index_add_(axis, idx, src)
def _segment_sum(src, seg, n):
    out = torch.zeros((n,) + src.shape[1:], dtype=src.dtype)
    return out.index_add_(0, seg, src)
def _pad(x, pw):
    flat = tuple(v for pair in reversed(pw) for v in pair)
    return torch.nn.functional.pad(x, flat)

kernel_name = 'parallel_sum__ssm_conv_s5__glu_gated_swiglu__prompt'

def setup_inputs():

    _w = (lambda a: (lambda t: t.to(torch.bfloat16) if t.is_floating_point() else t)(torch.as_tensor(a)))
    def _A_setup():
        B, S, D = 1, 2048, 640
        P = D
        Lambda_re = -0.5 * (lambda _x: torch.exp(torch.as_tensor(_x)))((lambda *s: torch.randn(*s, dtype=torch.bfloat16) * 0.2)(P))
        Lambda_im = (lambda *s: torch.randn(*s, dtype=torch.bfloat16) * 0.8)(P) * 1.0
        B_re = (lambda *s: torch.randn(*s, dtype=torch.bfloat16) * 0.2)(P, D) * (D ** -0.5)
        B_im = (lambda *s: torch.randn(*s, dtype=torch.bfloat16) * 0.2)(P, D) * (D ** -0.5)
        C_re = (lambda *s: torch.randn(*s, dtype=torch.bfloat16) * 0.2)(D, P) * (P ** -0.5)
        C_im = (lambda *s: torch.randn(*s, dtype=torch.bfloat16) * 0.2)(D, P) * (P ** -0.5)
        log_dt = (lambda *s: torch.randn(*s, dtype=torch.bfloat16) * 0.2)(P) * 0.3 - 2.0
        Dskip = (lambda *s: torch.randn(*s, dtype=torch.bfloat16) * 0.05)(D)
        return {
            "x": _w((lambda *s: torch.randn(*s, dtype=torch.bfloat16) * 0.05)(B, S, D)),
            "Lambda_re": _w(Lambda_re),
            "Lambda_im": _w(Lambda_im),
            "B_re": _w(B_re),
            "B_im": _w(B_im),
            "C_re": _w(C_re),
            "C_im": _w(C_im),
            "log_dt": _w(log_dt),
            "Dskip": _w(Dskip),
        }
    _A_in = _A_setup()

    def _B_setup():
        B, S, D, F = 1, 2048, 640, 1728
        return {
            "x": _w((lambda *s: torch.randn(*s, dtype=torch.bfloat16) * 0.05)(B, S, D)),
            "w1": _w((lambda *s: torch.randn(*s, dtype=torch.bfloat16) * 0.4)(D, F) * (2.0 / D) ** 0.5),
            "w3": _w((lambda *s: torch.randn(*s, dtype=torch.bfloat16) * 0.4)(D, F) * (2.0 / D) ** 0.5),
            "w2": _w((lambda *s: torch.randn(*s, dtype=torch.bfloat16) * 0.4)(F, D) * (2.0 / F) ** 0.5),
        }
    _B_in = _B_setup()

    return {
        "A_x": _A_in["x"],
        "A_Lambda_re": _A_in["Lambda_re"],
        "A_Lambda_im": _A_in["Lambda_im"],
        "A_B_re": _A_in["B_re"],
        "A_B_im": _A_in["B_im"],
        "A_C_re": _A_in["C_re"],
        "A_C_im": _A_in["C_im"],
        "A_log_dt": _A_in["log_dt"],
        "A_Dskip": _A_in["Dskip"],
        "B_x": _B_in["x"],
        "B_w1": _B_in["w1"],
        "B_w3": _B_in["w3"],
        "B_w2": _B_in["w2"],
    }

def reference(A_x, A_Lambda_re, A_Lambda_im, A_B_re, A_B_im, A_C_re, A_C_im, A_log_dt, A_Dskip, B_x, B_w1, B_w3, B_w2):
    def _A_ref(x, Lambda_re, Lambda_im, B_re, B_im, C_re, C_im, log_dt, Dskip):
        Bsz, L, H = x.shape
        Lam = Lambda_re + 1j * Lambda_im
        Bmat = B_re + 1j * B_im
        Cmat = C_re + 1j * C_im
        dt = torch.exp(log_dt)
        Lam_bar = torch.exp(dt * Lam)
        B_bar = ((Lam_bar - 1.0) / Lam)[:, None] * Bmat
        Bu = torch.einsum("bld,pd->blp", x + 0j, B_bar)
        h = torch.zeros_like(Bu[:, 0, :])
        hs = []
        for t in range(L):
            h = Lam_bar[None, :] * h + Bu[:, t, :]
            hs.append(h)
        hseq = torch.stack(hs, 1)
        y = 2.0 * torch.einsum("blp,dp->bld", hseq, Cmat).real + x * Dskip[None, None, :]
        return y

    def _B_ref(x, w1, w3, w2):
        gate = torch.einsum("bsd,df->bsf", x, w1)
        up = torch.einsum("bsd,df->bsf", x, w3)
        h = _silu(gate) * up
        out = torch.einsum("bsf,fd->bsd", h, w2)
        return out

    x = A_x
    xn = _layernorm(x, axis=-1)
    return x + _A_ref(xn, A_Lambda_re, A_Lambda_im, A_B_re, A_B_im, A_C_re, A_C_im, A_log_dt, A_Dskip) + _B_ref(xn, B_w1, B_w3, B_w2)
```

```asm
; @launch grid=(256,1,1) block=(256,1,1) lds=163840
.amdgcn_target "amdgcn-amd-amdhsa--gfx950"
.text
.globl parallel_sum__ssm_conv_s5__glu_gated_swiglu__prompt_kernel
.p2align 8
.type parallel_sum__ssm_conv_s5__glu_gated_swiglu__prompt_kernel,@function
parallel_sum__ssm_conv_s5__glu_gated_swiglu__prompt_kernel:
  s_cmp_ge_u32 s2, 256
  s_cbranch_scc1 K_end
  s_load_dwordx16 s[36:51], s[0:1], 0
  s_load_dwordx16 s[52:67], s[0:1], 64
  v_and_b32 v1, 63, v0
  v_lshrrev_b32 v2, 6, v0
  s_and_b32 s32, s2, 7
  v_readfirstlane_b32 s3, v2
  s_lshr_b32 s33, s2, 3
  s_lshr_b32 s34, s32, 2
  s_and_b32 s35, s32, 3
  s_and_b32 s71, s3, 1
  s_lshr_b32 s72, s3, 1
  s_getpc_b64 s[6:7]
K_pc:
  s_lshl2_add_u32 s76, s33, s3
  s_and_b32 s76, s76, 15
  s_lshl_b32 s76, s76, 13
  v_lshlrev_b32 v2, 7, v1
  v_add_u32 v2, s76, v2
  v_min_u32 v2, K_end-K_pc, v2
  s_cmp_lt_u32 s33, 28
  s_cbranch_scc1 K_nopf
  global_load_dword v64, v2, s[6:7]
K_nopf:
  s_lshl2_add_u32 s95, s2, s3
  v_lshrrev_b32 v62, 5, v1
  v_mul_u32_u24 v62, 1280, v62
  v_and_b32 v63, 31, v1
  v_lshl_add_u32 v62, v63, 3, v62
  s_lshl_b32 s31, s32, 5
  s_add_u32 s31, s31, s33
  s_lshl2_add_u32 s75, s31, s3
  s_mul_i32 s75, s75, 2560
  s_cmp_eq_u32 s35, 3
  s_cselect_b32 s76, 16, 8
  s_cmp_ge_u32 s33, s76
  s_cselect_b32 s70, 1, 0
  s_lshl_b32 s35, s35, 3
  s_add_u32 s33, s33, s35
  s_and_b32 s68, s33, 3
  s_lshl2_add_u32 s68, s34, s68
  s_lshr_b32 s69, s33, 2
  s_lshl_b32 s32, s68, 8
  s_lshl_b32 s33, s72, 7
  s_add_u32 s32, s32, s33
  s_lshl_b32 s33, s71, 3
  s_add_u32 s32, s32, s33
  v_and_b32 v2, 32, v1
  v_bfe_u32 v3, v1, 3, 1
  v_lshl_add_u32 v2, v3, 4, v2
  v_bfe_u32 v3, v1, 4, 1
  v_add3_u32 v2, v2, v3, s32
  v_mul_u32_u24 v2, 1280, v2
  v_lshrrev_b32 v3, 4, v1
  v_xor_b32 v3, v3, v1
  v_and_b32 v3, 7, v3
  v_lshlrev_b32 v3, 4, v3
  v_xor_b32 v4, 64, v3
  v_add_u32 v5, v2, v3
  v_add_u32 v6, v2, v4
  v_add_u32 v10, 0, v5
  v_add_u32 v11, 80896, v6
  v_add_u32 v12, 512, v5
  v_add_u32 v13, 81408, v6
  v_add_u32 v14, 5120, v5
  v_add_u32 v15, 86016, v6
  v_add_u32 v16, 5632, v5
  v_add_u32 v17, 86528, v6
  s_lshl_b32 s32, s69, 6
  s_lshl_b32 s33, s71, 5
  s_add_u32 s32, s32, s33
  v_lshrrev_b32 v2, 3, v1
  v_add_u32 v2, s32, v2
  v_mul_u32_u24 v2, 1280, v2
  v_add_u32 v5, v2, v3
  v_add_u32 v6, v2, v4
  v_add_u32 v18, 0, v5
  v_add_u32 v19, 9216, v6
  v_add_u32 v20, 18432, v5
  v_add_u32 v21, 27648, v6
  s_lshl_b32 s73, s3, 13
  s_lshl_b32 s74, s3, 12
  s_add_u32 s74, s74, 32768
  s_waitcnt lgkmcnt(0)
  s_mov_b32 s16, s36
  s_mov_b32 s17, s37
  s_mov_b32 s18, 0x280000
  s_mov_b32 s19, 0x20000
  v_mov_b32 v9, 163840
  global_load_dword v9, v9, s[66:67] sc1
  buffer_load_dwordx2 v[32:33], v62, s[16:19], s75 offen offset:0
  buffer_load_dwordx2 v[34:35], v62, s[16:19], s75 offen offset:256
  buffer_load_dwordx2 v[36:37], v62, s[16:19], s75 offen offset:512
  buffer_load_dwordx2 v[38:39], v62, s[16:19], s75 offen offset:768
  buffer_load_dwordx2 v[40:41], v62, s[16:19], s75 offen offset:1024
  s_cmp_lg_u32 s70, 0
  s_cbranch_scc1 K_ffn
  s_cmp_eq_u32 s72, 0
  s_cselect_b32 s12, s42, s44
  s_cselect_b32 s13, s43, s45
  s_mov_b32 s14, 0xc8000
  s_mov_b32 s15, 0x20000
  s_add_u32 m0, s73, 0
  s_movk_i32 s78, 0
  buffer_load_dwordx4 v10, s[16:19], s78 offen offset:0 lds
  buffer_load_dwordx4 v11, s[16:19], s78 offen offset:1024 lds
  buffer_load_dwordx4 v12, s[16:19], s78 offen offset:2048 lds
  buffer_load_dwordx4 v13, s[16:19], s78 offen offset:3072 lds
  s_add_u32 m0, s74, 0
  s_nop 0
  buffer_load_dwordx4 v18, s[12:15], s78 offen offset:0 lds
  buffer_load_dwordx4 v19, s[12:15], s78 offen offset:1024 lds
  s_add_u32 m0, s73, 4096
  s_movk_i32 s78, 0
  buffer_load_dwordx4 v14, s[16:19], s78 offen offset:0 lds
  buffer_load_dwordx4 v15, s[16:19], s78 offen offset:1024 lds
  buffer_load_dwordx4 v16, s[16:19], s78 offen offset:2048 lds
  buffer_load_dwordx4 v17, s[16:19], s78 offen offset:3072 lds
  s_add_u32 m0, s74, 0
  s_nop 0
  buffer_load_dwordx4 v20, s[12:15], s78 offen offset:2048 lds
  buffer_load_dwordx4 v21, s[12:15], s78 offen offset:3072 lds
  s_mov_b64 exec, 0
  s_cmp_eq_u32 s3, 0
  s_cbranch_scc1 TS_12
  s_cmp_eq_u32 s3, 1
  s_cbranch_scc1 TS_13
  s_cmp_eq_u32 s3, 2
  s_cbranch_scc1 TS_14
  s_branch TS_15
TR_S:
  s_mov_b64 exec, -1
  s_branch SSM_a
K_ffn:
  s_and_b32 s35, s2, 3
  s_lshr_b32 s33, s2, 3
  s_mul_i32 s35, s35, 24
  s_add_u32 s33, s33, s35
  s_sub_u32 s33, s33, s76
  s_and_b32 s68, s33, 7
  s_and_b32 s34, s2, 4
  s_lshl1_add_u32 s68, s34, s68
  s_lshr_b32 s69, s33, 3
  s_mul_i32 s70, s69, 160
  s_min_u32 s70, s70, 1568
  s_lshl_b32 s32, s68, 7
  s_lshl_b32 s33, s3, 5
  s_add_u32 s32, s32, s33
  v_lshrrev_b32 v2, 3, v1
  v_add_u32 v2, s32, v2
  v_mul_u32_u24 v2, 1280, v2
  v_lshrrev_b32 v3, 4, v1
  v_xor_b32 v3, v3, v1
  v_and_b32 v3, 7, v3
  v_lshlrev_b32 v3, 4, v3
  v_add_u32 v15, v2, v3
  v_xor_b32 v3, 64, v3
  v_add_u32 v16, v2, v3
  v_add_u32 v16, 9216, v16
  v_add_u32 v17, 20480, v15
  v_add_u32 v18, 20480, v16
  s_mul_i32 s73, s3, 5120
  s_lshl_b32 s74, s3, 12
  s_add_u32 s74, s74, 81920
  s_mul_i32 s32, s71, 320
  s_add_u32 m0, s74, 0
  s_lshl_b32 s33, s70, 1
  s_movk_i32 s34, 3277
  v_add_u32 v6, s32, v1
  v_add_u32 v2, 0, v6
  s_movk_i32 s78, 0
  v_mul_u32_u24 v3, s34, v2
  v_lshrrev_b32 v3, 16, v3
  v_lshrrev_b32 v5, 2, v3
  v_and_b32 v5, 2, v5
  buffer_load_dwordx4 v15, s[16:19], s78 offen offset:0 lds
  v_xor_b32 v2, v2, v5
  v_mul_u32_u24 v3, 3136, v3
  v_lshl_add_u32 v3, v2, 4, v3
  v_add_u32 v10, s33, v3
  buffer_load_dwordx4 v16, s[16:19], s78 offen offset:1024 lds
  v_add_u32 v2, 64, v6
  v_mul_u32_u24 v3, s34, v2
  v_lshrrev_b32 v3, 16, v3
  v_lshrrev_b32 v5, 2, v3
  s_add_u32 m0, s74, 2048
  v_and_b32 v5, 2, v5
  v_xor_b32 v2, v2, v5
  v_mul_u32_u24 v3, 3136, v3
  v_lshl_add_u32 v3, v2, 4, v3
  s_movk_i32 s78, 0
  v_add_u32 v11, s33, v3
  v_subrev_u32 v11, 1024, v11
  v_add_u32 v2, 128, v6
  v_mul_u32_u24 v3, s34, v2
  buffer_load_dwordx4 v17, s[16:19], s78 offen offset:0 lds
  v_lshrrev_b32 v3, 16, v3
  v_lshrrev_b32 v5, 2, v3
  v_and_b32 v5, 2, v5
  v_xor_b32 v2, v2, v5
  buffer_load_dwordx4 v18, s[16:19], s78 offen offset:1024 lds
  v_mul_u32_u24 v3, 3136, v3
  v_lshl_add_u32 v3, v2, 4, v3
  v_add_u32 v12, s33, v3
  v_subrev_u32 v12, 2048, v12
  s_cmp_eq_u32 s72, 0
  s_cselect_b32 s12, s56, s58
  s_cselect_b32 s13, s57, s59
  s_mov_b32 s14, 0x21c000
  s_mov_b32 s15, 0x20000
  v_add_u32 v2, 192, v6
  s_add_u32 m0, s73, 0
  v_mul_u32_u24 v3, s34, v2
  v_lshrrev_b32 v3, 16, v3
  v_lshrrev_b32 v5, 2, v3
  s_mov_b32 s77, 0
  v_and_b32 v5, 2, v5
  v_xor_b32 v2, v2, v5
  v_mul_u32_u24 v3, 3136, v3
  v_lshl_add_u32 v3, v2, 4, v3
  buffer_load_dwordx4 v10, s[12:15], s77 offen offset:0 lds
  v_add_u32 v13, s33, v3
  v_subrev_u32 v13, 3072, v13
  v_add_u32 v2, 256, v6
  v_mul_u32_u24 v3, s34, v2
  buffer_load_dwordx4 v11, s[12:15], s77 offen offset:1024 lds
  v_lshrrev_b32 v3, 16, v3
  v_lshrrev_b32 v5, 2, v3
  v_and_b32 v5, 2, v5
  v_xor_b32 v2, v2, v5
  buffer_load_dwordx4 v12, s[12:15], s77 offen offset:2048 lds
  v_mul_u32_u24 v3, 3136, v3
  v_lshl_add_u32 v3, v2, 4, v3
  v_add_u32 v14, s33, v3
  buffer_load_dwordx4 v13, s[12:15], s77 offen offset:3072 lds
  s_add_u32 m0, s73, 4096
  s_nop 0
  buffer_load_dwordx4 v14, s[12:15], s77 offen offset:0 lds
  s_mul_i32 s34, s69, 5
  s_lshr_b32 s34, s34, 1
  s_and_b32 s33, s68, 7
  s_lshr_b32 s35, s68, 3
  s_lshl1_add_u32 s32, s33, s35
  s_and_b32 s76, s69, 1
  s_lshl2_add_u32 s76, s76, 8
  s_cmp_ge_u32 s32, s76
  s_cbranch_scc1 FB_p
  s_mov_b64 exec, 0
  s_cmp_eq_u32 s3, 0
  s_cbranch_scc1 TS_0
  s_cmp_eq_u32 s3, 1
  s_cbranch_scc1 TS_1
  s_cmp_eq_u32 s3, 2
  s_cbranch_scc1 TS_2
  s_branch TS_3
TR_FA:
  s_mov_b64 exec, -1
  s_branch FA_a
FB_p:
  s_mov_b64 exec, 0
  s_cmp_eq_u32 s3, 0
  s_cbranch_scc1 TS_4
  s_cmp_eq_u32 s3, 1
  s_cbranch_scc1 TS_5
  s_cmp_eq_u32 s3, 2
  s_cbranch_scc1 TS_6
  s_branch TS_7
TR_FB:
  s_mov_b64 exec, -1
  s_branch FB_a
TR_P:
  s_cmp_eq_u32 s92, 0
  s_cbranch_scc1 TR_P0
  s_cmp_eq_u32 s92, 2
  s_cbranch_scc1 TR_P2
  s_branch TR_P1
.p2align 12
K_body:
FA_a:
TS_0:
  s_cbranch_execz TR_FA
  s_lshl2_add_u32 s32, s34, s32
  s_lshr_b32 s76, s33, 1
  s_add_u32 s76, s76, s34
  s_and_b32 s33, s33, 1
  s_mul_i32 s33, s33, 27
  s_add_u32 s33, s33, s76
  s_mov_b32 s34, s35
  s_lshl_b32 s76, s76, 7
  s_lshl2_add_u32 s97, s34, s3
  s_mul_i32 s97, s97, 27648
  s_add_u32 s97, s97, s76
  v_lshrrev_b32 v2, 3, v1
  v_mul_u32_u24 v2, 3456, v2
  v_and_b32 v3, 7, v1
  v_lshl_add_u32 v30, v3, 4, v2
  s_cmp_lt_u32 s33, 27
  s_cselect_b32 s24, s56, s58
  s_cselect_b32 s25, s57, s59
  s_mov_b32 s26, 0x21c000
  s_mov_b32 s27, 0x20000
  s_mov_b32 s8, s66
  s_mov_b32 s9, s67
  s_mov_b32 s10, 0x1a00000
  s_mov_b32 s11, 0x20000
  v_lshlrev_b32 v28, 4, v1
  v_add_u32 v29, 4096, v28
  v_lshlrev_b32 v8, 20, v1
  v_and_b32 v8, 0xfe000000, v8
  v_lshl_add_u32 v8, v1, 2, v8
  v_lshrrev_b32 v2, 4, v1
  v_bfe_u32 v3, v1, 2, 2
  v_lshl_add_u32 v3, v2, 3, v3
  v_mul_u32_u24 v3, 320, v3
  v_and_b32 v4, 3, v1
  v_lshl_add_u32 v3, v4, 3, v3
  v_and_b32 v4, 1, v2
  v_lshlrev_b32 v4, 5, v4
  s_mul_i32 s75, s72, 192
  v_add_u32 v5, s75, v3
  v_add_u32 v20, v5, v4
  v_sub_u32 v21, v5, v4
  s_lshl_b32 s75, s72, 5
  s_add_u32 s75, s75, 128
  v_xor_b32 v5, s75, v4
  v_add_u32 v22, v3, v5
  v_add_u32 v23, 61440, v20
  v_add_u32 v24, 61440, v21
  v_add_u32 v25, 61440, v22
  v_and_b32 v3, 15, v1
  v_lshrrev_b32 v4, 1, v3
  v_xor_b32 v4, v4, v2
  v_lshlrev_b32 v4, 4, v4
  v_lshl_add_u32 v3, v3, 7, v4
  s_lshl_b32 s75, s71, 13
  s_add_u32 s75, s75, 81920
  v_add_u32 v26, s75, v3
  v_xor_b32 v27, 64, v26
  s_waitcnt vmcnt(9)
  v_lshlrev_b32 v42, 16, v32
  s_add_u32 m0, s73, 20480
  v_and_b32 v43, 0xffff0000, v32
  v_lshlrev_b32 v44, 16, v33
  s_mov_b32 s77, 110592
  v_and_b32 v45, 0xffff0000, v33
  v_lshlrev_b32 v46, 16, v34
  v_and_b32 v47, 0xffff0000, v34
  buffer_load_dwordx4 v10, s[12:15], s77 offen offset:0 lds
  v_lshlrev_b32 v48, 16, v35
  v_and_b32 v49, 0xffff0000, v35
  buffer_load_dwordx4 v11, s[12:15], s77 offen offset:1024 lds
  v_lshlrev_b32 v50, 16, v36
  v_and_b32 v51, 0xffff0000, v36
  v_lshlrev_b32 v52, 16, v37
  buffer_load_dwordx4 v12, s[12:15], s77 offen offset:2048 lds
  v_and_b32 v53, 0xffff0000, v37
  v_lshlrev_b32 v54, 16, v38
  v_and_b32 v55, 0xffff0000, v38
  buffer_load_dwordx4 v13, s[12:15], s77 offen offset:3072 lds
  v_lshlrev_b32 v56, 16, v39
  v_and_b32 v57, 0xffff0000, v39
  s_add_u32 m0, s73, 24576
  v_lshlrev_b32 v58, 16, v40
  v_and_b32 v59, 0xffff0000, v40
  v_lshlrev_b32 v60, 16, v41
  buffer_load_dwordx4 v14, s[12:15], s77 offen offset:0 lds
  v_and_b32 v61, 0xffff0000, v41
  v_pk_add_f32 v[62:63], v[42:43], v[44:45] op_sel_hi:[1,1]
  v_pk_add_f32 v[62:63], v[62:63], v[46:47] op_sel_hi:[1,1]
  s_add_u32 s77, s97, 0
  v_pk_add_f32 v[62:63], v[62:63], v[48:49] op_sel_hi:[1,1]
  v_pk_add_f32 v[62:63], v[62:63], v[50:51] op_sel_hi:[1,1]
  buffer_load_dwordx4 a[112:115], v30, s[24:27], s77 offen
  v_pk_add_f32 v[62:63], v[62:63], v[52:53] op_sel_hi:[1,1]
  v_pk_add_f32 v[62:63], v[62:63], v[54:55] op_sel_hi:[1,1]
  v_pk_add_f32 v[62:63], v[62:63], v[56:57] op_sel_hi:[1,1]
  s_add_u32 s77, s97, 221184
  v_pk_add_f32 v[62:63], v[62:63], v[58:59] op_sel_hi:[1,1]
  v_pk_add_f32 v[62:63], v[62:63], v[60:61] op_sel_hi:[1,1]
  v_add_f32 v62, v62, v63
  buffer_load_dwordx4 a[116:119], v30, s[24:27], s77 offen
  s_nop 0
  v_add_f32_dpp v62, v62, v62 row_ror:8 row_mask:0xf bank_mask:0xf
  s_nop 1
  v_add_f32_dpp v62, v62, v62 row_ror:4 row_mask:0xf bank_mask:0xf
  s_add_u32 s77, s97, 442368
  s_nop 0
  v_add_f32_dpp v62, v62, v62 row_ror:2 row_mask:0xf bank_mask:0xf
  s_nop 1
  v_add_f32_dpp v62, v62, v62 row_ror:1 row_mask:0xf bank_mask:0xf
  v_mov_b32 v63, v62
  buffer_load_dwordx4 a[120:123], v30, s[24:27], s77 offen
  s_nop 0
  v_permlane16_swap_b32 v62, v63
  v_add_f32 v62, v62, v63
  v_mul_f32 v62, 0x3acccccd, v62
  s_add_u32 s77, s97, 663552
  v_pk_add_f32 v[42:43], v[42:43], v[62:63] op_sel_hi:[1,0] neg_lo:[0,1] neg_hi:[0,1]
  v_pk_add_f32 v[44:45], v[44:45], v[62:63] op_sel_hi:[1,0] neg_lo:[0,1] neg_hi:[0,1]
  buffer_load_dwordx4 a[124:127], v30, s[24:27], s77 offen
  v_pk_add_f32 v[46:47], v[46:47], v[62:63] op_sel_hi:[1,0] neg_lo:[0,1] neg_hi:[0,1]
  v_pk_add_f32 v[48:49], v[48:49], v[62:63] op_sel_hi:[1,0] neg_lo:[0,1] neg_hi:[0,1]
  v_pk_add_f32 v[50:51], v[50:51], v[62:63] op_sel_hi:[1,0] neg_lo:[0,1] neg_hi:[0,1]
  s_add_u32 s77, s97, 884736
  v_pk_add_f32 v[52:53], v[52:53], v[62:63] op_sel_hi:[1,0] neg_lo:[0,1] neg_hi:[0,1]
  v_pk_add_f32 v[54:55], v[54:55], v[62:63] op_sel_hi:[1,0] neg_lo:[0,1] neg_hi:[0,1]
  buffer_load_dwordx4 a[128:131], v30, s[24:27], s77 offen
  v_pk_add_f32 v[56:57], v[56:57], v[62:63] op_sel_hi:[1,0] neg_lo:[0,1] neg_hi:[0,1]
  v_pk_add_f32 v[58:59], v[58:59], v[62:63] op_sel_hi:[1,0] neg_lo:[0,1] neg_hi:[0,1]
  v_pk_add_f32 v[60:61], v[60:61], v[62:63] op_sel_hi:[1,0] neg_lo:[0,1] neg_hi:[0,1]
  s_add_u32 s77, s97, 1105920
  v_pk_mul_f32 v[64:65], v[42:43], v[42:43] op_sel_hi:[1,1]
  v_pk_fma_f32 v[64:65], v[44:45], v[44:45], v[64:65] op_sel_hi:[1,1,1]
  v_pk_fma_f32 v[64:65], v[46:47], v[46:47], v[64:65] op_sel_hi:[1,1,1]
  buffer_load_dwordx4 a[132:135], v30, s[24:27], s77 offen
  v_pk_fma_f32 v[64:65], v[48:49], v[48:49], v[64:65] op_sel_hi:[1,1,1]
  v_pk_fma_f32 v[64:65], v[50:51], v[50:51], v[64:65] op_sel_hi:[1,1,1]
  s_add_u32 s77, s97, 1327104
  v_pk_fma_f32 v[64:65], v[52:53], v[52:53], v[64:65] op_sel_hi:[1,1,1]
  v_pk_fma_f32 v[64:65], v[54:55], v[54:55], v[64:65] op_sel_hi:[1,1,1]
  v_pk_fma_f32 v[64:65], v[56:57], v[56:57], v[64:65] op_sel_hi:[1,1,1]
  buffer_load_dwordx4 a[136:139], v30, s[24:27], s77 offen
  v_pk_fma_f32 v[64:65], v[58:59], v[58:59], v[64:65] op_sel_hi:[1,1,1]
  v_pk_fma_f32 v[64:65], v[60:61], v[60:61], v[64:65] op_sel_hi:[1,1,1]
  v_add_f32 v64, v64, v65
  s_add_u32 s77, s97, 1548288
  s_nop 0
  v_add_f32_dpp v64, v64, v64 row_ror:8 row_mask:0xf bank_mask:0xf
  s_nop 1
  v_add_f32_dpp v64, v64, v64 row_ror:4 row_mask:0xf bank_mask:0xf
  buffer_load_dwordx4 a[140:143], v30, s[24:27], s77 offen
  s_nop 0
  v_add_f32_dpp v64, v64, v64 row_ror:2 row_mask:0xf bank_mask:0xf
  s_nop 1
  v_add_f32_dpp v64, v64, v64 row_ror:1 row_mask:0xf bank_mask:0xf
  v_mov_b32 v65, v64
  s_add_u32 s77, s97, 1769472
  s_nop 0
  v_permlane16_swap_b32 v64, v65
  v_add_f32 v64, v64, v65
  v_mul_f32 v64, 0x3acccccd, v64
  buffer_load_dwordx4 a[144:147], v30, s[24:27], s77 offen
  v_cvt_pk_bf16_f32 v62, v62, v64
  v_and_b32 v64, 0xffff0000, v62
  s_add_u32 s77, s97, 1990656
  v_add_f32 v64, 0x3727c5ac, v64
  v_cvt_pk_bf16_f32 v64, v64, v64
  v_and_b32 v64, 0xffff0000, v64
  buffer_load_dwordx4 a[148:151], v30, s[24:27], s77 offen
  v_sqrt_f32 v64, v64
  v_and_b32 v62, 0xffff, v62
  v_cvt_pk_bf16_f32 v64, v64, v64
  v_readfirstlane_b32 s96, v9
  v_and_b32 v64, 0xffff0000, v64
  v_or_b32 v62, v64, v62
  v_lshrrev_b32 v63, 5, v0
  v_lshlrev_b32 v63, 2, v63
  v_add_u32 v63, 114688, v63
  s_add_u32 s96, s96, 1
  ds_write_b32 v63, v62
  s_cmp_eq_u32 s72, 0
  s_cselect_b32 s20, s46, s48
  s_cselect_b32 s21, s47, s49
  s_mov_b32 s22, 0xc8000
  s_mov_b32 s23, 0x20000
  s_and_b32 s4, s32, 7
  s_lshr_b32 s5, s32, 3
  s_lshl1_add_u32 s99, s4, s71
  s_mul_i32 s99, s99, 51200
  s_lshl_b32 s75, s5, 7
  s_add_u32 s99, s99, s75
  s_cmp_lt_u32 s32, 80
  s_cselect_b32 s99, s99, 0x7f000000
  s_add_u32 s101, s73, 135168
  v_lshrrev_b32 v2, 3, v1
  v_mul_u32_u24 v2, 1280, v2
  v_lshrrev_b32 v3, 4, v1
  v_xor_b32 v3, v3, v1
  v_and_b32 v3, 7, v3
  v_lshl_add_u32 v2, v3, 4, v2
  s_lshl_b32 s75, s71, 6
  v_xor_b32 v84, s75, v2
  v_xor_b32 v85, 64, v84
  s_mov_b64 exec, 0
  s_mov_b32 s92, 0
  s_cmp_eq_u32 s3, 0
  s_cbranch_scc1 TS_9
  s_cmp_eq_u32 s3, 1
  s_cbranch_scc1 TS_10
  s_cmp_eq_u32 s3, 2
  s_cbranch_scc1 TS_11
  s_branch TS_18
TR_P0:
  s_mov_b64 exec, -1
  s_waitcnt vmcnt(15) lgkmcnt(0)
  s_barrier
  ds_read_b128 a[40:43], v26 offset:0
  ds_read_b128 a[44:47], v26 offset:2048
  ds_read_b128 a[48:51], v26 offset:4096
  ds_read_b128 a[52:55], v26 offset:6144
  ds_read_b64_tr_b16 a[0:1], v20 offset:0
  ds_read_b64_tr_b16 a[2:3], v20 offset:1280
  ds_read_b64_tr_b16 a[4:5], v20 offset:10240
  ds_read_b64_tr_b16 a[6:7], v20 offset:11520
  ds_read_b64_tr_b16 a[8:9], v21 offset:32
  ds_read_b64_tr_b16 a[10:11], v21 offset:1312
  ds_read_b64_tr_b16 a[12:13], v21 offset:10272
  ds_read_b64_tr_b16 a[14:15], v21 offset:11552
  ds_read_b64_tr_b16 a[16:17], v20 offset:64
  ds_read_b64_tr_b16 a[18:19], v20 offset:1344
  ds_read_b64_tr_b16 a[20:21], v20 offset:10304
  ds_read_b64_tr_b16 a[22:23], v20 offset:11584
  ds_read_b64_tr_b16 a[24:25], v21 offset:96
  ds_read_b64_tr_b16 a[26:27], v21 offset:1376
  ds_read_b64_tr_b16 a[28:29], v21 offset:10336
  ds_read_b64_tr_b16 a[30:31], v21 offset:11616
  ds_read_b64_tr_b16 a[32:33], v22 offset:0
  ds_read_b64_tr_b16 a[34:35], v22 offset:1280
  ds_read_b64_tr_b16 a[36:37], v22 offset:10240
  ds_read_b64_tr_b16 a[38:39], v22 offset:11520
  s_waitcnt vmcnt(10) lgkmcnt(0)
  s_barrier
  v_mfma_f32_16x16x32_bf16 v[96:99], a[0:3], a[40:43], 0
  ds_read_b128 a[96:99], v27 offset:0
  s_add_u32 m0, s74, 16384
  v_mfma_f32_16x16x32_bf16 v[100:103], a[0:3], a[44:47], 0
  ds_read_b128 a[100:103], v27 offset:2048
  s_movk_i32 s78, 128
  v_and_b32 v63, 7, v1
  v_mfma_f32_16x16x32_bf16 v[104:107], a[0:3], a[48:51], 0
  v_lshlrev_b32 v63, 2, v63
  ds_read_b128 a[104:107], v27 offset:4096
  buffer_load_dwordx4 v15, s[16:19], s78 offen offset:0 lds
  v_mfma_f32_16x16x32_bf16 v[108:111], a[0:3], a[52:55], 0
  v_add_u32 v63, 114688, v63
  ds_read_b128 a[108:111], v27 offset:6144
  buffer_load_dwordx4 v16, s[16:19], s78 offen offset:1024 lds
  v_mfma_f32_16x16x32_bf16 v[124:127], a[4:7], a[52:55], 0
  ds_read_b32 v62, v63
  v_lshlrev_b32 v64, 21, v0
  v_mfma_f32_16x16x32_bf16 v[120:123], a[4:7], a[48:51], 0
  ds_read_b64_tr_b16 a[56:57], v20 offset:20480
  s_add_u32 m0, s74, 18432
  v_and_b32 v64, 0xfe000000, v64
  v_mfma_f32_16x16x32_bf16 v[116:119], a[4:7], a[44:47], 0
  ds_read_b64_tr_b16 a[58:59], v20 offset:21760
  s_movk_i32 s78, 128
  v_lshl_add_u32 v64, v1, 3, v64
  v_mfma_f32_16x16x32_bf16 v[112:115], a[4:7], a[40:43], 0
  ds_read_b64_tr_b16 a[60:61], v20 offset:30720
  buffer_load_dwordx4 v17, s[16:19], s78 offen offset:0 lds
  v_mfma_f32_16x16x32_bf16 v[128:131], a[8:11], a[40:43], 0
  s_lshl_b32 s75, s31, 7
  ds_read_b64_tr_b16 a[62:63], v20 offset:32000
  buffer_load_dwordx4 v18, s[16:19], s78 offen offset:1024 lds
  v_mfma_f32_16x16x32_bf16 v[132:135], a[8:11], a[44:47], 0
  s_add_u32 s75, s75, 196608
  s_waitcnt lgkmcnt(4)
  v_mfma_f32_16x16x32_bf16 v[136:139], a[8:11], a[48:51], 0
  ds_read_b64_tr_b16 a[64:65], v21 offset:20512
  s_add_u32 m0, s73, 40960
  v_mov_b32 v63, s96
  v_mfma_f32_16x16x32_bf16 v[140:143], a[8:11], a[52:55], 0
  ds_read_b64_tr_b16 a[66:67], v21 offset:21792
  s_mov_b32 s77, 221184
  buffer_store_dwordx2 v[62:63], v64, s[8:11], s75 offen sc1
  v_mfma_f32_16x16x32_bf16 v[156:159], a[12:15], a[52:55], 0
  ds_read_b64_tr_b16 a[68:69], v21 offset:30752
  buffer_load_dwordx4 v10, s[12:15], s77 offen offset:0 lds
  v_mfma_f32_16x16x32_bf16 v[152:155], a[12:15], a[48:51], 0
  s_lshl2_add_u32 s5, s5, s3
  ds_read_b64_tr_b16 a[70:71], v21 offset:32032
  buffer_load_dwordx4 v11, s[12:15], s77 offen offset:1024 lds
  v_mfma_f32_16x16x32_bf16 v[148:151], a[12:15], a[44:47], 0
  s_mul_i32 s6, s4, 40
  s_add_u32 s6, s6, s5
  v_mfma_f32_16x16x32_bf16 v[144:147], a[12:15], a[40:43], 0
  ds_read_b64_tr_b16 a[72:73], v20 offset:20544
  buffer_load_dwordx4 v12, s[12:15], s77 offen offset:2048 lds
  v_mfma_f32_16x16x32_bf16 v[160:163], a[16:19], a[40:43], 0
  s_lshl_b32 s6, s6, 7
  ds_read_b64_tr_b16 a[74:75], v20 offset:21824
  buffer_load_dwordx4 v13, s[12:15], s77 offen offset:3072 lds
  v_mfma_f32_16x16x32_bf16 v[164:167], a[16:19], a[44:47], 0
  s_add_u32 s6, s6, 655360
  ds_read_b64_tr_b16 a[76:77], v20 offset:30784
  s_add_u32 m0, s73, 45056
  v_mfma_f32_16x16x32_bf16 v[168:171], a[16:19], a[48:51], 0
  s_mul_i32 s75, s5, 52429
  ds_read_b64_tr_b16 a[78:79], v20 offset:32064
  buffer_load_dwordx4 v14, s[12:15], s77 offen offset:0 lds
  v_mfma_f32_16x16x32_bf16 v[172:175], a[16:19], a[52:55], 0
  s_lshr_b32 s75, s75, 18
  s_mul_i32 s75, s75, 7
  v_mfma_f32_16x16x32_bf16 v[188:191], a[20:23], a[52:55], 0
  ds_read_b64_tr_b16 a[80:81], v21 offset:20576
  s_add_u32 m0, s101, 0
  s_add_u32 s5, s5, s75
  v_mfma_f32_16x16x32_bf16 v[184:187], a[20:23], a[48:51], 0
  ds_read_b64_tr_b16 a[82:83], v21 offset:21856
  s_add_u32 s77, s99, 0
  s_add_u32 s5, s5, 7
  v_mfma_f32_16x16x32_bf16 v[180:183], a[20:23], a[44:47], 0
  ds_read_b64_tr_b16 a[84:85], v21 offset:30816
  buffer_load_dwordx4 v84, s[20:23], s77 offen lds
  v_mfma_f32_16x16x32_bf16 v[176:179], a[20:23], a[40:43], 0
  s_mul_i32 s4, s4, 96
  ds_read_b64_tr_b16 a[86:87], v21 offset:32096
  s_add_u32 m0, s101, 1024
  v_mfma_f32_16x16x32_bf16 v[192:195], a[24:27], a[40:43], 0
  s_add_u32 s5, s5, s4
  s_mul_i32 s100, s5, 5120
  v_mfma_f32_16x16x32_bf16 v[196:199], a[24:27], a[44:47], 0
  ds_read_b64_tr_b16 a[88:89], v22 offset:20480
  s_add_u32 s77, s99, 10240
  s_add_u32 s100, s100, 1048576
  v_mfma_f32_16x16x32_bf16 v[200:203], a[24:27], a[48:51], 0
  ds_read_b64_tr_b16 a[90:91], v22 offset:21760
  buffer_load_dwordx4 v85, s[20:23], s77 offen lds
  v_mfma_f32_16x16x32_bf16 v[204:207], a[24:27], a[52:55], 0
  s_cmp_lt_u32 s32, 80
  s_cselect_b32 s100, s100, 0x7f000000
  s_cselect_b32 s6, s6, 0x7f000000
  v_mfma_f32_16x16x32_bf16 v[220:223], a[28:31], a[52:55], 0
  ds_read_b64_tr_b16 a[92:93], v22 offset:30720
  s_add_u32 m0, s101, 2048
  v_and_b32 v2, 15, v1
  v_mfma_f32_16x16x32_bf16 v[216:219], a[28:31], a[48:51], 0
  ds_read_b64_tr_b16 a[94:95], v22 offset:32000
  s_add_u32 s77, s99, 20480
  v_bfe_u32 v3, v1, 4, 1
  v_mfma_f32_16x16x32_bf16 v[212:215], a[28:31], a[44:47], 0
  s_lshl_b32 s75, s3, 1
  buffer_load_dwordx4 v84, s[20:23], s77 offen lds
  v_mfma_f32_16x16x32_bf16 v[208:211], a[28:31], a[40:43], 0
  v_add_u32 v3, s75, v3
  v_mfma_f32_16x16x32_bf16 v[224:227], a[32:35], a[40:43], 0
  s_add_u32 m0, s101, 3072
  v_lshrrev_b32 v4, 1, v2
  v_mfma_f32_16x16x32_bf16 v[228:231], a[32:35], a[44:47], 0
  s_add_u32 s77, s99, 30720
  v_xor_b32 v3, v3, v4
  v_mfma_f32_16x16x32_bf16 v[232:235], a[32:35], a[48:51], 0
  buffer_load_dwordx4 v85, s[20:23], s77 offen lds
  v_mfma_f32_16x16x32_bf16 v[236:239], a[32:35], a[52:55], 0
  v_lshlrev_b32 v3, 4, v3
  v_lshl_add_u32 v3, v2, 7, v3
  v_mfma_f32_16x16x32_bf16 v[252:255], a[36:39], a[52:55], 0
  s_add_u32 m0, s101, 4096
  v_lshrrev_b32 v4, 5, v1
  v_mfma_f32_16x16x32_bf16 v[248:251], a[36:39], a[48:51], 0
  s_add_u32 s77, s99, 40960
  v_mul_u32_u24 v4, 10240, v4
  v_mfma_f32_16x16x32_bf16 v[244:247], a[36:39], a[44:47], 0
  buffer_load_dwordx4 v84, s[20:23], s77 offen lds
  v_mfma_f32_16x16x32_bf16 v[240:243], a[36:39], a[40:43], 0
  v_add_u32 v3, v3, v4
  v_add_u32 v86, 135168, v3
  s_waitcnt vmcnt(5) lgkmcnt(0)
  s_barrier
  v_mfma_f32_16x16x32_bf16 v[96:99], a[56:59], a[96:99], v[96:99]
  ds_read_b128 a[40:43], v26 offset:16384
  s_add_u32 m0, s73, 61440
  v_mfma_f32_16x16x32_bf16 v[100:103], a[56:59], a[100:103], v[100:103]
  ds_read_b128 a[44:47], v26 offset:18432
  s_lshl_b32 s98, s33, 9
  v_mfma_f32_16x16x32_bf16 v[104:107], a[56:59], a[104:107], v[104:107]
  ds_read_b128 a[48:51], v26 offset:20480
  s_mov_b32 s77, 331776
  s_mul_i32 s34, s34, 27648
  v_mfma_f32_16x16x32_bf16 v[108:111], a[56:59], a[108:111], v[108:111]
  ds_read_b128 a[52:55], v26 offset:22528
  s_add_u32 s98, s98, s34
  v_mfma_f32_16x16x32_bf16 v[124:127], a[60:63], a[108:111], v[124:127]
  buffer_load_dwordx4 v10, s[12:15], s77 offen offset:0 lds
  v_mfma_f32_16x16x32_bf16 v[120:123], a[60:63], a[104:107], v[120:123]
  s_add_u32 s98, s98, 851968
  ds_read_b64_tr_b16 a[0:1], v20 offset:40960
  v_mfma_f32_16x16x32_bf16 v[116:119], a[60:63], a[100:103], v[116:119]
  s_cmp_eq_u32 s3, 0
  s_cselect_b32 s98, s98, 0x7f000000
  v_mfma_f32_16x16x32_bf16 v[112:115], a[60:63], a[96:99], v[112:115]
  ds_read_b64_tr_b16 a[2:3], v20 offset:42240
  ds_read_b64_tr_b16 a[4:5], v20 offset:51200
  v_mfma_f32_16x16x32_bf16 v[128:131], a[64:67], a[96:99], v[128:131]
  buffer_load_dwordx4 v11, s[12:15], s77 offen offset:1024 lds
  v_mfma_f32_16x16x32_bf16 v[132:135], a[64:67], a[100:103], v[132:135]
  v_and_b32 v2, 15, v1
  ds_read_b64_tr_b16 a[6:7], v20 offset:52480
  v_mfma_f32_16x16x32_bf16 v[136:139], a[64:67], a[104:107], v[136:139]
  v_and_b32 v3, 1, v1
  buffer_load_dwordx4 v12, s[12:15], s77 offen offset:2048 lds
  v_mfma_f32_16x16x32_bf16 v[140:143], a[64:67], a[108:111], v[140:143]
  v_lshlrev_b32 v3, 4, v3
  v_mfma_f32_16x16x32_bf16 v[156:159], a[68:71], a[108:111], v[156:159]
  ds_read_b64_tr_b16 a[8:9], v21 offset:40992
  v_mov_b32 v4, 0x3f80
  v_mfma_f32_16x16x32_bf16 v[152:155], a[68:71], a[104:107], v[152:155]
  ds_read_b64_tr_b16 a[10:11], v21 offset:42272
  ds_read_b64_tr_b16 a[12:13], v21 offset:51232
  v_mfma_f32_16x16x32_bf16 v[148:151], a[68:71], a[100:103], v[148:151]
  buffer_load_dwordx4 v13, s[12:15], s77 offen offset:3072 lds
  v_mfma_f32_16x16x32_bf16 v[144:147], a[68:71], a[96:99], v[144:147]
  v_lshlrev_b32 v3, v3, v4
  ds_read_b64_tr_b16 a[14:15], v21 offset:52512
  v_mfma_f32_16x16x32_bf16 v[160:163], a[72:75], a[96:99], v[160:163]
  v_lshrrev_b32 v2, 1, v2
  s_add_u32 m0, s73, 65536
  v_mfma_f32_16x16x32_bf16 v[164:167], a[72:75], a[100:103], v[164:167]
  v_cmp_eq_u32 vcc, 0, v2
  ds_read_b64_tr_b16 a[16:17], v20 offset:41024
  v_mfma_f32_16x16x32_bf16 v[168:171], a[72:75], a[104:107], v[168:171]
  v_cndmask_b32 v72, 0, v3, vcc
  ds_read_b64_tr_b16 a[18:19], v20 offset:42304
  v_mfma_f32_16x16x32_bf16 v[172:175], a[72:75], a[108:111], v[172:175]
  v_cmp_eq_u32 vcc, 1, v2
  ds_read_b64_tr_b16 a[20:21], v20 offset:51264
  v_mfma_f32_16x16x32_bf16 v[188:191], a[76:79], a[108:111], v[188:191]
  buffer_load_dwordx4 v14, s[12:15], s77 offen offset:0 lds
  v_mfma_f32_16x16x32_bf16 v[184:187], a[76:79], a[104:107], v[184:187]
  ds_read_b64_tr_b16 a[22:23], v20 offset:52544
  v_cndmask_b32 v73, 0, v3, vcc
  v_mfma_f32_16x16x32_bf16 v[180:183], a[76:79], a[100:103], v[180:183]
  s_add_u32 m0, s74, 32768
  v_cmp_eq_u32 vcc, 2, v2
  v_mfma_f32_16x16x32_bf16 v[176:179], a[76:79], a[96:99], v[176:179]
  ds_read_b64_tr_b16 a[24:25], v21 offset:41056
  v_cndmask_b32 v74, 0, v3, vcc
  v_mfma_f32_16x16x32_bf16 v[192:195], a[80:83], a[96:99], v[192:195]
  ds_read_b64_tr_b16 a[26:27], v21 offset:42336
  s_movk_i32 s78, 256
  v_mfma_f32_16x16x32_bf16 v[196:199], a[80:83], a[100:103], v[196:199]
  v_cmp_eq_u32 vcc, 3, v2
  ds_read_b64_tr_b16 a[28:29], v21 offset:51296
  v_mfma_f32_16x16x32_bf16 v[200:203], a[80:83], a[104:107], v[200:203]
  ds_read_b64_tr_b16 a[30:31], v21 offset:52576
  v_cndmask_b32 v75, 0, v3, vcc
  v_mfma_f32_16x16x32_bf16 v[204:207], a[80:83], a[108:111], v[204:207]
  buffer_load_dwordx4 v15, s[16:19], s78 offen offset:0 lds
  v_mfma_f32_16x16x32_bf16 v[220:223], a[84:87], a[108:111], v[220:223]
  v_and_b32 v2, 7, v1
  ds_read_b64_tr_b16 a[32:33], v22 offset:40960
  v_mfma_f32_16x16x32_bf16 v[216:219], a[84:87], a[104:107], v[216:219]
  v_lshlrev_b32 v2, 5, v2
  ds_read_b64_tr_b16 a[34:35], v22 offset:42240
  v_mfma_f32_16x16x32_bf16 v[212:215], a[84:87], a[100:103], v[212:215]
  buffer_load_dwordx4 v16, s[16:19], s78 offen offset:1024 lds
  v_mfma_f32_16x16x32_bf16 v[208:211], a[84:87], a[96:99], v[208:211]
  v_and_b32 v3, 16, v1
  ds_read_b64_tr_b16 a[36:37], v22 offset:51200
  v_mfma_f32_16x16x32_bf16 v[224:227], a[88:91], a[96:99], v[224:227]
  v_add_u32 v2, v2, v3
  ds_read_b64_tr_b16 a[38:39], v22 offset:52480
  v_mfma_f32_16x16x32_bf16 v[228:231], a[88:91], a[100:103], v[228:231]
  s_add_u32 m0, s74, 34816
  s_lshl_b32 s75, s3, 8
  v_mfma_f32_16x16x32_bf16 v[232:235], a[88:91], a[104:107], v[232:235]
  s_add_u32 s75, s75, 131072
  s_movk_i32 s78, 256
  v_mfma_f32_16x16x32_bf16 v[236:239], a[88:91], a[108:111], v[236:239]
  v_add_u32 v2, s75, v2
  v_and_b32 v3, 32, v1
  v_mfma_f32_16x16x32_bf16 v[252:255], a[92:95], a[108:111], v[252:255]
  buffer_load_dwordx4 v17, s[16:19], s78 offen offset:0 lds
  v_mfma_f32_16x16x32_bf16 v[248:251], a[92:95], a[104:107], v[248:251]
  v_lshl_add_u32 v80, v3, 5, v2
  v_lshlrev_b32 v82, 2, v1
  v_mfma_f32_16x16x32_bf16 v[244:247], a[92:95], a[100:103], v[244:247]
  buffer_load_dwordx4 v18, s[16:19], s78 offen offset:1024 lds
  v_mfma_f32_16x16x32_bf16 v[240:243], a[92:95], a[96:99], v[240:243]
  v_add_u32 v81, 131072, v82
  v_lshlrev_b32 v82, 3, v1
  s_waitcnt vmcnt(4) lgkmcnt(0)
  s_barrier
  v_mfma_f32_16x16x32_bf16 v[96:99], a[0:3], a[40:43], v[96:99]
  ds_read_b128 a[96:99], v27 offset:16384
  s_add_u32 m0, s73, 0
  v_mfma_f32_16x16x32_bf16 v[100:103], a[0:3], a[44:47], v[100:103]
  ds_read_b128 a[100:103], v27 offset:18432
  s_mov_b32 s77, 442368
  v_mfma_f32_16x16x32_bf16 v[104:107], a[0:3], a[48:51], v[104:107]
  ds_read_b128 a[104:107], v27 offset:20480
  v_mfma_f32_16x16x32_bf16 v[108:111], a[0:3], a[52:55], v[108:111]
  buffer_load_dwordx4 v10, s[12:15], s77 offen offset:0 lds
  v_mfma_f32_16x16x32_bf16 v[124:127], a[4:7], a[52:55], v[124:127]
  ds_read_b128 a[108:111], v27 offset:22528
  v_mfma_f32_16x16x32_bf16 v[76:79], v[72:75], a[112:115], 0
  v_mfma_f32_16x16x32_bf16 v[120:123], a[4:7], a[48:51], v[120:123]
  buffer_load_dwordx4 v11, s[12:15], s77 offen offset:1024 lds
  v_mfma_f32_16x16x32_bf16 v[116:119], a[4:7], a[44:47], v[116:119]
  ds_read_b64_tr_b16 a[56:57], v23 offset:0
  ds_read_b64_tr_b16 a[58:59], v23 offset:1280
  v_mfma_f32_16x16x32_bf16 v[112:115], a[4:7], a[40:43], v[112:115]
  buffer_load_dwordx4 v12, s[12:15], s77 offen offset:2048 lds
  v_mfma_f32_16x16x32_bf16 v[128:131], a[8:11], a[40:43], v[128:131]
  ds_read_b64_tr_b16 a[60:61], v23 offset:10240
  v_mfma_f32_16x16x32_bf16 v[76:79], v[72:75], a[116:119], v[76:79]
  ds_read_b64_tr_b16 a[62:63], v23 offset:11520
  v_mfma_f32_16x16x32_bf16 v[132:135], a[8:11], a[44:47], v[132:135]
  buffer_load_dwordx4 v13, s[12:15], s77 offen offset:3072 lds
  v_mfma_f32_16x16x32_bf16 v[136:139], a[8:11], a[48:51], v[136:139]
  ds_read_b64_tr_b16 a[64:65], v24 offset:32
  v_mfma_f32_16x16x32_bf16 v[140:143], a[8:11], a[52:55], v[140:143]
  ds_read_b64_tr_b16 a[66:67], v24 offset:1312
  s_add_u32 m0, s73, 4096
  v_mfma_f32_16x16x32_bf16 v[156:159], a[12:15], a[52:55], v[156:159]
  v_mfma_f32_16x16x32_bf16 v[76:79], v[72:75], a[120:123], v[76:79]
  ds_read_b64_tr_b16 a[68:69], v24 offset:10272
  v_mfma_f32_16x16x32_bf16 v[152:155], a[12:15], a[48:51], v[152:155]
  buffer_load_dwordx4 v14, s[12:15], s77 offen offset:0 lds
  v_mfma_f32_16x16x32_bf16 v[148:151], a[12:15], a[44:47], v[148:151]
  ds_read_b64_tr_b16 a[70:71], v24 offset:11552
  s_add_u32 m0, s73, 20480
  v_mfma_f32_16x16x32_bf16 v[144:147], a[12:15], a[40:43], v[144:147]
  v_mfma_f32_16x16x32_bf16 v[76:79], v[72:75], a[124:127], v[76:79]
  ds_read_b64_tr_b16 a[72:73], v23 offset:64
  v_mfma_f32_16x16x32_bf16 v[160:163], a[16:19], a[40:43], v[160:163]
  ds_read_b64_tr_b16 a[74:75], v23 offset:1344
  s_mov_b32 s77, 552960
  v_mfma_f32_16x16x32_bf16 v[164:167], a[16:19], a[44:47], v[164:167]
  ds_read_b64_tr_b16 a[76:77], v23 offset:10304
  v_mfma_f32_16x16x32_bf16 v[168:171], a[16:19], a[48:51], v[168:171]
  buffer_load_dwordx4 v10, s[12:15], s77 offen offset:0 lds
  v_mfma_f32_16x16x32_bf16 v[172:175], a[16:19], a[52:55], v[172:175]
  ds_read_b64_tr_b16 a[78:79], v23 offset:11584
  v_mfma_f32_16x16x32_bf16 v[76:79], v[72:75], a[128:131], v[76:79]
  v_mfma_f32_16x16x32_bf16 v[188:191], a[20:23], a[52:55], v[188:191]
  buffer_load_dwordx4 v11, s[12:15], s77 offen offset:1024 lds
  v_mfma_f32_16x16x32_bf16 v[184:187], a[20:23], a[48:51], v[184:187]
  ds_read_b64_tr_b16 a[80:81], v24 offset:96
  ds_read_b64_tr_b16 a[82:83], v24 offset:1376
  v_mfma_f32_16x16x32_bf16 v[180:183], a[20:23], a[44:47], v[180:183]
  buffer_load_dwordx4 v12, s[12:15], s77 offen offset:2048 lds
  v_mfma_f32_16x16x32_bf16 v[176:179], a[20:23], a[40:43], v[176:179]
  v_mfma_f32_16x16x32_bf16 v[76:79], v[72:75], a[132:135], v[76:79]
  ds_read_b64_tr_b16 a[84:85], v24 offset:10336
  ds_read_b64_tr_b16 a[86:87], v24 offset:11616
  v_mfma_f32_16x16x32_bf16 v[192:195], a[24:27], a[40:43], v[192:195]
  buffer_load_dwordx4 v13, s[12:15], s77 offen offset:3072 lds
  v_mfma_f32_16x16x32_bf16 v[196:199], a[24:27], a[44:47], v[196:199]
  ds_read_b64_tr_b16 a[88:89], v25 offset:0
  v_mfma_f32_16x16x32_bf16 v[76:79], v[72:75], a[136:139], v[76:79]
  v_mfma_f32_16x16x32_bf16 v[200:203], a[24:27], a[48:51], v[200:203]
  ds_read_b64_tr_b16 a[90:91], v25 offset:1280
  s_add_u32 m0, s73, 24576
  v_mfma_f32_16x16x32_bf16 v[204:207], a[24:27], a[52:55], v[204:207]
  buffer_load_dwordx4 v14, s[12:15], s77 offen offset:0 lds
  v_mfma_f32_16x16x32_bf16 v[220:223], a[28:31], a[52:55], v[220:223]
  ds_read_b64_tr_b16 a[92:93], v25 offset:10240
  ds_read_b64_tr_b16 a[94:95], v25 offset:11520
  v_mfma_f32_16x16x32_bf16 v[216:219], a[28:31], a[48:51], v[216:219]
  v_mfma_f32_16x16x32_bf16 v[76:79], v[72:75], a[140:143], v[76:79]
  ds_read_b128 a[152:155], v86 offset:0
  v_mfma_f32_16x16x32_bf16 v[212:215], a[28:31], a[44:47], v[212:215]
  v_mfma_f32_16x16x32_bf16 v[208:211], a[28:31], a[40:43], v[208:211]
  ds_read_b128 a[156:159], v86 offset:2048
  v_mfma_f32_16x16x32_bf16 v[224:227], a[32:35], a[40:43], v[224:227]
  v_mfma_f32_16x16x32_bf16 v[76:79], v[72:75], a[144:147], v[76:79]
  v_mfma_f32_16x16x32_bf16 v[228:231], a[32:35], a[44:47], v[228:231]
  ds_read_b128 a[160:163], v86 offset:4096
  v_mfma_f32_16x16x32_bf16 v[232:235], a[32:35], a[48:51], v[232:235]
  v_mfma_f32_16x16x32_bf16 v[236:239], a[32:35], a[52:55], v[236:239]
  ds_read_b128 a[164:167], v86 offset:6144
  v_mfma_f32_16x16x32_bf16 v[76:79], v[72:75], a[148:151], v[76:79]
  v_mfma_f32_16x16x32_bf16 v[252:255], a[36:39], a[52:55], v[252:255]
  v_mfma_f32_16x16x32_bf16 v[248:251], a[36:39], a[48:51], v[248:251]
  ds_read_b128 a[168:171], v86 offset:8192
  v_mfma_f32_16x16x32_bf16 v[244:247], a[36:39], a[44:47], v[244:247]
  v_mfma_f32_16x16x32_bf16 v[240:243], a[36:39], a[40:43], v[240:243]
  s_waitcnt vmcnt(5) lgkmcnt(0)
  s_barrier
  v_mfma_f32_16x16x32_bf16 v[96:99], a[56:59], a[96:99], v[96:99]
  ds_read_b128 a[40:43], v26 offset:32768
  s_add_u32 m0, s74, 0
  v_mfma_f32_16x16x32_bf16 v[100:103], a[56:59], a[100:103], v[100:103]
TS_1:
  s_cbranch_execz TR_FA
  ds_read_b128 a[44:47], v26 offset:34816
  s_movk_i32 s78, 384
  v_mfma_f32_16x16x32_bf16 v[104:107], a[56:59], a[104:107], v[104:107]
  v_add_f32_dpp v76, v76, v76 row_ror:8 row_mask:0xf bank_mask:0xf
  ds_read_b128 a[48:51], v26 offset:36864
  v_mfma_f32_16x16x32_bf16 v[108:111], a[56:59], a[108:111], v[108:111]
  buffer_load_dwordx4 v15, s[16:19], s78 offen offset:0 lds
  v_mfma_f32_16x16x32_bf16 v[124:127], a[60:63], a[108:111], v[124:127]
  ds_read_b128 a[52:55], v26 offset:38912
  v_add_f32_dpp v77, v77, v77 row_ror:8 row_mask:0xf bank_mask:0xf
  v_mfma_f32_16x16x32_bf16 v[120:123], a[60:63], a[104:107], v[120:123]
  buffer_load_dwordx4 v16, s[16:19], s78 offen offset:1024 lds
  v_mfma_f32_16x16x32_bf16 v[116:119], a[60:63], a[100:103], v[116:119]
  ds_read_b64_tr_b16 a[0:1], v20 offset:0
  ds_read_b64_tr_b16 a[2:3], v20 offset:1280
  v_mfma_f32_16x16x32_bf16 v[112:115], a[60:63], a[96:99], v[112:115]
  ds_read_b64_tr_b16 a[4:5], v20 offset:10240
  s_add_u32 m0, s74, 2048
  v_mfma_f32_16x16x32_bf16 v[128:131], a[64:67], a[96:99], v[128:131]
  v_add_f32_dpp v78, v78, v78 row_ror:8 row_mask:0xf bank_mask:0xf
  ds_read_b64_tr_b16 a[6:7], v20 offset:11520
  v_mfma_f32_16x16x32_bf16 v[132:135], a[64:67], a[100:103], v[132:135]
  s_movk_i32 s78, 384
  v_mfma_f32_16x16x32_bf16 v[136:139], a[64:67], a[104:107], v[136:139]
  ds_read_b64_tr_b16 a[8:9], v21 offset:32
  v_mfma_f32_16x16x32_bf16 v[140:143], a[64:67], a[108:111], v[140:143]
  buffer_load_dwordx4 v17, s[16:19], s78 offen offset:0 lds
  v_mfma_f32_16x16x32_bf16 v[156:159], a[68:71], a[108:111], v[156:159]
  ds_read_b64_tr_b16 a[10:11], v21 offset:1312
  v_add_f32_dpp v79, v79, v79 row_ror:8 row_mask:0xf bank_mask:0xf
  v_mfma_f32_16x16x32_bf16 v[152:155], a[68:71], a[104:107], v[152:155]
  buffer_load_dwordx4 v18, s[16:19], s78 offen offset:1024 lds
  v_mfma_f32_16x16x32_bf16 v[148:151], a[68:71], a[100:103], v[148:151]
  ds_read_b64_tr_b16 a[12:13], v21 offset:10272
  ds_read_b64_tr_b16 a[14:15], v21 offset:11552
  v_mfma_f32_16x16x32_bf16 v[144:147], a[68:71], a[96:99], v[144:147]
  s_add_u32 m0, s73, 40960
  ds_write_b128 v80, v[76:79]
  v_mfma_f32_16x16x32_bf16 v[160:163], a[72:75], a[96:99], v[160:163]
  ds_read_b64_tr_b16 a[16:17], v20 offset:64
  ds_read_b64_tr_b16 a[18:19], v20 offset:1344
  v_mfma_f32_16x16x32_bf16 v[164:167], a[72:75], a[100:103], v[164:167]
  s_mov_b32 s77, 663552
  ds_read_b64_tr_b16 a[20:21], v20 offset:10304
  v_mfma_f32_16x16x32_bf16 v[168:171], a[72:75], a[104:107], v[168:171]
  buffer_load_dwordx4 v10, s[12:15], s77 offen offset:0 lds
  v_mfma_f32_16x16x32_bf16 v[172:175], a[72:75], a[108:111], v[172:175]
  ds_read_b64_tr_b16 a[22:23], v20 offset:11584
  s_nop 0
  v_mfma_f32_16x16x32_bf16 v[188:191], a[76:79], a[108:111], v[188:191]
  buffer_load_dwordx4 v11, s[12:15], s77 offen offset:1024 lds
  v_mfma_f32_16x16x32_bf16 v[184:187], a[76:79], a[104:107], v[184:187]
  ds_read_b64_tr_b16 a[24:25], v21 offset:96
  ds_read_b64_tr_b16 a[26:27], v21 offset:1376
  v_mfma_f32_16x16x32_bf16 v[180:183], a[76:79], a[100:103], v[180:183]
  buffer_load_dwordx4 v12, s[12:15], s77 offen offset:2048 lds
  v_mfma_f32_16x16x32_bf16 v[176:179], a[76:79], a[96:99], v[176:179]
  s_nop 0
  ds_read_b64_tr_b16 a[28:29], v21 offset:10336
  v_mfma_f32_16x16x32_bf16 v[192:195], a[80:83], a[96:99], v[192:195]
  buffer_load_dwordx4 v13, s[12:15], s77 offen offset:3072 lds
  v_mfma_f32_16x16x32_bf16 v[196:199], a[80:83], a[100:103], v[196:199]
  ds_read_b64_tr_b16 a[30:31], v21 offset:11616
  ds_read_b64_tr_b16 a[32:33], v22 offset:0
  v_mfma_f32_16x16x32_bf16 v[200:203], a[80:83], a[104:107], v[200:203]
  s_nop 0
  ds_read_b64_tr_b16 a[34:35], v22 offset:1280
  v_mfma_f32_16x16x32_bf16 v[204:207], a[80:83], a[108:111], v[204:207]
  s_add_u32 m0, s73, 45056
  ds_read_b64_tr_b16 a[36:37], v22 offset:10240
  v_mfma_f32_16x16x32_bf16 v[220:223], a[84:87], a[108:111], v[220:223]
  buffer_load_dwordx4 v14, s[12:15], s77 offen offset:0 lds
  v_mfma_f32_16x16x32_bf16 v[216:219], a[84:87], a[104:107], v[216:219]
  buffer_store_dwordx4 a[152:155], v28, s[8:11], s100 offen offset:0 sc1
  v_mfma_f32_16x16x32_bf16 v[212:215], a[84:87], a[100:103], v[212:215]
  ds_read_b64_tr_b16 a[38:39], v22 offset:11520
  s_nop 0
  v_mfma_f32_16x16x32_bf16 v[208:211], a[84:87], a[96:99], v[208:211]
  buffer_store_dwordx4 a[156:159], v28, s[8:11], s100 offen offset:1024 sc1
  v_mfma_f32_16x16x32_bf16 v[224:227], a[88:91], a[96:99], v[224:227]
  s_nop 0
  v_mfma_f32_16x16x32_bf16 v[228:231], a[88:91], a[100:103], v[228:231]
  buffer_store_dwordx4 a[160:163], v28, s[8:11], s100 offen offset:2048 sc1
  v_mfma_f32_16x16x32_bf16 v[232:235], a[88:91], a[104:107], v[232:235]
  v_mfma_f32_16x16x32_bf16 v[236:239], a[88:91], a[108:111], v[236:239]
  buffer_store_dwordx4 a[164:167], v28, s[8:11], s100 offen offset:3072 sc1
  v_mfma_f32_16x16x32_bf16 v[252:255], a[92:95], a[108:111], v[252:255]
  s_nop 0
  v_mfma_f32_16x16x32_bf16 v[248:251], a[92:95], a[104:107], v[248:251]
  buffer_store_dwordx4 a[168:171], v29, s[8:11], s100 offen offset:0 sc1
  v_mfma_f32_16x16x32_bf16 v[244:247], a[92:95], a[100:103], v[244:247]
  v_mfma_f32_16x16x32_bf16 v[240:243], a[92:95], a[96:99], v[240:243]
  s_waitcnt vmcnt(14) lgkmcnt(0)
  s_barrier
  v_mfma_f32_16x16x32_bf16 v[96:99], a[0:3], a[40:43], v[96:99]
  ds_read_b128 a[96:99], v27 offset:32768
  s_add_u32 m0, s73, 61440
  v_mfma_f32_16x16x32_bf16 v[100:103], a[0:3], a[44:47], v[100:103]
  ds_read_b128 a[100:103], v27 offset:34816
  ds_read_b32 v72, v81 offset:0
  v_mfma_f32_16x16x32_bf16 v[104:107], a[0:3], a[48:51], v[104:107]
  ds_read_b128 a[104:107], v27 offset:36864
  s_mov_b32 s77, 774144
  v_mfma_f32_16x16x32_bf16 v[108:111], a[0:3], a[52:55], v[108:111]
  ds_read_b128 a[108:111], v27 offset:38912
  v_mfma_f32_16x16x32_bf16 v[124:127], a[4:7], a[52:55], v[124:127]
  buffer_load_dwordx4 v10, s[12:15], s77 offen offset:0 lds
  v_mfma_f32_16x16x32_bf16 v[120:123], a[4:7], a[48:51], v[120:123]
  ds_read_b32 v73, v81 offset:256
  ds_read_b64_tr_b16 a[56:57], v20 offset:20480
  v_mfma_f32_16x16x32_bf16 v[116:119], a[4:7], a[44:47], v[116:119]
  ds_read_b64_tr_b16 a[58:59], v20 offset:21760
  v_mfma_f32_16x16x32_bf16 v[112:115], a[4:7], a[40:43], v[112:115]
  buffer_load_dwordx4 v11, s[12:15], s77 offen offset:1024 lds
  v_mfma_f32_16x16x32_bf16 v[128:131], a[8:11], a[40:43], v[128:131]
  ds_read_b64_tr_b16 a[60:61], v20 offset:30720
  ds_read_b64_tr_b16 a[62:63], v20 offset:32000
  v_mfma_f32_16x16x32_bf16 v[132:135], a[8:11], a[44:47], v[132:135]
  buffer_load_dwordx4 v12, s[12:15], s77 offen offset:2048 lds
  v_mfma_f32_16x16x32_bf16 v[136:139], a[8:11], a[48:51], v[136:139]
  ds_read_b32 v74, v81 offset:512
  ds_read_b64_tr_b16 a[64:65], v21 offset:20512
  v_mfma_f32_16x16x32_bf16 v[140:143], a[8:11], a[52:55], v[140:143]
  ds_read_b64_tr_b16 a[66:67], v21 offset:21792
  v_mfma_f32_16x16x32_bf16 v[156:159], a[12:15], a[52:55], v[156:159]
  buffer_load_dwordx4 v13, s[12:15], s77 offen offset:3072 lds
  v_mfma_f32_16x16x32_bf16 v[152:155], a[12:15], a[48:51], v[152:155]
  ds_read_b64_tr_b16 a[68:69], v21 offset:30752
  ds_read_b32 v75, v81 offset:768
  v_mfma_f32_16x16x32_bf16 v[148:151], a[12:15], a[44:47], v[148:151]
  ds_read_b64_tr_b16 a[70:71], v21 offset:32032
  s_add_u32 m0, s73, 65536
  v_mfma_f32_16x16x32_bf16 v[144:147], a[12:15], a[40:43], v[144:147]
  ds_read_b64_tr_b16 a[72:73], v20 offset:20544
  v_mfma_f32_16x16x32_bf16 v[160:163], a[16:19], a[40:43], v[160:163]
  ds_read_b64_tr_b16 a[74:75], v20 offset:21824
  s_waitcnt lgkmcnt(3)
  v_mfma_f32_16x16x32_bf16 v[164:167], a[16:19], a[44:47], v[164:167]
  buffer_load_dwordx4 v14, s[12:15], s77 offen offset:0 lds
  v_mfma_f32_16x16x32_bf16 v[168:171], a[16:19], a[48:51], v[168:171]
  ds_read_b64_tr_b16 a[76:77], v20 offset:30784
  ds_read_b64_tr_b16 a[78:79], v20 offset:32064
  v_mfma_f32_16x16x32_bf16 v[172:175], a[16:19], a[52:55], v[172:175]
  s_add_u32 m0, s73, 0
  v_mfma_f32_16x16x32_bf16 v[188:191], a[20:23], a[52:55], v[188:191]
  ds_read_b64_tr_b16 a[80:81], v21 offset:20576
  v_add_f32 v72, v72, v73
  v_mfma_f32_16x16x32_bf16 v[184:187], a[20:23], a[48:51], v[184:187]
  ds_read_b64_tr_b16 a[82:83], v21 offset:21856
  s_mov_b32 s77, 884736
  v_mfma_f32_16x16x32_bf16 v[180:183], a[20:23], a[44:47], v[180:183]
  ds_read_b64_tr_b16 a[84:85], v21 offset:30816
  v_mfma_f32_16x16x32_bf16 v[176:179], a[20:23], a[40:43], v[176:179]
  ds_read_b64_tr_b16 a[86:87], v21 offset:32096
  v_add_f32 v74, v74, v75
  v_mfma_f32_16x16x32_bf16 v[192:195], a[24:27], a[40:43], v[192:195]
  buffer_load_dwordx4 v10, s[12:15], s77 offen offset:0 lds
  v_mfma_f32_16x16x32_bf16 v[196:199], a[24:27], a[44:47], v[196:199]
  ds_read_b64_tr_b16 a[88:89], v22 offset:20480
  v_mfma_f32_16x16x32_bf16 v[200:203], a[24:27], a[48:51], v[200:203]
  buffer_load_dwordx4 v11, s[12:15], s77 offen offset:1024 lds
  v_mfma_f32_16x16x32_bf16 v[204:207], a[24:27], a[52:55], v[204:207]
  ds_read_b64_tr_b16 a[90:91], v22 offset:21760
  ds_read_b64_tr_b16 a[92:93], v22 offset:30720
  v_mfma_f32_16x16x32_bf16 v[220:223], a[28:31], a[52:55], v[220:223]
  v_mov_b32 v73, s96
  ds_read_b64_tr_b16 a[94:95], v22 offset:32000
  v_mfma_f32_16x16x32_bf16 v[216:219], a[28:31], a[48:51], v[216:219]
  buffer_load_dwordx4 v12, s[12:15], s77 offen offset:2048 lds
  v_mfma_f32_16x16x32_bf16 v[212:215], a[28:31], a[44:47], v[212:215]
  v_mfma_f32_16x16x32_bf16 v[208:211], a[28:31], a[40:43], v[208:211]
  buffer_load_dwordx4 v13, s[12:15], s77 offen offset:3072 lds
  v_mfma_f32_16x16x32_bf16 v[224:227], a[32:35], a[40:43], v[224:227]
  v_add_f32 v72, v72, v74
  v_mfma_f32_16x16x32_bf16 v[228:231], a[32:35], a[44:47], v[228:231]
  v_mfma_f32_16x16x32_bf16 v[232:235], a[32:35], a[48:51], v[232:235]
  s_add_u32 m0, s73, 4096
  v_mfma_f32_16x16x32_bf16 v[236:239], a[32:35], a[52:55], v[236:239]
  buffer_store_dwordx2 v[72:73], v82, s[8:11], s98 offen sc1
  v_mfma_f32_16x16x32_bf16 v[252:255], a[36:39], a[52:55], v[252:255]
  buffer_load_dwordx4 v14, s[12:15], s77 offen offset:0 lds
  v_mfma_f32_16x16x32_bf16 v[248:251], a[36:39], a[48:51], v[248:251]
  v_mfma_f32_16x16x32_bf16 v[244:247], a[36:39], a[44:47], v[244:247]
  v_mfma_f32_16x16x32_bf16 v[240:243], a[36:39], a[40:43], v[240:243]
  s_waitcnt vmcnt(16) lgkmcnt(0)
  s_barrier
  v_mfma_f32_16x16x32_bf16 v[96:99], a[56:59], a[96:99], v[96:99]
  ds_read_b128 a[40:43], v26 offset:0
  s_add_u32 m0, s74, 16384
  v_mfma_f32_16x16x32_bf16 v[100:103], a[56:59], a[100:103], v[100:103]
  ds_read_b128 a[44:47], v26 offset:2048
  v_mov_b32 v3, s96
  v_mfma_f32_16x16x32_bf16 v[104:107], a[56:59], a[104:107], v[104:107]
  ds_read_b128 a[48:51], v26 offset:4096
  s_movk_i32 s78, 512
  v_mfma_f32_16x16x32_bf16 v[108:111], a[56:59], a[108:111], v[108:111]
  s_waitcnt vmcnt(11)
  ds_read_b128 a[52:55], v26 offset:6144
  v_mfma_f32_16x16x32_bf16 v[124:127], a[60:63], a[108:111], v[124:127]
  buffer_store_dword v3, v8, s[8:11], s6 offen sc1
  v_mfma_f32_16x16x32_bf16 v[120:123], a[60:63], a[104:107], v[120:123]
  buffer_load_dwordx4 v15, s[16:19], s78 offen offset:0 lds
  v_mfma_f32_16x16x32_bf16 v[116:119], a[60:63], a[100:103], v[116:119]
  ds_read_b64_tr_b16 a[0:1], v20 offset:40960
  s_and_b32 s28, s2, 1
  v_mfma_f32_16x16x32_bf16 v[112:115], a[60:63], a[96:99], v[112:115]
  buffer_load_dwordx4 v16, s[16:19], s78 offen offset:1024 lds
  v_mfma_f32_16x16x32_bf16 v[128:131], a[64:67], a[96:99], v[128:131]
  ds_read_b64_tr_b16 a[2:3], v20 offset:42240
  s_bfe_u32 s32, s2, 0x20001
  v_mfma_f32_16x16x32_bf16 v[132:135], a[64:67], a[100:103], v[132:135]
  ds_read_b64_tr_b16 a[4:5], v20 offset:51200
  ds_read_b64_tr_b16 a[6:7], v20 offset:52480
  v_mfma_f32_16x16x32_bf16 v[136:139], a[64:67], a[104:107], v[136:139]
  s_lshr_b32 s33, s2, 6
  s_add_u32 m0, s74, 18432
  v_mfma_f32_16x16x32_bf16 v[140:143], a[64:67], a[108:111], v[140:143]
  s_lshl2_add_u32 s80, s32, s33
  ds_read_b64_tr_b16 a[8:9], v21 offset:40992
  v_mfma_f32_16x16x32_bf16 v[156:159], a[68:71], a[108:111], v[156:159]
  ds_read_b64_tr_b16 a[10:11], v21 offset:42272
  s_bfe_u32 s81, s2, 0x30003
  v_mfma_f32_16x16x32_bf16 v[152:155], a[68:71], a[104:107], v[152:155]
  ds_read_b64_tr_b16 a[12:13], v21 offset:51232
  s_movk_i32 s78, 512
  v_mfma_f32_16x16x32_bf16 v[148:151], a[68:71], a[100:103], v[148:151]
  buffer_load_dwordx4 v17, s[16:19], s78 offen offset:0 lds
  v_mfma_f32_16x16x32_bf16 v[144:147], a[68:71], a[96:99], v[144:147]
  s_lshl2_add_u32 s29, s28, s3
  ds_read_b64_tr_b16 a[14:15], v21 offset:52512
  v_mfma_f32_16x16x32_bf16 v[160:163], a[72:75], a[96:99], v[160:163]
  s_mul_i32 s32, s29, 12
  ds_read_b64_tr_b16 a[16:17], v20 offset:41024
  v_mfma_f32_16x16x32_bf16 v[164:167], a[72:75], a[100:103], v[164:167]
  buffer_load_dwordx4 v18, s[16:19], s78 offen offset:1024 lds
  v_mfma_f32_16x16x32_bf16 v[168:171], a[72:75], a[104:107], v[168:171]
  s_mul_i32 s33, s81, 96
  ds_read_b64_tr_b16 a[18:19], v20 offset:42304
  v_mfma_f32_16x16x32_bf16 v[172:175], a[72:75], a[108:111], v[172:175]
  ds_read_b64_tr_b16 a[20:21], v20 offset:51264
  s_add_u32 s33, s33, s32
  v_mfma_f32_16x16x32_bf16 v[188:191], a[76:79], a[108:111], v[188:191]
  ds_read_b64_tr_b16 a[22:23], v20 offset:52544
  s_mul_i32 s82, s33, 5120
  v_mfma_f32_16x16x32_bf16 v[184:187], a[76:79], a[104:107], v[184:187]
  s_add_u32 m0, s73, 20480
  ds_read_b64_tr_b16 a[24:25], v21 offset:41056
  v_mfma_f32_16x16x32_bf16 v[180:183], a[76:79], a[100:103], v[180:183]
  s_add_u32 s82, s82, 1048576
  ds_read_b64_tr_b16 a[26:27], v21 offset:42336
  v_mfma_f32_16x16x32_bf16 v[176:179], a[76:79], a[96:99], v[176:179]
  s_mov_b32 s77, 995328
  s_lshl1_add_u32 s33, s80, s28
  v_mfma_f32_16x16x32_bf16 v[192:195], a[80:83], a[96:99], v[192:195]
  buffer_load_dwordx4 v10, s[12:15], s77 offen offset:0 lds
  v_mfma_f32_16x16x32_bf16 v[196:199], a[80:83], a[100:103], v[196:199]
  ds_read_b64_tr_b16 a[28:29], v21 offset:51296
  s_mul_i32 s34, s33, 96
  v_mfma_f32_16x16x32_bf16 v[200:203], a[80:83], a[104:107], v[200:203]
  buffer_load_dwordx4 v11, s[12:15], s77 offen offset:1024 lds
  v_mfma_f32_16x16x32_bf16 v[204:207], a[80:83], a[108:111], v[204:207]
  ds_read_b64_tr_b16 a[30:31], v21 offset:52576
  s_add_u32 s34, s34, s32
  v_mfma_f32_16x16x32_bf16 v[220:223], a[84:87], a[108:111], v[220:223]
  ds_read_b64_tr_b16 a[32:33], v22 offset:40960
  s_mul_i32 s83, s34, 4096
  v_mfma_f32_16x16x32_bf16 v[216:219], a[84:87], a[104:107], v[216:219]
  buffer_load_dwordx4 v12, s[12:15], s77 offen offset:2048 lds
  v_mfma_f32_16x16x32_bf16 v[212:215], a[84:87], a[100:103], v[212:215]
  ds_read_b64_tr_b16 a[34:35], v22 offset:42240
  ds_read_b64_tr_b16 a[36:37], v22 offset:51200
  v_mfma_f32_16x16x32_bf16 v[208:211], a[84:87], a[96:99], v[208:211]
  buffer_load_dwordx4 v13, s[12:15], s77 offen offset:3072 lds
  v_mfma_f32_16x16x32_bf16 v[224:227], a[88:91], a[96:99], v[224:227]
  s_add_u32 s83, s83, 10485760
  ds_read_b64_tr_b16 a[38:39], v22 offset:52480
  v_mfma_f32_16x16x32_bf16 v[228:231], a[88:91], a[100:103], v[228:231]
  s_xor_b32 s33, s33, 1
  s_mul_i32 s34, s33, 96
  v_mfma_f32_16x16x32_bf16 v[232:235], a[88:91], a[104:107], v[232:235]
  s_add_u32 s34, s34, s32
  s_mul_i32 s30, s34, 4096
  v_mfma_f32_16x16x32_bf16 v[236:239], a[88:91], a[108:111], v[236:239]
  s_add_u32 m0, s73, 24576
  s_add_u32 s30, s30, 10485760
  v_mfma_f32_16x16x32_bf16 v[252:255], a[92:95], a[108:111], v[252:255]
  buffer_load_dwordx4 v14, s[12:15], s77 offen offset:0 lds
  v_mfma_f32_16x16x32_bf16 v[248:251], a[92:95], a[104:107], v[248:251]
  s_lshl_b32 s93, s80, 14
  s_add_u32 s93, s93, 262144
  v_mfma_f32_16x16x32_bf16 v[244:247], a[92:95], a[100:103], v[244:247]
  v_mfma_f32_16x16x32_bf16 v[240:243], a[92:95], a[96:99], v[240:243]
  s_waitcnt vmcnt(16) lgkmcnt(0)
  s_barrier
  v_mfma_f32_16x16x32_bf16 v[96:99], a[0:3], a[40:43], v[96:99]
  ds_read_b128 a[96:99], v27 offset:0
  s_add_u32 m0, s73, 40960
  v_mfma_f32_16x16x32_bf16 v[100:103], a[0:3], a[44:47], v[100:103]
  ds_read_b128 a[100:103], v27 offset:2048
  s_lshl1_add_u32 s32, s69, s72
  v_mfma_f32_16x16x32_bf16 v[104:107], a[0:3], a[48:51], v[104:107]
  ds_read_b128 a[104:107], v27 offset:4096
  s_mov_b32 s77, 1105920
  v_mfma_f32_16x16x32_bf16 v[108:111], a[0:3], a[52:55], v[108:111]
  ds_read_b128 a[108:111], v27 offset:6144
  s_cmp_ge_u32 s32, 11
  s_cselect_b32 s33, 11, 0
  s_cselect_b32 s84, 48, 0
  v_mfma_f32_16x16x32_bf16 v[124:127], a[4:7], a[52:55], v[124:127]
  v_mfma_f32_16x16x32_bf16 v[120:123], a[4:7], a[48:51], v[120:123]
  buffer_load_dwordx4 v10, s[12:15], s77 offen offset:0 lds
  v_mfma_f32_16x16x32_bf16 v[116:119], a[4:7], a[44:47], v[116:119]
  ds_read_b64_tr_b16 a[56:57], v23 offset:0
  s_sub_u32 s33, s32, s33
  v_mfma_f32_16x16x32_bf16 v[112:115], a[4:7], a[40:43], v[112:115]
  buffer_load_dwordx4 v11, s[12:15], s77 offen offset:1024 lds
  v_mfma_f32_16x16x32_bf16 v[128:131], a[8:11], a[40:43], v[128:131]
  ds_read_b64_tr_b16 a[58:59], v23 offset:1280
  ds_read_b64_tr_b16 a[60:61], v23 offset:10240
  v_mfma_f32_16x16x32_bf16 v[132:135], a[8:11], a[44:47], v[132:135]
  buffer_load_dwordx4 v12, s[12:15], s77 offen offset:2048 lds
  v_mfma_f32_16x16x32_bf16 v[136:139], a[8:11], a[48:51], v[136:139]
  s_add_u32 s84, s84, s33
  ds_read_b64_tr_b16 a[62:63], v23 offset:11520
  v_mfma_f32_16x16x32_bf16 v[140:143], a[8:11], a[52:55], v[140:143]
  s_mul_i32 s33, s33, 43
  ds_read_b64_tr_b16 a[64:65], v24 offset:32
  v_mfma_f32_16x16x32_bf16 v[156:159], a[12:15], a[52:55], v[156:159]
  buffer_load_dwordx4 v13, s[12:15], s77 offen offset:3072 lds
  v_mfma_f32_16x16x32_bf16 v[152:155], a[12:15], a[48:51], v[152:155]
  ds_read_b64_tr_b16 a[66:67], v24 offset:1312
  s_lshr_b32 s33, s33, 7
  v_mfma_f32_16x16x32_bf16 v[148:151], a[12:15], a[44:47], v[148:151]
  ds_read_b64_tr_b16 a[68:69], v24 offset:10272
  ds_read_b64_tr_b16 a[70:71], v24 offset:11552
  v_mfma_f32_16x16x32_bf16 v[144:147], a[12:15], a[40:43], v[144:147]
  s_mul_i32 s33, s33, 9
  s_add_u32 m0, s73, 45056
  v_mfma_f32_16x16x32_bf16 v[160:163], a[16:19], a[40:43], v[160:163]
  ds_read_b64_tr_b16 a[72:73], v23 offset:64
  s_add_u32 s84, s84, s33
  v_mfma_f32_16x16x32_bf16 v[164:167], a[16:19], a[44:47], v[164:167]
  buffer_load_dwordx4 v14, s[12:15], s77 offen offset:0 lds
  v_mfma_f32_16x16x32_bf16 v[168:171], a[16:19], a[48:51], v[168:171]
  ds_read_b64_tr_b16 a[74:75], v23 offset:1344
  ds_read_b64_tr_b16 a[76:77], v23 offset:10304
  v_mfma_f32_16x16x32_bf16 v[172:175], a[16:19], a[52:55], v[172:175]
  s_mul_i32 s33, s69, 3
  ds_read_b64_tr_b16 a[78:79], v23 offset:11584
  v_mfma_f32_16x16x32_bf16 v[188:191], a[20:23], a[52:55], v[188:191]
  s_add_u32 m0, s74, 32768
  s_cmp_eq_u32 s69, 10
  s_cselect_b32 s34, 1, 0
  v_mfma_f32_16x16x32_bf16 v[184:187], a[20:23], a[48:51], v[184:187]
  ds_read_b64_tr_b16 a[80:81], v24 offset:96
  v_mfma_f32_16x16x32_bf16 v[180:183], a[20:23], a[44:47], v[180:183]
  ds_read_b64_tr_b16 a[82:83], v24 offset:1376
  s_movk_i32 s78, 640
  v_mfma_f32_16x16x32_bf16 v[176:179], a[20:23], a[40:43], v[176:179]
  s_sub_u32 s33, s33, s34
  ds_read_b64_tr_b16 a[84:85], v24 offset:10336
  v_mfma_f32_16x16x32_bf16 v[192:195], a[24:27], a[40:43], v[192:195]
  buffer_load_dwordx4 v15, s[16:19], s78 offen offset:0 lds
  v_mfma_f32_16x16x32_bf16 v[196:199], a[24:27], a[44:47], v[196:199]
  ds_read_b64_tr_b16 a[86:87], v24 offset:11616
  s_lshl1_add_u32 s85, s72, s33
  v_mfma_f32_16x16x32_bf16 v[200:203], a[24:27], a[48:51], v[200:203]
  buffer_load_dwordx4 v16, s[16:19], s78 offen offset:1024 lds
  v_mfma_f32_16x16x32_bf16 v[204:207], a[24:27], a[52:55], v[204:207]
  ds_read_b64_tr_b16 a[88:89], v25 offset:0
  s_add_u32 s86, s33, 1
  v_mfma_f32_16x16x32_bf16 v[220:223], a[28:31], a[52:55], v[220:223]
  ds_read_b64_tr_b16 a[90:91], v25 offset:1280
  ds_read_b64_tr_b16 a[92:93], v25 offset:10240
  v_mfma_f32_16x16x32_bf16 v[216:219], a[28:31], a[48:51], v[216:219]
  s_lshr_b32 s34, s85, 2
  ds_read_b64_tr_b16 a[94:95], v25 offset:11520
  v_mfma_f32_16x16x32_bf16 v[212:215], a[28:31], a[44:47], v[212:215]
  s_add_u32 m0, s74, 34816
  s_lshl_b32 s34, s34, 3
  v_mfma_f32_16x16x32_bf16 v[208:211], a[28:31], a[40:43], v[208:211]
  s_movk_i32 s78, 640
  s_add_u32 s85, s85, s34
  v_mfma_f32_16x16x32_bf16 v[224:227], a[32:35], a[40:43], v[224:227]
  v_mfma_f32_16x16x32_bf16 v[228:231], a[32:35], a[44:47], v[228:231]
  s_add_u32 s85, s85, 3
  v_mfma_f32_16x16x32_bf16 v[232:235], a[32:35], a[48:51], v[232:235]
  buffer_load_dwordx4 v17, s[16:19], s78 offen offset:0 lds
  v_mfma_f32_16x16x32_bf16 v[236:239], a[32:35], a[52:55], v[236:239]
  s_lshr_b32 s34, s86, 2
  v_mfma_f32_16x16x32_bf16 v[252:255], a[36:39], a[52:55], v[252:255]
  buffer_load_dwordx4 v18, s[16:19], s78 offen offset:1024 lds
  v_mfma_f32_16x16x32_bf16 v[248:251], a[36:39], a[48:51], v[248:251]
  s_lshl_b32 s34, s34, 3
  v_mfma_f32_16x16x32_bf16 v[244:247], a[36:39], a[44:47], v[244:247]
  v_mfma_f32_16x16x32_bf16 v[240:243], a[36:39], a[40:43], v[240:243]
  s_waitcnt vmcnt(14) lgkmcnt(0)
  s_barrier
  v_mfma_f32_16x16x32_bf16 v[96:99], a[56:59], a[96:99], v[96:99]
  ds_read_b128 a[40:43], v26 offset:16384
  s_add_u32 m0, s73, 61440
  v_mfma_f32_16x16x32_bf16 v[100:103], a[56:59], a[100:103], v[100:103]
  ds_read_b128 a[44:47], v26 offset:18432
  v_mfma_f32_16x16x32_bf16 v[104:107], a[56:59], a[104:107], v[104:107]
  ds_read_b128 a[48:51], v26 offset:20480
  v_mfma_f32_16x16x32_bf16 v[108:111], a[56:59], a[108:111], v[108:111]
  ds_read_b128 a[52:55], v26 offset:22528
  s_mov_b32 s77, 1216512
  v_mfma_f32_16x16x32_bf16 v[124:127], a[60:63], a[108:111], v[124:127]
  v_mfma_f32_16x16x32_bf16 v[120:123], a[60:63], a[104:107], v[120:123]
  ds_read_b64_tr_b16 a[0:1], v20 offset:0
  v_mfma_f32_16x16x32_bf16 v[116:119], a[60:63], a[100:103], v[116:119]
  buffer_load_dwordx4 v10, s[12:15], s77 offen offset:0 lds
  v_mfma_f32_16x16x32_bf16 v[112:115], a[60:63], a[96:99], v[112:115]
  ds_read_b64_tr_b16 a[2:3], v20 offset:1280
  ds_read_b64_tr_b16 a[4:5], v20 offset:10240
  v_mfma_f32_16x16x32_bf16 v[128:131], a[64:67], a[96:99], v[128:131]
  ds_read_b64_tr_b16 a[6:7], v20 offset:11520
  v_mfma_f32_16x16x32_bf16 v[132:135], a[64:67], a[100:103], v[132:135]
  buffer_load_dwordx4 v11, s[12:15], s77 offen offset:1024 lds
  v_mfma_f32_16x16x32_bf16 v[136:139], a[64:67], a[104:107], v[136:139]
  ds_read_b64_tr_b16 a[8:9], v21 offset:32
  v_mfma_f32_16x16x32_bf16 v[140:143], a[64:67], a[108:111], v[140:143]
  ds_read_b64_tr_b16 a[10:11], v21 offset:1312
  v_mfma_f32_16x16x32_bf16 v[156:159], a[68:71], a[108:111], v[156:159]
  ds_read_b64_tr_b16 a[12:13], v21 offset:10272
  v_mfma_f32_16x16x32_bf16 v[152:155], a[68:71], a[104:107], v[152:155]
  buffer_load_dwordx4 v12, s[12:15], s77 offen offset:2048 lds
  v_mfma_f32_16x16x32_bf16 v[148:151], a[68:71], a[100:103], v[148:151]
  ds_read_b64_tr_b16 a[14:15], v21 offset:11552
  v_mfma_f32_16x16x32_bf16 v[144:147], a[68:71], a[96:99], v[144:147]
  ds_read_b64_tr_b16 a[16:17], v20 offset:64
  v_mfma_f32_16x16x32_bf16 v[160:163], a[72:75], a[96:99], v[160:163]
  buffer_load_dwordx4 v13, s[12:15], s77 offen offset:3072 lds
  v_mfma_f32_16x16x32_bf16 v[164:167], a[72:75], a[100:103], v[164:167]
  ds_read_b64_tr_b16 a[18:19], v20 offset:1344
  ds_read_b64_tr_b16 a[20:21], v20 offset:10304
  v_mfma_f32_16x16x32_bf16 v[168:171], a[72:75], a[104:107], v[168:171]
  ds_read_b64_tr_b16 a[22:23], v20 offset:11584
  v_mfma_f32_16x16x32_bf16 v[172:175], a[72:75], a[108:111], v[172:175]
  s_add_u32 m0, s73, 65536
  v_mfma_f32_16x16x32_bf16 v[188:191], a[76:79], a[108:111], v[188:191]
  ds_read_b64_tr_b16 a[24:25], v21 offset:96
  v_mfma_f32_16x16x32_bf16 v[184:187], a[76:79], a[104:107], v[184:187]
  ds_read_b64_tr_b16 a[26:27], v21 offset:1376
  v_mfma_f32_16x16x32_bf16 v[180:183], a[76:79], a[100:103], v[180:183]
  buffer_load_dwordx4 v14, s[12:15], s77 offen offset:0 lds
  v_mfma_f32_16x16x32_bf16 v[176:179], a[76:79], a[96:99], v[176:179]
  ds_read_b64_tr_b16 a[28:29], v21 offset:10336
  ds_read_b64_tr_b16 a[30:31], v21 offset:11616
  v_mfma_f32_16x16x32_bf16 v[192:195], a[80:83], a[96:99], v[192:195]
  v_mfma_f32_16x16x32_bf16 v[196:199], a[80:83], a[100:103], v[196:199]
  ds_read_b64_tr_b16 a[32:33], v22 offset:0
  v_mfma_f32_16x16x32_bf16 v[200:203], a[80:83], a[104:107], v[200:203]
  ds_read_b64_tr_b16 a[34:35], v22 offset:1280
  s_add_u32 m0, s74, 0
  v_mfma_f32_16x16x32_bf16 v[204:207], a[80:83], a[108:111], v[204:207]
  ds_read_b64_tr_b16 a[36:37], v22 offset:10240
  v_mfma_f32_16x16x32_bf16 v[220:223], a[84:87], a[108:111], v[220:223]
  ds_read_b64_tr_b16 a[38:39], v22 offset:11520
  v_mfma_f32_16x16x32_bf16 v[216:219], a[84:87], a[104:107], v[216:219]
  s_movk_i32 s78, 768
  v_mfma_f32_16x16x32_bf16 v[212:215], a[84:87], a[100:103], v[212:215]
  v_mfma_f32_16x16x32_bf16 v[208:211], a[84:87], a[96:99], v[208:211]
  v_mfma_f32_16x16x32_bf16 v[224:227], a[88:91], a[96:99], v[224:227]
  buffer_load_dwordx4 v15, s[16:19], s78 offen offset:0 lds
  v_mfma_f32_16x16x32_bf16 v[228:231], a[88:91], a[100:103], v[228:231]
  v_mfma_f32_16x16x32_bf16 v[232:235], a[88:91], a[104:107], v[232:235]
  v_mfma_f32_16x16x32_bf16 v[236:239], a[88:91], a[108:111], v[236:239]
  buffer_load_dwordx4 v16, s[16:19], s78 offen offset:1024 lds
  v_mfma_f32_16x16x32_bf16 v[252:255], a[92:95], a[108:111], v[252:255]
  v_mfma_f32_16x16x32_bf16 v[248:251], a[92:95], a[104:107], v[248:251]
  v_mfma_f32_16x16x32_bf16 v[244:247], a[92:95], a[100:103], v[244:247]
  v_mfma_f32_16x16x32_bf16 v[240:243], a[92:95], a[96:99], v[240:243]
  s_waitcnt vmcnt(16) lgkmcnt(0)
  s_barrier
  v_mfma_f32_16x16x32_bf16 v[96:99], a[0:3], a[40:43], v[96:99]
  ds_read_b128 a[96:99], v27 offset:16384
  s_add_u32 m0, s73, 0
  v_mfma_f32_16x16x32_bf16 v[100:103], a[0:3], a[44:47], v[100:103]
  ds_read_b128 a[100:103], v27 offset:18432
  s_add_u32 s86, s86, s34
  v_mfma_f32_16x16x32_bf16 v[104:107], a[0:3], a[48:51], v[104:107]
  ds_read_b128 a[104:107], v27 offset:20480
  v_mfma_f32_16x16x32_bf16 v[108:111], a[0:3], a[52:55], v[108:111]
  ds_read_b128 a[108:111], v27 offset:22528
  s_mov_b32 s77, 1327104
  v_mfma_f32_16x16x32_bf16 v[124:127], a[4:7], a[52:55], v[124:127]
  s_add_u32 s86, s86, 3
  v_mfma_f32_16x16x32_bf16 v[120:123], a[4:7], a[48:51], v[120:123]
  ds_read_b64_tr_b16 a[56:57], v20 offset:20480
  s_lshl1_add_u32 s33, s68, s71
  v_mfma_f32_16x16x32_bf16 v[116:119], a[4:7], a[44:47], v[116:119]
  buffer_load_dwordx4 v10, s[12:15], s77 offen offset:0 lds
  v_mfma_f32_16x16x32_bf16 v[112:115], a[4:7], a[40:43], v[112:115]
  ds_read_b64_tr_b16 a[58:59], v20 offset:21760
  ds_read_b64_tr_b16 a[60:61], v20 offset:30720
  v_mfma_f32_16x16x32_bf16 v[128:131], a[8:11], a[40:43], v[128:131]
  s_mul_i32 s34, s33, 96
  ds_read_b64_tr_b16 a[62:63], v20 offset:32000
  v_mfma_f32_16x16x32_bf16 v[132:135], a[8:11], a[44:47], v[132:135]
  buffer_load_dwordx4 v11, s[12:15], s77 offen offset:1024 lds
  v_mfma_f32_16x16x32_bf16 v[136:139], a[8:11], a[48:51], v[136:139]
  s_add_u32 s84, s84, s34
  ds_read_b64_tr_b16 a[64:65], v21 offset:20512
  v_mfma_f32_16x16x32_bf16 v[140:143], a[8:11], a[52:55], v[140:143]
  ds_read_b64_tr_b16 a[66:67], v21 offset:21792
  s_mul_i32 s84, s84, 4096
  v_mfma_f32_16x16x32_bf16 v[156:159], a[12:15], a[52:55], v[156:159]
  ds_read_b64_tr_b16 a[68:69], v21 offset:30752
  v_mfma_f32_16x16x32_bf16 v[152:155], a[12:15], a[48:51], v[152:155]
  buffer_load_dwordx4 v12, s[12:15], s77 offen offset:2048 lds
  v_mfma_f32_16x16x32_bf16 v[148:151], a[12:15], a[44:47], v[148:151]
  ds_read_b64_tr_b16 a[70:71], v21 offset:32032
  s_add_u32 s84, s84, 10485760
  v_mfma_f32_16x16x32_bf16 v[144:147], a[12:15], a[40:43], v[144:147]
  ds_read_b64_tr_b16 a[72:73], v20 offset:20544
  s_add_u32 s85, s85, s34
  v_mfma_f32_16x16x32_bf16 v[160:163], a[16:19], a[40:43], v[160:163]
  buffer_load_dwordx4 v13, s[12:15], s77 offen offset:3072 lds
  v_mfma_f32_16x16x32_bf16 v[164:167], a[16:19], a[44:47], v[164:167]
  ds_read_b64_tr_b16 a[74:75], v20 offset:21824
  ds_read_b64_tr_b16 a[76:77], v20 offset:30784
  v_mfma_f32_16x16x32_bf16 v[168:171], a[16:19], a[48:51], v[168:171]
  s_mul_i32 s85, s85, 4096
  ds_read_b64_tr_b16 a[78:79], v20 offset:32064
  v_mfma_f32_16x16x32_bf16 v[172:175], a[16:19], a[52:55], v[172:175]
  s_add_u32 m0, s73, 4096
  s_add_u32 s85, s85, 10485760
  v_mfma_f32_16x16x32_bf16 v[188:191], a[20:23], a[52:55], v[188:191]
  ds_read_b64_tr_b16 a[80:81], v21 offset:20576
  v_mfma_f32_16x16x32_bf16 v[184:187], a[20:23], a[48:51], v[184:187]
  ds_read_b64_tr_b16 a[82:83], v21 offset:21856
  s_add_u32 s86, s86, s34
  v_mfma_f32_16x16x32_bf16 v[180:183], a[20:23], a[44:47], v[180:183]
  buffer_load_dwordx4 v14, s[12:15], s77 offen offset:0 lds
  v_mfma_f32_16x16x32_bf16 v[176:179], a[20:23], a[40:43], v[176:179]
  ds_read_b64_tr_b16 a[84:85], v21 offset:30816
  ds_read_b64_tr_b16 a[86:87], v21 offset:32096
  v_mfma_f32_16x16x32_bf16 v[192:195], a[24:27], a[40:43], v[192:195]
  s_mul_i32 s86, s86, 4096
  v_mfma_f32_16x16x32_bf16 v[196:199], a[24:27], a[44:47], v[196:199]
  ds_read_b64_tr_b16 a[88:89], v22 offset:20480
  s_add_u32 s86, s86, 10485760
  v_mfma_f32_16x16x32_bf16 v[200:203], a[24:27], a[48:51], v[200:203]
  ds_read_b64_tr_b16 a[90:91], v22 offset:21760
  s_add_u32 m0, s74, 2048
  v_mfma_f32_16x16x32_bf16 v[204:207], a[24:27], a[52:55], v[204:207]
TS_2:
  s_cbranch_execz TR_FA
  ds_read_b64_tr_b16 a[92:93], v22 offset:30720
  s_cmp_eq_u32 s32, 19
  s_cselect_b32 s85, 0x7f000000, s85
  v_mfma_f32_16x16x32_bf16 v[220:223], a[28:31], a[52:55], v[220:223]
  ds_read_b64_tr_b16 a[94:95], v22 offset:32000
  v_mfma_f32_16x16x32_bf16 v[216:219], a[28:31], a[48:51], v[216:219]
  s_movk_i32 s78, 768
  s_lshl1_add_u32 s87, s32, s71
  v_mfma_f32_16x16x32_bf16 v[212:215], a[28:31], a[44:47], v[212:215]
  v_mfma_f32_16x16x32_bf16 v[208:211], a[28:31], a[40:43], v[208:211]
  s_lshl_b32 s33, s68, 7
  v_mfma_f32_16x16x32_bf16 v[224:227], a[32:35], a[40:43], v[224:227]
  buffer_load_dwordx4 v17, s[16:19], s78 offen offset:0 lds
  v_mfma_f32_16x16x32_bf16 v[228:231], a[32:35], a[44:47], v[228:231]
  s_add_u32 s87, s87, s33
  v_mfma_f32_16x16x32_bf16 v[232:235], a[32:35], a[48:51], v[232:235]
  v_mfma_f32_16x16x32_bf16 v[236:239], a[32:35], a[52:55], v[236:239]
  buffer_load_dwordx4 v18, s[16:19], s78 offen offset:1024 lds
  v_mfma_f32_16x16x32_bf16 v[252:255], a[36:39], a[52:55], v[252:255]
  s_lshl_b32 s87, s87, 7
  v_mfma_f32_16x16x32_bf16 v[248:251], a[36:39], a[48:51], v[248:251]
  s_add_u32 s87, s87, 262144
  v_mfma_f32_16x16x32_bf16 v[244:247], a[36:39], a[44:47], v[244:247]
  v_mfma_f32_16x16x32_bf16 v[240:243], a[36:39], a[40:43], v[240:243]
  s_waitcnt vmcnt(14) lgkmcnt(0)
  s_barrier
  v_mfma_f32_16x16x32_bf16 v[96:99], a[56:59], a[96:99], v[96:99]
  ds_read_b128 a[40:43], v26 offset:32768
  s_add_u32 m0, s73, 20480
  v_mfma_f32_16x16x32_bf16 v[100:103], a[56:59], a[100:103], v[100:103]
  ds_read_b128 a[44:47], v26 offset:34816
  v_mfma_f32_16x16x32_bf16 v[104:107], a[56:59], a[104:107], v[104:107]
  ds_read_b128 a[48:51], v26 offset:36864
  v_mfma_f32_16x16x32_bf16 v[108:111], a[56:59], a[108:111], v[108:111]
  ds_read_b128 a[52:55], v26 offset:38912
  s_mov_b32 s77, 1437696
  v_mfma_f32_16x16x32_bf16 v[124:127], a[60:63], a[108:111], v[124:127]
  v_mfma_f32_16x16x32_bf16 v[120:123], a[60:63], a[104:107], v[120:123]
  ds_read_b64_tr_b16 a[0:1], v20 offset:40960
  v_mfma_f32_16x16x32_bf16 v[116:119], a[60:63], a[100:103], v[116:119]
  buffer_load_dwordx4 v10, s[12:15], s77 offen offset:0 lds
  v_mfma_f32_16x16x32_bf16 v[112:115], a[60:63], a[96:99], v[112:115]
  ds_read_b64_tr_b16 a[2:3], v20 offset:42240
  ds_read_b64_tr_b16 a[4:5], v20 offset:51200
  v_mfma_f32_16x16x32_bf16 v[128:131], a[64:67], a[96:99], v[128:131]
  ds_read_b64_tr_b16 a[6:7], v20 offset:52480
  v_mfma_f32_16x16x32_bf16 v[132:135], a[64:67], a[100:103], v[132:135]
  buffer_load_dwordx4 v11, s[12:15], s77 offen offset:1024 lds
  v_mfma_f32_16x16x32_bf16 v[136:139], a[64:67], a[104:107], v[136:139]
  ds_read_b64_tr_b16 a[8:9], v21 offset:40992
  v_mfma_f32_16x16x32_bf16 v[140:143], a[64:67], a[108:111], v[140:143]
  ds_read_b64_tr_b16 a[10:11], v21 offset:42272
  v_mfma_f32_16x16x32_bf16 v[156:159], a[68:71], a[108:111], v[156:159]
  ds_read_b64_tr_b16 a[12:13], v21 offset:51232
  v_mfma_f32_16x16x32_bf16 v[152:155], a[68:71], a[104:107], v[152:155]
  buffer_load_dwordx4 v12, s[12:15], s77 offen offset:2048 lds
  v_mfma_f32_16x16x32_bf16 v[148:151], a[68:71], a[100:103], v[148:151]
  ds_read_b64_tr_b16 a[14:15], v21 offset:52512
  v_mfma_f32_16x16x32_bf16 v[144:147], a[68:71], a[96:99], v[144:147]
  ds_read_b64_tr_b16 a[16:17], v20 offset:41024
  v_mfma_f32_16x16x32_bf16 v[160:163], a[72:75], a[96:99], v[160:163]
  buffer_load_dwordx4 v13, s[12:15], s77 offen offset:3072 lds
  v_mfma_f32_16x16x32_bf16 v[164:167], a[72:75], a[100:103], v[164:167]
  ds_read_b64_tr_b16 a[18:19], v20 offset:42304
  ds_read_b64_tr_b16 a[20:21], v20 offset:51264
  v_mfma_f32_16x16x32_bf16 v[168:171], a[72:75], a[104:107], v[168:171]
  ds_read_b64_tr_b16 a[22:23], v20 offset:52544
  v_mfma_f32_16x16x32_bf16 v[172:175], a[72:75], a[108:111], v[172:175]
  s_add_u32 m0, s73, 24576
  v_mfma_f32_16x16x32_bf16 v[188:191], a[76:79], a[108:111], v[188:191]
  ds_read_b64_tr_b16 a[24:25], v21 offset:41056
  v_mfma_f32_16x16x32_bf16 v[184:187], a[76:79], a[104:107], v[184:187]
  ds_read_b64_tr_b16 a[26:27], v21 offset:42336
  v_mfma_f32_16x16x32_bf16 v[180:183], a[76:79], a[100:103], v[180:183]
  buffer_load_dwordx4 v14, s[12:15], s77 offen offset:0 lds
  v_mfma_f32_16x16x32_bf16 v[176:179], a[76:79], a[96:99], v[176:179]
  ds_read_b64_tr_b16 a[28:29], v21 offset:51296
  ds_read_b64_tr_b16 a[30:31], v21 offset:52576
  v_mfma_f32_16x16x32_bf16 v[192:195], a[80:83], a[96:99], v[192:195]
  v_mfma_f32_16x16x32_bf16 v[196:199], a[80:83], a[100:103], v[196:199]
  ds_read_b64_tr_b16 a[32:33], v22 offset:40960
  v_mfma_f32_16x16x32_bf16 v[200:203], a[80:83], a[104:107], v[200:203]
  ds_read_b64_tr_b16 a[34:35], v22 offset:42240
  s_add_u32 m0, s74, 16384
  v_mfma_f32_16x16x32_bf16 v[204:207], a[80:83], a[108:111], v[204:207]
  ds_read_b64_tr_b16 a[36:37], v22 offset:51200
  v_mfma_f32_16x16x32_bf16 v[220:223], a[84:87], a[108:111], v[220:223]
  ds_read_b64_tr_b16 a[38:39], v22 offset:52480
  v_mfma_f32_16x16x32_bf16 v[216:219], a[84:87], a[104:107], v[216:219]
  s_movk_i32 s78, 896
  v_mfma_f32_16x16x32_bf16 v[212:215], a[84:87], a[100:103], v[212:215]
  v_mfma_f32_16x16x32_bf16 v[208:211], a[84:87], a[96:99], v[208:211]
  v_mfma_f32_16x16x32_bf16 v[224:227], a[88:91], a[96:99], v[224:227]
  buffer_load_dwordx4 v15, s[16:19], s78 offen offset:0 lds
  v_mfma_f32_16x16x32_bf16 v[228:231], a[88:91], a[100:103], v[228:231]
  v_mfma_f32_16x16x32_bf16 v[232:235], a[88:91], a[104:107], v[232:235]
  v_mfma_f32_16x16x32_bf16 v[236:239], a[88:91], a[108:111], v[236:239]
  buffer_load_dwordx4 v16, s[16:19], s78 offen offset:1024 lds
  v_mfma_f32_16x16x32_bf16 v[252:255], a[92:95], a[108:111], v[252:255]
  v_mfma_f32_16x16x32_bf16 v[248:251], a[92:95], a[104:107], v[248:251]
  v_mfma_f32_16x16x32_bf16 v[244:247], a[92:95], a[100:103], v[244:247]
  v_mfma_f32_16x16x32_bf16 v[240:243], a[92:95], a[96:99], v[240:243]
  s_waitcnt vmcnt(16) lgkmcnt(0)
  s_barrier
  v_mfma_f32_16x16x32_bf16 v[96:99], a[0:3], a[40:43], v[96:99]
  ds_read_b128 a[96:99], v27 offset:32768
  s_add_u32 m0, s73, 40960
  v_mfma_f32_16x16x32_bf16 v[100:103], a[0:3], a[44:47], v[100:103]
  ds_read_b128 a[100:103], v27 offset:34816
  v_mfma_f32_16x16x32_bf16 v[104:107], a[0:3], a[48:51], v[104:107]
  ds_read_b128 a[104:107], v27 offset:36864
  v_mfma_f32_16x16x32_bf16 v[108:111], a[0:3], a[52:55], v[108:111]
  ds_read_b128 a[108:111], v27 offset:38912
  s_mov_b32 s77, 1548288
  v_mfma_f32_16x16x32_bf16 v[124:127], a[4:7], a[52:55], v[124:127]
  v_mfma_f32_16x16x32_bf16 v[120:123], a[4:7], a[48:51], v[120:123]
  ds_read_b64_tr_b16 a[56:57], v23 offset:0
  v_mfma_f32_16x16x32_bf16 v[116:119], a[4:7], a[44:47], v[116:119]
  buffer_load_dwordx4 v10, s[12:15], s77 offen offset:0 lds
  v_mfma_f32_16x16x32_bf16 v[112:115], a[4:7], a[40:43], v[112:115]
  ds_read_b64_tr_b16 a[58:59], v23 offset:1280
  ds_read_b64_tr_b16 a[60:61], v23 offset:10240
  v_mfma_f32_16x16x32_bf16 v[128:131], a[8:11], a[40:43], v[128:131]
  ds_read_b64_tr_b16 a[62:63], v23 offset:11520
  v_mfma_f32_16x16x32_bf16 v[132:135], a[8:11], a[44:47], v[132:135]
  buffer_load_dwordx4 v11, s[12:15], s77 offen offset:1024 lds
  v_mfma_f32_16x16x32_bf16 v[136:139], a[8:11], a[48:51], v[136:139]
  ds_read_b64_tr_b16 a[64:65], v24 offset:32
  v_mfma_f32_16x16x32_bf16 v[140:143], a[8:11], a[52:55], v[140:143]
  ds_read_b64_tr_b16 a[66:67], v24 offset:1312
  v_mfma_f32_16x16x32_bf16 v[156:159], a[12:15], a[52:55], v[156:159]
  ds_read_b64_tr_b16 a[68:69], v24 offset:10272
  v_mfma_f32_16x16x32_bf16 v[152:155], a[12:15], a[48:51], v[152:155]
  buffer_load_dwordx4 v12, s[12:15], s77 offen offset:2048 lds
  v_mfma_f32_16x16x32_bf16 v[148:151], a[12:15], a[44:47], v[148:151]
  ds_read_b64_tr_b16 a[70:71], v24 offset:11552
  v_mfma_f32_16x16x32_bf16 v[144:147], a[12:15], a[40:43], v[144:147]
  ds_read_b64_tr_b16 a[72:73], v23 offset:64
  v_mfma_f32_16x16x32_bf16 v[160:163], a[16:19], a[40:43], v[160:163]
  buffer_load_dwordx4 v13, s[12:15], s77 offen offset:3072 lds
  v_mfma_f32_16x16x32_bf16 v[164:167], a[16:19], a[44:47], v[164:167]
  ds_read_b64_tr_b16 a[74:75], v23 offset:1344
  ds_read_b64_tr_b16 a[76:77], v23 offset:10304
  v_mfma_f32_16x16x32_bf16 v[168:171], a[16:19], a[48:51], v[168:171]
  ds_read_b64_tr_b16 a[78:79], v23 offset:11584
  v_mfma_f32_16x16x32_bf16 v[172:175], a[16:19], a[52:55], v[172:175]
  s_add_u32 m0, s73, 45056
  v_mfma_f32_16x16x32_bf16 v[188:191], a[20:23], a[52:55], v[188:191]
  ds_read_b64_tr_b16 a[80:81], v24 offset:96
  v_mfma_f32_16x16x32_bf16 v[184:187], a[20:23], a[48:51], v[184:187]
  ds_read_b64_tr_b16 a[82:83], v24 offset:1376
  v_mfma_f32_16x16x32_bf16 v[180:183], a[20:23], a[44:47], v[180:183]
  buffer_load_dwordx4 v14, s[12:15], s77 offen offset:0 lds
  v_mfma_f32_16x16x32_bf16 v[176:179], a[20:23], a[40:43], v[176:179]
  ds_read_b64_tr_b16 a[84:85], v24 offset:10336
  ds_read_b64_tr_b16 a[86:87], v24 offset:11616
  v_mfma_f32_16x16x32_bf16 v[192:195], a[24:27], a[40:43], v[192:195]
  v_mfma_f32_16x16x32_bf16 v[196:199], a[24:27], a[44:47], v[196:199]
  ds_read_b64_tr_b16 a[88:89], v25 offset:0
  v_mfma_f32_16x16x32_bf16 v[200:203], a[24:27], a[48:51], v[200:203]
  ds_read_b64_tr_b16 a[90:91], v25 offset:1280
  s_add_u32 m0, s74, 18432
  v_mfma_f32_16x16x32_bf16 v[204:207], a[24:27], a[52:55], v[204:207]
  ds_read_b64_tr_b16 a[92:93], v25 offset:10240
  v_mfma_f32_16x16x32_bf16 v[220:223], a[28:31], a[52:55], v[220:223]
  ds_read_b64_tr_b16 a[94:95], v25 offset:11520
  v_mfma_f32_16x16x32_bf16 v[216:219], a[28:31], a[48:51], v[216:219]
  s_movk_i32 s78, 896
  v_mfma_f32_16x16x32_bf16 v[212:215], a[28:31], a[44:47], v[212:215]
  v_mfma_f32_16x16x32_bf16 v[208:211], a[28:31], a[40:43], v[208:211]
  v_mfma_f32_16x16x32_bf16 v[224:227], a[32:35], a[40:43], v[224:227]
  buffer_load_dwordx4 v17, s[16:19], s78 offen offset:0 lds
  v_mfma_f32_16x16x32_bf16 v[228:231], a[32:35], a[44:47], v[228:231]
  v_mfma_f32_16x16x32_bf16 v[232:235], a[32:35], a[48:51], v[232:235]
  v_mfma_f32_16x16x32_bf16 v[236:239], a[32:35], a[52:55], v[236:239]
  buffer_load_dwordx4 v18, s[16:19], s78 offen offset:1024 lds
  v_mfma_f32_16x16x32_bf16 v[252:255], a[36:39], a[52:55], v[252:255]
  v_mfma_f32_16x16x32_bf16 v[248:251], a[36:39], a[48:51], v[248:251]
  v_mfma_f32_16x16x32_bf16 v[244:247], a[36:39], a[44:47], v[244:247]
  v_mfma_f32_16x16x32_bf16 v[240:243], a[36:39], a[40:43], v[240:243]
  s_waitcnt vmcnt(14) lgkmcnt(0)
  s_barrier
  v_mfma_f32_16x16x32_bf16 v[96:99], a[56:59], a[96:99], v[96:99]
  ds_read_b128 a[40:43], v26 offset:0
  s_add_u32 m0, s73, 61440
  v_mfma_f32_16x16x32_bf16 v[100:103], a[56:59], a[100:103], v[100:103]
  ds_read_b128 a[44:47], v26 offset:2048
  v_lshrrev_b32 v2, 4, v1
  v_mfma_f32_16x16x32_bf16 v[104:107], a[56:59], a[104:107], v[104:107]
  ds_read_b128 a[48:51], v26 offset:4096
  v_mfma_f32_16x16x32_bf16 v[108:111], a[56:59], a[108:111], v[108:111]
  ds_read_b128 a[52:55], v26 offset:6144
  s_mov_b32 s77, 1658880
  v_mfma_f32_16x16x32_bf16 v[124:127], a[60:63], a[108:111], v[124:127]
  v_and_b32 v3, 1, v2
  v_mfma_f32_16x16x32_bf16 v[120:123], a[60:63], a[104:107], v[120:123]
  ds_read_b64_tr_b16 a[0:1], v20 offset:0
  v_mfma_f32_16x16x32_bf16 v[116:119], a[60:63], a[100:103], v[116:119]
  buffer_load_dwordx4 v10, s[12:15], s77 offen offset:0 lds
  v_mfma_f32_16x16x32_bf16 v[112:115], a[60:63], a[96:99], v[112:115]
  ds_read_b64_tr_b16 a[2:3], v20 offset:1280
  ds_read_b64_tr_b16 a[4:5], v20 offset:10240
  v_mfma_f32_16x16x32_bf16 v[128:131], a[64:67], a[96:99], v[128:131]
  v_lshlrev_b32 v3, 10, v3
  ds_read_b64_tr_b16 a[6:7], v20 offset:11520
  v_mfma_f32_16x16x32_bf16 v[132:135], a[64:67], a[100:103], v[132:135]
  buffer_load_dwordx4 v11, s[12:15], s77 offen offset:1024 lds
  v_mfma_f32_16x16x32_bf16 v[136:139], a[64:67], a[104:107], v[136:139]
  ds_read_b64_tr_b16 a[8:9], v21 offset:32
  v_mfma_f32_16x16x32_bf16 v[140:143], a[64:67], a[108:111], v[140:143]
  ds_read_b64_tr_b16 a[10:11], v21 offset:1312
  v_lshrrev_b32 v2, 1, v2
  v_mfma_f32_16x16x32_bf16 v[156:159], a[68:71], a[108:111], v[156:159]
  ds_read_b64_tr_b16 a[12:13], v21 offset:10272
  v_mfma_f32_16x16x32_bf16 v[152:155], a[68:71], a[104:107], v[152:155]
  buffer_load_dwordx4 v12, s[12:15], s77 offen offset:2048 lds
  v_mfma_f32_16x16x32_bf16 v[148:151], a[68:71], a[100:103], v[148:151]
  ds_read_b64_tr_b16 a[14:15], v21 offset:11552
  v_lshl_add_u32 v3, v2, 8, v3
  v_mfma_f32_16x16x32_bf16 v[144:147], a[68:71], a[96:99], v[144:147]
  ds_read_b64_tr_b16 a[16:17], v20 offset:64
  v_mfma_f32_16x16x32_bf16 v[160:163], a[72:75], a[96:99], v[160:163]
  buffer_load_dwordx4 v13, s[12:15], s77 offen offset:3072 lds
  v_mfma_f32_16x16x32_bf16 v[164:167], a[72:75], a[100:103], v[164:167]
  ds_read_b64_tr_b16 a[18:19], v20 offset:1344
  ds_read_b64_tr_b16 a[20:21], v20 offset:10304
  v_mfma_f32_16x16x32_bf16 v[168:171], a[72:75], a[104:107], v[168:171]
  ds_read_b64_tr_b16 a[22:23], v20 offset:11584
  v_and_b32 v2, 15, v1
  v_mfma_f32_16x16x32_bf16 v[172:175], a[72:75], a[108:111], v[172:175]
  s_add_u32 m0, s73, 65536
  v_mfma_f32_16x16x32_bf16 v[188:191], a[76:79], a[108:111], v[188:191]
  ds_read_b64_tr_b16 a[24:25], v21 offset:96
  v_mfma_f32_16x16x32_bf16 v[184:187], a[76:79], a[104:107], v[184:187]
  ds_read_b64_tr_b16 a[26:27], v21 offset:1376
  v_lshl_add_u32 v3, v2, 4, v3
  v_mfma_f32_16x16x32_bf16 v[180:183], a[76:79], a[100:103], v[180:183]
  buffer_load_dwordx4 v14, s[12:15], s77 offen offset:0 lds
  v_mfma_f32_16x16x32_bf16 v[176:179], a[76:79], a[96:99], v[176:179]
  ds_read_b64_tr_b16 a[28:29], v21 offset:10336
  ds_read_b64_tr_b16 a[30:31], v21 offset:11616
  v_mfma_f32_16x16x32_bf16 v[192:195], a[80:83], a[96:99], v[192:195]
  v_mfma_f32_16x16x32_bf16 v[196:199], a[80:83], a[100:103], v[196:199]
  ds_read_b64_tr_b16 a[32:33], v22 offset:0
  s_lshl_b32 s75, s72, 9
  v_mfma_f32_16x16x32_bf16 v[200:203], a[80:83], a[104:107], v[200:203]
  ds_read_b64_tr_b16 a[34:35], v22 offset:1280
  s_add_u32 m0, s74, 32768
  v_mfma_f32_16x16x32_bf16 v[204:207], a[80:83], a[108:111], v[204:207]
  ds_read_b64_tr_b16 a[36:37], v22 offset:10240
  v_mfma_f32_16x16x32_bf16 v[220:223], a[84:87], a[108:111], v[220:223]
  ds_read_b64_tr_b16 a[38:39], v22 offset:11520
  v_add_u32 v30, s75, v3
  v_mfma_f32_16x16x32_bf16 v[216:219], a[84:87], a[104:107], v[216:219]
  s_movk_i32 s78, 1024
  v_mfma_f32_16x16x32_bf16 v[212:215], a[84:87], a[100:103], v[212:215]
  v_mfma_f32_16x16x32_bf16 v[208:211], a[84:87], a[96:99], v[208:211]
  v_mfma_f32_16x16x32_bf16 v[224:227], a[88:91], a[96:99], v[224:227]
  buffer_load_dwordx4 v15, s[16:19], s78 offen offset:0 lds
  v_mfma_f32_16x16x32_bf16 v[228:231], a[88:91], a[100:103], v[228:231]
  v_mov_b32 v31, s96
  v_mfma_f32_16x16x32_bf16 v[232:235], a[88:91], a[104:107], v[232:235]
  v_mfma_f32_16x16x32_bf16 v[236:239], a[88:91], a[108:111], v[236:239]
  buffer_load_dwordx4 v16, s[16:19], s78 offen offset:1024 lds
  v_mfma_f32_16x16x32_bf16 v[252:255], a[92:95], a[108:111], v[252:255]
  s_add_u32 s99, s87, 5632
  v_mfma_f32_16x16x32_bf16 v[248:251], a[92:95], a[104:107], v[248:251]
  v_mfma_f32_16x16x32_bf16 v[244:247], a[92:95], a[100:103], v[244:247]
  v_mfma_f32_16x16x32_bf16 v[240:243], a[92:95], a[96:99], v[240:243]
  s_waitcnt vmcnt(16) lgkmcnt(0)
  s_barrier
  v_mfma_f32_16x16x32_bf16 v[96:99], a[0:3], a[40:43], v[96:99]
  ds_read_b128 a[96:99], v27 offset:0
  s_add_u32 m0, s73, 0
  v_mfma_f32_16x16x32_bf16 v[100:103], a[0:3], a[44:47], v[100:103]
  ds_read_b128 a[100:103], v27 offset:2048
  s_lshl_b32 s31, s81, 3
  v_mfma_f32_16x16x32_bf16 v[104:107], a[0:3], a[48:51], v[104:107]
  ds_read_b128 a[104:107], v27 offset:4096
  v_mfma_f32_16x16x32_bf16 v[108:111], a[0:3], a[52:55], v[108:111]
  ds_read_b128 a[108:111], v27 offset:6144
  s_mov_b32 s77, 1769472
  v_mfma_f32_16x16x32_bf16 v[124:127], a[4:7], a[52:55], v[124:127]
  s_add_u32 s31, s31, s29
  v_mfma_f32_16x16x32_bf16 v[120:123], a[4:7], a[48:51], v[120:123]
  ds_read_b64_tr_b16 a[56:57], v20 offset:20480
  s_mul_i32 s31, s31, 640
  v_mfma_f32_16x16x32_bf16 v[116:119], a[4:7], a[44:47], v[116:119]
  buffer_load_dwordx4 v10, s[12:15], s77 offen offset:0 lds
  v_mfma_f32_16x16x32_bf16 v[112:115], a[4:7], a[40:43], v[112:115]
  ds_read_b64_tr_b16 a[58:59], v20 offset:21760
  ds_read_b64_tr_b16 a[60:61], v20 offset:30720
  v_mfma_f32_16x16x32_bf16 v[128:131], a[8:11], a[40:43], v[128:131]
  s_add_u32 s31, s31, 655360
  ds_read_b64_tr_b16 a[62:63], v20 offset:32000
  v_mfma_f32_16x16x32_bf16 v[132:135], a[8:11], a[44:47], v[132:135]
  buffer_load_dwordx4 v11, s[12:15], s77 offen offset:1024 lds
  v_mfma_f32_16x16x32_bf16 v[136:139], a[8:11], a[48:51], v[136:139]
  v_min_u32 v9, 4, v1
  ds_read_b64_tr_b16 a[64:65], v21 offset:20512
  v_mfma_f32_16x16x32_bf16 v[140:143], a[8:11], a[52:55], v[140:143]
  ds_read_b64_tr_b16 a[66:67], v21 offset:21792
  v_lshlrev_b32 v9, 7, v9
  v_mfma_f32_16x16x32_bf16 v[156:159], a[12:15], a[52:55], v[156:159]
  ds_read_b64_tr_b16 a[68:69], v21 offset:30752
  v_mfma_f32_16x16x32_bf16 v[152:155], a[12:15], a[48:51], v[152:155]
  buffer_load_dwordx4 v12, s[12:15], s77 offen offset:2048 lds
  v_mfma_f32_16x16x32_bf16 v[148:151], a[12:15], a[44:47], v[148:151]
  buffer_load_dword v9, v9, s[8:11], s31 offen sc1
  v_mfma_f32_16x16x32_bf16 v[144:147], a[12:15], a[40:43], v[144:147]
  ds_read_b64_tr_b16 a[70:71], v21 offset:32032
  ds_read_b64_tr_b16 a[72:73], v20 offset:20544
  v_mfma_f32_16x16x32_bf16 v[160:163], a[16:19], a[40:43], v[160:163]
  buffer_load_dwordx4 v13, s[12:15], s77 offen offset:3072 lds
  v_mfma_f32_16x16x32_bf16 v[164:167], a[16:19], a[44:47], v[164:167]
  v_and_b32 v2, 7, v1
  ds_read_b64_tr_b16 a[74:75], v20 offset:21824
  v_mfma_f32_16x16x32_bf16 v[168:171], a[16:19], a[48:51], v[168:171]
  ds_read_b64_tr_b16 a[76:77], v20 offset:30784
  v_lshlrev_b32 v2, 3, v2
  v_mfma_f32_16x16x32_bf16 v[172:175], a[16:19], a[52:55], v[172:175]
  ds_read_b64_tr_b16 a[78:79], v20 offset:32064
  s_add_u32 m0, s73, 4096
  v_mfma_f32_16x16x32_bf16 v[188:191], a[20:23], a[52:55], v[188:191]
  ds_read_b64_tr_b16 a[80:81], v21 offset:20576
  v_and_b32 v3, 8, v1
  v_mfma_f32_16x16x32_bf16 v[184:187], a[20:23], a[48:51], v[184:187]
  ds_read_b64_tr_b16 a[82:83], v21 offset:21856
  v_mfma_f32_16x16x32_bf16 v[180:183], a[20:23], a[44:47], v[180:183]
  buffer_load_dwordx4 v14, s[12:15], s77 offen offset:0 lds
  v_mfma_f32_16x16x32_bf16 v[176:179], a[20:23], a[40:43], v[176:179]
  ds_read_b64_tr_b16 a[84:85], v21 offset:30816
  v_lshl_add_u32 v2, v3, 4, v2
  v_mfma_f32_16x16x32_bf16 v[192:195], a[24:27], a[40:43], v[192:195]
  ds_read_b64_tr_b16 a[86:87], v21 offset:32096
  s_lshl1_add_u32 s75, s68, s71
  v_mfma_f32_16x16x32_bf16 v[196:199], a[24:27], a[44:47], v[196:199]
  ds_read_b64_tr_b16 a[88:89], v22 offset:20480
  v_mfma_f32_16x16x32_bf16 v[200:203], a[24:27], a[48:51], v[200:203]
  ds_read_b64_tr_b16 a[90:91], v22 offset:21760
  s_add_u32 m0, s74, 34816
  v_mfma_f32_16x16x32_bf16 v[204:207], a[24:27], a[52:55], v[204:207]
  s_lshl_b32 s75, s75, 10
  ds_read_b64_tr_b16 a[92:93], v22 offset:30720
  v_mfma_f32_16x16x32_bf16 v[220:223], a[28:31], a[52:55], v[220:223]
  ds_read_b64_tr_b16 a[94:95], v22 offset:32000
  s_add_u32 s75, s75, 196608
  v_mfma_f32_16x16x32_bf16 v[216:219], a[28:31], a[48:51], v[216:219]
  s_movk_i32 s78, 1024
  v_mfma_f32_16x16x32_bf16 v[212:215], a[28:31], a[44:47], v[212:215]
  buffer_load_dwordx2 v[64:65], v2, s[8:11], s75 offen offset:0 sc1
  v_mfma_f32_16x16x32_bf16 v[208:211], a[28:31], a[40:43], v[208:211]
  v_mfma_f32_16x16x32_bf16 v[224:227], a[32:35], a[40:43], v[224:227]
  buffer_load_dwordx4 v17, s[16:19], s78 offen offset:0 lds
  v_mfma_f32_16x16x32_bf16 v[228:231], a[32:35], a[44:47], v[228:231]
  buffer_load_dwordx2 v[66:67], v2, s[8:11], s75 offen offset:256 sc1
  v_mfma_f32_16x16x32_bf16 v[232:235], a[32:35], a[48:51], v[232:235]
  buffer_load_dwordx2 v[68:69], v2, s[8:11], s75 offen offset:512 sc1
  v_mfma_f32_16x16x32_bf16 v[236:239], a[32:35], a[52:55], v[236:239]
  buffer_load_dwordx4 v18, s[16:19], s78 offen offset:1024 lds
  v_mfma_f32_16x16x32_bf16 v[252:255], a[36:39], a[52:55], v[252:255]
  buffer_load_dwordx2 v[70:71], v2, s[8:11], s75 offen offset:768 sc1
  v_mfma_f32_16x16x32_bf16 v[248:251], a[36:39], a[48:51], v[248:251]
  v_mfma_f32_16x16x32_bf16 v[244:247], a[36:39], a[44:47], v[244:247]
  v_mfma_f32_16x16x32_bf16 v[240:243], a[36:39], a[40:43], v[240:243]
  s_waitcnt vmcnt(19) lgkmcnt(0)
  s_barrier
  v_mfma_f32_16x16x32_bf16 v[96:99], a[56:59], a[96:99], v[96:99]
  ds_read_b128 a[40:43], v26 offset:16384
  s_add_u32 m0, s73, 20480
  v_mfma_f32_16x16x32_bf16 v[100:103], a[56:59], a[100:103], v[100:103]
  ds_read_b128 a[44:47], v26 offset:18432
  s_mul_i32 s75, s72, 1728
  v_mfma_f32_16x16x32_bf16 v[104:107], a[56:59], a[104:107], v[104:107]
  ds_read_b128 a[48:51], v26 offset:20480
  v_mfma_f32_16x16x32_bf16 v[108:111], a[56:59], a[108:111], v[108:111]
  ds_read_b128 a[52:55], v26 offset:22528
  s_mov_b32 s77, 1880064
  v_mfma_f32_16x16x32_bf16 v[124:127], a[60:63], a[108:111], v[124:127]
  s_mul_i32 s76, s71, 80
  v_mfma_f32_16x16x32_bf16 v[120:123], a[60:63], a[104:107], v[120:123]
  ds_read_b64_tr_b16 a[0:1], v20 offset:40960
  v_mfma_f32_16x16x32_bf16 v[116:119], a[60:63], a[100:103], v[116:119]
  buffer_load_dwordx4 v10, s[12:15], s77 offen offset:0 lds
  v_mfma_f32_16x16x32_bf16 v[112:115], a[60:63], a[96:99], v[112:115]
  ds_read_b64_tr_b16 a[2:3], v20 offset:42240
  ds_read_b64_tr_b16 a[4:5], v20 offset:51200
  v_mfma_f32_16x16x32_bf16 v[128:131], a[64:67], a[96:99], v[128:131]
  ds_read_b64_tr_b16 a[6:7], v20 offset:52480
  s_add_u32 s75, s75, s76
  v_mfma_f32_16x16x32_bf16 v[132:135], a[64:67], a[100:103], v[132:135]
  buffer_load_dwordx4 v11, s[12:15], s77 offen offset:1024 lds
  v_mfma_f32_16x16x32_bf16 v[136:139], a[64:67], a[104:107], v[136:139]
  ds_read_b64_tr_b16 a[8:9], v21 offset:40992
  v_mfma_f32_16x16x32_bf16 v[140:143], a[64:67], a[108:111], v[140:143]
  ds_read_b64_tr_b16 a[10:11], v21 offset:42272
  v_mfma_f32_16x16x32_bf16 v[156:159], a[68:71], a[108:111], v[156:159]
  ds_read_b64_tr_b16 a[12:13], v21 offset:51232
  s_add_u32 s75, s75, s70
  v_mfma_f32_16x16x32_bf16 v[152:155], a[68:71], a[104:107], v[152:155]
  buffer_load_dwordx4 v12, s[12:15], s77 offen offset:2048 lds
  v_mfma_f32_16x16x32_bf16 v[148:151], a[68:71], a[100:103], v[148:151]
  ds_read_b64_tr_b16 a[14:15], v21 offset:52512
  v_mfma_f32_16x16x32_bf16 v[144:147], a[68:71], a[96:99], v[144:147]
  ds_read_b64_tr_b16 a[16:17], v20 offset:41024
  v_mfma_f32_16x16x32_bf16 v[160:163], a[72:75], a[96:99], v[160:163]
  buffer_load_dwordx4 v13, s[12:15], s77 offen offset:3072 lds
  v_mfma_f32_16x16x32_bf16 v[164:167], a[72:75], a[100:103], v[164:167]
  ds_read_b64_tr_b16 a[18:19], v20 offset:42304
  s_lshl_b32 s75, s75, 3
  v_mfma_f32_16x16x32_bf16 v[168:171], a[72:75], a[104:107], v[168:171]
  ds_read_b64_tr_b16 a[20:21], v20 offset:51264
  ds_read_b64_tr_b16 a[22:23], v20 offset:52544
  v_mfma_f32_16x16x32_bf16 v[172:175], a[72:75], a[108:111], v[172:175]
  s_add_u32 m0, s73, 24576
  v_mfma_f32_16x16x32_bf16 v[188:191], a[76:79], a[108:111], v[188:191]
  ds_read_b64_tr_b16 a[24:25], v21 offset:41056
  s_add_u32 s75, s75, 851968
  v_mfma_f32_16x16x32_bf16 v[184:187], a[76:79], a[104:107], v[184:187]
  ds_read_b64_tr_b16 a[26:27], v21 offset:42336
  v_mfma_f32_16x16x32_bf16 v[180:183], a[76:79], a[100:103], v[180:183]
  buffer_load_dwordx4 v14, s[12:15], s77 offen offset:0 lds
  v_mfma_f32_16x16x32_bf16 v[176:179], a[76:79], a[96:99], v[176:179]
  ds_read_b64_tr_b16 a[28:29], v21 offset:51296
  ds_read_b64_tr_b16 a[30:31], v21 offset:52576
  v_mfma_f32_16x16x32_bf16 v[192:195], a[80:83], a[96:99], v[192:195]
  s_add_u32 s76, s75, 27648
  v_mfma_f32_16x16x32_bf16 v[196:199], a[80:83], a[100:103], v[196:199]
  ds_read_b64_tr_b16 a[32:33], v22 offset:40960
  v_mfma_f32_16x16x32_bf16 v[200:203], a[80:83], a[104:107], v[200:203]
  ds_read_b64_tr_b16 a[34:35], v22 offset:42240
  s_add_u32 m0, s74, 0
  v_mfma_f32_16x16x32_bf16 v[204:207], a[80:83], a[108:111], v[204:207]
  ds_read_b64_tr_b16 a[36:37], v22 offset:51200
  v_min_u32 v2, 624, v28
  v_mfma_f32_16x16x32_bf16 v[220:223], a[84:87], a[108:111], v[220:223]
  ds_read_b64_tr_b16 a[38:39], v22 offset:52480
  v_mfma_f32_16x16x32_bf16 v[216:219], a[84:87], a[104:107], v[216:219]
  s_movk_i32 s78, 1152
  v_mfma_f32_16x16x32_bf16 v[212:215], a[84:87], a[100:103], v[212:215]
  v_mfma_f32_16x16x32_bf16 v[208:211], a[84:87], a[96:99], v[208:211]
  buffer_load_dwordx4 v[56:59], v2, s[8:11], s75 offen sc1
  v_mfma_f32_16x16x32_bf16 v[224:227], a[88:91], a[96:99], v[224:227]
  buffer_load_dwordx4 v15, s[16:19], s78 offen offset:0 lds
  v_mfma_f32_16x16x32_bf16 v[228:231], a[88:91], a[100:103], v[228:231]
  v_mfma_f32_16x16x32_bf16 v[232:235], a[88:91], a[104:107], v[232:235]
  v_mfma_f32_16x16x32_bf16 v[236:239], a[88:91], a[108:111], v[236:239]
  buffer_load_dwordx4 v16, s[16:19], s78 offen offset:1024 lds
  v_mfma_f32_16x16x32_bf16 v[252:255], a[92:95], a[108:111], v[252:255]
  buffer_load_dwordx4 v[60:63], v2, s[8:11], s76 offen sc1
  v_mfma_f32_16x16x32_bf16 v[248:251], a[92:95], a[104:107], v[248:251]
  v_mfma_f32_16x16x32_bf16 v[244:247], a[92:95], a[100:103], v[244:247]
  v_mfma_f32_16x16x32_bf16 v[240:243], a[92:95], a[96:99], v[240:243]
  s_waitcnt vmcnt(23) lgkmcnt(0)
  s_barrier
  v_mfma_f32_16x16x32_bf16 v[96:99], a[0:3], a[40:43], v[96:99]
  ds_read_b128 a[96:99], v27 offset:16384
  s_add_u32 m0, s73, 40960
  v_mfma_f32_16x16x32_bf16 v[100:103], a[0:3], a[44:47], v[100:103]
  ds_read_b128 a[100:103], v27 offset:18432
  v_mfma_f32_16x16x32_bf16 v[104:107], a[0:3], a[48:51], v[104:107]
  ds_read_b128 a[104:107], v27 offset:20480
  v_mfma_f32_16x16x32_bf16 v[108:111], a[0:3], a[52:55], v[108:111]
  ds_read_b128 a[108:111], v27 offset:22528
  s_mov_b32 s77, 1990656
  v_mfma_f32_16x16x32_bf16 v[124:127], a[4:7], a[52:55], v[124:127]
  v_mfma_f32_16x16x32_bf16 v[120:123], a[4:7], a[48:51], v[120:123]
  ds_read_b64_tr_b16 a[56:57], v23 offset:0
  v_mfma_f32_16x16x32_bf16 v[116:119], a[4:7], a[44:47], v[116:119]
  buffer_load_dwordx4 v10, s[12:15], s77 offen offset:0 lds
  v_mfma_f32_16x16x32_bf16 v[112:115], a[4:7], a[40:43], v[112:115]
  ds_read_b64_tr_b16 a[58:59], v23 offset:1280
  ds_read_b64_tr_b16 a[60:61], v23 offset:10240
  v_mfma_f32_16x16x32_bf16 v[128:131], a[8:11], a[40:43], v[128:131]
  ds_read_b64_tr_b16 a[62:63], v23 offset:11520
  v_mfma_f32_16x16x32_bf16 v[132:135], a[8:11], a[44:47], v[132:135]
  buffer_load_dwordx4 v11, s[12:15], s77 offen offset:1024 lds
  v_mfma_f32_16x16x32_bf16 v[136:139], a[8:11], a[48:51], v[136:139]
  ds_read_b64_tr_b16 a[64:65], v24 offset:32
  v_mfma_f32_16x16x32_bf16 v[140:143], a[8:11], a[52:55], v[140:143]
  ds_read_b64_tr_b16 a[66:67], v24 offset:1312
  v_mfma_f32_16x16x32_bf16 v[156:159], a[12:15], a[52:55], v[156:159]
  ds_read_b64_tr_b16 a[68:69], v24 offset:10272
  v_mfma_f32_16x16x32_bf16 v[152:155], a[12:15], a[48:51], v[152:155]
  buffer_load_dwordx4 v12, s[12:15], s77 offen offset:2048 lds
  v_mfma_f32_16x16x32_bf16 v[148:151], a[12:15], a[44:47], v[148:151]
  ds_read_b64_tr_b16 a[70:71], v24 offset:11552
  v_mfma_f32_16x16x32_bf16 v[144:147], a[12:15], a[40:43], v[144:147]
  ds_read_b64_tr_b16 a[72:73], v23 offset:64
  v_mfma_f32_16x16x32_bf16 v[160:163], a[16:19], a[40:43], v[160:163]
  buffer_load_dwordx4 v13, s[12:15], s77 offen offset:3072 lds
  v_mfma_f32_16x16x32_bf16 v[164:167], a[16:19], a[44:47], v[164:167]
  ds_read_b64_tr_b16 a[74:75], v23 offset:1344
  ds_read_b64_tr_b16 a[76:77], v23 offset:10304
  v_mfma_f32_16x16x32_bf16 v[168:171], a[16:19], a[48:51], v[168:171]
  ds_read_b64_tr_b16 a[78:79], v23 offset:11584
  v_mfma_f32_16x16x32_bf16 v[172:175], a[16:19], a[52:55], v[172:175]
  s_add_u32 m0, s73, 45056
  v_mfma_f32_16x16x32_bf16 v[188:191], a[20:23], a[52:55], v[188:191]
  ds_read_b64_tr_b16 a[80:81], v24 offset:96
  v_mfma_f32_16x16x32_bf16 v[184:187], a[20:23], a[48:51], v[184:187]
  ds_read_b64_tr_b16 a[82:83], v24 offset:1376
  v_mfma_f32_16x16x32_bf16 v[180:183], a[20:23], a[44:47], v[180:183]
  buffer_load_dwordx4 v14, s[12:15], s77 offen offset:0 lds
  v_mfma_f32_16x16x32_bf16 v[176:179], a[20:23], a[40:43], v[176:179]
  ds_read_b64_tr_b16 a[84:85], v24 offset:10336
  ds_read_b64_tr_b16 a[86:87], v24 offset:11616
  v_mfma_f32_16x16x32_bf16 v[192:195], a[24:27], a[40:43], v[192:195]
  v_mfma_f32_16x16x32_bf16 v[196:199], a[24:27], a[44:47], v[196:199]
  ds_read_b64_tr_b16 a[88:89], v25 offset:0
  v_mfma_f32_16x16x32_bf16 v[200:203], a[24:27], a[48:51], v[200:203]
  ds_read_b64_tr_b16 a[90:91], v25 offset:1280
  s_add_u32 m0, s74, 2048
  v_mfma_f32_16x16x32_bf16 v[204:207], a[24:27], a[52:55], v[204:207]
  ds_read_b64_tr_b16 a[92:93], v25 offset:10240
  v_mfma_f32_16x16x32_bf16 v[220:223], a[28:31], a[52:55], v[220:223]
  ds_read_b64_tr_b16 a[94:95], v25 offset:11520
  v_mfma_f32_16x16x32_bf16 v[216:219], a[28:31], a[48:51], v[216:219]
  s_movk_i32 s78, 1152
  v_mfma_f32_16x16x32_bf16 v[212:215], a[28:31], a[44:47], v[212:215]
  v_mfma_f32_16x16x32_bf16 v[208:211], a[28:31], a[40:43], v[208:211]
  v_mfma_f32_16x16x32_bf16 v[224:227], a[32:35], a[40:43], v[224:227]
  buffer_load_dwordx4 v17, s[16:19], s78 offen offset:0 lds
  v_mfma_f32_16x16x32_bf16 v[228:231], a[32:35], a[44:47], v[228:231]
  v_mfma_f32_16x16x32_bf16 v[232:235], a[32:35], a[48:51], v[232:235]
  v_mfma_f32_16x16x32_bf16 v[236:239], a[32:35], a[52:55], v[236:239]
  buffer_load_dwordx4 v18, s[16:19], s78 offen offset:1024 lds
  v_mfma_f32_16x16x32_bf16 v[252:255], a[36:39], a[52:55], v[252:255]
  v_mfma_f32_16x16x32_bf16 v[248:251], a[36:39], a[48:51], v[248:251]
  v_mfma_f32_16x16x32_bf16 v[244:247], a[36:39], a[44:47], v[244:247]
  v_mfma_f32_16x16x32_bf16 v[240:243], a[36:39], a[40:43], v[240:243]
  s_waitcnt vmcnt(24)
  v_cmp_ne_u32 vcc, s96, v9
  s_cbranch_vccz FAC_ok
  s_mov_b32 s7, 0x40000
FAC_l:
  s_lshl_b32 s31, s81, 3
TS_3:
  s_cbranch_execz TR_FA
  s_add_u32 s31, s31, s29
  s_mul_i32 s31, s31, 640
  s_add_u32 s31, s31, 655360
  v_min_u32 v9, 4, v1
  v_lshlrev_b32 v9, 7, v9
  buffer_load_dword v9, v9, s[8:11], s31 offen sc1
  s_waitcnt vmcnt(0)
  v_cmp_ne_u32 vcc, s96, v9
  s_sub_u32 s7, s7, 1
  s_cbranch_scc1 FAC_ok
  s_cbranch_vccnz FAC_l
FAC_ok:
  s_waitcnt vmcnt(17) lgkmcnt(0)
  s_barrier
  v_mfma_f32_16x16x32_bf16 v[96:99], a[56:59], a[96:99], v[96:99]
  ds_read_b128 a[40:43], v26 offset:32768
  s_add_u32 m0, s73, 61440
  v_mfma_f32_16x16x32_bf16 v[100:103], a[56:59], a[100:103], v[100:103]
  ds_read_b128 a[44:47], v26 offset:34816
  s_mul_i32 s31, s29, 7680
  v_mfma_f32_16x16x32_bf16 v[104:107], a[56:59], a[104:107], v[104:107]
  ds_read_b128 a[48:51], v26 offset:36864
  v_mfma_f32_16x16x32_bf16 v[108:111], a[56:59], a[108:111], v[108:111]
  ds_read_b128 a[52:55], v26 offset:38912
  s_mov_b32 s77, 2101248
  v_mfma_f32_16x16x32_bf16 v[124:127], a[60:63], a[108:111], v[124:127]
  s_add_u32 s31, s31, 720896
  v_mfma_f32_16x16x32_bf16 v[120:123], a[60:63], a[104:107], v[120:123]
  ds_read_b64_tr_b16 a[0:1], v20 offset:0
  v_mfma_f32_16x16x32_bf16 v[116:119], a[60:63], a[100:103], v[116:119]
  buffer_load_dwordx4 v10, s[12:15], s77 offen offset:0 lds
  v_mfma_f32_16x16x32_bf16 v[112:115], a[60:63], a[96:99], v[112:115]
  ds_read_b64_tr_b16 a[2:3], v20 offset:1280
  s_mul_i32 s32, s81, 5
  v_mfma_f32_16x16x32_bf16 v[128:131], a[64:67], a[96:99], v[128:131]
  ds_read_b64_tr_b16 a[4:5], v20 offset:10240
  ds_read_b64_tr_b16 a[6:7], v20 offset:11520
  v_mfma_f32_16x16x32_bf16 v[132:135], a[64:67], a[100:103], v[132:135]
  buffer_load_dwordx4 v11, s[12:15], s77 offen offset:1024 lds
  v_mfma_f32_16x16x32_bf16 v[136:139], a[64:67], a[104:107], v[136:139]
  s_cmp_eq_u32 s3, 3
  s_cselect_b32 s33, 2, 63
  v_mfma_f32_16x16x32_bf16 v[140:143], a[64:67], a[108:111], v[140:143]
  ds_read_b64_tr_b16 a[8:9], v21 offset:32
  ds_read_b64_tr_b16 a[10:11], v21 offset:1312
  v_mfma_f32_16x16x32_bf16 v[156:159], a[68:71], a[108:111], v[156:159]
  buffer_load_dwordx4 v12, s[12:15], s77 offen offset:2048 lds
  v_mfma_f32_16x16x32_bf16 v[152:155], a[68:71], a[104:107], v[152:155]
  v_lshrrev_b32 v9, 1, v1
  ds_read_b64_tr_b16 a[12:13], v21 offset:10272
  v_mfma_f32_16x16x32_bf16 v[148:151], a[68:71], a[100:103], v[148:151]
  ds_read_b64_tr_b16 a[14:15], v21 offset:11552
  v_min_u32 v9, 6, v9
  v_mfma_f32_16x16x32_bf16 v[144:147], a[68:71], a[96:99], v[144:147]
  buffer_load_dwordx4 v13, s[12:15], s77 offen offset:3072 lds
  v_mfma_f32_16x16x32_bf16 v[160:163], a[72:75], a[96:99], v[160:163]
  ds_read_b64_tr_b16 a[16:17], v20 offset:64
  ds_read_b64_tr_b16 a[18:19], v20 offset:1344
  v_mfma_f32_16x16x32_bf16 v[164:167], a[72:75], a[100:103], v[164:167]
  ds_read_b64_tr_b16 a[20:21], v20 offset:10304
  v_cmp_eq_u32 vcc, s33, v9
  v_mfma_f32_16x16x32_bf16 v[168:171], a[72:75], a[104:107], v[168:171]
  ds_read_b64_tr_b16 a[22:23], v20 offset:11584
  s_add_u32 m0, s73, 65536
  v_mfma_f32_16x16x32_bf16 v[172:175], a[72:75], a[108:111], v[172:175]
  v_mfma_f32_16x16x32_bf16 v[188:191], a[76:79], a[108:111], v[188:191]
  ds_read_b64_tr_b16 a[24:25], v21 offset:96
  v_and_b32 v2, 1, v1
  v_mfma_f32_16x16x32_bf16 v[184:187], a[76:79], a[104:107], v[184:187]
  buffer_load_dwordx4 v14, s[12:15], s77 offen offset:0 lds
  v_mfma_f32_16x16x32_bf16 v[180:183], a[76:79], a[100:103], v[180:183]
  ds_read_b64_tr_b16 a[26:27], v21 offset:1376
  ds_read_b64_tr_b16 a[28:29], v21 offset:10336
  v_mfma_f32_16x16x32_bf16 v[176:179], a[76:79], a[96:99], v[176:179]
  v_lshl_add_u32 v2, v2, 2, s32
  ds_read_b64_tr_b16 a[30:31], v21 offset:11616
  v_mfma_f32_16x16x32_bf16 v[192:195], a[80:83], a[96:99], v[192:195]
  s_add_u32 s79, s82, 35840
  v_mfma_f32_16x16x32_bf16 v[196:199], a[80:83], a[100:103], v[196:199]
  ds_read_b64_tr_b16 a[32:33], v22 offset:0
  v_cndmask_b32 v9, v9, 1, vcc
  v_mfma_f32_16x16x32_bf16 v[200:203], a[80:83], a[104:107], v[200:203]
  ds_read_b64_tr_b16 a[34:35], v22 offset:1280
  v_mfma_f32_16x16x32_bf16 v[204:207], a[80:83], a[108:111], v[204:207]
  buffer_load_dwordx4 a[116:119], v28, s[8:11], s79 offen offset:0 sc1
  v_mfma_f32_16x16x32_bf16 v[220:223], a[84:87], a[108:111], v[220:223]
  ds_read_b64_tr_b16 a[36:37], v22 offset:10240
  ds_read_b64_tr_b16 a[38:39], v22 offset:11520
  v_mfma_f32_16x16x32_bf16 v[216:219], a[84:87], a[104:107], v[216:219]
  v_lshrrev_b32 v2, 3, v2
  v_mfma_f32_16x16x32_bf16 v[212:215], a[84:87], a[100:103], v[212:215]
  buffer_load_dwordx4 a[120:123], v28, s[8:11], s79 offen offset:1024 sc1
  v_mfma_f32_16x16x32_bf16 v[208:211], a[84:87], a[96:99], v[208:211]
  v_mad_u32_u24 v9, v9, 5, v2
  v_mfma_f32_16x16x32_bf16 v[224:227], a[88:91], a[96:99], v[224:227]
  v_mfma_f32_16x16x32_bf16 v[228:231], a[88:91], a[100:103], v[228:231]
  buffer_load_dwordx4 a[124:127], v28, s[8:11], s79 offen offset:2048 sc1
  v_mfma_f32_16x16x32_bf16 v[232:235], a[88:91], a[104:107], v[232:235]
  v_lshlrev_b32 v9, 7, v9
  v_mfma_f32_16x16x32_bf16 v[236:239], a[88:91], a[108:111], v[236:239]
  v_mfma_f32_16x16x32_bf16 v[252:255], a[92:95], a[108:111], v[252:255]
  buffer_load_dwordx4 a[128:131], v28, s[8:11], s79 offen offset:3072 sc1
  v_mfma_f32_16x16x32_bf16 v[248:251], a[92:95], a[104:107], v[248:251]
  buffer_load_dword v9, v9, s[8:11], s31 offen sc1
  v_mfma_f32_16x16x32_bf16 v[244:247], a[92:95], a[100:103], v[244:247]
  v_mfma_f32_16x16x32_bf16 v[240:243], a[92:95], a[96:99], v[240:243]
  s_waitcnt vmcnt(21) lgkmcnt(0)
  s_barrier
  v_mfma_f32_16x16x32_bf16 v[96:99], a[0:3], a[40:43], v[96:99]
  buffer_load_dwordx4 a[132:135], v29, s[8:11], s79 offen offset:0 sc1
  v_mfma_f32_16x16x32_bf16 v[100:103], a[0:3], a[44:47], v[100:103]
  ds_read_b128 a[96:99], v27 offset:32768
  ds_read_b128 a[100:103], v27 offset:34816
  v_mfma_f32_16x16x32_bf16 v[104:107], a[0:3], a[48:51], v[104:107]
  s_waitcnt vmcnt(18)
  ds_read_b128 a[104:107], v27 offset:36864
  v_mfma_f32_16x16x32_bf16 v[108:111], a[0:3], a[52:55], v[108:111]
  ds_read_b128 a[108:111], v27 offset:38912
  s_add_u32 s79, s82, 40960
  v_mfma_f32_16x16x32_bf16 v[124:127], a[4:7], a[52:55], v[124:127]
  v_xor_b32 v4, s96, v57
  v_mfma_f32_16x16x32_bf16 v[120:123], a[4:7], a[48:51], v[120:123]
  ds_read_b64_tr_b16 a[56:57], v20 offset:20480
  v_xor_b32 v5, s96, v59
  v_mfma_f32_16x16x32_bf16 v[116:119], a[4:7], a[44:47], v[116:119]
  ds_read_b64_tr_b16 a[58:59], v20 offset:21760
  v_mfma_f32_16x16x32_bf16 v[112:115], a[4:7], a[40:43], v[112:115]
  buffer_load_dwordx4 a[136:139], v28, s[8:11], s79 offen offset:0 sc1
  v_mfma_f32_16x16x32_bf16 v[128:131], a[8:11], a[40:43], v[128:131]
  ds_read_b64_tr_b16 a[60:61], v20 offset:30720
  v_or_b32 v4, v4, v5
  v_mfma_f32_16x16x32_bf16 v[132:135], a[8:11], a[44:47], v[132:135]
  ds_read_b64_tr_b16 a[62:63], v20 offset:32000
  v_xor_b32 v5, s96, v61
  v_mfma_f32_16x16x32_bf16 v[136:139], a[8:11], a[48:51], v[136:139]
  ds_read_b64_tr_b16 a[64:65], v21 offset:20512
  v_mfma_f32_16x16x32_bf16 v[140:143], a[8:11], a[52:55], v[140:143]
  buffer_load_dwordx4 a[140:143], v28, s[8:11], s79 offen offset:1024 sc1
  v_mfma_f32_16x16x32_bf16 v[156:159], a[12:15], a[52:55], v[156:159]
  ds_read_b64_tr_b16 a[66:67], v21 offset:21792
  ds_read_b64_tr_b16 a[68:69], v21 offset:30752
  v_mfma_f32_16x16x32_bf16 v[152:155], a[12:15], a[48:51], v[152:155]
  v_or_b32 v4, v4, v5
  ds_read_b64_tr_b16 a[70:71], v21 offset:32032
  v_mfma_f32_16x16x32_bf16 v[148:151], a[12:15], a[44:47], v[148:151]
  v_xor_b32 v5, s96, v63
  v_mfma_f32_16x16x32_bf16 v[144:147], a[12:15], a[40:43], v[144:147]
  buffer_load_dwordx4 a[144:147], v28, s[8:11], s79 offen offset:2048 sc1
  v_mfma_f32_16x16x32_bf16 v[160:163], a[16:19], a[40:43], v[160:163]
  ds_read_b64_tr_b16 a[72:73], v20 offset:20544
  ds_read_b64_tr_b16 a[74:75], v20 offset:21824
  v_mfma_f32_16x16x32_bf16 v[164:167], a[16:19], a[44:47], v[164:167]
  v_or_b32 v4, v4, v5
  ds_read_b64_tr_b16 a[76:77], v20 offset:30784
  v_mfma_f32_16x16x32_bf16 v[168:171], a[16:19], a[48:51], v[168:171]
  ds_read_b64_tr_b16 a[78:79], v20 offset:32064
  v_xor_b32 v5, s96, v65
  v_mfma_f32_16x16x32_bf16 v[172:175], a[16:19], a[52:55], v[172:175]
  buffer_load_dwordx4 a[148:151], v28, s[8:11], s79 offen offset:3072 sc1
  v_mfma_f32_16x16x32_bf16 v[188:191], a[20:23], a[52:55], v[188:191]
  ds_read_b64_tr_b16 a[80:81], v21 offset:20576
  v_mfma_f32_16x16x32_bf16 v[184:187], a[20:23], a[48:51], v[184:187]
  ds_read_b64_tr_b16 a[82:83], v21 offset:21856
  v_or_b32 v4, v4, v5
  v_mfma_f32_16x16x32_bf16 v[180:183], a[20:23], a[44:47], v[180:183]
  ds_read_b64_tr_b16 a[84:85], v21 offset:30816
  v_mfma_f32_16x16x32_bf16 v[176:179], a[20:23], a[40:43], v[176:179]
  buffer_load_dwordx4 a[152:155], v29, s[8:11], s79 offen offset:0 sc1
  v_mfma_f32_16x16x32_bf16 v[192:195], a[24:27], a[40:43], v[192:195]
  ds_read_b64_tr_b16 a[86:87], v21 offset:32096
  v_xor_b32 v5, s96, v67
  v_mfma_f32_16x16x32_bf16 v[196:199], a[24:27], a[44:47], v[196:199]
  ds_read_b64_tr_b16 a[88:89], v22 offset:20480
  v_or_b32 v4, v4, v5
  v_mfma_f32_16x16x32_bf16 v[200:203], a[24:27], a[48:51], v[200:203]
  ds_read_b64_tr_b16 a[90:91], v22 offset:21760
  v_mfma_f32_16x16x32_bf16 v[204:207], a[24:27], a[52:55], v[204:207]
  ds_read_b64_tr_b16 a[92:93], v22 offset:30720
  s_add_u32 s79, s82, 46080
  v_mfma_f32_16x16x32_bf16 v[220:223], a[28:31], a[52:55], v[220:223]
  v_xor_b32 v5, s96, v69
  ds_read_b64_tr_b16 a[94:95], v22 offset:32000
  v_mfma_f32_16x16x32_bf16 v[216:219], a[28:31], a[48:51], v[216:219]
  v_mfma_f32_16x16x32_bf16 v[212:215], a[28:31], a[44:47], v[212:215]
  v_or_b32 v4, v4, v5
  v_mfma_f32_16x16x32_bf16 v[208:211], a[28:31], a[40:43], v[208:211]
  buffer_load_dwordx4 a[156:159], v28, s[8:11], s79 offen offset:0 sc1
  v_mfma_f32_16x16x32_bf16 v[224:227], a[32:35], a[40:43], v[224:227]
  v_xor_b32 v5, s96, v71
  v_mfma_f32_16x16x32_bf16 v[228:231], a[32:35], a[44:47], v[228:231]
  v_mfma_f32_16x16x32_bf16 v[232:235], a[32:35], a[48:51], v[232:235]
  v_or_b32 v4, v4, v5
  v_mfma_f32_16x16x32_bf16 v[236:239], a[32:35], a[52:55], v[236:239]
  buffer_load_dwordx4 a[160:163], v28, s[8:11], s79 offen offset:1024 sc1
  v_mfma_f32_16x16x32_bf16 v[252:255], a[36:39], a[52:55], v[252:255]
  v_cmp_ne_u32 vcc, 0, v4
  v_mfma_f32_16x16x32_bf16 v[248:251], a[36:39], a[48:51], v[248:251]
  v_mfma_f32_16x16x32_bf16 v[244:247], a[36:39], a[44:47], v[244:247]
  v_mfma_f32_16x16x32_bf16 v[240:243], a[36:39], a[40:43], v[240:243]
  s_cbranch_vccz FAG_ok
  s_mov_b32 s7, 0x40000
FAG_l:
  s_mul_i32 s75, s72, 1728
  s_mul_i32 s76, s71, 80
  s_add_u32 s75, s75, s76
  s_add_u32 s75, s75, s70
  s_lshl_b32 s75, s75, 3
  s_add_u32 s75, s75, 851968
  s_add_u32 s76, s75, 27648
  v_min_u32 v2, 624, v28
  buffer_load_dwordx4 v[56:59], v2, s[8:11], s75 offen sc1
  buffer_load_dwordx4 v[60:63], v2, s[8:11], s76 offen sc1
  v_and_b32 v2, 7, v1
  v_lshlrev_b32 v2, 3, v2
  v_and_b32 v3, 8, v1
  v_lshl_add_u32 v2, v3, 4, v2
  s_lshl1_add_u32 s75, s68, s71
  s_lshl_b32 s75, s75, 10
  s_add_u32 s75, s75, 196608
  buffer_load_dwordx2 v[64:65], v2, s[8:11], s75 offen offset:0 sc1
  buffer_load_dwordx2 v[66:67], v2, s[8:11], s75 offen offset:256 sc1
  buffer_load_dwordx2 v[68:69], v2, s[8:11], s75 offen offset:512 sc1
  buffer_load_dwordx2 v[70:71], v2, s[8:11], s75 offen offset:768 sc1
  s_waitcnt vmcnt(0)
  v_xor_b32 v4, s96, v57
  v_xor_b32 v5, s96, v59
  v_or_b32 v4, v4, v5
  v_xor_b32 v5, s96, v61
  v_or_b32 v4, v4, v5
  v_xor_b32 v5, s96, v63
  v_or_b32 v4, v4, v5
  v_xor_b32 v5, s96, v65
  v_or_b32 v4, v4, v5
  v_xor_b32 v5, s96, v67
  v_or_b32 v4, v4, v5
  v_xor_b32 v5, s96, v69
  v_or_b32 v4, v4, v5
  v_xor_b32 v5, s96, v71
  v_or_b32 v4, v4, v5
  v_cmp_ne_u32 vcc, 0, v4
  s_sub_u32 s7, s7, 1
  s_cbranch_scc1 FAG_ok
  s_cbranch_vccnz FAG_l
FAG_ok:
  s_waitcnt vmcnt(8)
  v_cmp_ne_u32 vcc, s96, v9
  s_cbranch_vccz FAP_ok
  s_mov_b32 s7, 0x40000
FAP_l:
  s_mul_i32 s31, s29, 7680
  s_add_u32 s31, s31, 720896
  s_mul_i32 s32, s81, 5
  s_cmp_eq_u32 s3, 3
  s_cselect_b32 s33, 2, 63
  v_lshrrev_b32 v9, 1, v1
  v_min_u32 v9, 6, v9
  v_cmp_eq_u32 vcc, s33, v9
  v_and_b32 v2, 1, v1
  v_lshl_add_u32 v2, v2, 2, s32
  v_cndmask_b32 v9, v9, 1, vcc
  v_lshrrev_b32 v2, 3, v2
  v_mad_u32_u24 v9, v9, 5, v2
  v_lshlrev_b32 v9, 7, v9
  buffer_load_dword v9, v9, s[8:11], s31 offen sc1
  s_waitcnt vmcnt(0)
  v_cmp_ne_u32 vcc, s96, v9
  s_sub_u32 s7, s7, 1
  s_cbranch_scc1 FAP_ok
  s_cbranch_vccnz FAP_l
FAP_ok:
  s_waitcnt lgkmcnt(0)
  s_barrier
  v_mfma_f32_16x16x32_bf16 v[96:99], a[56:59], a[96:99], v[96:99]
  buffer_load_dwordx4 a[164:167], v28, s[8:11], s79 offen offset:2048 sc1
  v_mfma_f32_16x16x32_bf16 v[100:103], a[56:59], a[100:103], v[100:103]
  ds_read_b128 a[40:43], v26 offset:0
  ds_read_b128 a[44:47], v26 offset:2048
  v_mfma_f32_16x16x32_bf16 v[104:107], a[56:59], a[104:107], v[104:107]
  v_add_f32 v56, v56, v60
  ds_read_b128 a[48:51], v26 offset:4096
  v_mfma_f32_16x16x32_bf16 v[108:111], a[56:59], a[108:111], v[108:111]
  buffer_load_dwordx4 a[168:171], v28, s[8:11], s79 offen offset:3072 sc1
  v_mfma_f32_16x16x32_bf16 v[124:127], a[60:63], a[108:111], v[124:127]
  v_add_f32 v57, v58, v62
  ds_read_b128 a[52:55], v26 offset:6144
  v_mfma_f32_16x16x32_bf16 v[120:123], a[60:63], a[104:107], v[120:123]
  s_lshl_b32 s75, s72, 10
  s_mul_i32 s76, s71, 320
  v_mfma_f32_16x16x32_bf16 v[116:119], a[60:63], a[100:103], v[116:119]
  ds_read_b64_tr_b16 a[0:1], v20 offset:40960
  ds_read_b64_tr_b16 a[2:3], v20 offset:42240
  v_mfma_f32_16x16x32_bf16 v[112:115], a[60:63], a[96:99], v[112:115]
  buffer_load_dwordx4 a[172:175], v29, s[8:11], s79 offen offset:0 sc1
  v_mfma_f32_16x16x32_bf16 v[128:131], a[64:67], a[96:99], v[128:131]
  s_add_u32 s75, s75, s76
  ds_read_b64_tr_b16 a[4:5], v20 offset:51200
  v_mfma_f32_16x16x32_bf16 v[132:135], a[64:67], a[100:103], v[132:135]
  s_add_u32 s75, s75, 131072
  ds_read_b64_tr_b16 a[6:7], v20 offset:52480
  v_mfma_f32_16x16x32_bf16 v[136:139], a[64:67], a[104:107], v[136:139]
  v_min_u32 v2, 39, v1
  ds_read_b64_tr_b16 a[8:9], v21 offset:40992
  v_mfma_f32_16x16x32_bf16 v[140:143], a[64:67], a[108:111], v[140:143]
  v_lshl_add_u32 v2, v2, 3, s75
  ds_read_b64_tr_b16 a[10:11], v21 offset:42272
  v_mfma_f32_16x16x32_bf16 v[156:159], a[68:71], a[108:111], v[156:159]
  s_add_u32 s79, s82, 51200
  ds_write_b64 v2, v[56:57]
  v_mfma_f32_16x16x32_bf16 v[152:155], a[68:71], a[104:107], v[152:155]
  ds_read_b64_tr_b16 a[12:13], v21 offset:51232
  v_lshlrev_b32 v44, 16, v64
  v_mfma_f32_16x16x32_bf16 v[148:151], a[68:71], a[100:103], v[148:151]
  ds_read_b64_tr_b16 a[14:15], v21 offset:52512
  v_and_b32 v52, 0xffff0000, v64
  v_mfma_f32_16x16x32_bf16 v[144:147], a[68:71], a[96:99], v[144:147]
  buffer_load_dwordx4 a[176:179], v28, s[8:11], s79 offen offset:0 sc1
  v_mfma_f32_16x16x32_bf16 v[160:163], a[72:75], a[96:99], v[160:163]
  ds_read_b64_tr_b16 a[16:17], v20 offset:41024
  v_rcp_f32 v48, v52
  v_mfma_f32_16x16x32_bf16 v[164:167], a[72:75], a[100:103], v[164:167]
  ds_read_b64_tr_b16 a[18:19], v20 offset:42304
  v_mfma_f32_16x16x32_bf16 v[168:171], a[72:75], a[104:107], v[168:171]
  v_mul_f32 v52, v52, v52
  ds_read_b64_tr_b16 a[20:21], v20 offset:51264
  v_mfma_f32_16x16x32_bf16 v[172:175], a[72:75], a[108:111], v[172:175]
  buffer_load_dwordx4 a[180:183], v28, s[8:11], s79 offen offset:1024 sc1
  v_mfma_f32_16x16x32_bf16 v[188:191], a[76:79], a[108:111], v[188:191]
  ds_read_b64_tr_b16 a[22:23], v20 offset:52544
  v_mul_f32 v48, 0xbfb8aa3b, v48
  v_mfma_f32_16x16x32_bf16 v[184:187], a[76:79], a[104:107], v[184:187]
  v_lshlrev_b32 v45, 16, v66
  ds_read_b64_tr_b16 a[24:25], v21 offset:41056
  v_mfma_f32_16x16x32_bf16 v[180:183], a[76:79], a[100:103], v[180:183]
  v_and_b32 v53, 0xffff0000, v66
  ds_read_b64_tr_b16 a[26:27], v21 offset:42336
  v_mfma_f32_16x16x32_bf16 v[176:179], a[76:79], a[96:99], v[176:179]
  buffer_load_dwordx4 a[184:187], v28, s[8:11], s79 offen offset:2048 sc1
  v_mfma_f32_16x16x32_bf16 v[192:195], a[80:83], a[96:99], v[192:195]
  v_rcp_f32 v49, v53
  v_mfma_f32_16x16x32_bf16 v[196:199], a[80:83], a[100:103], v[196:199]
  ds_read_b64_tr_b16 a[28:29], v21 offset:51296
  ds_read_b64_tr_b16 a[30:31], v21 offset:52576
  v_mfma_f32_16x16x32_bf16 v[200:203], a[80:83], a[104:107], v[200:203]
  v_mul_f32 v53, v53, v53
  v_mul_f32 v49, 0xbfb8aa3b, v49
  v_mfma_f32_16x16x32_bf16 v[204:207], a[80:83], a[108:111], v[204:207]
  buffer_load_dwordx4 a[188:191], v28, s[8:11], s79 offen offset:3072 sc1
  v_mfma_f32_16x16x32_bf16 v[220:223], a[84:87], a[108:111], v[220:223]
  ds_read_b64_tr_b16 a[32:33], v22 offset:40960
  v_lshlrev_b32 v46, 16, v68
  v_mfma_f32_16x16x32_bf16 v[216:219], a[84:87], a[104:107], v[216:219]
  ds_read_b64_tr_b16 a[34:35], v22 offset:42240
  ds_read_b64_tr_b16 a[36:37], v22 offset:51200
  v_mfma_f32_16x16x32_bf16 v[212:215], a[84:87], a[100:103], v[212:215]
  v_and_b32 v54, 0xffff0000, v68
  ds_read_b64_tr_b16 a[38:39], v22 offset:52480
  v_mfma_f32_16x16x32_bf16 v[208:211], a[84:87], a[96:99], v[208:211]
  buffer_load_dwordx4 a[192:195], v29, s[8:11], s79 offen offset:0 sc1
  v_mfma_f32_16x16x32_bf16 v[224:227], a[88:91], a[96:99], v[224:227]
  v_rcp_f32 v50, v54
  v_mfma_f32_16x16x32_bf16 v[228:231], a[88:91], a[100:103], v[228:231]
  v_mul_f32 v54, v54, v54
  v_mul_f32 v50, 0xbfb8aa3b, v50
  v_mfma_f32_16x16x32_bf16 v[232:235], a[88:91], a[104:107], v[232:235]
  v_lshlrev_b32 v47, 16, v70
  v_and_b32 v55, 0xffff0000, v70
  v_mfma_f32_16x16x32_bf16 v[236:239], a[88:91], a[108:111], v[236:239]
  s_add_u32 s79, s82, 56320
  v_rcp_f32 v51, v55
  v_mfma_f32_16x16x32_bf16 v[252:255], a[92:95], a[108:111], v[252:255]
  v_mul_f32 v55, v55, v55
  v_mfma_f32_16x16x32_bf16 v[248:251], a[92:95], a[104:107], v[248:251]
  v_mul_f32 v51, 0xbfb8aa3b, v51
  v_mfma_f32_16x16x32_bf16 v[244:247], a[92:95], a[100:103], v[244:247]
  v_mfma_f32_16x16x32_bf16 v[240:243], a[92:95], a[96:99], v[240:243]
  s_waitcnt lgkmcnt(0)
  s_barrier
  v_mfma_f32_16x16x32_bf16 v[96:99], a[0:3], a[40:43], v[96:99]
  buffer_load_dwordx4 a[196:199], v28, s[8:11], s79 offen offset:0 sc1
  v_mfma_f32_16x16x32_bf16 v[100:103], a[0:3], a[44:47], v[100:103]
  ds_read_b128 a[96:99], v27 offset:0
  ds_read_b128 a[100:103], v27 offset:2048
  v_mfma_f32_16x16x32_bf16 v[104:107], a[0:3], a[48:51], v[104:107]
  v_and_b32 v2, 48, v1
  ds_read_b128 a[104:107], v27 offset:4096
  v_mfma_f32_16x16x32_bf16 v[108:111], a[0:3], a[52:55], v[108:111]
  buffer_load_dwordx4 a[200:203], v28, s[8:11], s79 offen offset:1024 sc1
  v_mfma_f32_16x16x32_bf16 v[124:127], a[4:7], a[52:55], v[124:127]
  ds_read_b128 a[108:111], v27 offset:6144
  s_mul_i32 s75, s72, 384
  v_mfma_f32_16x16x32_bf16 v[120:123], a[4:7], a[48:51], v[120:123]
  ds_read_b64_tr_b16 a[56:57], v23 offset:0
  s_add_u32 s75, s75, 131072
  v_mfma_f32_16x16x32_bf16 v[116:119], a[4:7], a[44:47], v[116:119]
  ds_read_b64_tr_b16 a[58:59], v23 offset:1280
  v_mfma_f32_16x16x32_bf16 v[112:115], a[4:7], a[40:43], v[112:115]
  buffer_load_dwordx4 a[204:207], v28, s[8:11], s79 offen offset:2048 sc1
  v_mfma_f32_16x16x32_bf16 v[128:131], a[8:11], a[40:43], v[128:131]
  ds_read_b64_tr_b16 a[60:61], v23 offset:10240
  v_add_u32 v3, s75, v2
  v_mfma_f32_16x16x32_bf16 v[132:135], a[8:11], a[44:47], v[132:135]
  ds_read_b64_tr_b16 a[62:63], v23 offset:11520
  s_lshl_b32 s75, s72, 6
  v_mfma_f32_16x16x32_bf16 v[136:139], a[8:11], a[48:51], v[136:139]
  ds_read_b64_tr_b16 a[64:65], v24 offset:32
  v_mfma_f32_16x16x32_bf16 v[140:143], a[8:11], a[52:55], v[140:143]
  buffer_load_dwordx4 a[208:211], v28, s[8:11], s79 offen offset:3072 sc1
  v_mfma_f32_16x16x32_bf16 v[156:159], a[12:15], a[52:55], v[156:159]
  ds_read_b64_tr_b16 a[66:67], v24 offset:1312
  ds_read_b64_tr_b16 a[68:69], v24 offset:10272
  v_mfma_f32_16x16x32_bf16 v[152:155], a[12:15], a[48:51], v[152:155]
  s_add_u32 s75, s75, 131328
  ds_read_b64_tr_b16 a[70:71], v24 offset:11552
  v_mfma_f32_16x16x32_bf16 v[148:151], a[12:15], a[44:47], v[148:151]
  v_add_u32 v2, s75, v2
  v_mfma_f32_16x16x32_bf16 v[144:147], a[12:15], a[40:43], v[144:147]
  buffer_load_dwordx4 a[212:215], v29, s[8:11], s79 offen offset:0 sc1
  v_mfma_f32_16x16x32_bf16 v[160:163], a[16:19], a[40:43], v[160:163]
  ds_read_b64_tr_b16 a[72:73], v23 offset:64
  ds_read_b64_tr_b16 a[74:75], v23 offset:1344
  v_mfma_f32_16x16x32_bf16 v[164:167], a[16:19], a[44:47], v[164:167]
  ds_read_b128 v[56:59], v3 offset:0
  ds_read_b64_tr_b16 a[76:77], v23 offset:10304
  v_mfma_f32_16x16x32_bf16 v[168:171], a[16:19], a[48:51], v[168:171]
  ds_read_b64_tr_b16 a[78:79], v23 offset:11584
  ds_read_b128 v[60:63], v3 offset:1024
  v_mfma_f32_16x16x32_bf16 v[172:175], a[16:19], a[52:55], v[172:175]
  s_add_u32 s79, s82, 0
  v_mfma_f32_16x16x32_bf16 v[188:191], a[20:23], a[52:55], v[188:191]
  ds_read_b64_tr_b16 a[80:81], v24 offset:96
  v_mfma_f32_16x16x32_bf16 v[184:187], a[20:23], a[48:51], v[184:187]
  ds_read_b64_tr_b16 a[82:83], v24 offset:1376
  ds_read_b128 v[64:67], v3 offset:64
  v_mfma_f32_16x16x32_bf16 v[180:183], a[20:23], a[44:47], v[180:183]
  ds_read_b64_tr_b16 a[84:85], v24 offset:10336
  v_mfma_f32_16x16x32_bf16 v[176:179], a[20:23], a[40:43], v[176:179]
  buffer_load_dwordx4 a[216:219], v28, s[8:11], s79 offen offset:0 sc1
  v_mfma_f32_16x16x32_bf16 v[192:195], a[24:27], a[40:43], v[192:195]
  ds_read_b64_tr_b16 a[86:87], v24 offset:11616
  ds_read_b128 v[68:71], v3 offset:1088
  v_mfma_f32_16x16x32_bf16 v[196:199], a[24:27], a[44:47], v[196:199]
  ds_read_b64_tr_b16 a[88:89], v25 offset:0
  ds_read_b128 v[72:75], v3 offset:128
  v_mfma_f32_16x16x32_bf16 v[200:203], a[24:27], a[48:51], v[200:203]
  ds_read_b64_tr_b16 a[90:91], v25 offset:1280
  v_mfma_f32_16x16x32_bf16 v[204:207], a[24:27], a[52:55], v[204:207]
  buffer_load_dwordx4 a[220:223], v28, s[8:11], s79 offen offset:1024 sc1
  v_mfma_f32_16x16x32_bf16 v[220:223], a[28:31], a[52:55], v[220:223]
  ds_read_b64_tr_b16 a[92:93], v25 offset:10240
  ds_read_b128 v[76:79], v3 offset:1152
  v_mfma_f32_16x16x32_bf16 v[216:219], a[28:31], a[48:51], v[216:219]
  ds_read_b64_tr_b16 a[94:95], v25 offset:11520
  v_mfma_f32_16x16x32_bf16 v[212:215], a[28:31], a[44:47], v[212:215]
  ds_read_b128 v[80:83], v3 offset:192
  v_mfma_f32_16x16x32_bf16 v[208:211], a[28:31], a[40:43], v[208:211]
  buffer_load_dwordx4 a[224:227], v28, s[8:11], s79 offen offset:2048 sc1
  v_mfma_f32_16x16x32_bf16 v[224:227], a[32:35], a[40:43], v[224:227]
  ds_read_b128 v[84:87], v3 offset:1216
  v_mfma_f32_16x16x32_bf16 v[228:231], a[32:35], a[44:47], v[228:231]
  v_mfma_f32_16x16x32_bf16 v[232:235], a[32:35], a[48:51], v[232:235]
  ds_read_b128 v[88:91], v2 offset:0
  v_mfma_f32_16x16x32_bf16 v[236:239], a[32:35], a[52:55], v[236:239]
  buffer_load_dwordx4 a[228:231], v28, s[8:11], s79 offen offset:3072 sc1
  v_mfma_f32_16x16x32_bf16 v[252:255], a[36:39], a[52:55], v[252:255]
  ds_read_b128 v[92:95], v2 offset:1024
  v_mfma_f32_16x16x32_bf16 v[248:251], a[36:39], a[48:51], v[248:251]
  v_mfma_f32_16x16x32_bf16 v[244:247], a[36:39], a[44:47], v[244:247]
  v_mfma_f32_16x16x32_bf16 v[240:243], a[36:39], a[40:43], v[240:243]
  s_waitcnt lgkmcnt(0)
  s_barrier
  v_mfma_f32_16x16x32_bf16 v[96:99], a[56:59], a[96:99], v[96:99]
  buffer_load_dwordx4 a[232:235], v29, s[8:11], s79 offen offset:0 sc1
  v_mfma_f32_16x16x32_bf16 v[100:103], a[56:59], a[100:103], v[100:103]
  s_mov_b32 s24, s52
  s_mov_b32 s25, s53
  v_mfma_f32_16x16x32_bf16 v[104:107], a[56:59], a[104:107], v[104:107]
  s_mov_b32 s26, 0x500
  s_mov_b32 s27, 0x20000
  v_mfma_f32_16x16x32_bf16 v[108:111], a[56:59], a[108:111], v[108:111]
  s_mov_b32 s20, s62
  v_mfma_f32_16x16x32_bf16 v[124:127], a[60:63], a[108:111], v[124:127]
  s_mov_b32 s21, s63
  s_mov_b32 s22, 0x500000
  v_mfma_f32_16x16x32_bf16 v[120:123], a[60:63], a[104:107], v[120:123]
  s_add_u32 s79, s82, 5120
  s_mov_b32 s23, 0x20000
  v_mfma_f32_16x16x32_bf16 v[116:119], a[60:63], a[100:103], v[116:119]
  s_lshl1_add_u32 s32, s80, s28
  s_lshl_b32 s32, s32, 6
  v_mfma_f32_16x16x32_bf16 v[112:115], a[60:63], a[96:99], v[112:115]
  s_lshl_b32 s33, s3, 4
  s_add_u32 s32, s32, s33
  v_mfma_f32_16x16x32_bf16 v[128:131], a[64:67], a[96:99], v[128:131]
  v_and_b32 v2, 12, v1
  v_lshrrev_b32 v3, 4, v1
  v_mfma_f32_16x16x32_bf16 v[132:135], a[64:67], a[100:103], v[132:135]
  v_add_u32 v2, v2, v3
  v_mfma_f32_16x16x32_bf16 v[136:139], a[64:67], a[104:107], v[136:139]
  v_mul_u32_u24 v12, 160, v2
  v_add_u32 v2, s32, v2
  v_mfma_f32_16x16x32_bf16 v[140:143], a[64:67], a[108:111], v[140:143]
  buffer_load_dwordx4 a[236:239], v28, s[8:11], s79 offen offset:0 sc1
  v_mfma_f32_16x16x32_bf16 v[156:159], a[68:71], a[108:111], v[156:159]
  v_lshrrev_b32 v15, 3, v2
  v_lshlrev_b32 v15, 7, v15
  v_mfma_f32_16x16x32_bf16 v[152:155], a[68:71], a[104:107], v[152:155]
  v_and_b32 v3, 7, v2
  v_lshl_add_u32 v15, v3, 3, v15
  v_mfma_f32_16x16x32_bf16 v[148:151], a[68:71], a[100:103], v[148:151]
  v_mul_u32_u24 v2, 2560, v2
  s_mul_i32 s98, s81, 160
  v_mfma_f32_16x16x32_bf16 v[144:147], a[68:71], a[96:99], v[144:147]
  s_mul_i32 s97, s32, 1280
  s_add_u32 s97, s97, s98
  v_mfma_f32_16x16x32_bf16 v[160:163], a[72:75], a[96:99], v[160:163]
  buffer_load_dwordx4 a[240:243], v28, s[8:11], s79 offen offset:1024 sc1
  v_mfma_f32_16x16x32_bf16 v[164:167], a[72:75], a[100:103], v[164:167]
  s_lshl_b32 s33, s98, 1
  v_and_b32 v3, 3, v1
  v_mfma_f32_16x16x32_bf16 v[168:171], a[72:75], a[104:107], v[168:171]
  v_lshl_add_u32 v13, v3, 4, v2
  v_add_u32 v13, s33, v13
  v_mfma_f32_16x16x32_bf16 v[172:175], a[72:75], a[108:111], v[172:175]
  s_mul_i32 s101, s3, 20480
  s_add_u32 s100, s101, 81920
  v_mfma_f32_16x16x32_bf16 v[188:191], a[76:79], a[108:111], v[188:191]
  v_lshl_add_u32 v14, v3, 3, s100
  v_add_u32 v12, v12, v14
  v_mfma_f32_16x16x32_bf16 v[184:187], a[76:79], a[104:107], v[184:187]
  s_movk_i32 s33, 6554
  v_add_u32 v2, 0, v1
  v_mfma_f32_16x16x32_bf16 v[180:183], a[76:79], a[100:103], v[180:183]
  buffer_load_dwordx4 a[244:247], v28, s[8:11], s79 offen offset:2048 sc1
  v_mfma_f32_16x16x32_bf16 v[176:179], a[76:79], a[96:99], v[176:179]
  v_min_u32 v2, 159, v2
  v_mul_u32_u24 v3, s33, v2
  v_mfma_f32_16x16x32_bf16 v[192:195], a[80:83], a[96:99], v[192:195]
  v_lshrrev_b32 v3, 16, v3
  v_mul_u32_u24 v3, 1120, v3
  v_mfma_f32_16x16x32_bf16 v[196:199], a[80:83], a[100:103], v[196:199]
  v_lshl_add_u32 v16, v2, 4, v3
  v_add_u32 v2, 64, v1
  v_mfma_f32_16x16x32_bf16 v[200:203], a[80:83], a[104:107], v[200:203]
  v_min_u32 v2, 159, v2
  v_mul_u32_u24 v3, s33, v2
  v_mfma_f32_16x16x32_bf16 v[204:207], a[80:83], a[108:111], v[204:207]
  buffer_load_dwordx4 a[248:251], v28, s[8:11], s79 offen offset:3072 sc1
  v_mfma_f32_16x16x32_bf16 v[220:223], a[84:87], a[108:111], v[220:223]
  v_lshrrev_b32 v3, 16, v3
  v_mul_u32_u24 v3, 1120, v3
  v_mfma_f32_16x16x32_bf16 v[216:219], a[84:87], a[104:107], v[216:219]
  v_lshl_add_u32 v17, v2, 4, v3
  v_add_u32 v2, 128, v1
  v_mfma_f32_16x16x32_bf16 v[212:215], a[84:87], a[100:103], v[212:215]
  v_min_u32 v2, 159, v2
  v_mul_u32_u24 v3, s33, v2
  v_mfma_f32_16x16x32_bf16 v[208:211], a[84:87], a[96:99], v[208:211]
  v_lshrrev_b32 v3, 16, v3
  v_mul_u32_u24 v3, 1120, v3
  v_mfma_f32_16x16x32_bf16 v[224:227], a[88:91], a[96:99], v[224:227]
  v_lshl_add_u32 v18, v2, 4, v3
  v_min_u32 v19, 144, v28
  v_mfma_f32_16x16x32_bf16 v[228:231], a[88:91], a[100:103], v[228:231]
  buffer_load_dwordx4 a[252:255], v29, s[8:11], s79 offen offset:0 sc1
  v_mfma_f32_16x16x32_bf16 v[232:235], a[88:91], a[104:107], v[232:235]
  s_mul_i32 s75, s3, 5120
  v_add_u32 v23, s75, v28
  v_mfma_f32_16x16x32_bf16 v[236:239], a[88:91], a[108:111], v[236:239]
  v_add_u32 v24, 40960, v23
  s_mul_i32 s4, s95, 5120
  v_mfma_f32_16x16x32_bf16 v[252:255], a[92:95], a[108:111], v[252:255]
  s_add_u32 s4, s4, 5242880
  s_xor_b32 s5, s95, 4
  v_mfma_f32_16x16x32_bf16 v[248:251], a[92:95], a[104:107], v[248:251]
  s_mul_i32 s5, s5, 5120
  s_add_u32 s5, s5, 5242880
  v_mfma_f32_16x16x32_bf16 v[244:247], a[92:95], a[100:103], v[244:247]
  s_lshl_b32 s6, s95, 7
  s_add_u32 s6, s6, 524288
  v_mfma_f32_16x16x32_bf16 v[240:243], a[92:95], a[96:99], v[240:243]
  s_branch FFN_EP
FB_a:
TS_4:
  s_cbranch_execz TS_8
  s_sub_u32 s32, s32, s76
  s_lshl_b32 s35, s69, 2
  s_sub_u32 s35, s35, s34
  s_lshl2_add_u32 s34, s35, s32
  s_lshl2_add_u32 s32, s34, s3
  s_mul_i32 s34, s32, 52429
  s_lshr_b32 s34, s34, 18
  s_mul_i32 s33, s34, 5
  s_sub_u32 s33, s32, s33
  s_mul_i32 s99, s34, 40960
  s_lshl_b32 s35, s33, 8
  s_add_u32 s99, s99, s35
  s_lshl_b32 s101, s3, 13
TS_5:
  s_cbranch_execz TR_FB
  s_add_u32 s101, s101, 131072
  v_lshrrev_b32 v2, 4, v1
  v_mul_u32_u24 v30, 1280, v2
  v_and_b32 v3, 15, v1
  v_lshlrev_b32 v2, 1, v2
  v_xor_b32 v3, v3, v2
  v_lshl_add_u32 v30, v3, 4, v30
  v_xor_b32 v31, 128, v30
  s_mov_b32 s20, s60
  s_mov_b32 s21, s61
  s_mov_b32 s22, 0x21c000
  s_mov_b32 s23, 0x20000
  s_mov_b32 s8, s66
  s_mov_b32 s9, s67
  s_mov_b32 s10, 0x1a00000
  s_mov_b32 s11, 0x20000
  v_lshlrev_b32 v28, 4, v1
  v_add_u32 v29, 4096, v28
  v_lshlrev_b32 v8, 20, v1
  v_and_b32 v8, 0xfe000000, v8
  v_lshl_add_u32 v8, v1, 2, v8
  v_lshrrev_b32 v2, 4, v1
  v_bfe_u32 v3, v1, 2, 2
  v_lshl_add_u32 v3, v2, 3, v3
  v_mul_u32_u24 v3, 320, v3
  v_and_b32 v4, 3, v1
  v_lshl_add_u32 v3, v4, 3, v3
  v_and_b32 v4, 1, v2
  v_lshlrev_b32 v4, 5, v4
  s_mul_i32 s75, s72, 192
  v_add_u32 v5, s75, v3
  v_add_u32 v20, v5, v4
  v_sub_u32 v21, v5, v4
  s_lshl_b32 s75, s72, 5
  s_add_u32 s75, s75, 128
  v_xor_b32 v5, s75, v4
  v_add_u32 v22, v3, v5
  v_add_u32 v23, 61440, v20
  v_add_u32 v24, 61440, v21
  v_add_u32 v25, 61440, v22
  v_and_b32 v3, 15, v1
  v_lshrrev_b32 v4, 1, v3
  v_xor_b32 v4, v4, v2
  v_lshlrev_b32 v4, 4, v4
  v_lshl_add_u32 v3, v3, 7, v4
  s_lshl_b32 s75, s71, 13
  s_add_u32 s75, s75, 81920
  v_add_u32 v26, s75, v3
  v_xor_b32 v27, 64, v26
  s_waitcnt vmcnt(9)
  v_lshlrev_b32 v42, 16, v32
  s_add_u32 m0, s73, 20480
  v_and_b32 v43, 0xffff0000, v32
  v_lshlrev_b32 v44, 16, v33
  v_and_b32 v45, 0xffff0000, v33
  v_lshlrev_b32 v46, 16, v34
  v_and_b32 v47, 0xffff0000, v34
  v_lshlrev_b32 v48, 16, v35
  v_and_b32 v49, 0xffff0000, v35
  v_lshlrev_b32 v50, 16, v36
  v_and_b32 v51, 0xffff0000, v36
  s_mov_b32 s77, 110592
  v_lshlrev_b32 v52, 16, v37
  v_and_b32 v53, 0xffff0000, v37
  v_lshlrev_b32 v54, 16, v38
  v_and_b32 v55, 0xffff0000, v38
  v_lshlrev_b32 v56, 16, v39
  v_and_b32 v57, 0xffff0000, v39
  v_lshlrev_b32 v58, 16, v40
  v_and_b32 v59, 0xffff0000, v40
  v_lshlrev_b32 v60, 16, v41
  buffer_load_dwordx4 v10, s[12:15], s77 offen offset:0 lds
  v_and_b32 v61, 0xffff0000, v41
  v_pk_add_f32 v[62:63], v[42:43], v[44:45] op_sel_hi:[1,1]
  v_pk_add_f32 v[62:63], v[62:63], v[46:47] op_sel_hi:[1,1]
  v_pk_add_f32 v[62:63], v[62:63], v[48:49] op_sel_hi:[1,1]
  v_pk_add_f32 v[62:63], v[62:63], v[50:51] op_sel_hi:[1,1]
  v_pk_add_f32 v[62:63], v[62:63], v[52:53] op_sel_hi:[1,1]
  v_pk_add_f32 v[62:63], v[62:63], v[54:55] op_sel_hi:[1,1]
  v_pk_add_f32 v[62:63], v[62:63], v[56:57] op_sel_hi:[1,1]
  v_pk_add_f32 v[62:63], v[62:63], v[58:59] op_sel_hi:[1,1]
  buffer_load_dwordx4 v11, s[12:15], s77 offen offset:1024 lds
  v_pk_add_f32 v[62:63], v[62:63], v[60:61] op_sel_hi:[1,1]
  v_add_f32 v62, v62, v63
  s_nop 1
  v_add_f32_dpp v62, v62, v62 row_ror:8 row_mask:0xf bank_mask:0xf
  s_nop 1
  v_add_f32_dpp v62, v62, v62 row_ror:4 row_mask:0xf bank_mask:0xf
  s_nop 1
  v_add_f32_dpp v62, v62, v62 row_ror:2 row_mask:0xf bank_mask:0xf
  s_nop 1
  v_add_f32_dpp v62, v62, v62 row_ror:1 row_mask:0xf bank_mask:0xf
  v_mov_b32 v63, v62
  s_nop 1
  v_permlane16_swap_b32 v62, v63
  v_add_f32 v62, v62, v63
  v_mul_f32 v62, 0x3acccccd, v62
  buffer_load_dwordx4 v12, s[12:15], s77 offen offset:2048 lds
  v_pk_add_f32 v[42:43], v[42:43], v[62:63] op_sel_hi:[1,0] neg_lo:[0,1] neg_hi:[0,1]
  v_pk_add_f32 v[44:45], v[44:45], v[62:63] op_sel_hi:[1,0] neg_lo:[0,1] neg_hi:[0,1]
  v_pk_add_f32 v[46:47], v[46:47], v[62:63] op_sel_hi:[1,0] neg_lo:[0,1] neg_hi:[0,1]
  v_pk_add_f32 v[48:49], v[48:49], v[62:63] op_sel_hi:[1,0] neg_lo:[0,1] neg_hi:[0,1]
  v_pk_add_f32 v[50:51], v[50:51], v[62:63] op_sel_hi:[1,0] neg_lo:[0,1] neg_hi:[0,1]
  v_pk_add_f32 v[52:53], v[52:53], v[62:63] op_sel_hi:[1,0] neg_lo:[0,1] neg_hi:[0,1]
  v_pk_add_f32 v[54:55], v[54:55], v[62:63] op_sel_hi:[1,0] neg_lo:[0,1] neg_hi:[0,1]
  v_pk_add_f32 v[56:57], v[56:57], v[62:63] op_sel_hi:[1,0] neg_lo:[0,1] neg_hi:[0,1]
  v_pk_add_f32 v[58:59], v[58:59], v[62:63] op_sel_hi:[1,0] neg_lo:[0,1] neg_hi:[0,1]
  buffer_load_dwordx4 v13, s[12:15], s77 offen offset:3072 lds
  v_pk_add_f32 v[60:61], v[60:61], v[62:63] op_sel_hi:[1,0] neg_lo:[0,1] neg_hi:[0,1]
  v_pk_mul_f32 v[64:65], v[42:43], v[42:43] op_sel_hi:[1,1]
  v_pk_fma_f32 v[64:65], v[44:45], v[44:45], v[64:65] op_sel_hi:[1,1,1]
  v_pk_fma_f32 v[64:65], v[46:47], v[46:47], v[64:65] op_sel_hi:[1,1,1]
  v_pk_fma_f32 v[64:65], v[48:49], v[48:49], v[64:65] op_sel_hi:[1,1,1]
  v_pk_fma_f32 v[64:65], v[50:51], v[50:51], v[64:65] op_sel_hi:[1,1,1]
  v_pk_fma_f32 v[64:65], v[52:53], v[52:53], v[64:65] op_sel_hi:[1,1,1]
  v_pk_fma_f32 v[64:65], v[54:55], v[54:55], v[64:65] op_sel_hi:[1,1,1]
  v_pk_fma_f32 v[64:65], v[56:57], v[56:57], v[64:65] op_sel_hi:[1,1,1]
  s_add_u32 m0, s73, 24576
  v_pk_fma_f32 v[64:65], v[58:59], v[58:59], v[64:65] op_sel_hi:[1,1,1]
  v_pk_fma_f32 v[64:65], v[60:61], v[60:61], v[64:65] op_sel_hi:[1,1,1]
  v_add_f32 v64, v64, v65
  s_nop 1
  v_add_f32_dpp v64, v64, v64 row_ror:8 row_mask:0xf bank_mask:0xf
  s_nop 1
  v_add_f32_dpp v64, v64, v64 row_ror:4 row_mask:0xf bank_mask:0xf
  s_nop 1
  v_add_f32_dpp v64, v64, v64 row_ror:2 row_mask:0xf bank_mask:0xf
  s_nop 1
  v_add_f32_dpp v64, v64, v64 row_ror:1 row_mask:0xf bank_mask:0xf
  v_mov_b32 v65, v64
  s_nop 1
  v_permlane16_swap_b32 v64, v65
  buffer_load_dwordx4 v14, s[12:15], s77 offen offset:0 lds
  v_add_f32 v64, v64, v65
  v_mul_f32 v64, 0x3acccccd, v64
  v_cvt_pk_bf16_f32 v62, v62, v64
  v_and_b32 v64, 0xffff0000, v62
  v_add_f32 v64, 0x3727c5ac, v64
  v_cvt_pk_bf16_f32 v64, v64, v64
  v_and_b32 v64, 0xffff0000, v64
  v_sqrt_f32 v64, v64
  v_and_b32 v62, 0xffff, v62
  v_cvt_pk_bf16_f32 v64, v64, v64
  v_readfirstlane_b32 s96, v9
  v_and_b32 v64, 0xffff0000, v64
  v_or_b32 v62, v64, v62
  v_lshrrev_b32 v63, 5, v0
  v_lshlrev_b32 v63, 2, v63
  v_add_u32 v63, 114688, v63
  s_add_u32 s96, s96, 1
  ds_write_b32 v63, v62
  s_mov_b64 exec, 0
  s_mov_b32 s92, 2
  s_cmp_eq_u32 s3, 0
  s_cbranch_scc1 TS_9
  s_cmp_eq_u32 s3, 1
  s_cbranch_scc1 TS_10
  s_cmp_eq_u32 s3, 2
  s_cbranch_scc1 TS_11
  s_branch TS_18
TR_P2:
  s_mov_b64 exec, -1
  s_waitcnt vmcnt(5) lgkmcnt(0)
  s_barrier
  ds_read_b128 a[40:43], v26 offset:0
  ds_read_b128 a[44:47], v26 offset:2048
  ds_read_b128 a[48:51], v26 offset:4096
  ds_read_b128 a[52:55], v26 offset:6144
  ds_read_b64_tr_b16 a[0:1], v20 offset:0
  ds_read_b64_tr_b16 a[2:3], v20 offset:1280
  ds_read_b64_tr_b16 a[4:5], v20 offset:10240
  ds_read_b64_tr_b16 a[6:7], v20 offset:11520
  ds_read_b64_tr_b16 a[8:9], v21 offset:32
  ds_read_b64_tr_b16 a[10:11], v21 offset:1312
  ds_read_b64_tr_b16 a[12:13], v21 offset:10272
  ds_read_b64_tr_b16 a[14:15], v21 offset:11552
  ds_read_b64_tr_b16 a[16:17], v20 offset:64
  ds_read_b64_tr_b16 a[18:19], v20 offset:1344
  ds_read_b64_tr_b16 a[20:21], v20 offset:10304
  ds_read_b64_tr_b16 a[22:23], v20 offset:11584
  ds_read_b64_tr_b16 a[24:25], v21 offset:96
  ds_read_b64_tr_b16 a[26:27], v21 offset:1376
  ds_read_b64_tr_b16 a[28:29], v21 offset:10336
  ds_read_b64_tr_b16 a[30:31], v21 offset:11616
  ds_read_b64_tr_b16 a[32:33], v22 offset:0
  ds_read_b64_tr_b16 a[34:35], v22 offset:1280
  ds_read_b64_tr_b16 a[36:37], v22 offset:10240
  ds_read_b64_tr_b16 a[38:39], v22 offset:11520
  s_waitcnt vmcnt(0) lgkmcnt(0)
  s_barrier
  v_mfma_f32_16x16x32_bf16 v[96:99], a[0:3], a[40:43], 0
  ds_read_b128 a[96:99], v27 offset:0
  s_add_u32 m0, s74, 16384
  s_movk_i32 s78, 128
  v_mfma_f32_16x16x32_bf16 v[100:103], a[0:3], a[44:47], 0
  ds_read_b128 a[100:103], v27 offset:2048
  buffer_load_dwordx4 v15, s[16:19], s78 offen offset:0 lds
  v_and_b32 v63, 7, v1
  v_lshlrev_b32 v63, 2, v63
  v_mfma_f32_16x16x32_bf16 v[104:107], a[0:3], a[48:51], 0
  ds_read_b128 a[104:107], v27 offset:4096
  buffer_load_dwordx4 v16, s[16:19], s78 offen offset:1024 lds
  v_add_u32 v63, 114688, v63
  ds_read_b32 v62, v63
  v_mfma_f32_16x16x32_bf16 v[108:111], a[0:3], a[52:55], 0
  ds_read_b128 a[108:111], v27 offset:6144
  s_add_u32 m0, s74, 18432
  v_lshlrev_b32 v64, 21, v0
  v_and_b32 v64, 0xfe000000, v64
  v_mfma_f32_16x16x32_bf16 v[124:127], a[4:7], a[52:55], 0
  s_movk_i32 s78, 128
  v_lshl_add_u32 v64, v1, 3, v64
  s_lshl_b32 s75, s31, 7
  v_mfma_f32_16x16x32_bf16 v[120:123], a[4:7], a[48:51], 0
  ds_read_b64_tr_b16 a[56:57], v20 offset:20480
  buffer_load_dwordx4 v17, s[16:19], s78 offen offset:0 lds
  s_add_u32 s75, s75, 196608
  s_waitcnt lgkmcnt(2)
  v_mfma_f32_16x16x32_bf16 v[116:119], a[4:7], a[44:47], 0
  ds_read_b64_tr_b16 a[58:59], v20 offset:21760
  buffer_load_dwordx4 v18, s[16:19], s78 offen offset:1024 lds
  v_mov_b32 v63, s96
  buffer_store_dwordx2 v[62:63], v64, s[8:11], s75 offen sc1
  v_mfma_f32_16x16x32_bf16 v[112:115], a[4:7], a[40:43], 0
  ds_read_b64_tr_b16 a[60:61], v20 offset:30720
  s_add_u32 m0, s73, 40960
  s_mul_i32 s35, s34, 52429
  s_lshr_b32 s35, s35, 18
  v_mfma_f32_16x16x32_bf16 v[128:131], a[8:11], a[40:43], 0
  ds_read_b64_tr_b16 a[62:63], v20 offset:32000
  s_mov_b32 s77, 221184
  s_mul_i32 s75, s35, 5
  s_sub_u32 s75, s34, s75
  v_mfma_f32_16x16x32_bf16 v[132:135], a[8:11], a[44:47], 0
  buffer_load_dwordx4 v10, s[12:15], s77 offen offset:0 lds
  s_sub_u32 s76, s34, 49
  s_cmp_ge_u32 s34, 49
  s_cselect_b32 s35, 10, s35
  s_cselect_b32 s75, s76, s75
  v_mfma_f32_16x16x32_bf16 v[136:139], a[8:11], a[48:51], 0
  ds_read_b64_tr_b16 a[64:65], v21 offset:20512
  buffer_load_dwordx4 v11, s[12:15], s77 offen offset:1024 lds
  s_cmp_eq_u32 s75, 3
  s_cselect_b32 s76, 1, 0
  v_mfma_f32_16x16x32_bf16 v[140:143], a[8:11], a[52:55], 0
  s_lshl1_add_u32 s76, s35, s76
  ds_read_b64_tr_b16 a[66:67], v21 offset:21792
  buffer_load_dwordx4 v12, s[12:15], s77 offen offset:2048 lds
  s_cmp_ge_u32 s76, 11
  s_cselect_b32 s79, 11, 0
  s_cselect_b32 s100, 48, 0
  v_mfma_f32_16x16x32_bf16 v[156:159], a[12:15], a[52:55], 0
  s_sub_u32 s79, s76, s79
  ds_read_b64_tr_b16 a[68:69], v21 offset:30752
  buffer_load_dwordx4 v13, s[12:15], s77 offen offset:3072 lds
  v_mfma_f32_16x16x32_bf16 v[152:155], a[12:15], a[48:51], 0
  s_add_u32 s100, s100, s79
  s_mul_i32 s79, s79, 43
  ds_read_b64_tr_b16 a[70:71], v21 offset:32032
  s_add_u32 m0, s73, 45056
  v_mfma_f32_16x16x32_bf16 v[148:151], a[12:15], a[44:47], 0
  s_lshr_b32 s79, s79, 7
  s_mul_i32 s79, s79, 9
  buffer_load_dwordx4 v14, s[12:15], s77 offen offset:0 lds
  v_mfma_f32_16x16x32_bf16 v[144:147], a[12:15], a[40:43], 0
  s_add_u32 s100, s100, s79
  s_mul_i32 s76, s35, 3
  ds_read_b64_tr_b16 a[72:73], v20 offset:20544
  s_add_u32 m0, s101, 0
  v_mfma_f32_16x16x32_bf16 v[160:163], a[16:19], a[40:43], 0
  s_lshr_b32 s79, s75, 1
  s_add_u32 s76, s76, s79
  ds_read_b64_tr_b16 a[74:75], v20 offset:21824
  s_add_u32 s77, s99, 0
  v_mfma_f32_16x16x32_bf16 v[164:167], a[16:19], a[44:47], 0
  s_cmp_eq_u32 s35, 10
  s_cselect_b32 s79, 1, 0
  s_sub_u32 s76, s76, s79
  ds_read_b64_tr_b16 a[76:77], v20 offset:30784
  v_mfma_f32_16x16x32_bf16 v[168:171], a[16:19], a[48:51], 0
  buffer_load_dwordx4 v30, s[20:23], s77 offen lds
  s_lshr_b32 s79, s76, 2
  s_lshl_b32 s79, s79, 3
  v_mfma_f32_16x16x32_bf16 v[172:175], a[16:19], a[52:55], 0
  ds_read_b64_tr_b16 a[78:79], v20 offset:32064
  s_add_u32 m0, s101, 1024
  s_add_u32 s76, s76, s79
  s_add_u32 s76, s76, 3
  v_mfma_f32_16x16x32_bf16 v[188:191], a[20:23], a[52:55], 0
  s_add_u32 s77, s99, 5120
  s_lshr_b32 s79, 9, s75
  ds_read_b64_tr_b16 a[80:81], v21 offset:20576
  buffer_load_dwordx4 v31, s[20:23], s77 offen lds
  v_mfma_f32_16x16x32_bf16 v[184:187], a[20:23], a[48:51], 0
  s_bitcmp1_b32 s79, 0
  s_cselect_b32 s100, s100, s76
  s_mul_i32 s98, s100, 5
  ds_read_b64_tr_b16 a[82:83], v21 offset:21856
  v_mfma_f32_16x16x32_bf16 v[180:183], a[20:23], a[44:47], 0
  s_add_u32 m0, s101, 2048
  s_add_u32 s98, s98, s33
  s_lshl_b32 s98, s98, 7
  ds_read_b64_tr_b16 a[84:85], v21 offset:30816
  v_mfma_f32_16x16x32_bf16 v[176:179], a[20:23], a[40:43], 0
  s_add_u32 s77, s99, 10240
  s_add_u32 s98, s98, 720896
  s_mul_i32 s100, s100, 5120
  ds_read_b64_tr_b16 a[86:87], v21 offset:32096
  v_mfma_f32_16x16x32_bf16 v[192:195], a[24:27], a[40:43], 0
  buffer_load_dwordx4 v31, s[20:23], s77 offen lds
  s_lshl_b32 s79, s33, 13
  s_add_u32 s100, s100, s79
  v_mfma_f32_16x16x32_bf16 v[196:199], a[24:27], a[44:47], 0
  s_add_u32 m0, s101, 3072
  s_add_u32 s100, s100, 1048576
  s_cmp_lt_u32 s32, 270
  s_cselect_b32 s100, s100, 0x7f000000
  s_cselect_b32 s98, s98, 0x7f000000
  v_mfma_f32_16x16x32_bf16 v[200:203], a[24:27], a[48:51], 0
  ds_read_b64_tr_b16 a[88:89], v22 offset:20480
  s_add_u32 s77, s99, 15360
  s_cmp_eq_u32 s75, 2
  s_cselect_b32 s75, 8, 4
  s_cselect_b32 s76, 1, 4
  v_mfma_f32_16x16x32_bf16 v[204:207], a[24:27], a[52:55], 0
  s_lshl_b32 s76, s76, 10
  ds_read_b64_tr_b16 a[90:91], v22 offset:21760
  buffer_load_dwordx4 v30, s[20:23], s77 offen lds
  v_mfma_f32_16x16x32_bf16 v[220:223], a[28:31], a[52:55], 0
  v_lshrrev_b32 v2, 4, v1
  v_mul_u32_u24 v2, s75, v2
  ds_read_b64_tr_b16 a[92:93], v22 offset:30720
  s_add_u32 m0, s101, 4096
  v_mfma_f32_16x16x32_bf16 v[216:219], a[28:31], a[48:51], 0
  v_bfe_u32 v3, v1, 2, 2
  v_add_u32 v2, v2, v3
  ds_read_b64_tr_b16 a[94:95], v22 offset:32000
  s_add_u32 s77, s99, 20480
  v_mfma_f32_16x16x32_bf16 v[212:215], a[28:31], a[44:47], 0
  v_lshlrev_b32 v2, 8, v2
  v_and_b32 v3, 3, v1
  buffer_load_dwordx4 v30, s[20:23], s77 offen lds
  v_mfma_f32_16x16x32_bf16 v[208:211], a[28:31], a[40:43], 0
  v_lshl_add_u32 v2, v3, 3, v2
  v_mov_b32 v80, v2
  s_add_u32 m0, s101, 5120
  v_lshrrev_b32 v3, 1, v80
  v_mfma_f32_16x16x32_bf16 v[224:227], a[32:35], a[40:43], 0
  v_and_b32 v3, 0x400, v3
  s_add_u32 s77, s99, 25600
  v_xor_b32 v3, v3, v80
  v_bfe_u32 v3, v3, 8, 3
  v_mfma_f32_16x16x32_bf16 v[228:231], a[32:35], a[44:47], 0
  buffer_load_dwordx4 v31, s[20:23], s77 offen lds
  v_lshl_add_u32 v80, v3, 5, v80
  v_add_u32 v80, s101, v80
  v_mfma_f32_16x16x32_bf16 v[232:235], a[32:35], a[48:51], 0
  s_add_u32 m0, s101, 6144
  v_add_u32 v81, s76, v2
  v_lshrrev_b32 v3, 1, v81
  s_add_u32 s77, s99, 30720
  v_mfma_f32_16x16x32_bf16 v[236:239], a[32:35], a[52:55], 0
  v_and_b32 v3, 0x400, v3
  v_xor_b32 v3, v3, v81
  buffer_load_dwordx4 v31, s[20:23], s77 offen lds
  v_mfma_f32_16x16x32_bf16 v[252:255], a[36:39], a[52:55], 0
  v_bfe_u32 v3, v3, 8, 3
  v_lshl_add_u32 v81, v3, 5, v81
  s_add_u32 m0, s101, 7168
  v_mfma_f32_16x16x32_bf16 v[248:251], a[36:39], a[48:51], 0
  v_add_u32 v81, s101, v81
  s_mul_i32 s33, s33, 419432
  s_add_u32 s77, s99, 35840
  v_mfma_f32_16x16x32_bf16 v[244:247], a[36:39], a[44:47], 0
  s_add_u32 s79, s33, 0
  s_lshr_b32 s79, s79, 18
  buffer_load_dwordx4 v30, s[20:23], s77 offen lds
  v_mfma_f32_16x16x32_bf16 v[240:243], a[36:39], a[40:43], 0
  s_mul_i32 s79, s79, 486400
  s_waitcnt vmcnt(8) lgkmcnt(0)
  s_barrier
  v_mfma_f32_16x16x32_bf16 v[96:99], a[56:59], a[96:99], v[96:99]
  ds_read_b128 a[40:43], v26 offset:16384
  s_add_u32 m0, s73, 61440
  v_mfma_f32_16x16x32_bf16 v[100:103], a[56:59], a[100:103], v[100:103]
  ds_read_b128 a[44:47], v26 offset:18432
  s_add_u32 s4, s100, s79
  v_mfma_f32_16x16x32_bf16 v[104:107], a[56:59], a[104:107], v[104:107]
  ds_read_b128 a[48:51], v26 offset:20480
  s_mov_b32 s77, 331776
  v_mfma_f32_16x16x32_bf16 v[108:111], a[56:59], a[108:111], v[108:111]
  s_add_u32 s79, s33, 52429
  ds_read_b128 a[52:55], v26 offset:22528
  v_mfma_f32_16x16x32_bf16 v[124:127], a[60:63], a[108:111], v[124:127]
  buffer_load_dwordx4 v10, s[12:15], s77 offen offset:0 lds
  v_mfma_f32_16x16x32_bf16 v[120:123], a[60:63], a[104:107], v[120:123]
  s_lshr_b32 s79, s79, 18
  s_mul_i32 s79, s79, 486400
  v_mfma_f32_16x16x32_bf16 v[116:119], a[60:63], a[100:103], v[116:119]
  ds_read_b64_tr_b16 a[0:1], v20 offset:40960
  ds_read_b64_tr_b16 a[2:3], v20 offset:42240
  v_mfma_f32_16x16x32_bf16 v[112:115], a[60:63], a[96:99], v[112:115]
  buffer_load_dwordx4 v11, s[12:15], s77 offen offset:1024 lds
  v_mfma_f32_16x16x32_bf16 v[128:131], a[64:67], a[96:99], v[128:131]
  s_add_u32 s5, s100, s79
  ds_read_b64_tr_b16 a[4:5], v20 offset:51200
  v_mfma_f32_16x16x32_bf16 v[132:135], a[64:67], a[100:103], v[132:135]
  buffer_load_dwordx4 v12, s[12:15], s77 offen offset:2048 lds
  v_mfma_f32_16x16x32_bf16 v[136:139], a[64:67], a[104:107], v[136:139]
  s_add_u32 s79, s33, 104858
  ds_read_b64_tr_b16 a[6:7], v20 offset:52480
  v_mfma_f32_16x16x32_bf16 v[140:143], a[64:67], a[108:111], v[140:143]
  s_lshr_b32 s79, s79, 18
  ds_read_b64_tr_b16 a[8:9], v21 offset:40992
  v_mfma_f32_16x16x32_bf16 v[156:159], a[68:71], a[108:111], v[156:159]
  buffer_load_dwordx4 v13, s[12:15], s77 offen offset:3072 lds
  v_mfma_f32_16x16x32_bf16 v[152:155], a[68:71], a[104:107], v[152:155]
  s_mul_i32 s79, s79, 486400
  ds_read_b64_tr_b16 a[10:11], v21 offset:42272
  v_mfma_f32_16x16x32_bf16 v[148:151], a[68:71], a[100:103], v[148:151]
  s_add_u32 s6, s100, s79
  ds_read_b64_tr_b16 a[12:13], v21 offset:51232
  v_mfma_f32_16x16x32_bf16 v[144:147], a[68:71], a[96:99], v[144:147]
  s_add_u32 s79, s33, 157287
  ds_read_b64_tr_b16 a[14:15], v21 offset:52512
  v_mfma_f32_16x16x32_bf16 v[160:163], a[72:75], a[96:99], v[160:163]
  s_add_u32 m0, s73, 65536
  s_lshr_b32 s79, s79, 18
  v_mfma_f32_16x16x32_bf16 v[164:167], a[72:75], a[100:103], v[164:167]
  buffer_load_dwordx4 v14, s[12:15], s77 offen offset:0 lds
  v_mfma_f32_16x16x32_bf16 v[168:171], a[72:75], a[104:107], v[168:171]
  ds_read_b64_tr_b16 a[16:17], v20 offset:41024
  s_mul_i32 s79, s79, 486400
  v_mfma_f32_16x16x32_bf16 v[172:175], a[72:75], a[108:111], v[172:175]
  ds_read_b64_tr_b16 a[18:19], v20 offset:42304
  s_add_u32 s97, s100, s79
  v_mfma_f32_16x16x32_bf16 v[188:191], a[76:79], a[108:111], v[188:191]
  ds_read_b64_tr_b16 a[20:21], v20 offset:51264
  ds_read_b64_tr_b16 a[22:23], v20 offset:52544
  v_mfma_f32_16x16x32_bf16 v[184:187], a[76:79], a[104:107], v[184:187]
  s_add_u32 s79, s33, 209716
  s_add_u32 m0, s74, 32768
  v_mfma_f32_16x16x32_bf16 v[180:183], a[76:79], a[100:103], v[180:183]
  s_lshr_b32 s79, s79, 18
  ds_read_b64_tr_b16 a[24:25], v21 offset:41056
  v_mfma_f32_16x16x32_bf16 v[176:179], a[76:79], a[96:99], v[176:179]
  s_mul_i32 s79, s79, 486400
  ds_read_b64_tr_b16 a[26:27], v21 offset:42336
  v_mfma_f32_16x16x32_bf16 v[192:195], a[80:83], a[96:99], v[192:195]
  s_movk_i32 s78, 256
  s_add_u32 s24, s100, s79
  v_mfma_f32_16x16x32_bf16 v[196:199], a[80:83], a[100:103], v[196:199]
  buffer_load_dwordx4 v15, s[16:19], s78 offen offset:0 lds
  v_mfma_f32_16x16x32_bf16 v[200:203], a[80:83], a[104:107], v[200:203]
  buffer_load_dwordx4 v16, s[16:19], s78 offen offset:1024 lds
  v_mfma_f32_16x16x32_bf16 v[204:207], a[80:83], a[108:111], v[204:207]
  ds_read_b64_tr_b16 a[28:29], v21 offset:51296
  ds_read_b64_tr_b16 a[30:31], v21 offset:52576
  v_mfma_f32_16x16x32_bf16 v[220:223], a[84:87], a[108:111], v[220:223]
  s_add_u32 s79, s33, 262145
  s_lshr_b32 s79, s79, 18
  v_mfma_f32_16x16x32_bf16 v[216:219], a[84:87], a[104:107], v[216:219]
  ds_read_b64_tr_b16 a[32:33], v22 offset:40960
  s_mul_i32 s79, s79, 486400
  v_mfma_f32_16x16x32_bf16 v[212:215], a[84:87], a[100:103], v[212:215]
  ds_read_b64_tr_b16 a[34:35], v22 offset:42240
  ds_read_b64_tr_b16 a[36:37], v22 offset:51200
  v_mfma_f32_16x16x32_bf16 v[208:211], a[84:87], a[96:99], v[208:211]
  s_add_u32 s25, s100, s79
  ds_read_b64_tr_b16 a[38:39], v22 offset:52480
  v_mfma_f32_16x16x32_bf16 v[224:227], a[88:91], a[96:99], v[224:227]
  s_add_u32 s79, s33, 314574
  s_add_u32 m0, s74, 34816
  v_mfma_f32_16x16x32_bf16 v[228:231], a[88:91], a[100:103], v[228:231]
  s_lshr_b32 s79, s79, 18
  s_movk_i32 s78, 256
  v_mfma_f32_16x16x32_bf16 v[232:235], a[88:91], a[104:107], v[232:235]
  buffer_load_dwordx4 v17, s[16:19], s78 offen offset:0 lds
  v_mfma_f32_16x16x32_bf16 v[236:239], a[88:91], a[108:111], v[236:239]
  s_mul_i32 s79, s79, 486400
  s_add_u32 s26, s100, s79
  v_mfma_f32_16x16x32_bf16 v[252:255], a[92:95], a[108:111], v[252:255]
  buffer_load_dwordx4 v18, s[16:19], s78 offen offset:1024 lds
  v_mfma_f32_16x16x32_bf16 v[248:251], a[92:95], a[104:107], v[248:251]
  s_add_u32 s79, s33, 367003
  s_lshr_b32 s79, s79, 18
  v_mfma_f32_16x16x32_bf16 v[244:247], a[92:95], a[100:103], v[244:247]
  s_mul_i32 s79, s79, 486400
  s_add_u32 s27, s100, s79
  v_mfma_f32_16x16x32_bf16 v[240:243], a[92:95], a[96:99], v[240:243]
  s_waitcnt vmcnt(4) lgkmcnt(0)
  s_barrier
  v_mfma_f32_16x16x32_bf16 v[96:99], a[0:3], a[40:43], v[96:99]
  ds_read_b128 a[96:99], v27 offset:16384
  s_add_u32 m0, s73, 0
  v_mfma_f32_16x16x32_bf16 v[100:103], a[0:3], a[44:47], v[100:103]
  ds_read_b128 a[100:103], v27 offset:18432
  v_mfma_f32_16x16x32_bf16 v[104:107], a[0:3], a[48:51], v[104:107]
  ds_read_b128 a[104:107], v27 offset:20480
  s_mov_b32 s77, 442368
  v_xor_b32 v82, 0, v80
  v_mfma_f32_16x16x32_bf16 v[108:111], a[0:3], a[52:55], v[108:111]
  ds_read_b128 a[108:111], v27 offset:22528
  ds_read_b64_tr_b16 a[152:153], v82
  v_mfma_f32_16x16x32_bf16 v[124:127], a[4:7], a[52:55], v[124:127]
  buffer_load_dwordx4 v10, s[12:15], s77 offen offset:0 lds
  v_xor_b32 v83, 0, v81
  v_mfma_f32_16x16x32_bf16 v[120:123], a[4:7], a[48:51], v[120:123]
  ds_read_b64_tr_b16 a[56:57], v23 offset:0
  ds_read_b64_tr_b16 a[154:155], v83
  v_mfma_f32_16x16x32_bf16 v[116:119], a[4:7], a[44:47], v[116:119]
  ds_read_b64_tr_b16 a[58:59], v23 offset:1280
  v_xor_b32 v82, 32, v80
  v_mfma_f32_16x16x32_bf16 v[112:115], a[4:7], a[40:43], v[112:115]
  ds_read_b64_tr_b16 a[60:61], v23 offset:10240
  buffer_load_dwordx4 v11, s[12:15], s77 offen offset:1024 lds
  v_mfma_f32_16x16x32_bf16 v[128:131], a[8:11], a[40:43], v[128:131]
  ds_read_b64_tr_b16 a[156:157], v82
  ds_read_b64_tr_b16 a[62:63], v23 offset:11520
  v_mfma_f32_16x16x32_bf16 v[132:135], a[8:11], a[44:47], v[132:135]
  buffer_load_dwordx4 v12, s[12:15], s77 offen offset:2048 lds
  v_mfma_f32_16x16x32_bf16 v[136:139], a[8:11], a[48:51], v[136:139]
  v_xor_b32 v83, 32, v81
  ds_read_b64_tr_b16 a[64:65], v24 offset:32
  v_mfma_f32_16x16x32_bf16 v[140:143], a[8:11], a[52:55], v[140:143]
  ds_read_b64_tr_b16 a[158:159], v83
  ds_read_b64_tr_b16 a[66:67], v24 offset:1312
  v_mfma_f32_16x16x32_bf16 v[156:159], a[12:15], a[52:55], v[156:159]
  v_xor_b32 v82, 64, v80
  ds_read_b64_tr_b16 a[68:69], v24 offset:10272
  v_mfma_f32_16x16x32_bf16 v[152:155], a[12:15], a[48:51], v[152:155]
  buffer_load_dwordx4 v13, s[12:15], s77 offen offset:3072 lds
  v_mfma_f32_16x16x32_bf16 v[148:151], a[12:15], a[44:47], v[148:151]
  ds_read_b64_tr_b16 a[160:161], v82
  ds_read_b64_tr_b16 a[70:71], v24 offset:11552
  v_mfma_f32_16x16x32_bf16 v[144:147], a[12:15], a[40:43], v[144:147]
  v_xor_b32 v83, 64, v81
  s_add_u32 m0, s73, 4096
  v_mfma_f32_16x16x32_bf16 v[160:163], a[16:19], a[40:43], v[160:163]
  ds_read_b64_tr_b16 a[162:163], v83
  ds_read_b64_tr_b16 a[72:73], v23 offset:64
  v_mfma_f32_16x16x32_bf16 v[164:167], a[16:19], a[44:47], v[164:167]
  v_xor_b32 v82, 96, v80
  ds_read_b64_tr_b16 a[74:75], v23 offset:1344
  v_mfma_f32_16x16x32_bf16 v[168:171], a[16:19], a[48:51], v[168:171]
  ds_read_b64_tr_b16 a[76:77], v23 offset:10304
  buffer_load_dwordx4 v14, s[12:15], s77 offen offset:0 lds
  v_mfma_f32_16x16x32_bf16 v[172:175], a[16:19], a[52:55], v[172:175]
  ds_read_b64_tr_b16 a[164:165], v82
  v_mfma_f32_16x16x32_bf16 v[188:191], a[20:23], a[52:55], v[188:191]
  ds_read_b64_tr_b16 a[78:79], v23 offset:11584
  v_xor_b32 v83, 96, v81
  v_mfma_f32_16x16x32_bf16 v[184:187], a[20:23], a[48:51], v[184:187]
  s_add_u32 m0, s73, 20480
  ds_read_b64_tr_b16 a[166:167], v83
  v_mfma_f32_16x16x32_bf16 v[180:183], a[20:23], a[44:47], v[180:183]
  ds_read_b64_tr_b16 a[80:81], v24 offset:96
  v_xor_b32 v82, 128, v80
  v_mfma_f32_16x16x32_bf16 v[176:179], a[20:23], a[40:43], v[176:179]
  ds_read_b64_tr_b16 a[82:83], v24 offset:1376
  s_mov_b32 s77, 552960
  v_mfma_f32_16x16x32_bf16 v[192:195], a[24:27], a[40:43], v[192:195]
  ds_read_b64_tr_b16 a[168:169], v82
  ds_read_b64_tr_b16 a[84:85], v24 offset:10336
  v_mfma_f32_16x16x32_bf16 v[196:199], a[24:27], a[44:47], v[196:199]
  v_xor_b32 v83, 128, v81
  ds_read_b64_tr_b16 a[86:87], v24 offset:11616
  v_mfma_f32_16x16x32_bf16 v[200:203], a[24:27], a[48:51], v[200:203]
  buffer_load_dwordx4 v10, s[12:15], s77 offen offset:0 lds
  v_mfma_f32_16x16x32_bf16 v[204:207], a[24:27], a[52:55], v[204:207]
  ds_read_b64_tr_b16 a[170:171], v83
  ds_read_b64_tr_b16 a[88:89], v25 offset:0
  v_mfma_f32_16x16x32_bf16 v[220:223], a[28:31], a[52:55], v[220:223]
  v_xor_b32 v82, 160, v80
  ds_read_b64_tr_b16 a[90:91], v25 offset:1280
  v_mfma_f32_16x16x32_bf16 v[216:219], a[28:31], a[48:51], v[216:219]
  buffer_load_dwordx4 v11, s[12:15], s77 offen offset:1024 lds
  v_mfma_f32_16x16x32_bf16 v[212:215], a[28:31], a[44:47], v[212:215]
  ds_read_b64_tr_b16 a[172:173], v82
  ds_read_b64_tr_b16 a[92:93], v25 offset:10240
  v_mfma_f32_16x16x32_bf16 v[208:211], a[28:31], a[40:43], v[208:211]
  v_xor_b32 v83, 160, v81
  ds_read_b64_tr_b16 a[94:95], v25 offset:11520
  v_mfma_f32_16x16x32_bf16 v[224:227], a[32:35], a[40:43], v[224:227]
  ds_read_b64_tr_b16 a[174:175], v83
  buffer_load_dwordx4 v12, s[12:15], s77 offen offset:2048 lds
  v_mfma_f32_16x16x32_bf16 v[228:231], a[32:35], a[44:47], v[228:231]
  v_xor_b32 v82, 192, v80
  v_mfma_f32_16x16x32_bf16 v[232:235], a[32:35], a[48:51], v[232:235]
  ds_read_b64_tr_b16 a[176:177], v82
  buffer_load_dwordx4 v13, s[12:15], s77 offen offset:3072 lds
  v_mfma_f32_16x16x32_bf16 v[236:239], a[32:35], a[52:55], v[236:239]
  v_xor_b32 v83, 192, v81
  v_mfma_f32_16x16x32_bf16 v[252:255], a[36:39], a[52:55], v[252:255]
  ds_read_b64_tr_b16 a[178:179], v83
  s_add_u32 m0, s73, 24576
  v_mfma_f32_16x16x32_bf16 v[248:251], a[36:39], a[48:51], v[248:251]
  v_xor_b32 v82, 224, v80
TS_6:
  s_cbranch_execz TR_FB
  ds_read_b64_tr_b16 a[180:181], v82
  v_mfma_f32_16x16x32_bf16 v[244:247], a[36:39], a[44:47], v[244:247]
  buffer_load_dwordx4 v14, s[12:15], s77 offen offset:0 lds
  v_mfma_f32_16x16x32_bf16 v[240:243], a[36:39], a[40:43], v[240:243]
  v_xor_b32 v83, 224, v81
  ds_read_b64_tr_b16 a[182:183], v83
  s_waitcnt vmcnt(5) lgkmcnt(0)
  s_barrier
  v_mfma_f32_16x16x32_bf16 v[96:99], a[56:59], a[96:99], v[96:99]
  ds_read_b128 a[40:43], v26 offset:32768
  s_add_u32 m0, s74, 0
  v_mfma_f32_16x16x32_bf16 v[100:103], a[56:59], a[100:103], v[100:103]
  buffer_store_dwordx4 a[152:155], v28, s[8:11], s4 offen offset:0 sc1
  v_mfma_f32_16x16x32_bf16 v[104:107], a[56:59], a[104:107], v[104:107]
  ds_read_b128 a[44:47], v26 offset:34816
  ds_read_b128 a[48:51], v26 offset:36864
  v_mfma_f32_16x16x32_bf16 v[108:111], a[56:59], a[108:111], v[108:111]
  s_movk_i32 s78, 384
  ds_read_b128 a[52:55], v26 offset:38912
  v_mfma_f32_16x16x32_bf16 v[124:127], a[60:63], a[108:111], v[124:127]
  buffer_load_dwordx4 v15, s[16:19], s78 offen offset:0 lds
  v_mfma_f32_16x16x32_bf16 v[120:123], a[60:63], a[104:107], v[120:123]
  buffer_store_dwordx4 a[156:159], v28, s[8:11], s5 offen offset:1024 sc1
  v_mfma_f32_16x16x32_bf16 v[116:119], a[60:63], a[100:103], v[116:119]
  ds_read_b64_tr_b16 a[0:1], v20 offset:0
  ds_read_b64_tr_b16 a[2:3], v20 offset:1280
  v_mfma_f32_16x16x32_bf16 v[112:115], a[60:63], a[96:99], v[112:115]
  buffer_load_dwordx4 v16, s[16:19], s78 offen offset:1024 lds
  v_mfma_f32_16x16x32_bf16 v[128:131], a[64:67], a[96:99], v[128:131]
  ds_read_b64_tr_b16 a[4:5], v20 offset:10240
  ds_read_b64_tr_b16 a[6:7], v20 offset:11520
  v_mfma_f32_16x16x32_bf16 v[132:135], a[64:67], a[100:103], v[132:135]
  s_add_u32 m0, s74, 2048
  v_mfma_f32_16x16x32_bf16 v[136:139], a[64:67], a[104:107], v[136:139]
  buffer_store_dwordx4 a[160:163], v28, s[8:11], s6 offen offset:2048 sc1
  v_mfma_f32_16x16x32_bf16 v[140:143], a[64:67], a[108:111], v[140:143]
  ds_read_b64_tr_b16 a[8:9], v21 offset:32
  ds_read_b64_tr_b16 a[10:11], v21 offset:1312
  v_mfma_f32_16x16x32_bf16 v[156:159], a[68:71], a[108:111], v[156:159]
  ds_read_b64_tr_b16 a[12:13], v21 offset:10272
  s_movk_i32 s78, 384
  v_mfma_f32_16x16x32_bf16 v[152:155], a[68:71], a[104:107], v[152:155]
  ds_read_b64_tr_b16 a[14:15], v21 offset:11552
  v_mfma_f32_16x16x32_bf16 v[148:151], a[68:71], a[100:103], v[148:151]
  buffer_load_dwordx4 v17, s[16:19], s78 offen offset:0 lds
  v_mfma_f32_16x16x32_bf16 v[144:147], a[68:71], a[96:99], v[144:147]
  buffer_store_dwordx4 a[164:167], v28, s[8:11], s97 offen offset:3072 sc1
  v_mfma_f32_16x16x32_bf16 v[160:163], a[72:75], a[96:99], v[160:163]
  ds_read_b64_tr_b16 a[16:17], v20 offset:64
  ds_read_b64_tr_b16 a[18:19], v20 offset:1344
  v_mfma_f32_16x16x32_bf16 v[164:167], a[72:75], a[100:103], v[164:167]
  buffer_load_dwordx4 v18, s[16:19], s78 offen offset:1024 lds
  v_mfma_f32_16x16x32_bf16 v[168:171], a[72:75], a[104:107], v[168:171]
  ds_read_b64_tr_b16 a[20:21], v20 offset:10304
  ds_read_b64_tr_b16 a[22:23], v20 offset:11584
  v_mfma_f32_16x16x32_bf16 v[172:175], a[72:75], a[108:111], v[172:175]
  s_add_u32 m0, s73, 40960
  v_mfma_f32_16x16x32_bf16 v[188:191], a[76:79], a[108:111], v[188:191]
  buffer_store_dwordx4 a[168:171], v29, s[8:11], s24 offen offset:0 sc1
  v_mfma_f32_16x16x32_bf16 v[184:187], a[76:79], a[104:107], v[184:187]
  ds_read_b64_tr_b16 a[24:25], v21 offset:96
  ds_read_b64_tr_b16 a[26:27], v21 offset:1376
  v_mfma_f32_16x16x32_bf16 v[180:183], a[76:79], a[100:103], v[180:183]
  s_mov_b32 s77, 663552
  ds_read_b64_tr_b16 a[28:29], v21 offset:10336
  v_mfma_f32_16x16x32_bf16 v[176:179], a[76:79], a[96:99], v[176:179]
  ds_read_b64_tr_b16 a[30:31], v21 offset:11616
  v_mfma_f32_16x16x32_bf16 v[192:195], a[80:83], a[96:99], v[192:195]
  buffer_load_dwordx4 v10, s[12:15], s77 offen offset:0 lds
  v_mfma_f32_16x16x32_bf16 v[196:199], a[80:83], a[100:103], v[196:199]
  buffer_store_dwordx4 a[172:175], v29, s[8:11], s25 offen offset:1024 sc1
  v_mfma_f32_16x16x32_bf16 v[200:203], a[80:83], a[104:107], v[200:203]
  buffer_load_dwordx4 v11, s[12:15], s77 offen offset:1024 lds
  v_mfma_f32_16x16x32_bf16 v[204:207], a[80:83], a[108:111], v[204:207]
  ds_read_b64_tr_b16 a[32:33], v22 offset:0
  ds_read_b64_tr_b16 a[34:35], v22 offset:1280
  v_mfma_f32_16x16x32_bf16 v[220:223], a[84:87], a[108:111], v[220:223]
  ds_read_b64_tr_b16 a[36:37], v22 offset:10240
  ds_read_b64_tr_b16 a[38:39], v22 offset:11520
  v_mfma_f32_16x16x32_bf16 v[216:219], a[84:87], a[104:107], v[216:219]
  buffer_load_dwordx4 v12, s[12:15], s77 offen offset:2048 lds
  v_mfma_f32_16x16x32_bf16 v[212:215], a[84:87], a[100:103], v[212:215]
  buffer_store_dwordx4 a[176:179], v29, s[8:11], s26 offen offset:2048 sc1
  v_mfma_f32_16x16x32_bf16 v[208:211], a[84:87], a[96:99], v[208:211]
  buffer_load_dwordx4 v13, s[12:15], s77 offen offset:3072 lds
  v_mfma_f32_16x16x32_bf16 v[224:227], a[88:91], a[96:99], v[224:227]
  v_mfma_f32_16x16x32_bf16 v[228:231], a[88:91], a[100:103], v[228:231]
  v_mfma_f32_16x16x32_bf16 v[232:235], a[88:91], a[104:107], v[232:235]
  buffer_store_dwordx4 a[180:183], v29, s[8:11], s27 offen offset:3072 sc1
  v_mfma_f32_16x16x32_bf16 v[236:239], a[88:91], a[108:111], v[236:239]
  s_add_u32 m0, s73, 45056
  v_mfma_f32_16x16x32_bf16 v[252:255], a[92:95], a[108:111], v[252:255]
  buffer_load_dwordx4 v14, s[12:15], s77 offen offset:0 lds
  v_mfma_f32_16x16x32_bf16 v[248:251], a[92:95], a[104:107], v[248:251]
  v_mfma_f32_16x16x32_bf16 v[244:247], a[92:95], a[100:103], v[244:247]
  v_mfma_f32_16x16x32_bf16 v[240:243], a[92:95], a[96:99], v[240:243]
  s_waitcnt vmcnt(17) lgkmcnt(0)
  s_barrier
  v_mfma_f32_16x16x32_bf16 v[96:99], a[0:3], a[40:43], v[96:99]
  ds_read_b128 a[96:99], v27 offset:32768
  s_add_u32 m0, s73, 61440
  v_mfma_f32_16x16x32_bf16 v[100:103], a[0:3], a[44:47], v[100:103]
  ds_read_b128 a[100:103], v27 offset:34816
  v_mfma_f32_16x16x32_bf16 v[104:107], a[0:3], a[48:51], v[104:107]
  ds_read_b128 a[104:107], v27 offset:36864
  s_mov_b32 s77, 774144
  v_mfma_f32_16x16x32_bf16 v[108:111], a[0:3], a[52:55], v[108:111]
  ds_read_b128 a[108:111], v27 offset:38912
  v_mfma_f32_16x16x32_bf16 v[124:127], a[4:7], a[52:55], v[124:127]
  buffer_load_dwordx4 v10, s[12:15], s77 offen offset:0 lds
  v_mfma_f32_16x16x32_bf16 v[120:123], a[4:7], a[48:51], v[120:123]
  ds_read_b64_tr_b16 a[56:57], v20 offset:20480
  v_mfma_f32_16x16x32_bf16 v[116:119], a[4:7], a[44:47], v[116:119]
  ds_read_b64_tr_b16 a[58:59], v20 offset:21760
  v_mfma_f32_16x16x32_bf16 v[112:115], a[4:7], a[40:43], v[112:115]
  buffer_load_dwordx4 v11, s[12:15], s77 offen offset:1024 lds
  v_mfma_f32_16x16x32_bf16 v[128:131], a[8:11], a[40:43], v[128:131]
  ds_read_b64_tr_b16 a[60:61], v20 offset:30720
  ds_read_b64_tr_b16 a[62:63], v20 offset:32000
  v_mfma_f32_16x16x32_bf16 v[132:135], a[8:11], a[44:47], v[132:135]
  buffer_load_dwordx4 v12, s[12:15], s77 offen offset:2048 lds
  v_mfma_f32_16x16x32_bf16 v[136:139], a[8:11], a[48:51], v[136:139]
  ds_read_b64_tr_b16 a[64:65], v21 offset:20512
  v_mfma_f32_16x16x32_bf16 v[140:143], a[8:11], a[52:55], v[140:143]
  ds_read_b64_tr_b16 a[66:67], v21 offset:21792
  v_mfma_f32_16x16x32_bf16 v[156:159], a[12:15], a[52:55], v[156:159]
  buffer_load_dwordx4 v13, s[12:15], s77 offen offset:3072 lds
  v_mfma_f32_16x16x32_bf16 v[152:155], a[12:15], a[48:51], v[152:155]
  ds_read_b64_tr_b16 a[68:69], v21 offset:30752
  ds_read_b64_tr_b16 a[70:71], v21 offset:32032
  v_mfma_f32_16x16x32_bf16 v[148:151], a[12:15], a[44:47], v[148:151]
  s_add_u32 m0, s73, 65536
  v_mfma_f32_16x16x32_bf16 v[144:147], a[12:15], a[40:43], v[144:147]
  ds_read_b64_tr_b16 a[72:73], v20 offset:20544
  v_mfma_f32_16x16x32_bf16 v[160:163], a[16:19], a[40:43], v[160:163]
  ds_read_b64_tr_b16 a[74:75], v20 offset:21824
  v_mfma_f32_16x16x32_bf16 v[164:167], a[16:19], a[44:47], v[164:167]
  buffer_load_dwordx4 v14, s[12:15], s77 offen offset:0 lds
  v_mfma_f32_16x16x32_bf16 v[168:171], a[16:19], a[48:51], v[168:171]
  ds_read_b64_tr_b16 a[76:77], v20 offset:30784
  ds_read_b64_tr_b16 a[78:79], v20 offset:32064
  v_mfma_f32_16x16x32_bf16 v[172:175], a[16:19], a[52:55], v[172:175]
  s_add_u32 m0, s73, 0
  v_mfma_f32_16x16x32_bf16 v[188:191], a[20:23], a[52:55], v[188:191]
  ds_read_b64_tr_b16 a[80:81], v21 offset:20576
  v_mfma_f32_16x16x32_bf16 v[184:187], a[20:23], a[48:51], v[184:187]
  ds_read_b64_tr_b16 a[82:83], v21 offset:21856
  s_mov_b32 s77, 884736
  v_mfma_f32_16x16x32_bf16 v[180:183], a[20:23], a[44:47], v[180:183]
  ds_read_b64_tr_b16 a[84:85], v21 offset:30816
  v_mfma_f32_16x16x32_bf16 v[176:179], a[20:23], a[40:43], v[176:179]
  ds_read_b64_tr_b16 a[86:87], v21 offset:32096
  v_mfma_f32_16x16x32_bf16 v[192:195], a[24:27], a[40:43], v[192:195]
  buffer_load_dwordx4 v10, s[12:15], s77 offen offset:0 lds
  v_mfma_f32_16x16x32_bf16 v[196:199], a[24:27], a[44:47], v[196:199]
  ds_read_b64_tr_b16 a[88:89], v22 offset:20480
  v_mfma_f32_16x16x32_bf16 v[200:203], a[24:27], a[48:51], v[200:203]
  buffer_load_dwordx4 v11, s[12:15], s77 offen offset:1024 lds
  v_mfma_f32_16x16x32_bf16 v[204:207], a[24:27], a[52:55], v[204:207]
  ds_read_b64_tr_b16 a[90:91], v22 offset:21760
  ds_read_b64_tr_b16 a[92:93], v22 offset:30720
  v_mfma_f32_16x16x32_bf16 v[220:223], a[28:31], a[52:55], v[220:223]
  ds_read_b64_tr_b16 a[94:95], v22 offset:32000
  v_mfma_f32_16x16x32_bf16 v[216:219], a[28:31], a[48:51], v[216:219]
  buffer_load_dwordx4 v12, s[12:15], s77 offen offset:2048 lds
  v_mfma_f32_16x16x32_bf16 v[212:215], a[28:31], a[44:47], v[212:215]
  v_mfma_f32_16x16x32_bf16 v[208:211], a[28:31], a[40:43], v[208:211]
  buffer_load_dwordx4 v13, s[12:15], s77 offen offset:3072 lds
  v_mfma_f32_16x16x32_bf16 v[224:227], a[32:35], a[40:43], v[224:227]
  v_mfma_f32_16x16x32_bf16 v[228:231], a[32:35], a[44:47], v[228:231]
  v_mfma_f32_16x16x32_bf16 v[232:235], a[32:35], a[48:51], v[232:235]
  s_add_u32 m0, s73, 4096
  v_mfma_f32_16x16x32_bf16 v[236:239], a[32:35], a[52:55], v[236:239]
  v_mfma_f32_16x16x32_bf16 v[252:255], a[36:39], a[52:55], v[252:255]
  buffer_load_dwordx4 v14, s[12:15], s77 offen offset:0 lds
  v_mfma_f32_16x16x32_bf16 v[248:251], a[36:39], a[48:51], v[248:251]
  v_mfma_f32_16x16x32_bf16 v[244:247], a[36:39], a[44:47], v[244:247]
  v_mfma_f32_16x16x32_bf16 v[240:243], a[36:39], a[40:43], v[240:243]
  s_waitcnt vmcnt(10) lgkmcnt(0)
  s_barrier
  v_mfma_f32_16x16x32_bf16 v[96:99], a[56:59], a[96:99], v[96:99]
  ds_read_b128 a[40:43], v26 offset:0
  s_add_u32 m0, s74, 16384
  v_mfma_f32_16x16x32_bf16 v[100:103], a[56:59], a[100:103], v[100:103]
  ds_read_b128 a[44:47], v26 offset:2048
  s_and_b32 s28, s2, 1
  v_mfma_f32_16x16x32_bf16 v[104:107], a[56:59], a[104:107], v[104:107]
  ds_read_b128 a[48:51], v26 offset:4096
  s_movk_i32 s78, 512
  v_mfma_f32_16x16x32_bf16 v[108:111], a[56:59], a[108:111], v[108:111]
  s_bfe_u32 s32, s2, 0x20001
  ds_read_b128 a[52:55], v26 offset:6144
  v_mfma_f32_16x16x32_bf16 v[124:127], a[60:63], a[108:111], v[124:127]
  buffer_load_dwordx4 v15, s[16:19], s78 offen offset:0 lds
  v_mfma_f32_16x16x32_bf16 v[120:123], a[60:63], a[104:107], v[120:123]
  s_lshr_b32 s33, s2, 6
  ds_read_b64_tr_b16 a[0:1], v20 offset:40960
  v_mfma_f32_16x16x32_bf16 v[116:119], a[60:63], a[100:103], v[116:119]
  s_lshl2_add_u32 s80, s32, s33
  ds_read_b64_tr_b16 a[2:3], v20 offset:42240
  v_mfma_f32_16x16x32_bf16 v[112:115], a[60:63], a[96:99], v[112:115]
  buffer_load_dwordx4 v16, s[16:19], s78 offen offset:1024 lds
  v_mfma_f32_16x16x32_bf16 v[128:131], a[64:67], a[96:99], v[128:131]
  ds_read_b64_tr_b16 a[4:5], v20 offset:51200
  s_bfe_u32 s81, s2, 0x30003
  v_mfma_f32_16x16x32_bf16 v[132:135], a[64:67], a[100:103], v[132:135]
  ds_read_b64_tr_b16 a[6:7], v20 offset:52480
  s_add_u32 m0, s74, 18432
  v_mfma_f32_16x16x32_bf16 v[136:139], a[64:67], a[104:107], v[136:139]
  s_lshl2_add_u32 s29, s28, s3
  ds_read_b64_tr_b16 a[8:9], v21 offset:40992
  v_mfma_f32_16x16x32_bf16 v[140:143], a[64:67], a[108:111], v[140:143]
  s_mul_i32 s32, s29, 12
  ds_read_b64_tr_b16 a[10:11], v21 offset:42272
  v_mfma_f32_16x16x32_bf16 v[156:159], a[68:71], a[108:111], v[156:159]
  ds_read_b64_tr_b16 a[12:13], v21 offset:51232
  s_movk_i32 s78, 512
  v_mfma_f32_16x16x32_bf16 v[152:155], a[68:71], a[104:107], v[152:155]
  s_mul_i32 s33, s81, 96
  ds_read_b64_tr_b16 a[14:15], v21 offset:52512
  v_mfma_f32_16x16x32_bf16 v[148:151], a[68:71], a[100:103], v[148:151]
  buffer_load_dwordx4 v17, s[16:19], s78 offen offset:0 lds
  v_mfma_f32_16x16x32_bf16 v[144:147], a[68:71], a[96:99], v[144:147]
  s_add_u32 s33, s33, s32
  ds_read_b64_tr_b16 a[16:17], v20 offset:41024
  v_mfma_f32_16x16x32_bf16 v[160:163], a[72:75], a[96:99], v[160:163]
  s_mul_i32 s82, s33, 5120
  ds_read_b64_tr_b16 a[18:19], v20 offset:42304
  v_mfma_f32_16x16x32_bf16 v[164:167], a[72:75], a[100:103], v[164:167]
  buffer_load_dwordx4 v18, s[16:19], s78 offen offset:1024 lds
  v_mfma_f32_16x16x32_bf16 v[168:171], a[72:75], a[104:107], v[168:171]
  ds_read_b64_tr_b16 a[20:21], v20 offset:51264
  s_add_u32 s82, s82, 1048576
  v_mfma_f32_16x16x32_bf16 v[172:175], a[72:75], a[108:111], v[172:175]
  ds_read_b64_tr_b16 a[22:23], v20 offset:52544
  s_add_u32 m0, s73, 20480
  v_mfma_f32_16x16x32_bf16 v[188:191], a[76:79], a[108:111], v[188:191]
  s_lshl1_add_u32 s33, s80, s28
  ds_read_b64_tr_b16 a[24:25], v21 offset:41056
  v_mfma_f32_16x16x32_bf16 v[184:187], a[76:79], a[104:107], v[184:187]
  s_mul_i32 s34, s33, 96
  ds_read_b64_tr_b16 a[26:27], v21 offset:42336
  v_mfma_f32_16x16x32_bf16 v[180:183], a[76:79], a[100:103], v[180:183]
  s_mov_b32 s77, 995328
  ds_read_b64_tr_b16 a[28:29], v21 offset:51296
  v_mfma_f32_16x16x32_bf16 v[176:179], a[76:79], a[96:99], v[176:179]
  s_add_u32 s34, s34, s32
  ds_read_b64_tr_b16 a[30:31], v21 offset:52576
  v_mfma_f32_16x16x32_bf16 v[192:195], a[80:83], a[96:99], v[192:195]
  buffer_load_dwordx4 v10, s[12:15], s77 offen offset:0 lds
  v_mfma_f32_16x16x32_bf16 v[196:199], a[80:83], a[100:103], v[196:199]
  s_mul_i32 s83, s34, 4096
  ds_read_b64_tr_b16 a[32:33], v22 offset:40960
  v_mfma_f32_16x16x32_bf16 v[200:203], a[80:83], a[104:107], v[200:203]
  buffer_load_dwordx4 v11, s[12:15], s77 offen offset:1024 lds
  v_mfma_f32_16x16x32_bf16 v[204:207], a[80:83], a[108:111], v[204:207]
  s_add_u32 s83, s83, 10485760
  ds_read_b64_tr_b16 a[34:35], v22 offset:42240
  v_mfma_f32_16x16x32_bf16 v[220:223], a[84:87], a[108:111], v[220:223]
  ds_read_b64_tr_b16 a[36:37], v22 offset:51200
  s_xor_b32 s33, s33, 1
  v_mfma_f32_16x16x32_bf16 v[216:219], a[84:87], a[104:107], v[216:219]
  buffer_load_dwordx4 v12, s[12:15], s77 offen offset:2048 lds
  v_mfma_f32_16x16x32_bf16 v[212:215], a[84:87], a[100:103], v[212:215]
  ds_read_b64_tr_b16 a[38:39], v22 offset:52480
  s_mul_i32 s34, s33, 96
  v_mfma_f32_16x16x32_bf16 v[208:211], a[84:87], a[96:99], v[208:211]
  buffer_load_dwordx4 v13, s[12:15], s77 offen offset:3072 lds
  v_mfma_f32_16x16x32_bf16 v[224:227], a[88:91], a[96:99], v[224:227]
  s_add_u32 s34, s34, s32
  s_mul_i32 s30, s34, 4096
  v_mfma_f32_16x16x32_bf16 v[228:231], a[88:91], a[100:103], v[228:231]
  v_mfma_f32_16x16x32_bf16 v[232:235], a[88:91], a[104:107], v[232:235]
  s_add_u32 m0, s73, 24576
  s_add_u32 s30, s30, 10485760
  v_mfma_f32_16x16x32_bf16 v[236:239], a[88:91], a[108:111], v[236:239]
  s_lshl_b32 s93, s80, 14
  v_mfma_f32_16x16x32_bf16 v[252:255], a[92:95], a[108:111], v[252:255]
  buffer_load_dwordx4 v14, s[12:15], s77 offen offset:0 lds
  v_mfma_f32_16x16x32_bf16 v[248:251], a[92:95], a[104:107], v[248:251]
  s_add_u32 s93, s93, 262144
  v_mfma_f32_16x16x32_bf16 v[244:247], a[92:95], a[100:103], v[244:247]
  v_mfma_f32_16x16x32_bf16 v[240:243], a[92:95], a[96:99], v[240:243]
  s_waitcnt vmcnt(14) lgkmcnt(0)
  s_barrier
  v_mfma_f32_16x16x32_bf16 v[96:99], a[0:3], a[40:43], v[96:99]
  ds_read_b128 a[96:99], v27 offset:0
  s_add_u32 m0, s73, 40960
  v_mfma_f32_16x16x32_bf16 v[100:103], a[0:3], a[44:47], v[100:103]
  ds_read_b128 a[100:103], v27 offset:2048
  s_lshl1_add_u32 s32, s69, s72
  v_mfma_f32_16x16x32_bf16 v[104:107], a[0:3], a[48:51], v[104:107]
  ds_read_b128 a[104:107], v27 offset:4096
  s_mov_b32 s77, 1105920
  v_mfma_f32_16x16x32_bf16 v[108:111], a[0:3], a[52:55], v[108:111]
  ds_read_b128 a[108:111], v27 offset:6144
  s_cmp_ge_u32 s32, 11
  s_cselect_b32 s33, 11, 0
  s_cselect_b32 s84, 48, 0
  v_mfma_f32_16x16x32_bf16 v[124:127], a[4:7], a[52:55], v[124:127]
  v_mfma_f32_16x16x32_bf16 v[120:123], a[4:7], a[48:51], v[120:123]
  buffer_load_dwordx4 v10, s[12:15], s77 offen offset:0 lds
  v_mfma_f32_16x16x32_bf16 v[116:119], a[4:7], a[44:47], v[116:119]
  ds_read_b64_tr_b16 a[56:57], v23 offset:0
  s_sub_u32 s33, s32, s33
  v_mfma_f32_16x16x32_bf16 v[112:115], a[4:7], a[40:43], v[112:115]
  buffer_load_dwordx4 v11, s[12:15], s77 offen offset:1024 lds
  v_mfma_f32_16x16x32_bf16 v[128:131], a[8:11], a[40:43], v[128:131]
  ds_read_b64_tr_b16 a[58:59], v23 offset:1280
  ds_read_b64_tr_b16 a[60:61], v23 offset:10240
  v_mfma_f32_16x16x32_bf16 v[132:135], a[8:11], a[44:47], v[132:135]
  buffer_load_dwordx4 v12, s[12:15], s77 offen offset:2048 lds
  v_mfma_f32_16x16x32_bf16 v[136:139], a[8:11], a[48:51], v[136:139]
  s_add_u32 s84, s84, s33
  ds_read_b64_tr_b16 a[62:63], v23 offset:11520
  v_mfma_f32_16x16x32_bf16 v[140:143], a[8:11], a[52:55], v[140:143]
  s_mul_i32 s33, s33, 43
  ds_read_b64_tr_b16 a[64:65], v24 offset:32
  v_mfma_f32_16x16x32_bf16 v[156:159], a[12:15], a[52:55], v[156:159]
  buffer_load_dwordx4 v13, s[12:15], s77 offen offset:3072 lds
  v_mfma_f32_16x16x32_bf16 v[152:155], a[12:15], a[48:51], v[152:155]
  ds_read_b64_tr_b16 a[66:67], v24 offset:1312
  s_lshr_b32 s33, s33, 7
  v_mfma_f32_16x16x32_bf16 v[148:151], a[12:15], a[44:47], v[148:151]
  ds_read_b64_tr_b16 a[68:69], v24 offset:10272
  ds_read_b64_tr_b16 a[70:71], v24 offset:11552
  v_mfma_f32_16x16x32_bf16 v[144:147], a[12:15], a[40:43], v[144:147]
  s_mul_i32 s33, s33, 9
  s_add_u32 m0, s73, 45056
  v_mfma_f32_16x16x32_bf16 v[160:163], a[16:19], a[40:43], v[160:163]
  ds_read_b64_tr_b16 a[72:73], v23 offset:64
  s_add_u32 s84, s84, s33
  v_mfma_f32_16x16x32_bf16 v[164:167], a[16:19], a[44:47], v[164:167]
  buffer_load_dwordx4 v14, s[12:15], s77 offen offset:0 lds
  v_mfma_f32_16x16x32_bf16 v[168:171], a[16:19], a[48:51], v[168:171]
  ds_read_b64_tr_b16 a[74:75], v23 offset:1344
  ds_read_b64_tr_b16 a[76:77], v23 offset:10304
  v_mfma_f32_16x16x32_bf16 v[172:175], a[16:19], a[52:55], v[172:175]
  s_mul_i32 s33, s69, 3
  ds_read_b64_tr_b16 a[78:79], v23 offset:11584
  v_mfma_f32_16x16x32_bf16 v[188:191], a[20:23], a[52:55], v[188:191]
  s_add_u32 m0, s74, 32768
  s_cmp_eq_u32 s69, 10
  s_cselect_b32 s34, 1, 0
  v_mfma_f32_16x16x32_bf16 v[184:187], a[20:23], a[48:51], v[184:187]
  ds_read_b64_tr_b16 a[80:81], v24 offset:96
  v_mfma_f32_16x16x32_bf16 v[180:183], a[20:23], a[44:47], v[180:183]
  ds_read_b64_tr_b16 a[82:83], v24 offset:1376
  s_movk_i32 s78, 640
  v_mfma_f32_16x16x32_bf16 v[176:179], a[20:23], a[40:43], v[176:179]
  s_sub_u32 s33, s33, s34
  ds_read_b64_tr_b16 a[84:85], v24 offset:10336
  v_mfma_f32_16x16x32_bf16 v[192:195], a[24:27], a[40:43], v[192:195]
  buffer_load_dwordx4 v15, s[16:19], s78 offen offset:0 lds
  v_mfma_f32_16x16x32_bf16 v[196:199], a[24:27], a[44:47], v[196:199]
  ds_read_b64_tr_b16 a[86:87], v24 offset:11616
  s_lshl1_add_u32 s85, s72, s33
  v_mfma_f32_16x16x32_bf16 v[200:203], a[24:27], a[48:51], v[200:203]
  buffer_load_dwordx4 v16, s[16:19], s78 offen offset:1024 lds
  v_mfma_f32_16x16x32_bf16 v[204:207], a[24:27], a[52:55], v[204:207]
  ds_read_b64_tr_b16 a[88:89], v25 offset:0
  s_add_u32 s86, s33, 1
  v_mfma_f32_16x16x32_bf16 v[220:223], a[28:31], a[52:55], v[220:223]
  ds_read_b64_tr_b16 a[90:91], v25 offset:1280
  ds_read_b64_tr_b16 a[92:93], v25 offset:10240
  v_mfma_f32_16x16x32_bf16 v[216:219], a[28:31], a[48:51], v[216:219]
  s_lshr_b32 s34, s85, 2
  ds_read_b64_tr_b16 a[94:95], v25 offset:11520
  v_mfma_f32_16x16x32_bf16 v[212:215], a[28:31], a[44:47], v[212:215]
  s_add_u32 m0, s74, 34816
  s_lshl_b32 s34, s34, 3
  v_mfma_f32_16x16x32_bf16 v[208:211], a[28:31], a[40:43], v[208:211]
  s_movk_i32 s78, 640
  s_add_u32 s85, s85, s34
  v_mfma_f32_16x16x32_bf16 v[224:227], a[32:35], a[40:43], v[224:227]
  v_mfma_f32_16x16x32_bf16 v[228:231], a[32:35], a[44:47], v[228:231]
  s_add_u32 s85, s85, 3
  v_mfma_f32_16x16x32_bf16 v[232:235], a[32:35], a[48:51], v[232:235]
  buffer_load_dwordx4 v17, s[16:19], s78 offen offset:0 lds
  v_mfma_f32_16x16x32_bf16 v[236:239], a[32:35], a[52:55], v[236:239]
  s_lshr_b32 s34, s86, 2
  v_mfma_f32_16x16x32_bf16 v[252:255], a[36:39], a[52:55], v[252:255]
  buffer_load_dwordx4 v18, s[16:19], s78 offen offset:1024 lds
  v_mfma_f32_16x16x32_bf16 v[248:251], a[36:39], a[48:51], v[248:251]
  s_lshl_b32 s34, s34, 3
  v_mfma_f32_16x16x32_bf16 v[244:247], a[36:39], a[44:47], v[244:247]
  v_mfma_f32_16x16x32_bf16 v[240:243], a[36:39], a[40:43], v[240:243]
  s_waitcnt vmcnt(14) lgkmcnt(0)
  s_barrier
  v_mfma_f32_16x16x32_bf16 v[96:99], a[56:59], a[96:99], v[96:99]
  ds_read_b128 a[40:43], v26 offset:16384
  s_add_u32 m0, s73, 61440
  v_mfma_f32_16x16x32_bf16 v[100:103], a[56:59], a[100:103], v[100:103]
  ds_read_b128 a[44:47], v26 offset:18432
  v_mov_b32 v3, s96
  v_mfma_f32_16x16x32_bf16 v[104:107], a[56:59], a[104:107], v[104:107]
  ds_read_b128 a[48:51], v26 offset:20480
  v_mfma_f32_16x16x32_bf16 v[108:111], a[56:59], a[108:111], v[108:111]
  ds_read_b128 a[52:55], v26 offset:22528
  s_mov_b32 s77, 1216512
  v_mfma_f32_16x16x32_bf16 v[124:127], a[60:63], a[108:111], v[124:127]
  v_mfma_f32_16x16x32_bf16 v[120:123], a[60:63], a[104:107], v[120:123]
  ds_read_b64_tr_b16 a[0:1], v20 offset:0
  v_mfma_f32_16x16x32_bf16 v[116:119], a[60:63], a[100:103], v[116:119]
  buffer_load_dwordx4 v10, s[12:15], s77 offen offset:0 lds
  v_mfma_f32_16x16x32_bf16 v[112:115], a[60:63], a[96:99], v[112:115]
  ds_read_b64_tr_b16 a[2:3], v20 offset:1280
  ds_read_b64_tr_b16 a[4:5], v20 offset:10240
  v_mfma_f32_16x16x32_bf16 v[128:131], a[64:67], a[96:99], v[128:131]
  ds_read_b64_tr_b16 a[6:7], v20 offset:11520
  v_mfma_f32_16x16x32_bf16 v[132:135], a[64:67], a[100:103], v[132:135]
  buffer_load_dwordx4 v11, s[12:15], s77 offen offset:1024 lds
  v_mfma_f32_16x16x32_bf16 v[136:139], a[64:67], a[104:107], v[136:139]
  ds_read_b64_tr_b16 a[8:9], v21 offset:32
  v_mfma_f32_16x16x32_bf16 v[140:143], a[64:67], a[108:111], v[140:143]
  ds_read_b64_tr_b16 a[10:11], v21 offset:1312
  v_mfma_f32_16x16x32_bf16 v[156:159], a[68:71], a[108:111], v[156:159]
  ds_read_b64_tr_b16 a[12:13], v21 offset:10272
  v_mfma_f32_16x16x32_bf16 v[152:155], a[68:71], a[104:107], v[152:155]
  buffer_load_dwordx4 v12, s[12:15], s77 offen offset:2048 lds
  v_mfma_f32_16x16x32_bf16 v[148:151], a[68:71], a[100:103], v[148:151]
  ds_read_b64_tr_b16 a[14:15], v21 offset:11552
  v_mfma_f32_16x16x32_bf16 v[144:147], a[68:71], a[96:99], v[144:147]
  ds_read_b64_tr_b16 a[16:17], v20 offset:64
  v_mfma_f32_16x16x32_bf16 v[160:163], a[72:75], a[96:99], v[160:163]
  buffer_load_dwordx4 v13, s[12:15], s77 offen offset:3072 lds
  v_mfma_f32_16x16x32_bf16 v[164:167], a[72:75], a[100:103], v[164:167]
  ds_read_b64_tr_b16 a[18:19], v20 offset:1344
  ds_read_b64_tr_b16 a[20:21], v20 offset:10304
  v_mfma_f32_16x16x32_bf16 v[168:171], a[72:75], a[104:107], v[168:171]
  ds_read_b64_tr_b16 a[22:23], v20 offset:11584
  v_mfma_f32_16x16x32_bf16 v[172:175], a[72:75], a[108:111], v[172:175]
  s_add_u32 m0, s73, 65536
  v_mfma_f32_16x16x32_bf16 v[188:191], a[76:79], a[108:111], v[188:191]
  ds_read_b64_tr_b16 a[24:25], v21 offset:96
  v_mfma_f32_16x16x32_bf16 v[184:187], a[76:79], a[104:107], v[184:187]
  ds_read_b64_tr_b16 a[26:27], v21 offset:1376
  v_mfma_f32_16x16x32_bf16 v[180:183], a[76:79], a[100:103], v[180:183]
  buffer_load_dwordx4 v14, s[12:15], s77 offen offset:0 lds
  v_mfma_f32_16x16x32_bf16 v[176:179], a[76:79], a[96:99], v[176:179]
  ds_read_b64_tr_b16 a[28:29], v21 offset:10336
  ds_read_b64_tr_b16 a[30:31], v21 offset:11616
  v_mfma_f32_16x16x32_bf16 v[192:195], a[80:83], a[96:99], v[192:195]
  v_mfma_f32_16x16x32_bf16 v[196:199], a[80:83], a[100:103], v[196:199]
  ds_read_b64_tr_b16 a[32:33], v22 offset:0
  v_mfma_f32_16x16x32_bf16 v[200:203], a[80:83], a[104:107], v[200:203]
  buffer_store_dword v3, v8, s[8:11], s98 offen sc1
  v_mfma_f32_16x16x32_bf16 v[204:207], a[80:83], a[108:111], v[204:207]
  ds_read_b64_tr_b16 a[34:35], v22 offset:1280
  s_add_u32 m0, s74, 0
  v_mfma_f32_16x16x32_bf16 v[220:223], a[84:87], a[108:111], v[220:223]
  ds_read_b64_tr_b16 a[36:37], v22 offset:10240
  ds_read_b64_tr_b16 a[38:39], v22 offset:11520
  v_mfma_f32_16x16x32_bf16 v[216:219], a[84:87], a[104:107], v[216:219]
  s_movk_i32 s78, 768
  v_mfma_f32_16x16x32_bf16 v[212:215], a[84:87], a[100:103], v[212:215]
  v_mfma_f32_16x16x32_bf16 v[208:211], a[84:87], a[96:99], v[208:211]
  v_mfma_f32_16x16x32_bf16 v[224:227], a[88:91], a[96:99], v[224:227]
  buffer_load_dwordx4 v15, s[16:19], s78 offen offset:0 lds
  v_mfma_f32_16x16x32_bf16 v[228:231], a[88:91], a[100:103], v[228:231]
  v_mfma_f32_16x16x32_bf16 v[232:235], a[88:91], a[104:107], v[232:235]
  v_mfma_f32_16x16x32_bf16 v[236:239], a[88:91], a[108:111], v[236:239]
  buffer_load_dwordx4 v16, s[16:19], s78 offen offset:1024 lds
  v_mfma_f32_16x16x32_bf16 v[252:255], a[92:95], a[108:111], v[252:255]
  v_mfma_f32_16x16x32_bf16 v[248:251], a[92:95], a[104:107], v[248:251]
  v_mfma_f32_16x16x32_bf16 v[244:247], a[92:95], a[100:103], v[244:247]
  v_mfma_f32_16x16x32_bf16 v[240:243], a[92:95], a[96:99], v[240:243]
  s_waitcnt vmcnt(17) lgkmcnt(0)
  s_barrier
  v_mfma_f32_16x16x32_bf16 v[96:99], a[0:3], a[40:43], v[96:99]
  ds_read_b128 a[96:99], v27 offset:16384
  s_add_u32 m0, s73, 0
  v_mfma_f32_16x16x32_bf16 v[100:103], a[0:3], a[44:47], v[100:103]
  ds_read_b128 a[100:103], v27 offset:18432
  s_add_u32 s86, s86, s34
  v_mfma_f32_16x16x32_bf16 v[104:107], a[0:3], a[48:51], v[104:107]
  ds_read_b128 a[104:107], v27 offset:20480
  v_mfma_f32_16x16x32_bf16 v[108:111], a[0:3], a[52:55], v[108:111]
  ds_read_b128 a[108:111], v27 offset:22528
  s_mov_b32 s77, 1327104
  v_mfma_f32_16x16x32_bf16 v[124:127], a[4:7], a[52:55], v[124:127]
  s_add_u32 s86, s86, 3
  v_mfma_f32_16x16x32_bf16 v[120:123], a[4:7], a[48:51], v[120:123]
  ds_read_b64_tr_b16 a[56:57], v20 offset:20480
  s_lshl1_add_u32 s33, s68, s71
  v_mfma_f32_16x16x32_bf16 v[116:119], a[4:7], a[44:47], v[116:119]
  buffer_load_dwordx4 v10, s[12:15], s77 offen offset:0 lds
  v_mfma_f32_16x16x32_bf16 v[112:115], a[4:7], a[40:43], v[112:115]
  ds_read_b64_tr_b16 a[58:59], v20 offset:21760
  ds_read_b64_tr_b16 a[60:61], v20 offset:30720
  v_mfma_f32_16x16x32_bf16 v[128:131], a[8:11], a[40:43], v[128:131]
  s_mul_i32 s34, s33, 96
  ds_read_b64_tr_b16 a[62:63], v20 offset:32000
  v_mfma_f32_16x16x32_bf16 v[132:135], a[8:11], a[44:47], v[132:135]
  buffer_load_dwordx4 v11, s[12:15], s77 offen offset:1024 lds
  v_mfma_f32_16x16x32_bf16 v[136:139], a[8:11], a[48:51], v[136:139]
  s_add_u32 s84, s84, s34
  ds_read_b64_tr_b16 a[64:65], v21 offset:20512
  v_mfma_f32_16x16x32_bf16 v[140:143], a[8:11], a[52:55], v[140:143]
  ds_read_b64_tr_b16 a[66:67], v21 offset:21792
  s_mul_i32 s84, s84, 4096
  v_mfma_f32_16x16x32_bf16 v[156:159], a[12:15], a[52:55], v[156:159]
  ds_read_b64_tr_b16 a[68:69], v21 offset:30752
  v_mfma_f32_16x16x32_bf16 v[152:155], a[12:15], a[48:51], v[152:155]
  buffer_load_dwordx4 v12, s[12:15], s77 offen offset:2048 lds
  v_mfma_f32_16x16x32_bf16 v[148:151], a[12:15], a[44:47], v[148:151]
  ds_read_b64_tr_b16 a[70:71], v21 offset:32032
  s_add_u32 s84, s84, 10485760
  v_mfma_f32_16x16x32_bf16 v[144:147], a[12:15], a[40:43], v[144:147]
  ds_read_b64_tr_b16 a[72:73], v20 offset:20544
  s_add_u32 s85, s85, s34
  v_mfma_f32_16x16x32_bf16 v[160:163], a[16:19], a[40:43], v[160:163]
  buffer_load_dwordx4 v13, s[12:15], s77 offen offset:3072 lds
  v_mfma_f32_16x16x32_bf16 v[164:167], a[16:19], a[44:47], v[164:167]
  ds_read_b64_tr_b16 a[74:75], v20 offset:21824
  ds_read_b64_tr_b16 a[76:77], v20 offset:30784
  v_mfma_f32_16x16x32_bf16 v[168:171], a[16:19], a[48:51], v[168:171]
  s_mul_i32 s85, s85, 4096
  ds_read_b64_tr_b16 a[78:79], v20 offset:32064
  v_mfma_f32_16x16x32_bf16 v[172:175], a[16:19], a[52:55], v[172:175]
  s_add_u32 m0, s73, 4096
  s_add_u32 s85, s85, 10485760
  v_mfma_f32_16x16x32_bf16 v[188:191], a[20:23], a[52:55], v[188:191]
  ds_read_b64_tr_b16 a[80:81], v21 offset:20576
  v_mfma_f32_16x16x32_bf16 v[184:187], a[20:23], a[48:51], v[184:187]
  ds_read_b64_tr_b16 a[82:83], v21 offset:21856
  s_add_u32 s86, s86, s34
  v_mfma_f32_16x16x32_bf16 v[180:183], a[20:23], a[44:47], v[180:183]
  buffer_load_dwordx4 v14, s[12:15], s77 offen offset:0 lds
  v_mfma_f32_16x16x32_bf16 v[176:179], a[20:23], a[40:43], v[176:179]
  ds_read_b64_tr_b16 a[84:85], v21 offset:30816
  ds_read_b64_tr_b16 a[86:87], v21 offset:32096
  v_mfma_f32_16x16x32_bf16 v[192:195], a[24:27], a[40:43], v[192:195]
  s_mul_i32 s86, s86, 4096
  v_mfma_f32_16x16x32_bf16 v[196:199], a[24:27], a[44:47], v[196:199]
  ds_read_b64_tr_b16 a[88:89], v22 offset:20480
  s_add_u32 s86, s86, 10485760
  v_mfma_f32_16x16x32_bf16 v[200:203], a[24:27], a[48:51], v[200:203]
  ds_read_b64_tr_b16 a[90:91], v22 offset:21760
  s_add_u32 m0, s74, 2048
  v_mfma_f32_16x16x32_bf16 v[204:207], a[24:27], a[52:55], v[204:207]
  ds_read_b64_tr_b16 a[92:93], v22 offset:30720
  s_cmp_eq_u32 s32, 19
TS_7:
  s_cbranch_execz TR_FB
  s_cselect_b32 s85, 0x7f000000, s85
  v_mfma_f32_16x16x32_bf16 v[220:223], a[28:31], a[52:55], v[220:223]
  ds_read_b64_tr_b16 a[94:95], v22 offset:32000
  v_mfma_f32_16x16x32_bf16 v[216:219], a[28:31], a[48:51], v[216:219]
  s_movk_i32 s78, 768
  s_lshl1_add_u32 s87, s32, s71
  v_mfma_f32_16x16x32_bf16 v[212:215], a[28:31], a[44:47], v[212:215]
  v_mfma_f32_16x16x32_bf16 v[208:211], a[28:31], a[40:43], v[208:211]
  s_lshl_b32 s33, s68, 7
  v_mfma_f32_16x16x32_bf16 v[224:227], a[32:35], a[40:43], v[224:227]
  buffer_load_dwordx4 v17, s[16:19], s78 offen offset:0 lds
  v_mfma_f32_16x16x32_bf16 v[228:231], a[32:35], a[44:47], v[228:231]
  s_add_u32 s87, s87, s33
  v_mfma_f32_16x16x32_bf16 v[232:235], a[32:35], a[48:51], v[232:235]
  v_mfma_f32_16x16x32_bf16 v[236:239], a[32:35], a[52:55], v[236:239]
  buffer_load_dwordx4 v18, s[16:19], s78 offen offset:1024 lds
  v_mfma_f32_16x16x32_bf16 v[252:255], a[36:39], a[52:55], v[252:255]
  s_lshl_b32 s87, s87, 7
  v_mfma_f32_16x16x32_bf16 v[248:251], a[36:39], a[48:51], v[248:251]
  s_add_u32 s87, s87, 262144
  v_mfma_f32_16x16x32_bf16 v[244:247], a[36:39], a[44:47], v[244:247]
  v_mfma_f32_16x16x32_bf16 v[240:243], a[36:39], a[40:43], v[240:243]
  s_waitcnt vmcnt(15) lgkmcnt(0)
  s_barrier
  v_mfma_f32_16x16x32_bf16 v[96:99], a[56:59], a[96:99], v[96:99]
  ds_read_b128 a[40:43], v26 offset:32768
  s_add_u32 m0, s73, 20480
  v_mfma_f32_16x16x32_bf16 v[100:103], a[56:59], a[100:103], v[100:103]
  ds_read_b128 a[44:47], v26 offset:34816
  v_mfma_f32_16x16x32_bf16 v[104:107], a[56:59], a[104:107], v[104:107]
  ds_read_b128 a[48:51], v26 offset:36864
  v_mfma_f32_16x16x32_bf16 v[108:111], a[56:59], a[108:111], v[108:111]
  ds_read_b128 a[52:55], v26 offset:38912
  s_mov_b32 s77, 1437696
  v_mfma_f32_16x16x32_bf16 v[124:127], a[60:63], a[108:111], v[124:127]
  v_mfma_f32_16x16x32_bf16 v[120:123], a[60:63], a[104:107], v[120:123]
  ds_read_b64_tr_b16 a[0:1], v20 offset:40960
  v_mfma_f32_16x16x32_bf16 v[116:119], a[60:63], a[100:103], v[116:119]
  buffer_load_dwordx4 v10, s[12:15], s77 offen offset:0 lds
  v_mfma_f32_16x16x32_bf16 v[112:115], a[60:63], a[96:99], v[112:115]
  ds_read_b64_tr_b16 a[2:3], v20 offset:42240
  ds_read_b64_tr_b16 a[4:5], v20 offset:51200
  v_mfma_f32_16x16x32_bf16 v[128:131], a[64:67], a[96:99], v[128:131]
  ds_read_b64_tr_b16 a[6:7], v20 offset:52480
  v_mfma_f32_16x16x32_bf16 v[132:135], a[64:67], a[100:103], v[132:135]
  buffer_load_dwordx4 v11, s[12:15], s77 offen offset:1024 lds
  v_mfma_f32_16x16x32_bf16 v[136:139], a[64:67], a[104:107], v[136:139]
  ds_read_b64_tr_b16 a[8:9], v21 offset:40992
  v_mfma_f32_16x16x32_bf16 v[140:143], a[64:67], a[108:111], v[140:143]
  ds_read_b64_tr_b16 a[10:11], v21 offset:42272
  v_mfma_f32_16x16x32_bf16 v[156:159], a[68:71], a[108:111], v[156:159]
  ds_read_b64_tr_b16 a[12:13], v21 offset:51232
  v_mfma_f32_16x16x32_bf16 v[152:155], a[68:71], a[104:107], v[152:155]
  buffer_load_dwordx4 v12, s[12:15], s77 offen offset:2048 lds
  v_mfma_f32_16x16x32_bf16 v[148:151], a[68:71], a[100:103], v[148:151]
  ds_read_b64_tr_b16 a[14:15], v21 offset:52512
  v_mfma_f32_16x16x32_bf16 v[144:147], a[68:71], a[96:99], v[144:147]
  ds_read_b64_tr_b16 a[16:17], v20 offset:41024
  v_mfma_f32_16x16x32_bf16 v[160:163], a[72:75], a[96:99], v[160:163]
  buffer_load_dwordx4 v13, s[12:15], s77 offen offset:3072 lds
  v_mfma_f32_16x16x32_bf16 v[164:167], a[72:75], a[100:103], v[164:167]
  ds_read_b64_tr_b16 a[18:19], v20 offset:42304
  ds_read_b64_tr_b16 a[20:21], v20 offset:51264
  v_mfma_f32_16x16x32_bf16 v[168:171], a[72:75], a[104:107], v[168:171]
  ds_read_b64_tr_b16 a[22:23], v20 offset:52544
  v_mfma_f32_16x16x32_bf16 v[172:175], a[72:75], a[108:111], v[172:175]
  s_add_u32 m0, s73, 24576
  v_mfma_f32_16x16x32_bf16 v[188:191], a[76:79], a[108:111], v[188:191]
  ds_read_b64_tr_b16 a[24:25], v21 offset:41056
  v_mfma_f32_16x16x32_bf16 v[184:187], a[76:79], a[104:107], v[184:187]
  ds_read_b64_tr_b16 a[26:27], v21 offset:42336
  v_mfma_f32_16x16x32_bf16 v[180:183], a[76:79], a[100:103], v[180:183]
  buffer_load_dwordx4 v14, s[12:15], s77 offen offset:0 lds
  v_mfma_f32_16x16x32_bf16 v[176:179], a[76:79], a[96:99], v[176:179]
  ds_read_b64_tr_b16 a[28:29], v21 offset:51296
  ds_read_b64_tr_b16 a[30:31], v21 offset:52576
  v_mfma_f32_16x16x32_bf16 v[192:195], a[80:83], a[96:99], v[192:195]
  v_mfma_f32_16x16x32_bf16 v[196:199], a[80:83], a[100:103], v[196:199]
  ds_read_b64_tr_b16 a[32:33], v22 offset:40960
  v_mfma_f32_16x16x32_bf16 v[200:203], a[80:83], a[104:107], v[200:203]
  ds_read_b64_tr_b16 a[34:35], v22 offset:42240
  s_add_u32 m0, s74, 16384
  v_mfma_f32_16x16x32_bf16 v[204:207], a[80:83], a[108:111], v[204:207]
  ds_read_b64_tr_b16 a[36:37], v22 offset:51200
  v_mfma_f32_16x16x32_bf16 v[220:223], a[84:87], a[108:111], v[220:223]
  ds_read_b64_tr_b16 a[38:39], v22 offset:52480
  v_mfma_f32_16x16x32_bf16 v[216:219], a[84:87], a[104:107], v[216:219]
  s_movk_i32 s78, 896
  v_mfma_f32_16x16x32_bf16 v[212:215], a[84:87], a[100:103], v[212:215]
  v_mfma_f32_16x16x32_bf16 v[208:211], a[84:87], a[96:99], v[208:211]
  v_mfma_f32_16x16x32_bf16 v[224:227], a[88:91], a[96:99], v[224:227]
  buffer_load_dwordx4 v15, s[16:19], s78 offen offset:0 lds
  v_mfma_f32_16x16x32_bf16 v[228:231], a[88:91], a[100:103], v[228:231]
  v_mfma_f32_16x16x32_bf16 v[232:235], a[88:91], a[104:107], v[232:235]
  v_mfma_f32_16x16x32_bf16 v[236:239], a[88:91], a[108:111], v[236:239]
  buffer_load_dwordx4 v16, s[16:19], s78 offen offset:1024 lds
  v_mfma_f32_16x16x32_bf16 v[252:255], a[92:95], a[108:111], v[252:255]
  v_mfma_f32_16x16x32_bf16 v[248:251], a[92:95], a[104:107], v[248:251]
  v_mfma_f32_16x16x32_bf16 v[244:247], a[92:95], a[100:103], v[244:247]
  v_mfma_f32_16x16x32_bf16 v[240:243], a[92:95], a[96:99], v[240:243]
  s_waitcnt vmcnt(17) lgkmcnt(0)
  s_barrier
  v_mfma_f32_16x16x32_bf16 v[96:99], a[0:3], a[40:43], v[96:99]
  ds_read_b128 a[96:99], v27 offset:32768
  s_add_u32 m0, s73, 40960
  v_mfma_f32_16x16x32_bf16 v[100:103], a[0:3], a[44:47], v[100:103]
  ds_read_b128 a[100:103], v27 offset:34816
  v_mfma_f32_16x16x32_bf16 v[104:107], a[0:3], a[48:51], v[104:107]
  ds_read_b128 a[104:107], v27 offset:36864
  v_mfma_f32_16x16x32_bf16 v[108:111], a[0:3], a[52:55], v[108:111]
  ds_read_b128 a[108:111], v27 offset:38912
  s_mov_b32 s77, 1548288
  v_mfma_f32_16x16x32_bf16 v[124:127], a[4:7], a[52:55], v[124:127]
  v_mfma_f32_16x16x32_bf16 v[120:123], a[4:7], a[48:51], v[120:123]
  ds_read_b64_tr_b16 a[56:57], v23 offset:0
  v_mfma_f32_16x16x32_bf16 v[116:119], a[4:7], a[44:47], v[116:119]
  buffer_load_dwordx4 v10, s[12:15], s77 offen offset:0 lds
  v_mfma_f32_16x16x32_bf16 v[112:115], a[4:7], a[40:43], v[112:115]
  ds_read_b64_tr_b16 a[58:59], v23 offset:1280
  ds_read_b64_tr_b16 a[60:61], v23 offset:10240
  v_mfma_f32_16x16x32_bf16 v[128:131], a[8:11], a[40:43], v[128:131]
  ds_read_b64_tr_b16 a[62:63], v23 offset:11520
  v_mfma_f32_16x16x32_bf16 v[132:135], a[8:11], a[44:47], v[132:135]
  buffer_load_dwordx4 v11, s[12:15], s77 offen offset:1024 lds
  v_mfma_f32_16x16x32_bf16 v[136:139], a[8:11], a[48:51], v[136:139]
  ds_read_b64_tr_b16 a[64:65], v24 offset:32
  v_mfma_f32_16x16x32_bf16 v[140:143], a[8:11], a[52:55], v[140:143]
  ds_read_b64_tr_b16 a[66:67], v24 offset:1312
  v_mfma_f32_16x16x32_bf16 v[156:159], a[12:15], a[52:55], v[156:159]
  ds_read_b64_tr_b16 a[68:69], v24 offset:10272
  v_mfma_f32_16x16x32_bf16 v[152:155], a[12:15], a[48:51], v[152:155]
  buffer_load_dwordx4 v12, s[12:15], s77 offen offset:2048 lds
  v_mfma_f32_16x16x32_bf16 v[148:151], a[12:15], a[44:47], v[148:151]
  ds_read_b64_tr_b16 a[70:71], v24 offset:11552
  v_mfma_f32_16x16x32_bf16 v[144:147], a[12:15], a[40:43], v[144:147]
  ds_read_b64_tr_b16 a[72:73], v23 offset:64
  v_mfma_f32_16x16x32_bf16 v[160:163], a[16:19], a[40:43], v[160:163]
  buffer_load_dwordx4 v13, s[12:15], s77 offen offset:3072 lds
  v_mfma_f32_16x16x32_bf16 v[164:167], a[16:19], a[44:47], v[164:167]
  ds_read_b64_tr_b16 a[74:75], v23 offset:1344
  ds_read_b64_tr_b16 a[76:77], v23 offset:10304
  v_mfma_f32_16x16x32_bf16 v[168:171], a[16:19], a[48:51], v[168:171]
  ds_read_b64_tr_b16 a[78:79], v23 offset:11584
  v_mfma_f32_16x16x32_bf16 v[172:175], a[16:19], a[52:55], v[172:175]
  s_add_u32 m0, s73, 45056
  v_mfma_f32_16x16x32_bf16 v[188:191], a[20:23], a[52:55], v[188:191]
  ds_read_b64_tr_b16 a[80:81], v24 offset:96
  v_mfma_f32_16x16x32_bf16 v[184:187], a[20:23], a[48:51], v[184:187]
  ds_read_b64_tr_b16 a[82:83], v24 offset:1376
  v_mfma_f32_16x16x32_bf16 v[180:183], a[20:23], a[44:47], v[180:183]
  buffer_load_dwordx4 v14, s[12:15], s77 offen offset:0 lds
  v_mfma_f32_16x16x32_bf16 v[176:179], a[20:23], a[40:43], v[176:179]
  ds_read_b64_tr_b16 a[84:85], v24 offset:10336
  ds_read_b64_tr_b16 a[86:87], v24 offset:11616
  v_mfma_f32_16x16x32_bf16 v[192:195], a[24:27], a[40:43], v[192:195]
  v_mfma_f32_16x16x32_bf16 v[196:199], a[24:27], a[44:47], v[196:199]
  ds_read_b64_tr_b16 a[88:89], v25 offset:0
  v_mfma_f32_16x16x32_bf16 v[200:203], a[24:27], a[48:51], v[200:203]
  ds_read_b64_tr_b16 a[90:91], v25 offset:1280
  s_add_u32 m0, s74, 18432
  v_mfma_f32_16x16x32_bf16 v[204:207], a[24:27], a[52:55], v[204:207]
  ds_read_b64_tr_b16 a[92:93], v25 offset:10240
  v_mfma_f32_16x16x32_bf16 v[220:223], a[28:31], a[52:55], v[220:223]
  ds_read_b64_tr_b16 a[94:95], v25 offset:11520
  v_mfma_f32_16x16x32_bf16 v[216:219], a[28:31], a[48:51], v[216:219]
  s_movk_i32 s78, 896
  v_mfma_f32_16x16x32_bf16 v[212:215], a[28:31], a[44:47], v[212:215]
  v_mfma_f32_16x16x32_bf16 v[208:211], a[28:31], a[40:43], v[208:211]
  v_mfma_f32_16x16x32_bf16 v[224:227], a[32:35], a[40:43], v[224:227]
  buffer_load_dwordx4 v17, s[16:19], s78 offen offset:0 lds
  v_mfma_f32_16x16x32_bf16 v[228:231], a[32:35], a[44:47], v[228:231]
  v_mfma_f32_16x16x32_bf16 v[232:235], a[32:35], a[48:51], v[232:235]
  v_mfma_f32_16x16x32_bf16 v[236:239], a[32:35], a[52:55], v[236:239]
  buffer_load_dwordx4 v18, s[16:19], s78 offen offset:1024 lds
  v_mfma_f32_16x16x32_bf16 v[252:255], a[36:39], a[52:55], v[252:255]
  v_mfma_f32_16x16x32_bf16 v[248:251], a[36:39], a[48:51], v[248:251]
  v_mfma_f32_16x16x32_bf16 v[244:247], a[36:39], a[44:47], v[244:247]
  v_mfma_f32_16x16x32_bf16 v[240:243], a[36:39], a[40:43], v[240:243]
  s_waitcnt vmcnt(14) lgkmcnt(0)
  s_barrier
  v_mfma_f32_16x16x32_bf16 v[96:99], a[56:59], a[96:99], v[96:99]
  ds_read_b128 a[40:43], v26 offset:0
  s_add_u32 m0, s73, 61440
  v_mfma_f32_16x16x32_bf16 v[100:103], a[56:59], a[100:103], v[100:103]
  ds_read_b128 a[44:47], v26 offset:2048
  v_lshrrev_b32 v2, 4, v1
  v_mfma_f32_16x16x32_bf16 v[104:107], a[56:59], a[104:107], v[104:107]
  ds_read_b128 a[48:51], v26 offset:4096
  v_mfma_f32_16x16x32_bf16 v[108:111], a[56:59], a[108:111], v[108:111]
  ds_read_b128 a[52:55], v26 offset:6144
  s_mov_b32 s77, 1658880
  v_mfma_f32_16x16x32_bf16 v[124:127], a[60:63], a[108:111], v[124:127]
  v_and_b32 v3, 1, v2
  v_mfma_f32_16x16x32_bf16 v[120:123], a[60:63], a[104:107], v[120:123]
  ds_read_b64_tr_b16 a[0:1], v20 offset:0
  v_mfma_f32_16x16x32_bf16 v[116:119], a[60:63], a[100:103], v[116:119]
  buffer_load_dwordx4 v10, s[12:15], s77 offen offset:0 lds
  v_mfma_f32_16x16x32_bf16 v[112:115], a[60:63], a[96:99], v[112:115]
  ds_read_b64_tr_b16 a[2:3], v20 offset:1280
  ds_read_b64_tr_b16 a[4:5], v20 offset:10240
  v_mfma_f32_16x16x32_bf16 v[128:131], a[64:67], a[96:99], v[128:131]
  v_lshlrev_b32 v3, 10, v3
  ds_read_b64_tr_b16 a[6:7], v20 offset:11520
  v_mfma_f32_16x16x32_bf16 v[132:135], a[64:67], a[100:103], v[132:135]
  buffer_load_dwordx4 v11, s[12:15], s77 offen offset:1024 lds
  v_mfma_f32_16x16x32_bf16 v[136:139], a[64:67], a[104:107], v[136:139]
  ds_read_b64_tr_b16 a[8:9], v21 offset:32
  v_mfma_f32_16x16x32_bf16 v[140:143], a[64:67], a[108:111], v[140:143]
  ds_read_b64_tr_b16 a[10:11], v21 offset:1312
  v_lshrrev_b32 v2, 1, v2
  v_mfma_f32_16x16x32_bf16 v[156:159], a[68:71], a[108:111], v[156:159]
  ds_read_b64_tr_b16 a[12:13], v21 offset:10272
  v_mfma_f32_16x16x32_bf16 v[152:155], a[68:71], a[104:107], v[152:155]
  buffer_load_dwordx4 v12, s[12:15], s77 offen offset:2048 lds
  v_mfma_f32_16x16x32_bf16 v[148:151], a[68:71], a[100:103], v[148:151]
  ds_read_b64_tr_b16 a[14:15], v21 offset:11552
  v_lshl_add_u32 v3, v2, 8, v3
  v_mfma_f32_16x16x32_bf16 v[144:147], a[68:71], a[96:99], v[144:147]
  ds_read_b64_tr_b16 a[16:17], v20 offset:64
  v_mfma_f32_16x16x32_bf16 v[160:163], a[72:75], a[96:99], v[160:163]
  buffer_load_dwordx4 v13, s[12:15], s77 offen offset:3072 lds
  v_mfma_f32_16x16x32_bf16 v[164:167], a[72:75], a[100:103], v[164:167]
  ds_read_b64_tr_b16 a[18:19], v20 offset:1344
  ds_read_b64_tr_b16 a[20:21], v20 offset:10304
  v_mfma_f32_16x16x32_bf16 v[168:171], a[72:75], a[104:107], v[168:171]
  ds_read_b64_tr_b16 a[22:23], v20 offset:11584
  v_and_b32 v2, 15, v1
  v_mfma_f32_16x16x32_bf16 v[172:175], a[72:75], a[108:111], v[172:175]
  s_add_u32 m0, s73, 65536
  v_mfma_f32_16x16x32_bf16 v[188:191], a[76:79], a[108:111], v[188:191]
  ds_read_b64_tr_b16 a[24:25], v21 offset:96
  v_mfma_f32_16x16x32_bf16 v[184:187], a[76:79], a[104:107], v[184:187]
  ds_read_b64_tr_b16 a[26:27], v21 offset:1376
  v_lshl_add_u32 v3, v2, 4, v3
  v_mfma_f32_16x16x32_bf16 v[180:183], a[76:79], a[100:103], v[180:183]
  buffer_load_dwordx4 v14, s[12:15], s77 offen offset:0 lds
  v_mfma_f32_16x16x32_bf16 v[176:179], a[76:79], a[96:99], v[176:179]
  ds_read_b64_tr_b16 a[28:29], v21 offset:10336
  ds_read_b64_tr_b16 a[30:31], v21 offset:11616
  v_mfma_f32_16x16x32_bf16 v[192:195], a[80:83], a[96:99], v[192:195]
  v_mfma_f32_16x16x32_bf16 v[196:199], a[80:83], a[100:103], v[196:199]
  ds_read_b64_tr_b16 a[32:33], v22 offset:0
  s_lshl_b32 s75, s72, 9
  v_mfma_f32_16x16x32_bf16 v[200:203], a[80:83], a[104:107], v[200:203]
  ds_read_b64_tr_b16 a[34:35], v22 offset:1280
  s_add_u32 m0, s74, 32768
  v_mfma_f32_16x16x32_bf16 v[204:207], a[80:83], a[108:111], v[204:207]
  ds_read_b64_tr_b16 a[36:37], v22 offset:10240
  v_mfma_f32_16x16x32_bf16 v[220:223], a[84:87], a[108:111], v[220:223]
  ds_read_b64_tr_b16 a[38:39], v22 offset:11520
  v_add_u32 v30, s75, v3
  v_mfma_f32_16x16x32_bf16 v[216:219], a[84:87], a[104:107], v[216:219]
  s_movk_i32 s78, 1024
  v_mfma_f32_16x16x32_bf16 v[212:215], a[84:87], a[100:103], v[212:215]
  v_mfma_f32_16x16x32_bf16 v[208:211], a[84:87], a[96:99], v[208:211]
  v_mfma_f32_16x16x32_bf16 v[224:227], a[88:91], a[96:99], v[224:227]
  buffer_load_dwordx4 v15, s[16:19], s78 offen offset:0 lds
  v_mfma_f32_16x16x32_bf16 v[228:231], a[88:91], a[100:103], v[228:231]
  v_mov_b32 v31, s96
  v_mfma_f32_16x16x32_bf16 v[232:235], a[88:91], a[104:107], v[232:235]
  v_mfma_f32_16x16x32_bf16 v[236:239], a[88:91], a[108:111], v[236:239]
  buffer_load_dwordx4 v16, s[16:19], s78 offen offset:1024 lds
  v_mfma_f32_16x16x32_bf16 v[252:255], a[92:95], a[108:111], v[252:255]
  s_add_u32 s99, s87, 5632
  v_mfma_f32_16x16x32_bf16 v[248:251], a[92:95], a[104:107], v[248:251]
  v_mfma_f32_16x16x32_bf16 v[244:247], a[92:95], a[100:103], v[244:247]
  v_mfma_f32_16x16x32_bf16 v[240:243], a[92:95], a[96:99], v[240:243]
  s_waitcnt vmcnt(16) lgkmcnt(0)
  s_barrier
  v_mfma_f32_16x16x32_bf16 v[96:99], a[0:3], a[40:43], v[96:99]
  ds_read_b128 a[96:99], v27 offset:0
  s_add_u32 m0, s73, 0
  v_mfma_f32_16x16x32_bf16 v[100:103], a[0:3], a[44:47], v[100:103]
  ds_read_b128 a[100:103], v27 offset:2048
  s_lshl_b32 s31, s81, 3
  v_mfma_f32_16x16x32_bf16 v[104:107], a[0:3], a[48:51], v[104:107]
  ds_read_b128 a[104:107], v27 offset:4096
  v_mfma_f32_16x16x32_bf16 v[108:111], a[0:3], a[52:55], v[108:111]
  ds_read_b128 a[108:111], v27 offset:6144
  s_mov_b32 s77, 1769472
  v_mfma_f32_16x16x32_bf16 v[124:127], a[4:7], a[52:55], v[124:127]
  s_add_u32 s31, s31, s29
  v_mfma_f32_16x16x32_bf16 v[120:123], a[4:7], a[48:51], v[120:123]
  ds_read_b64_tr_b16 a[56:57], v20 offset:20480
  s_mul_i32 s31, s31, 640
  v_mfma_f32_16x16x32_bf16 v[116:119], a[4:7], a[44:47], v[116:119]
  buffer_load_dwordx4 v10, s[12:15], s77 offen offset:0 lds
  v_mfma_f32_16x16x32_bf16 v[112:115], a[4:7], a[40:43], v[112:115]
  ds_read_b64_tr_b16 a[58:59], v20 offset:21760
  ds_read_b64_tr_b16 a[60:61], v20 offset:30720
  v_mfma_f32_16x16x32_bf16 v[128:131], a[8:11], a[40:43], v[128:131]
  s_add_u32 s31, s31, 655360
  ds_read_b64_tr_b16 a[62:63], v20 offset:32000
  v_mfma_f32_16x16x32_bf16 v[132:135], a[8:11], a[44:47], v[132:135]
  buffer_load_dwordx4 v11, s[12:15], s77 offen offset:1024 lds
  v_mfma_f32_16x16x32_bf16 v[136:139], a[8:11], a[48:51], v[136:139]
  v_min_u32 v9, 4, v1
  ds_read_b64_tr_b16 a[64:65], v21 offset:20512
  v_mfma_f32_16x16x32_bf16 v[140:143], a[8:11], a[52:55], v[140:143]
  ds_read_b64_tr_b16 a[66:67], v21 offset:21792
  v_lshlrev_b32 v9, 7, v9
  v_mfma_f32_16x16x32_bf16 v[156:159], a[12:15], a[52:55], v[156:159]
  ds_read_b64_tr_b16 a[68:69], v21 offset:30752
  v_mfma_f32_16x16x32_bf16 v[152:155], a[12:15], a[48:51], v[152:155]
  buffer_load_dwordx4 v12, s[12:15], s77 offen offset:2048 lds
  v_mfma_f32_16x16x32_bf16 v[148:151], a[12:15], a[44:47], v[148:151]
  buffer_load_dword v9, v9, s[8:11], s31 offen sc1
  v_mfma_f32_16x16x32_bf16 v[144:147], a[12:15], a[40:43], v[144:147]
  ds_read_b64_tr_b16 a[70:71], v21 offset:32032
  ds_read_b64_tr_b16 a[72:73], v20 offset:20544
  v_mfma_f32_16x16x32_bf16 v[160:163], a[16:19], a[40:43], v[160:163]
  buffer_load_dwordx4 v13, s[12:15], s77 offen offset:3072 lds
  v_mfma_f32_16x16x32_bf16 v[164:167], a[16:19], a[44:47], v[164:167]
  v_and_b32 v2, 7, v1
  ds_read_b64_tr_b16 a[74:75], v20 offset:21824
  v_mfma_f32_16x16x32_bf16 v[168:171], a[16:19], a[48:51], v[168:171]
  ds_read_b64_tr_b16 a[76:77], v20 offset:30784
  v_lshlrev_b32 v2, 3, v2
  v_mfma_f32_16x16x32_bf16 v[172:175], a[16:19], a[52:55], v[172:175]
  ds_read_b64_tr_b16 a[78:79], v20 offset:32064
  s_add_u32 m0, s73, 4096
  v_mfma_f32_16x16x32_bf16 v[188:191], a[20:23], a[52:55], v[188:191]
  ds_read_b64_tr_b16 a[80:81], v21 offset:20576
  v_and_b32 v3, 8, v1
  v_mfma_f32_16x16x32_bf16 v[184:187], a[20:23], a[48:51], v[184:187]
  ds_read_b64_tr_b16 a[82:83], v21 offset:21856
  v_mfma_f32_16x16x32_bf16 v[180:183], a[20:23], a[44:47], v[180:183]
  buffer_load_dwordx4 v14, s[12:15], s77 offen offset:0 lds
  v_mfma_f32_16x16x32_bf16 v[176:179], a[20:23], a[40:43], v[176:179]
  ds_read_b64_tr_b16 a[84:85], v21 offset:30816
  v_lshl_add_u32 v2, v3, 4, v2
  v_mfma_f32_16x16x32_bf16 v[192:195], a[24:27], a[40:43], v[192:195]
  ds_read_b64_tr_b16 a[86:87], v21 offset:32096
  s_lshl1_add_u32 s75, s68, s71
  v_mfma_f32_16x16x32_bf16 v[196:199], a[24:27], a[44:47], v[196:199]
  ds_read_b64_tr_b16 a[88:89], v22 offset:20480
  v_mfma_f32_16x16x32_bf16 v[200:203], a[24:27], a[48:51], v[200:203]
  ds_read_b64_tr_b16 a[90:91], v22 offset:21760
  s_add_u32 m0, s74, 34816
  v_mfma_f32_16x16x32_bf16 v[204:207], a[24:27], a[52:55], v[204:207]
  s_lshl_b32 s75, s75, 10
  ds_read_b64_tr_b16 a[92:93], v22 offset:30720
  v_mfma_f32_16x16x32_bf16 v[220:223], a[28:31], a[52:55], v[220:223]
  ds_read_b64_tr_b16 a[94:95], v22 offset:32000
  s_add_u32 s75, s75, 196608
  v_mfma_f32_16x16x32_bf16 v[216:219], a[28:31], a[48:51], v[216:219]
  s_movk_i32 s78, 1024
  v_mfma_f32_16x16x32_bf16 v[212:215], a[28:31], a[44:47], v[212:215]
  buffer_load_dwordx2 v[64:65], v2, s[8:11], s75 offen offset:0 sc1
  v_mfma_f32_16x16x32_bf16 v[208:211], a[28:31], a[40:43], v[208:211]
  v_mfma_f32_16x16x32_bf16 v[224:227], a[32:35], a[40:43], v[224:227]
  buffer_load_dwordx4 v17, s[16:19], s78 offen offset:0 lds
  v_mfma_f32_16x16x32_bf16 v[228:231], a[32:35], a[44:47], v[228:231]
  buffer_load_dwordx2 v[66:67], v2, s[8:11], s75 offen offset:256 sc1
  v_mfma_f32_16x16x32_bf16 v[232:235], a[32:35], a[48:51], v[232:235]
  buffer_load_dwordx2 v[68:69], v2, s[8:11], s75 offen offset:512 sc1
  v_mfma_f32_16x16x32_bf16 v[236:239], a[32:35], a[52:55], v[236:239]
  buffer_load_dwordx4 v18, s[16:19], s78 offen offset:1024 lds
  v_mfma_f32_16x16x32_bf16 v[252:255], a[36:39], a[52:55], v[252:255]
  buffer_load_dwordx2 v[70:71], v2, s[8:11], s75 offen offset:768 sc1
  v_mfma_f32_16x16x32_bf16 v[248:251], a[36:39], a[48:51], v[248:251]
  v_mfma_f32_16x16x32_bf16 v[244:247], a[36:39], a[44:47], v[244:247]
  v_mfma_f32_16x16x32_bf16 v[240:243], a[36:39], a[40:43], v[240:243]
  s_waitcnt vmcnt(19) lgkmcnt(0)
  s_barrier
  v_mfma_f32_16x16x32_bf16 v[96:99], a[56:59], a[96:99], v[96:99]
  ds_read_b128 a[40:43], v26 offset:16384
  s_add_u32 m0, s73, 20480
  v_mfma_f32_16x16x32_bf16 v[100:103], a[56:59], a[100:103], v[100:103]
  ds_read_b128 a[44:47], v26 offset:18432
  s_mul_i32 s75, s72, 1728
  v_mfma_f32_16x16x32_bf16 v[104:107], a[56:59], a[104:107], v[104:107]
  ds_read_b128 a[48:51], v26 offset:20480
  v_mfma_f32_16x16x32_bf16 v[108:111], a[56:59], a[108:111], v[108:111]
  ds_read_b128 a[52:55], v26 offset:22528
  s_mov_b32 s77, 1880064
  v_mfma_f32_16x16x32_bf16 v[124:127], a[60:63], a[108:111], v[124:127]
  s_mul_i32 s76, s71, 80
  v_mfma_f32_16x16x32_bf16 v[120:123], a[60:63], a[104:107], v[120:123]
  ds_read_b64_tr_b16 a[0:1], v20 offset:40960
  v_mfma_f32_16x16x32_bf16 v[116:119], a[60:63], a[100:103], v[116:119]
  buffer_load_dwordx4 v10, s[12:15], s77 offen offset:0 lds
  v_mfma_f32_16x16x32_bf16 v[112:115], a[60:63], a[96:99], v[112:115]
  ds_read_b64_tr_b16 a[2:3], v20 offset:42240
  ds_read_b64_tr_b16 a[4:5], v20 offset:51200
  v_mfma_f32_16x16x32_bf16 v[128:131], a[64:67], a[96:99], v[128:131]
  ds_read_b64_tr_b16 a[6:7], v20 offset:52480
  s_add_u32 s75, s75, s76
  v_mfma_f32_16x16x32_bf16 v[132:135], a[64:67], a[100:103], v[132:135]
  buffer_load_dwordx4 v11, s[12:15], s77 offen offset:1024 lds
  v_mfma_f32_16x16x32_bf16 v[136:139], a[64:67], a[104:107], v[136:139]
  ds_read_b64_tr_b16 a[8:9], v21 offset:40992
  v_mfma_f32_16x16x32_bf16 v[140:143], a[64:67], a[108:111], v[140:143]
  ds_read_b64_tr_b16 a[10:11], v21 offset:42272
  v_mfma_f32_16x16x32_bf16 v[156:159], a[68:71], a[108:111], v[156:159]
  ds_read_b64_tr_b16 a[12:13], v21 offset:51232
  s_add_u32 s75, s75, s70
  v_mfma_f32_16x16x32_bf16 v[152:155], a[68:71], a[104:107], v[152:155]
  buffer_load_dwordx4 v12, s[12:15], s77 offen offset:2048 lds
  v_mfma_f32_16x16x32_bf16 v[148:151], a[68:71], a[100:103], v[148:151]
  ds_read_b64_tr_b16 a[14:15], v21 offset:52512
  v_mfma_f32_16x16x32_bf16 v[144:147], a[68:71], a[96:99], v[144:147]
  ds_read_b64_tr_b16 a[16:17], v20 offset:41024
  v_mfma_f32_16x16x32_bf16 v[160:163], a[72:75], a[96:99], v[160:163]
  buffer_load_dwordx4 v13, s[12:15], s77 offen offset:3072 lds
  v_mfma_f32_16x16x32_bf16 v[164:167], a[72:75], a[100:103], v[164:167]
  ds_read_b64_tr_b16 a[18:19], v20 offset:42304
  s_lshl_b32 s75, s75, 3
  v_mfma_f32_16x16x32_bf16 v[168:171], a[72:75], a[104:107], v[168:171]
  ds_read_b64_tr_b16 a[20:21], v20 offset:51264
  ds_read_b64_tr_b16 a[22:23], v20 offset:52544
  v_mfma_f32_16x16x32_bf16 v[172:175], a[72:75], a[108:111], v[172:175]
  s_add_u32 m0, s73, 24576
  v_mfma_f32_16x16x32_bf16 v[188:191], a[76:79], a[108:111], v[188:191]
  ds_read_b64_tr_b16 a[24:25], v21 offset:41056
  s_add_u32 s75, s75, 851968
  v_mfma_f32_16x16x32_bf16 v[184:187], a[76:79], a[104:107], v[184:187]
  ds_read_b64_tr_b16 a[26:27], v21 offset:42336
  v_mfma_f32_16x16x32_bf16 v[180:183], a[76:79], a[100:103], v[180:183]
  buffer_load_dwordx4 v14, s[12:15], s77 offen offset:0 lds
  v_mfma_f32_16x16x32_bf16 v[176:179], a[76:79], a[96:99], v[176:179]
  ds_read_b64_tr_b16 a[28:29], v21 offset:51296
  ds_read_b64_tr_b16 a[30:31], v21 offset:52576
  v_mfma_f32_16x16x32_bf16 v[192:195], a[80:83], a[96:99], v[192:195]
  s_add_u32 s76, s75, 27648
  v_mfma_f32_16x16x32_bf16 v[196:199], a[80:83], a[100:103], v[196:199]
  ds_read_b64_tr_b16 a[32:33], v22 offset:40960
  v_mfma_f32_16x16x32_bf16 v[200:203], a[80:83], a[104:107], v[200:203]
  ds_read_b64_tr_b16 a[34:35], v22 offset:42240
  s_add_u32 m0, s74, 0
  v_mfma_f32_16x16x32_bf16 v[204:207], a[80:83], a[108:111], v[204:207]
  ds_read_b64_tr_b16 a[36:37], v22 offset:51200
  v_min_u32 v2, 624, v28
  v_mfma_f32_16x16x32_bf16 v[220:223], a[84:87], a[108:111], v[220:223]
  ds_read_b64_tr_b16 a[38:39], v22 offset:52480
  v_mfma_f32_16x16x32_bf16 v[216:219], a[84:87], a[104:107], v[216:219]
  s_movk_i32 s78, 1152
  v_mfma_f32_16x16x32_bf16 v[212:215], a[84:87], a[100:103], v[212:215]
  v_mfma_f32_16x16x32_bf16 v[208:211], a[84:87], a[96:99], v[208:211]
  buffer_load_dwordx4 v[56:59], v2, s[8:11], s75 offen sc1
  v_mfma_f32_16x16x32_bf16 v[224:227], a[88:91], a[96:99], v[224:227]
  buffer_load_dwordx4 v15, s[16:19], s78 offen offset:0 lds
  v_mfma_f32_16x16x32_bf16 v[228:231], a[88:91], a[100:103], v[228:231]
  v_mfma_f32_16x16x32_bf16 v[232:235], a[88:91], a[104:107], v[232:235]
  v_mfma_f32_16x16x32_bf16 v[236:239], a[88:91], a[108:111], v[236:239]
  buffer_load_dwordx4 v16, s[16:19], s78 offen offset:1024 lds
  v_mfma_f32_16x16x32_bf16 v[252:255], a[92:95], a[108:111], v[252:255]
  buffer_load_dwordx4 v[60:63], v2, s[8:11], s76 offen sc1
  v_mfma_f32_16x16x32_bf16 v[248:251], a[92:95], a[104:107], v[248:251]
  v_mfma_f32_16x16x32_bf16 v[244:247], a[92:95], a[100:103], v[244:247]
  v_mfma_f32_16x16x32_bf16 v[240:243], a[92:95], a[96:99], v[240:243]
  s_waitcnt vmcnt(23) lgkmcnt(0)
  s_barrier
  v_mfma_f32_16x16x32_bf16 v[96:99], a[0:3], a[40:43], v[96:99]
  ds_read_b128 a[96:99], v27 offset:16384
  s_add_u32 m0, s73, 40960
  v_mfma_f32_16x16x32_bf16 v[100:103], a[0:3], a[44:47], v[100:103]
  ds_read_b128 a[100:103], v27 offset:18432
  v_mfma_f32_16x16x32_bf16 v[104:107], a[0:3], a[48:51], v[104:107]
  ds_read_b128 a[104:107], v27 offset:20480
  v_mfma_f32_16x16x32_bf16 v[108:111], a[0:3], a[52:55], v[108:111]
  ds_read_b128 a[108:111], v27 offset:22528
  s_mov_b32 s77, 1990656
  v_mfma_f32_16x16x32_bf16 v[124:127], a[4:7], a[52:55], v[124:127]
  v_mfma_f32_16x16x32_bf16 v[120:123], a[4:7], a[48:51], v[120:123]
  ds_read_b64_tr_b16 a[56:57], v23 offset:0
  v_mfma_f32_16x16x32_bf16 v[116:119], a[4:7], a[44:47], v[116:119]
  buffer_load_dwordx4 v10, s[12:15], s77 offen offset:0 lds
  v_mfma_f32_16x16x32_bf16 v[112:115], a[4:7], a[40:43], v[112:115]
  ds_read_b64_tr_b16 a[58:59], v23 offset:1280
  ds_read_b64_tr_b16 a[60:61], v23 offset:10240
  v_mfma_f32_16x16x32_bf16 v[128:131], a[8:11], a[40:43], v[128:131]
  ds_read_b64_tr_b16 a[62:63], v23 offset:11520
  v_mfma_f32_16x16x32_bf16 v[132:135], a[8:11], a[44:47], v[132:135]
  buffer_load_dwordx4 v11, s[12:15], s77 offen offset:1024 lds
  v_mfma_f32_16x16x32_bf16 v[136:139], a[8:11], a[48:51], v[136:139]
  ds_read_b64_tr_b16 a[64:65], v24 offset:32
  v_mfma_f32_16x16x32_bf16 v[140:143], a[8:11], a[52:55], v[140:143]
  ds_read_b64_tr_b16 a[66:67], v24 offset:1312
  v_mfma_f32_16x16x32_bf16 v[156:159], a[12:15], a[52:55], v[156:159]
  ds_read_b64_tr_b16 a[68:69], v24 offset:10272
  v_mfma_f32_16x16x32_bf16 v[152:155], a[12:15], a[48:51], v[152:155]
  buffer_load_dwordx4 v12, s[12:15], s77 offen offset:2048 lds
  v_mfma_f32_16x16x32_bf16 v[148:151], a[12:15], a[44:47], v[148:151]
  ds_read_b64_tr_b16 a[70:71], v24 offset:11552
  v_mfma_f32_16x16x32_bf16 v[144:147], a[12:15], a[40:43], v[144:147]
  ds_read_b64_tr_b16 a[72:73], v23 offset:64
  v_mfma_f32_16x16x32_bf16 v[160:163], a[16:19], a[40:43], v[160:163]
  buffer_load_dwordx4 v13, s[12:15], s77 offen offset:3072 lds
  v_mfma_f32_16x16x32_bf16 v[164:167], a[16:19], a[44:47], v[164:167]
  ds_read_b64_tr_b16 a[74:75], v23 offset:1344
  ds_read_b64_tr_b16 a[76:77], v23 offset:10304
  v_mfma_f32_16x16x32_bf16 v[168:171], a[16:19], a[48:51], v[168:171]
  ds_read_b64_tr_b16 a[78:79], v23 offset:11584
  v_mfma_f32_16x16x32_bf16 v[172:175], a[16:19], a[52:55], v[172:175]
  s_add_u32 m0, s73, 45056
  v_mfma_f32_16x16x32_bf16 v[188:191], a[20:23], a[52:55], v[188:191]
  ds_read_b64_tr_b16 a[80:81], v24 offset:96
  v_mfma_f32_16x16x32_bf16 v[184:187], a[20:23], a[48:51], v[184:187]
  ds_read_b64_tr_b16 a[82:83], v24 offset:1376
  v_mfma_f32_16x16x32_bf16 v[180:183], a[20:23], a[44:47], v[180:183]
  buffer_load_dwordx4 v14, s[12:15], s77 offen offset:0 lds
  v_mfma_f32_16x16x32_bf16 v[176:179], a[20:23], a[40:43], v[176:179]
  ds_read_b64_tr_b16 a[84:85], v24 offset:10336
  ds_read_b64_tr_b16 a[86:87], v24 offset:11616
  v_mfma_f32_16x16x32_bf16 v[192:195], a[24:27], a[40:43], v[192:195]
  v_mfma_f32_16x16x32_bf16 v[196:199], a[24:27], a[44:47], v[196:199]
  ds_read_b64_tr_b16 a[88:89], v25 offset:0
  v_mfma_f32_16x16x32_bf16 v[200:203], a[24:27], a[48:51], v[200:203]
  ds_read_b64_tr_b16 a[90:91], v25 offset:1280
  s_add_u32 m0, s74, 2048
  v_mfma_f32_16x16x32_bf16 v[204:207], a[24:27], a[52:55], v[204:207]
  ds_read_b64_tr_b16 a[92:93], v25 offset:10240
  v_mfma_f32_16x16x32_bf16 v[220:223], a[28:31], a[52:55], v[220:223]
  ds_read_b64_tr_b16 a[94:95], v25 offset:11520
  v_mfma_f32_16x16x32_bf16 v[216:219], a[28:31], a[48:51], v[216:219]
  s_movk_i32 s78, 1152
  v_mfma_f32_16x16x32_bf16 v[212:215], a[28:31], a[44:47], v[212:215]
  v_mfma_f32_16x16x32_bf16 v[208:211], a[28:31], a[40:43], v[208:211]
  v_mfma_f32_16x16x32_bf16 v[224:227], a[32:35], a[40:43], v[224:227]
  buffer_load_dwordx4 v17, s[16:19], s78 offen offset:0 lds
  v_mfma_f32_16x16x32_bf16 v[228:231], a[32:35], a[44:47], v[228:231]
  v_mfma_f32_16x16x32_bf16 v[232:235], a[32:35], a[48:51], v[232:235]
  v_mfma_f32_16x16x32_bf16 v[236:239], a[32:35], a[52:55], v[236:239]
  buffer_load_dwordx4 v18, s[16:19], s78 offen offset:1024 lds
  v_mfma_f32_16x16x32_bf16 v[252:255], a[36:39], a[52:55], v[252:255]
  v_mfma_f32_16x16x32_bf16 v[248:251], a[36:39], a[48:51], v[248:251]
  v_mfma_f32_16x16x32_bf16 v[244:247], a[36:39], a[44:47], v[244:247]
  v_mfma_f32_16x16x32_bf16 v[240:243], a[36:39], a[40:43], v[240:243]
  s_waitcnt vmcnt(24)
  v_cmp_ne_u32 vcc, s96, v9
  s_cbranch_vccz FBC_ok
  s_mov_b32 s7, 0x40000
FBC_l:
  s_lshl_b32 s31, s81, 3
  s_add_u32 s31, s31, s29
  s_mul_i32 s31, s31, 640
  s_add_u32 s31, s31, 655360
TS_8:
  s_cbranch_execz TR_FB
  v_min_u32 v9, 4, v1
  v_lshlrev_b32 v9, 7, v9
  buffer_load_dword v9, v9, s[8:11], s31 offen sc1
  s_waitcnt vmcnt(0)
  v_cmp_ne_u32 vcc, s96, v9
  s_sub_u32 s7, s7, 1
  s_cbranch_scc1 FBC_ok
  s_cbranch_vccnz FBC_l
FBC_ok:
  s_waitcnt vmcnt(17) lgkmcnt(0)
  s_barrier
  v_mfma_f32_16x16x32_bf16 v[96:99], a[56:59], a[96:99], v[96:99]
  ds_read_b128 a[40:43], v26 offset:32768
  s_add_u32 m0, s73, 61440
  v_mfma_f32_16x16x32_bf16 v[100:103], a[56:59], a[100:103], v[100:103]
  ds_read_b128 a[44:47], v26 offset:34816
  s_mul_i32 s31, s29, 7680
  v_mfma_f32_16x16x32_bf16 v[104:107], a[56:59], a[104:107], v[104:107]
  ds_read_b128 a[48:51], v26 offset:36864
  v_mfma_f32_16x16x32_bf16 v[108:111], a[56:59], a[108:111], v[108:111]
  ds_read_b128 a[52:55], v26 offset:38912
  s_mov_b32 s77, 2101248
  v_mfma_f32_16x16x32_bf16 v[124:127], a[60:63], a[108:111], v[124:127]
  s_add_u32 s31, s31, 720896
  v_mfma_f32_16x16x32_bf16 v[120:123], a[60:63], a[104:107], v[120:123]
  ds_read_b64_tr_b16 a[0:1], v20 offset:0
  v_mfma_f32_16x16x32_bf16 v[116:119], a[60:63], a[100:103], v[116:119]
  buffer_load_dwordx4 v10, s[12:15], s77 offen offset:0 lds
  v_mfma_f32_16x16x32_bf16 v[112:115], a[60:63], a[96:99], v[112:115]
  ds_read_b64_tr_b16 a[2:3], v20 offset:1280
  s_mul_i32 s32, s81, 5
  v_mfma_f32_16x16x32_bf16 v[128:131], a[64:67], a[96:99], v[128:131]
  ds_read_b64_tr_b16 a[4:5], v20 offset:10240
  ds_read_b64_tr_b16 a[6:7], v20 offset:11520
  v_mfma_f32_16x16x32_bf16 v[132:135], a[64:67], a[100:103], v[132:135]
  buffer_load_dwordx4 v11, s[12:15], s77 offen offset:1024 lds
  v_mfma_f32_16x16x32_bf16 v[136:139], a[64:67], a[104:107], v[136:139]
  s_cmp_eq_u32 s3, 3
  s_cselect_b32 s33, 2, 63
  v_mfma_f32_16x16x32_bf16 v[140:143], a[64:67], a[108:111], v[140:143]
  ds_read_b64_tr_b16 a[8:9], v21 offset:32
  ds_read_b64_tr_b16 a[10:11], v21 offset:1312
  v_mfma_f32_16x16x32_bf16 v[156:159], a[68:71], a[108:111], v[156:159]
  buffer_load_dwordx4 v12, s[12:15], s77 offen offset:2048 lds
  v_mfma_f32_16x16x32_bf16 v[152:155], a[68:71], a[104:107], v[152:155]
  v_lshrrev_b32 v9, 1, v1
  ds_read_b64_tr_b16 a[12:13], v21 offset:10272
  v_mfma_f32_16x16x32_bf16 v[148:151], a[68:71], a[100:103], v[148:151]
  ds_read_b64_tr_b16 a[14:15], v21 offset:11552
  v_min_u32 v9, 6, v9
  v_mfma_f32_16x16x32_bf16 v[144:147], a[68:71], a[96:99], v[144:147]
  buffer_load_dwordx4 v13, s[12:15], s77 offen offset:3072 lds
  v_mfma_f32_16x16x32_bf16 v[160:163], a[72:75], a[96:99], v[160:163]
  ds_read_b64_tr_b16 a[16:17], v20 offset:64
  ds_read_b64_tr_b16 a[18:19], v20 offset:1344
  v_mfma_f32_16x16x32_bf16 v[164:167], a[72:75], a[100:103], v[164:167]
  ds_read_b64_tr_b16 a[20:21], v20 offset:10304
  v_cmp_eq_u32 vcc, s33, v9
  v_mfma_f32_16x16x32_bf16 v[168:171], a[72:75], a[104:107], v[168:171]
  ds_read_b64_tr_b16 a[22:23], v20 offset:11584
  s_add_u32 m0, s73, 65536
  v_mfma_f32_16x16x32_bf16 v[172:175], a[72:75], a[108:111], v[172:175]
  v_mfma_f32_16x16x32_bf16 v[188:191], a[76:79], a[108:111], v[188:191]
  ds_read_b64_tr_b16 a[24:25], v21 offset:96
  v_and_b32 v2, 1, v1
  v_mfma_f32_16x16x32_bf16 v[184:187], a[76:79], a[104:107], v[184:187]
  buffer_load_dwordx4 v14, s[12:15], s77 offen offset:0 lds
  v_mfma_f32_16x16x32_bf16 v[180:183], a[76:79], a[100:103], v[180:183]
  ds_read_b64_tr_b16 a[26:27], v21 offset:1376
  ds_read_b64_tr_b16 a[28:29], v21 offset:10336
  v_mfma_f32_16x16x32_bf16 v[176:179], a[76:79], a[96:99], v[176:179]
  v_lshl_add_u32 v2, v2, 2, s32
  ds_read_b64_tr_b16 a[30:31], v21 offset:11616
  v_mfma_f32_16x16x32_bf16 v[192:195], a[80:83], a[96:99], v[192:195]
  s_add_u32 s79, s82, 35840
  v_mfma_f32_16x16x32_bf16 v[196:199], a[80:83], a[100:103], v[196:199]
  ds_read_b64_tr_b16 a[32:33], v22 offset:0
  v_cndmask_b32 v9, v9, 1, vcc
  v_mfma_f32_16x16x32_bf16 v[200:203], a[80:83], a[104:107], v[200:203]
  ds_read_b64_tr_b16 a[34:35], v22 offset:1280
  v_mfma_f32_16x16x32_bf16 v[204:207], a[80:83], a[108:111], v[204:207]
  buffer_load_dwordx4 a[116:119], v28, s[8:11], s79 offen offset:0 sc1
  v_mfma_f32_16x16x32_bf16 v[220:223], a[84:87], a[108:111], v[220:223]
  ds_read_b64_tr_b16 a[36:37], v22 offset:10240
  ds_read_b64_tr_b16 a[38:39], v22 offset:11520
  v_mfma_f32_16x16x32_bf16 v[216:219], a[84:87], a[104:107], v[216:219]
  v_lshrrev_b32 v2, 3, v2
  v_mfma_f32_16x16x32_bf16 v[212:215], a[84:87], a[100:103], v[212:215]
  buffer_load_dwordx4 a[120:123], v28, s[8:11], s79 offen offset:1024 sc1
  v_mfma_f32_16x16x32_bf16 v[208:211], a[84:87], a[96:99], v[208:211]
  v_mad_u32_u24 v9, v9, 5, v2
  v_mfma_f32_16x16x32_bf16 v[224:227], a[88:91], a[96:99], v[224:227]
  v_mfma_f32_16x16x32_bf16 v[228:231], a[88:91], a[100:103], v[228:231]
  buffer_load_dwordx4 a[124:127], v28, s[8:11], s79 offen offset:2048 sc1
  v_mfma_f32_16x16x32_bf16 v[232:235], a[88:91], a[104:107], v[232:235]
  v_lshlrev_b32 v9, 7, v9
  v_mfma_f32_16x16x32_bf16 v[236:239], a[88:91], a[108:111], v[236:239]
  v_mfma_f32_16x16x32_bf16 v[252:255], a[92:95], a[108:111], v[252:255]
  buffer_load_dwordx4 a[128:131], v28, s[8:11], s79 offen offset:3072 sc1
  v_mfma_f32_16x16x32_bf16 v[248:251], a[92:95], a[104:107], v[248:251]
  buffer_load_dword v9, v9, s[8:11], s31 offen sc1
  v_mfma_f32_16x16x32_bf16 v[244:247], a[92:95], a[100:103], v[244:247]
  v_mfma_f32_16x16x32_bf16 v[240:243], a[92:95], a[96:99], v[240:243]
  s_waitcnt vmcnt(21) lgkmcnt(0)
  s_barrier
  v_mfma_f32_16x16x32_bf16 v[96:99], a[0:3], a[40:43], v[96:99]
  buffer_load_dwordx4 a[132:135], v29, s[8:11], s79 offen offset:0 sc1
  v_mfma_f32_16x16x32_bf16 v[100:103], a[0:3], a[44:47], v[100:103]
  ds_read_b128 a[96:99], v27 offset:32768
  ds_read_b128 a[100:103], v27 offset:34816
  v_mfma_f32_16x16x32_bf16 v[104:107], a[0:3], a[48:51], v[104:107]
  s_waitcnt vmcnt(18)
  ds_read_b128 a[104:107], v27 offset:36864
  v_mfma_f32_16x16x32_bf16 v[108:111], a[0:3], a[52:55], v[108:111]
  ds_read_b128 a[108:111], v27 offset:38912
  s_add_u32 s79, s82, 40960
  v_mfma_f32_16x16x32_bf16 v[124:127], a[4:7], a[52:55], v[124:127]
  v_xor_b32 v4, s96, v57
  v_mfma_f32_16x16x32_bf16 v[120:123], a[4:7], a[48:51], v[120:123]
  ds_read_b64_tr_b16 a[56:57], v20 offset:20480
  v_xor_b32 v5, s96, v59
  v_mfma_f32_16x16x32_bf16 v[116:119], a[4:7], a[44:47], v[116:119]
  ds_read_b64_tr_b16 a[58:59], v20 offset:21760
  v_mfma_f32_16x16x32_bf16 v[112:115], a[4:7], a[40:43], v[112:115]
  buffer_load_dwordx4 a[136:139], v28, s[8:11], s79 offen offset:0 sc1
  v_mfma_f32_16x16x32_bf16 v[128:131], a[8:11], a[40:43], v[128:131]
  ds_read_b64_tr_b16 a[60:61], v20 offset:30720
  v_or_b32 v4, v4, v5
  v_mfma_f32_16x16x32_bf16 v[132:135], a[8:11], a[44:47], v[132:135]
  ds_read_b64_tr_b16 a[62:63], v20 offset:32000
  v_xor_b32 v5, s96, v61
  v_mfma_f32_16x16x32_bf16 v[136:139], a[8:11], a[48:51], v[136:139]
  ds_read_b64_tr_b16 a[64:65], v21 offset:20512
  v_mfma_f32_16x16x32_bf16 v[140:143], a[8:11], a[52:55], v[140:143]
  buffer_load_dwordx4 a[140:143], v28, s[8:11], s79 offen offset:1024 sc1
  v_mfma_f32_16x16x32_bf16 v[156:159], a[12:15], a[52:55], v[156:159]
  ds_read_b64_tr_b16 a[66:67], v21 offset:21792
  ds_read_b64_tr_b16 a[68:69], v21 offset:30752
  v_mfma_f32_16x16x32_bf16 v[152:155], a[12:15], a[48:51], v[152:155]
  v_or_b32 v4, v4, v5
  ds_read_b64_tr_b16 a[70:71], v21 offset:32032
  v_mfma_f32_16x16x32_bf16 v[148:151], a[12:15], a[44:47], v[148:151]
  v_xor_b32 v5, s96, v63
  v_mfma_f32_16x16x32_bf16 v[144:147], a[12:15], a[40:43], v[144:147]
  buffer_load_dwordx4 a[144:147], v28, s[8:11], s79 offen offset:2048 sc1
  v_mfma_f32_16x16x32_bf16 v[160:163], a[16:19], a[40:43], v[160:163]
  ds_read_b64_tr_b16 a[72:73], v20 offset:20544
  ds_read_b64_tr_b16 a[74:75], v20 offset:21824
  v_mfma_f32_16x16x32_bf16 v[164:167], a[16:19], a[44:47], v[164:167]
  v_or_b32 v4, v4, v5
  ds_read_b64_tr_b16 a[76:77], v20 offset:30784
  v_mfma_f32_16x16x32_bf16 v[168:171], a[16:19], a[48:51], v[168:171]
  ds_read_b64_tr_b16 a[78:79], v20 offset:32064
  v_xor_b32 v5, s96, v65
  v_mfma_f32_16x16x32_bf16 v[172:175], a[16:19], a[52:55], v[172:175]
  buffer_load_dwordx4 a[148:151], v28, s[8:11], s79 offen offset:3072 sc1
  v_mfma_f32_16x16x32_bf16 v[188:191], a[20:23], a[52:55], v[188:191]
  ds_read_b64_tr_b16 a[80:81], v21 offset:20576
  v_mfma_f32_16x16x32_bf16 v[184:187], a[20:23], a[48:51], v[184:187]
  ds_read_b64_tr_b16 a[82:83], v21 offset:21856
  v_or_b32 v4, v4, v5
  v_mfma_f32_16x16x32_bf16 v[180:183], a[20:23], a[44:47], v[180:183]
  ds_read_b64_tr_b16 a[84:85], v21 offset:30816
  v_mfma_f32_16x16x32_bf16 v[176:179], a[20:23], a[40:43], v[176:179]
  buffer_load_dwordx4 a[152:155], v29, s[8:11], s79 offen offset:0 sc1
  v_mfma_f32_16x16x32_bf16 v[192:195], a[24:27], a[40:43], v[192:195]
  ds_read_b64_tr_b16 a[86:87], v21 offset:32096
  v_xor_b32 v5, s96, v67
  v_mfma_f32_16x16x32_bf16 v[196:199], a[24:27], a[44:47], v[196:199]
  ds_read_b64_tr_b16 a[88:89], v22 offset:20480
  v_or_b32 v4, v4, v5
  v_mfma_f32_16x16x32_bf16 v[200:203], a[24:27], a[48:51], v[200:203]
  ds_read_b64_tr_b16 a[90:91], v22 offset:21760
  v_mfma_f32_16x16x32_bf16 v[204:207], a[24:27], a[52:55], v[204:207]
  ds_read_b64_tr_b16 a[92:93], v22 offset:30720
  s_add_u32 s79, s82, 46080
  v_mfma_f32_16x16x32_bf16 v[220:223], a[28:31], a[52:55], v[220:223]
  v_xor_b32 v5, s96, v69
  ds_read_b64_tr_b16 a[94:95], v22 offset:32000
  v_mfma_f32_16x16x32_bf16 v[216:219], a[28:31], a[48:51], v[216:219]
  v_mfma_f32_16x16x32_bf16 v[212:215], a[28:31], a[44:47], v[212:215]
  v_or_b32 v4, v4, v5
  v_mfma_f32_16x16x32_bf16 v[208:211], a[28:31], a[40:43], v[208:211]
  buffer_load_dwordx4 a[156:159], v28, s[8:11], s79 offen offset:0 sc1
  v_mfma_f32_16x16x32_bf16 v[224:227], a[32:35], a[40:43], v[224:227]
  v_xor_b32 v5, s96, v71
  v_mfma_f32_16x16x32_bf16 v[228:231], a[32:35], a[44:47], v[228:231]
  v_mfma_f32_16x16x32_bf16 v[232:235], a[32:35], a[48:51], v[232:235]
  v_or_b32 v4, v4, v5
  v_mfma_f32_16x16x32_bf16 v[236:239], a[32:35], a[52:55], v[236:239]
  buffer_load_dwordx4 a[160:163], v28, s[8:11], s79 offen offset:1024 sc1
  v_mfma_f32_16x16x32_bf16 v[252:255], a[36:39], a[52:55], v[252:255]
  v_cmp_ne_u32 vcc, 0, v4
  v_mfma_f32_16x16x32_bf16 v[248:251], a[36:39], a[48:51], v[248:251]
  v_mfma_f32_16x16x32_bf16 v[244:247], a[36:39], a[44:47], v[244:247]
  v_mfma_f32_16x16x32_bf16 v[240:243], a[36:39], a[40:43], v[240:243]
  s_cbranch_vccz FBG_ok
  s_mov_b32 s7, 0x40000
FBG_l:
  s_mul_i32 s75, s72, 1728
  s_mul_i32 s76, s71, 80
  s_add_u32 s75, s75, s76
  s_add_u32 s75, s75, s70
  s_lshl_b32 s75, s75, 3
  s_add_u32 s75, s75, 851968
  s_add_u32 s76, s75, 27648
  v_min_u32 v2, 624, v28
  buffer_load_dwordx4 v[56:59], v2, s[8:11], s75 offen sc1
  buffer_load_dwordx4 v[60:63], v2, s[8:11], s76 offen sc1
  v_and_b32 v2, 7, v1
  v_lshlrev_b32 v2, 3, v2
  v_and_b32 v3, 8, v1
  v_lshl_add_u32 v2, v3, 4, v2
  s_lshl1_add_u32 s75, s68, s71
  s_lshl_b32 s75, s75, 10
  s_add_u32 s75, s75, 196608
  buffer_load_dwordx2 v[64:65], v2, s[8:11], s75 offen offset:0 sc1
  buffer_load_dwordx2 v[66:67], v2, s[8:11], s75 offen offset:256 sc1
  buffer_load_dwordx2 v[68:69], v2, s[8:11], s75 offen offset:512 sc1
  buffer_load_dwordx2 v[70:71], v2, s[8:11], s75 offen offset:768 sc1
  s_waitcnt vmcnt(0)
  v_xor_b32 v4, s96, v57
  v_xor_b32 v5, s96, v59
  v_or_b32 v4, v4, v5
  v_xor_b32 v5, s96, v61
  v_or_b32 v4, v4, v5
  v_xor_b32 v5, s96, v63
  v_or_b32 v4, v4, v5
  v_xor_b32 v5, s96, v65
  v_or_b32 v4, v4, v5
  v_xor_b32 v5, s96, v67
  v_or_b32 v4, v4, v5
  v_xor_b32 v5, s96, v69
  v_or_b32 v4, v4, v5
  v_xor_b32 v5, s96, v71
  v_or_b32 v4, v4, v5
  v_cmp_ne_u32 vcc, 0, v4
  s_sub_u32 s7, s7, 1
  s_cbranch_scc1 FBG_ok
  s_cbranch_vccnz FBG_l
FBG_ok:
  s_waitcnt vmcnt(8)
  v_cmp_ne_u32 vcc, s96, v9
  s_cbranch_vccz FBP_ok
  s_mov_b32 s7, 0x40000
FBP_l:
  s_mul_i32 s31, s29, 7680
  s_add_u32 s31, s31, 720896
  s_mul_i32 s32, s81, 5
  s_cmp_eq_u32 s3, 3
  s_cselect_b32 s33, 2, 63
  v_lshrrev_b32 v9, 1, v1
  v_min_u32 v9, 6, v9
  v_cmp_eq_u32 vcc, s33, v9
  v_and_b32 v2, 1, v1
  v_lshl_add_u32 v2, v2, 2, s32
  v_cndmask_b32 v9, v9, 1, vcc
  v_lshrrev_b32 v2, 3, v2
  v_mad_u32_u24 v9, v9, 5, v2
  v_lshlrev_b32 v9, 7, v9
  buffer_load_dword v9, v9, s[8:11], s31 offen sc1
  s_waitcnt vmcnt(0)
  v_cmp_ne_u32 vcc, s96, v9
  s_sub_u32 s7, s7, 1
  s_cbranch_scc1 FBP_ok
  s_cbranch_vccnz FBP_l
FBP_ok:
  s_waitcnt lgkmcnt(0)
  s_barrier
  v_mfma_f32_16x16x32_bf16 v[96:99], a[56:59], a[96:99], v[96:99]
  buffer_load_dwordx4 a[164:167], v28, s[8:11], s79 offen offset:2048 sc1
  v_mfma_f32_16x16x32_bf16 v[100:103], a[56:59], a[100:103], v[100:103]
  ds_read_b128 a[40:43], v26 offset:0
  ds_read_b128 a[44:47], v26 offset:2048
  v_mfma_f32_16x16x32_bf16 v[104:107], a[56:59], a[104:107], v[104:107]
  v_add_f32 v56, v56, v60
  ds_read_b128 a[48:51], v26 offset:4096
  v_mfma_f32_16x16x32_bf16 v[108:111], a[56:59], a[108:111], v[108:111]
  buffer_load_dwordx4 a[168:171], v28, s[8:11], s79 offen offset:3072 sc1
  v_mfma_f32_16x16x32_bf16 v[124:127], a[60:63], a[108:111], v[124:127]
  v_add_f32 v57, v58, v62
  ds_read_b128 a[52:55], v26 offset:6144
  v_mfma_f32_16x16x32_bf16 v[120:123], a[60:63], a[104:107], v[120:123]
  s_lshl_b32 s75, s72, 10
  s_mul_i32 s76, s71, 320
  v_mfma_f32_16x16x32_bf16 v[116:119], a[60:63], a[100:103], v[116:119]
  ds_read_b64_tr_b16 a[0:1], v20 offset:40960
  ds_read_b64_tr_b16 a[2:3], v20 offset:42240
  v_mfma_f32_16x16x32_bf16 v[112:115], a[60:63], a[96:99], v[112:115]
  buffer_load_dwordx4 a[172:175], v29, s[8:11], s79 offen offset:0 sc1
  v_mfma_f32_16x16x32_bf16 v[128:131], a[64:67], a[96:99], v[128:131]
  s_add_u32 s75, s75, s76
  ds_read_b64_tr_b16 a[4:5], v20 offset:51200
  v_mfma_f32_16x16x32_bf16 v[132:135], a[64:67], a[100:103], v[132:135]
  s_add_u32 s75, s75, 131072
  ds_read_b64_tr_b16 a[6:7], v20 offset:52480
  v_mfma_f32_16x16x32_bf16 v[136:139], a[64:67], a[104:107], v[136:139]
  v_min_u32 v2, 39, v1
  ds_read_b64_tr_b16 a[8:9], v21 offset:40992
  v_mfma_f32_16x16x32_bf16 v[140:143], a[64:67], a[108:111], v[140:143]
  v_lshl_add_u32 v2, v2, 3, s75
  ds_read_b64_tr_b16 a[10:11], v21 offset:42272
  v_mfma_f32_16x16x32_bf16 v[156:159], a[68:71], a[108:111], v[156:159]
  s_add_u32 s79, s82, 51200
  ds_write_b64 v2, v[56:57]
  v_mfma_f32_16x16x32_bf16 v[152:155], a[68:71], a[104:107], v[152:155]
  ds_read_b64_tr_b16 a[12:13], v21 offset:51232
  v_lshlrev_b32 v44, 16, v64
  v_mfma_f32_16x16x32_bf16 v[148:151], a[68:71], a[100:103], v[148:151]
  ds_read_b64_tr_b16 a[14:15], v21 offset:52512
  v_and_b32 v52, 0xffff0000, v64
  v_mfma_f32_16x16x32_bf16 v[144:147], a[68:71], a[96:99], v[144:147]
  buffer_load_dwordx4 a[176:179], v28, s[8:11], s79 offen offset:0 sc1
  v_mfma_f32_16x16x32_bf16 v[160:163], a[72:75], a[96:99], v[160:163]
  ds_read_b64_tr_b16 a[16:17], v20 offset:41024
  v_rcp_f32 v48, v52
  v_mfma_f32_16x16x32_bf16 v[164:167], a[72:75], a[100:103], v[164:167]
  ds_read_b64_tr_b16 a[18:19], v20 offset:42304
  v_mfma_f32_16x16x32_bf16 v[168:171], a[72:75], a[104:107], v[168:171]
  v_mul_f32 v52, v52, v52
  ds_read_b64_tr_b16 a[20:21], v20 offset:51264
  v_mfma_f32_16x16x32_bf16 v[172:175], a[72:75], a[108:111], v[172:175]
  buffer_load_dwordx4 a[180:183], v28, s[8:11], s79 offen offset:1024 sc1
  v_mfma_f32_16x16x32_bf16 v[188:191], a[76:79], a[108:111], v[188:191]
  ds_read_b64_tr_b16 a[22:23], v20 offset:52544
  v_mul_f32 v48, 0xbfb8aa3b, v48
  v_mfma_f32_16x16x32_bf16 v[184:187], a[76:79], a[104:107], v[184:187]
  v_lshlrev_b32 v45, 16, v66
  ds_read_b64_tr_b16 a[24:25], v21 offset:41056
  v_mfma_f32_16x16x32_bf16 v[180:183], a[76:79], a[100:103], v[180:183]
  v_and_b32 v53, 0xffff0000, v66
  ds_read_b64_tr_b16 a[26:27], v21 offset:42336
  v_mfma_f32_16x16x32_bf16 v[176:179], a[76:79], a[96:99], v[176:179]
  buffer_load_dwordx4 a[184:187], v28, s[8:11], s79 offen offset:2048 sc1
  v_mfma_f32_16x16x32_bf16 v[192:195], a[80:83], a[96:99], v[192:195]
  v_rcp_f32 v49, v53
  v_mfma_f32_16x16x32_bf16 v[196:199], a[80:83], a[100:103], v[196:199]
  ds_read_b64_tr_b16 a[28:29], v21 offset:51296
  ds_read_b64_tr_b16 a[30:31], v21 offset:52576
  v_mfma_f32_16x16x32_bf16 v[200:203], a[80:83], a[104:107], v[200:203]
  v_mul_f32 v53, v53, v53
  v_mul_f32 v49, 0xbfb8aa3b, v49
  v_mfma_f32_16x16x32_bf16 v[204:207], a[80:83], a[108:111], v[204:207]
  buffer_load_dwordx4 a[188:191], v28, s[8:11], s79 offen offset:3072 sc1
  v_mfma_f32_16x16x32_bf16 v[220:223], a[84:87], a[108:111], v[220:223]
  ds_read_b64_tr_b16 a[32:33], v22 offset:40960
  v_lshlrev_b32 v46, 16, v68
  v_mfma_f32_16x16x32_bf16 v[216:219], a[84:87], a[104:107], v[216:219]
  ds_read_b64_tr_b16 a[34:35], v22 offset:42240
  ds_read_b64_tr_b16 a[36:37], v22 offset:51200
  v_mfma_f32_16x16x32_bf16 v[212:215], a[84:87], a[100:103], v[212:215]
  v_and_b32 v54, 0xffff0000, v68
  ds_read_b64_tr_b16 a[38:39], v22 offset:52480
  v_mfma_f32_16x16x32_bf16 v[208:211], a[84:87], a[96:99], v[208:211]
  buffer_load_dwordx4 a[192:195], v29, s[8:11], s79 offen offset:0 sc1
  v_mfma_f32_16x16x32_bf16 v[224:227], a[88:91], a[96:99], v[224:227]
  v_rcp_f32 v50, v54
  v_mfma_f32_16x16x32_bf16 v[228:231], a[88:91], a[100:103], v[228:231]
  v_mul_f32 v54, v54, v54
  v_mul_f32 v50, 0xbfb8aa3b, v50
  v_mfma_f32_16x16x32_bf16 v[232:235], a[88:91], a[104:107], v[232:235]
  v_lshlrev_b32 v47, 16, v70
  v_and_b32 v55, 0xffff0000, v70
  v_mfma_f32_16x16x32_bf16 v[236:239], a[88:91], a[108:111], v[236:239]
  s_add_u32 s79, s82, 56320
  v_rcp_f32 v51, v55
  v_mfma_f32_16x16x32_bf16 v[252:255], a[92:95], a[108:111], v[252:255]
  v_mul_f32 v55, v55, v55
  v_mfma_f32_16x16x32_bf16 v[248:251], a[92:95], a[104:107], v[248:251]
  v_mul_f32 v51, 0xbfb8aa3b, v51
  v_mfma_f32_16x16x32_bf16 v[244:247], a[92:95], a[100:103], v[244:247]
  v_mfma_f32_16x16x32_bf16 v[240:243], a[92:95], a[96:99], v[240:243]
  s_waitcnt lgkmcnt(0)
  s_barrier
  v_mfma_f32_16x16x32_bf16 v[96:99], a[0:3], a[40:43], v[96:99]
  buffer_load_dwordx4 a[196:199], v28, s[8:11], s79 offen offset:0 sc1
  v_mfma_f32_16x16x32_bf16 v[100:103], a[0:3], a[44:47], v[100:103]
  ds_read_b128 a[96:99], v27 offset:0
  ds_read_b128 a[100:103], v27 offset:2048
  v_mfma_f32_16x16x32_bf16 v[104:107], a[0:3], a[48:51], v[104:107]
  v_and_b32 v2, 48, v1
  ds_read_b128 a[104:107], v27 offset:4096
  v_mfma_f32_16x16x32_bf16 v[108:111], a[0:3], a[52:55], v[108:111]
  buffer_load_dwordx4 a[200:203], v28, s[8:11], s79 offen offset:1024 sc1
  v_mfma_f32_16x16x32_bf16 v[124:127], a[4:7], a[52:55], v[124:127]
  ds_read_b128 a[108:111], v27 offset:6144
  s_mul_i32 s75, s72, 384
  v_mfma_f32_16x16x32_bf16 v[120:123], a[4:7], a[48:51], v[120:123]
  ds_read_b64_tr_b16 a[56:57], v23 offset:0
  s_add_u32 s75, s75, 131072
  v_mfma_f32_16x16x32_bf16 v[116:119], a[4:7], a[44:47], v[116:119]
  ds_read_b64_tr_b16 a[58:59], v23 offset:1280
  v_mfma_f32_16x16x32_bf16 v[112:115], a[4:7], a[40:43], v[112:115]
  buffer_load_dwordx4 a[204:207], v28, s[8:11], s79 offen offset:2048 sc1
  v_mfma_f32_16x16x32_bf16 v[128:131], a[8:11], a[40:43], v[128:131]
  ds_read_b64_tr_b16 a[60:61], v23 offset:10240
  v_add_u32 v3, s75, v2
  v_mfma_f32_16x16x32_bf16 v[132:135], a[8:11], a[44:47], v[132:135]
  ds_read_b64_tr_b16 a[62:63], v23 offset:11520
  s_lshl_b32 s75, s72, 6
  v_mfma_f32_16x16x32_bf16 v[136:139], a[8:11], a[48:51], v[136:139]
  ds_read_b64_tr_b16 a[64:65], v24 offset:32
  v_mfma_f32_16x16x32_bf16 v[140:143], a[8:11], a[52:55], v[140:143]
  buffer_load_dwordx4 a[208:211], v28, s[8:11], s79 offen offset:3072 sc1
  v_mfma_f32_16x16x32_bf16 v[156:159], a[12:15], a[52:55], v[156:159]
  ds_read_b64_tr_b16 a[66:67], v24 offset:1312
  ds_read_b64_tr_b16 a[68:69], v24 offset:10272
  v_mfma_f32_16x16x32_bf16 v[152:155], a[12:15], a[48:51], v[152:155]
  s_add_u32 s75, s75, 131328
  ds_read_b64_tr_b16 a[70:71], v24 offset:11552
  v_mfma_f32_16x16x32_bf16 v[148:151], a[12:15], a[44:47], v[148:151]
  v_add_u32 v2, s75, v2
  v_mfma_f32_16x16x32_bf16 v[144:147], a[12:15], a[40:43], v[144:147]
  buffer_load_dwordx4 a[212:215], v29, s[8:11], s79 offen offset:0 sc1
  v_mfma_f32_16x16x32_bf16 v[160:163], a[16:19], a[40:43], v[160:163]
  ds_read_b64_tr_b16 a[72:73], v23 offset:64
  ds_read_b64_tr_b16 a[74:75], v23 offset:1344
  v_mfma_f32_16x16x32_bf16 v[164:167], a[16:19], a[44:47], v[164:167]
  ds_read_b128 v[56:59], v3 offset:0
  ds_read_b64_tr_b16 a[76:77], v23 offset:10304
  v_mfma_f32_16x16x32_bf16 v[168:171], a[16:19], a[48:51], v[168:171]
  ds_read_b64_tr_b16 a[78:79], v23 offset:11584
  ds_read_b128 v[60:63], v3 offset:1024
  v_mfma_f32_16x16x32_bf16 v[172:175], a[16:19], a[52:55], v[172:175]
  s_add_u32 s79, s82, 0
  v_mfma_f32_16x16x32_bf16 v[188:191], a[20:23], a[52:55], v[188:191]
  ds_read_b64_tr_b16 a[80:81], v24 offset:96
  v_mfma_f32_16x16x32_bf16 v[184:187], a[20:23], a[48:51], v[184:187]
  ds_read_b64_tr_b16 a[82:83], v24 offset:1376
  ds_read_b128 v[64:67], v3 offset:64
  v_mfma_f32_16x16x32_bf16 v[180:183], a[20:23], a[44:47], v[180:183]
  ds_read_b64_tr_b16 a[84:85], v24 offset:10336
  v_mfma_f32_16x16x32_bf16 v[176:179], a[20:23], a[40:43], v[176:179]
  buffer_load_dwordx4 a[216:219], v28, s[8:11], s79 offen offset:0 sc1
  v_mfma_f32_16x16x32_bf16 v[192:195], a[24:27], a[40:43], v[192:195]
  ds_read_b64_tr_b16 a[86:87], v24 offset:11616
  ds_read_b128 v[68:71], v3 offset:1088
  v_mfma_f32_16x16x32_bf16 v[196:199], a[24:27], a[44:47], v[196:199]
  ds_read_b64_tr_b16 a[88:89], v25 offset:0
  ds_read_b128 v[72:75], v3 offset:128
  v_mfma_f32_16x16x32_bf16 v[200:203], a[24:27], a[48:51], v[200:203]
  ds_read_b64_tr_b16 a[90:91], v25 offset:1280
  v_mfma_f32_16x16x32_bf16 v[204:207], a[24:27], a[52:55], v[204:207]
  buffer_load_dwordx4 a[220:223], v28, s[8:11], s79 offen offset:1024 sc1
  v_mfma_f32_16x16x32_bf16 v[220:223], a[28:31], a[52:55], v[220:223]
  ds_read_b64_tr_b16 a[92:93], v25 offset:10240
  ds_read_b128 v[76:79], v3 offset:1152
  v_mfma_f32_16x16x32_bf16 v[216:219], a[28:31], a[48:51], v[216:219]
  ds_read_b64_tr_b16 a[94:95], v25 offset:11520
  v_mfma_f32_16x16x32_bf16 v[212:215], a[28:31], a[44:47], v[212:215]
  ds_read_b128 v[80:83], v3 offset:192
  v_mfma_f32_16x16x32_bf16 v[208:211], a[28:31], a[40:43], v[208:211]
  buffer_load_dwordx4 a[224:227], v28, s[8:11], s79 offen offset:2048 sc1
  v_mfma_f32_16x16x32_bf16 v[224:227], a[32:35], a[40:43], v[224:227]
  ds_read_b128 v[84:87], v3 offset:1216
  v_mfma_f32_16x16x32_bf16 v[228:231], a[32:35], a[44:47], v[228:231]
  v_mfma_f32_16x16x32_bf16 v[232:235], a[32:35], a[48:51], v[232:235]
  ds_read_b128 v[88:91], v2 offset:0
  v_mfma_f32_16x16x32_bf16 v[236:239], a[32:35], a[52:55], v[236:239]
  buffer_load_dwordx4 a[228:231], v28, s[8:11], s79 offen offset:3072 sc1
  v_mfma_f32_16x16x32_bf16 v[252:255], a[36:39], a[52:55], v[252:255]
  ds_read_b128 v[92:95], v2 offset:1024
  v_mfma_f32_16x16x32_bf16 v[248:251], a[36:39], a[48:51], v[248:251]
  v_mfma_f32_16x16x32_bf16 v[244:247], a[36:39], a[44:47], v[244:247]
  v_mfma_f32_16x16x32_bf16 v[240:243], a[36:39], a[40:43], v[240:243]
  s_waitcnt lgkmcnt(0)
  s_barrier
  v_mfma_f32_16x16x32_bf16 v[96:99], a[56:59], a[96:99], v[96:99]
  buffer_load_dwordx4 a[232:235], v29, s[8:11], s79 offen offset:0 sc1
  v_mfma_f32_16x16x32_bf16 v[100:103], a[56:59], a[100:103], v[100:103]
  s_mov_b32 s24, s52
  s_mov_b32 s25, s53
  v_mfma_f32_16x16x32_bf16 v[104:107], a[56:59], a[104:107], v[104:107]
  s_mov_b32 s26, 0x500
  s_mov_b32 s27, 0x20000
  v_mfma_f32_16x16x32_bf16 v[108:111], a[56:59], a[108:111], v[108:111]
  s_mov_b32 s20, s62
  v_mfma_f32_16x16x32_bf16 v[124:127], a[60:63], a[108:111], v[124:127]
  s_mov_b32 s21, s63
  s_mov_b32 s22, 0x500000
  v_mfma_f32_16x16x32_bf16 v[120:123], a[60:63], a[104:107], v[120:123]
  s_add_u32 s79, s82, 5120
  s_mov_b32 s23, 0x20000
  v_mfma_f32_16x16x32_bf16 v[116:119], a[60:63], a[100:103], v[116:119]
  s_lshl1_add_u32 s32, s80, s28
  s_lshl_b32 s32, s32, 6
  v_mfma_f32_16x16x32_bf16 v[112:115], a[60:63], a[96:99], v[112:115]
  s_lshl_b32 s33, s3, 4
  s_add_u32 s32, s32, s33
  v_mfma_f32_16x16x32_bf16 v[128:131], a[64:67], a[96:99], v[128:131]
  v_and_b32 v2, 12, v1
  v_lshrrev_b32 v3, 4, v1
  v_mfma_f32_16x16x32_bf16 v[132:135], a[64:67], a[100:103], v[132:135]
  v_add_u32 v2, v2, v3
  v_mfma_f32_16x16x32_bf16 v[136:139], a[64:67], a[104:107], v[136:139]
  v_mul_u32_u24 v12, 160, v2
  v_add_u32 v2, s32, v2
  v_mfma_f32_16x16x32_bf16 v[140:143], a[64:67], a[108:111], v[140:143]
  buffer_load_dwordx4 a[236:239], v28, s[8:11], s79 offen offset:0 sc1
  v_mfma_f32_16x16x32_bf16 v[156:159], a[68:71], a[108:111], v[156:159]
  v_lshrrev_b32 v15, 3, v2
  v_lshlrev_b32 v15, 7, v15
  v_mfma_f32_16x16x32_bf16 v[152:155], a[68:71], a[104:107], v[152:155]
  v_and_b32 v3, 7, v2
  v_lshl_add_u32 v15, v3, 3, v15
  v_mfma_f32_16x16x32_bf16 v[148:151], a[68:71], a[100:103], v[148:151]
  v_mul_u32_u24 v2, 2560, v2
  s_mul_i32 s98, s81, 160
  v_mfma_f32_16x16x32_bf16 v[144:147], a[68:71], a[96:99], v[144:147]
  s_mul_i32 s97, s32, 1280
  s_add_u32 s97, s97, s98
  v_mfma_f32_16x16x32_bf16 v[160:163], a[72:75], a[96:99], v[160:163]
  buffer_load_dwordx4 a[240:243], v28, s[8:11], s79 offen offset:1024 sc1
  v_mfma_f32_16x16x32_bf16 v[164:167], a[72:75], a[100:103], v[164:167]
  s_lshl_b32 s33, s98, 1
  v_and_b32 v3, 3, v1
  v_mfma_f32_16x16x32_bf16 v[168:171], a[72:75], a[104:107], v[168:171]
  v_lshl_add_u32 v13, v3, 4, v2
  v_add_u32 v13, s33, v13
  v_mfma_f32_16x16x32_bf16 v[172:175], a[72:75], a[108:111], v[172:175]
  s_mul_i32 s101, s3, 20480
  s_add_u32 s100, s101, 81920
  v_mfma_f32_16x16x32_bf16 v[188:191], a[76:79], a[108:111], v[188:191]
  v_lshl_add_u32 v14, v3, 3, s100
  v_add_u32 v12, v12, v14
  v_mfma_f32_16x16x32_bf16 v[184:187], a[76:79], a[104:107], v[184:187]
  s_movk_i32 s33, 6554
  v_add_u32 v2, 0, v1
  v_mfma_f32_16x16x32_bf16 v[180:183], a[76:79], a[100:103], v[180:183]
  buffer_load_dwordx4 a[244:247], v28, s[8:11], s79 offen offset:2048 sc1
  v_mfma_f32_16x16x32_bf16 v[176:179], a[76:79], a[96:99], v[176:179]
  v_min_u32 v2, 159, v2
  v_mul_u32_u24 v3, s33, v2
  v_mfma_f32_16x16x32_bf16 v[192:195], a[80:83], a[96:99], v[192:195]
  v_lshrrev_b32 v3, 16, v3
  v_mul_u32_u24 v3, 1120, v3
  v_mfma_f32_16x16x32_bf16 v[196:199], a[80:83], a[100:103], v[196:199]
  v_lshl_add_u32 v16, v2, 4, v3
  v_add_u32 v2, 64, v1
  v_mfma_f32_16x16x32_bf16 v[200:203], a[80:83], a[104:107], v[200:203]
  v_min_u32 v2, 159, v2
  v_mul_u32_u24 v3, s33, v2
  v_mfma_f32_16x16x32_bf16 v[204:207], a[80:83], a[108:111], v[204:207]
  buffer_load_dwordx4 a[248:251], v28, s[8:11], s79 offen offset:3072 sc1
  v_mfma_f32_16x16x32_bf16 v[220:223], a[84:87], a[108:111], v[220:223]
  v_lshrrev_b32 v3, 16, v3
  v_mul_u32_u24 v3, 1120, v3
  v_mfma_f32_16x16x32_bf16 v[216:219], a[84:87], a[104:107], v[216:219]
  v_lshl_add_u32 v17, v2, 4, v3
  v_add_u32 v2, 128, v1
  v_mfma_f32_16x16x32_bf16 v[212:215], a[84:87], a[100:103], v[212:215]
  v_min_u32 v2, 159, v2
  v_mul_u32_u24 v3, s33, v2
  v_mfma_f32_16x16x32_bf16 v[208:211], a[84:87], a[96:99], v[208:211]
  v_lshrrev_b32 v3, 16, v3
  v_mul_u32_u24 v3, 1120, v3
  v_mfma_f32_16x16x32_bf16 v[224:227], a[88:91], a[96:99], v[224:227]
  v_lshl_add_u32 v18, v2, 4, v3
  v_min_u32 v19, 144, v28
  v_mfma_f32_16x16x32_bf16 v[228:231], a[88:91], a[100:103], v[228:231]
  buffer_load_dwordx4 a[252:255], v29, s[8:11], s79 offen offset:0 sc1
  v_mfma_f32_16x16x32_bf16 v[232:235], a[88:91], a[104:107], v[232:235]
  s_mul_i32 s75, s3, 5120
  v_add_u32 v23, s75, v28
  v_mfma_f32_16x16x32_bf16 v[236:239], a[88:91], a[108:111], v[236:239]
  v_add_u32 v24, 40960, v23
  s_mul_i32 s4, s95, 5120
  v_mfma_f32_16x16x32_bf16 v[252:255], a[92:95], a[108:111], v[252:255]
  s_add_u32 s4, s4, 5242880
  s_xor_b32 s5, s95, 4
  v_mfma_f32_16x16x32_bf16 v[248:251], a[92:95], a[104:107], v[248:251]
  s_mul_i32 s5, s5, 5120
  s_add_u32 s5, s5, 5242880
  v_mfma_f32_16x16x32_bf16 v[244:247], a[92:95], a[100:103], v[244:247]
  s_lshl_b32 s6, s95, 7
  s_add_u32 s6, s6, 524288
  v_mfma_f32_16x16x32_bf16 v[240:243], a[92:95], a[96:99], v[240:243]
FFN_EP:
TS_9:
  s_cbranch_execz TR_P
  s_waitcnt lgkmcnt(0)
  s_nop 6
  v_pk_fma_f32 v[96:97], v[56:57], v[44:45], v[96:97] op_sel_hi:[1,0,1] neg_lo:[0,1,0] neg_hi:[0,1,0]
  s_add_u32 m0, s100, 0
  v_pk_fma_f32 v[98:99], v[58:59], v[44:45], v[98:99] op_sel_hi:[1,0,1] neg_lo:[0,1,0] neg_hi:[0,1,0]
  v_pk_mul_f32 v[32:33], v[96:97], v[48:49] op_sel_hi:[1,0]
  v_pk_mul_f32 v[34:35], v[98:99], v[48:49] op_sel_hi:[1,0]
  v_pk_fma_f32 v[112:113], v[60:61], v[44:45], v[112:113] op_sel_hi:[1,0,1] neg_lo:[0,1,0] neg_hi:[0,1,0]
  v_pk_fma_f32 v[114:115], v[62:63], v[44:45], v[114:115] op_sel_hi:[1,0,1] neg_lo:[0,1,0] neg_hi:[0,1,0]
  v_exp_f32 v32, v32
  v_exp_f32 v33, v33
  v_exp_f32 v34, v34
  v_exp_f32 v35, v35
  v_pk_mul_f32 v[96:97], v[96:97], v[112:113] op_sel_hi:[1,1]
TS_10:
  s_cbranch_execz TS_20
  v_pk_mul_f32 v[98:99], v[98:99], v[114:115] op_sel_hi:[1,1]
  v_pk_fma_f32 v[32:33], v[32:33], v[52:53], v[52:53] op_sel_hi:[1,0,0]
  v_pk_fma_f32 v[34:35], v[34:35], v[52:53], v[52:53] op_sel_hi:[1,0,0]
  v_rcp_f32 v32, v32
  buffer_load_dwordx4 v16, s[16:19], s97 offen lds
  v_rcp_f32 v33, v33
  v_rcp_f32 v34, v34
  v_rcp_f32 v35, v35
  v_pk_mul_f32 v[96:97], v[96:97], v[32:33] op_sel_hi:[1,1]
  v_pk_mul_f32 v[98:99], v[98:99], v[34:35] op_sel_hi:[1,1]
  v_cvt_pk_bf16_f32 v112, v96, v97
  v_cvt_pk_bf16_f32 v113, v98, v99
  v_pk_fma_f32 v[128:129], v[64:65], v[44:45], v[128:129] op_sel_hi:[1,0,1] neg_lo:[0,1,0] neg_hi:[0,1,0]
  v_pk_fma_f32 v[130:131], v[66:67], v[44:45], v[130:131] op_sel_hi:[1,0,1] neg_lo:[0,1,0] neg_hi:[0,1,0]
  v_pk_mul_f32 v[32:33], v[128:129], v[48:49] op_sel_hi:[1,0]
  v_pk_mul_f32 v[34:35], v[130:131], v[48:49] op_sel_hi:[1,0]
  v_pk_fma_f32 v[144:145], v[68:69], v[44:45], v[144:145] op_sel_hi:[1,0,1] neg_lo:[0,1,0] neg_hi:[0,1,0]
  v_pk_fma_f32 v[146:147], v[70:71], v[44:45], v[146:147] op_sel_hi:[1,0,1] neg_lo:[0,1,0] neg_hi:[0,1,0]
  v_exp_f32 v32, v32
  v_exp_f32 v33, v33
  s_add_u32 m0, s100, 1024
  v_exp_f32 v34, v34
  v_exp_f32 v35, v35
  v_pk_mul_f32 v[128:129], v[128:129], v[144:145] op_sel_hi:[1,1]
  v_pk_mul_f32 v[130:131], v[130:131], v[146:147] op_sel_hi:[1,1]
  v_pk_fma_f32 v[32:33], v[32:33], v[52:53], v[52:53] op_sel_hi:[1,0,0]
  v_pk_fma_f32 v[34:35], v[34:35], v[52:53], v[52:53] op_sel_hi:[1,0,0]
  v_rcp_f32 v32, v32
  v_rcp_f32 v33, v33
  v_rcp_f32 v34, v34
  v_rcp_f32 v35, v35
  v_pk_mul_f32 v[128:129], v[128:129], v[32:33] op_sel_hi:[1,1]
  v_pk_mul_f32 v[130:131], v[130:131], v[34:35] op_sel_hi:[1,1]
  v_cvt_pk_bf16_f32 v114, v128, v129
  v_cvt_pk_bf16_f32 v115, v130, v131
  buffer_store_dwordx4 v[112:115], v28, s[8:11], s84 offen offset:0 sc1
  v_pk_fma_f32 v[100:101], v[44:45], v[56:57], v[100:101] op_sel:[1,0,0] op_sel_hi:[1,1,1] neg_lo:[1,0,0] neg_hi:[1,0,0]
  buffer_load_dwordx4 v17, s[16:19], s97 offen lds
  v_pk_fma_f32 v[102:103], v[44:45], v[58:59], v[102:103] op_sel:[1,0,0] op_sel_hi:[1,1,1] neg_lo:[1,0,0] neg_hi:[1,0,0]
  v_pk_mul_f32 v[32:33], v[48:49], v[100:101] op_sel:[1,0] op_sel_hi:[1,1]
  v_pk_mul_f32 v[34:35], v[48:49], v[102:103] op_sel:[1,0] op_sel_hi:[1,1]
  v_pk_fma_f32 v[116:117], v[44:45], v[60:61], v[116:117] op_sel:[1,0,0] op_sel_hi:[1,1,1] neg_lo:[1,0,0] neg_hi:[1,0,0]
  v_pk_fma_f32 v[118:119], v[44:45], v[62:63], v[118:119] op_sel:[1,0,0] op_sel_hi:[1,1,1] neg_lo:[1,0,0] neg_hi:[1,0,0]
  v_exp_f32 v32, v32
  v_exp_f32 v33, v33
  v_exp_f32 v34, v34
  v_exp_f32 v35, v35
  v_pk_mul_f32 v[100:101], v[100:101], v[116:117] op_sel_hi:[1,1]
  v_pk_mul_f32 v[102:103], v[102:103], v[118:119] op_sel_hi:[1,1]
  v_pk_fma_f32 v[32:33], v[52:53], v[32:33], v[52:53] op_sel:[1,0,1] op_sel_hi:[1,1,1]
  v_pk_fma_f32 v[34:35], v[52:53], v[34:35], v[52:53] op_sel:[1,0,1] op_sel_hi:[1,1,1]
  v_rcp_f32 v32, v32
  s_add_u32 m0, s100, 2048
  v_rcp_f32 v33, v33
  v_rcp_f32 v34, v34
  v_rcp_f32 v35, v35
  v_pk_mul_f32 v[100:101], v[100:101], v[32:33] op_sel_hi:[1,1]
  v_pk_mul_f32 v[102:103], v[102:103], v[34:35] op_sel_hi:[1,1]
  v_cvt_pk_bf16_f32 v116, v100, v101
  v_cvt_pk_bf16_f32 v117, v102, v103
  v_pk_fma_f32 v[132:133], v[44:45], v[64:65], v[132:133] op_sel:[1,0,0] op_sel_hi:[1,1,1] neg_lo:[1,0,0] neg_hi:[1,0,0]
  v_pk_fma_f32 v[134:135], v[44:45], v[66:67], v[134:135] op_sel:[1,0,0] op_sel_hi:[1,1,1] neg_lo:[1,0,0] neg_hi:[1,0,0]
  v_pk_mul_f32 v[32:33], v[48:49], v[132:133] op_sel:[1,0] op_sel_hi:[1,1]
  v_pk_mul_f32 v[34:35], v[48:49], v[134:135] op_sel:[1,0] op_sel_hi:[1,1]
  v_pk_fma_f32 v[148:149], v[44:45], v[68:69], v[148:149] op_sel:[1,0,0] op_sel_hi:[1,1,1] neg_lo:[1,0,0] neg_hi:[1,0,0]
  v_pk_fma_f32 v[150:151], v[44:45], v[70:71], v[150:151] op_sel:[1,0,0] op_sel_hi:[1,1,1] neg_lo:[1,0,0] neg_hi:[1,0,0]
  v_exp_f32 v32, v32
  v_exp_f32 v33, v33
  buffer_load_dwordx4 v18, s[16:19], s97 offen lds
  v_exp_f32 v34, v34
  v_exp_f32 v35, v35
  v_pk_mul_f32 v[132:133], v[132:133], v[148:149] op_sel_hi:[1,1]
  v_pk_mul_f32 v[134:135], v[134:135], v[150:151] op_sel_hi:[1,1]
  v_pk_fma_f32 v[32:33], v[52:53], v[32:33], v[52:53] op_sel:[1,0,1] op_sel_hi:[1,1,1]
  v_pk_fma_f32 v[34:35], v[52:53], v[34:35], v[52:53] op_sel:[1,0,1] op_sel_hi:[1,1,1]
  v_rcp_f32 v32, v32
  v_rcp_f32 v33, v33
  v_rcp_f32 v34, v34
  v_rcp_f32 v35, v35
  v_pk_mul_f32 v[132:133], v[132:133], v[32:33] op_sel_hi:[1,1]
  v_pk_mul_f32 v[134:135], v[134:135], v[34:35] op_sel_hi:[1,1]
  v_cvt_pk_bf16_f32 v118, v132, v133
  v_cvt_pk_bf16_f32 v119, v134, v135
  buffer_store_dwordx4 v[116:119], v28, s[8:11], s84 offen offset:1024 sc1
  v_pk_fma_f32 v[104:105], v[56:57], v[46:47], v[104:105] op_sel_hi:[1,0,1] neg_lo:[0,1,0] neg_hi:[0,1,0]
  s_add_u32 m0, s100, 3072
  v_pk_fma_f32 v[106:107], v[58:59], v[46:47], v[106:107] op_sel_hi:[1,0,1] neg_lo:[0,1,0] neg_hi:[0,1,0]
  v_pk_mul_f32 v[32:33], v[104:105], v[50:51] op_sel_hi:[1,0]
  v_pk_mul_f32 v[34:35], v[106:107], v[50:51] op_sel_hi:[1,0]
  v_pk_fma_f32 v[120:121], v[60:61], v[46:47], v[120:121] op_sel_hi:[1,0,1] neg_lo:[0,1,0] neg_hi:[0,1,0]
  v_pk_fma_f32 v[122:123], v[62:63], v[46:47], v[122:123] op_sel_hi:[1,0,1] neg_lo:[0,1,0] neg_hi:[0,1,0]
  v_exp_f32 v32, v32
  v_exp_f32 v33, v33
  v_exp_f32 v34, v34
  v_exp_f32 v35, v35
  v_pk_mul_f32 v[104:105], v[104:105], v[120:121] op_sel_hi:[1,1]
  v_pk_mul_f32 v[106:107], v[106:107], v[122:123] op_sel_hi:[1,1]
  v_pk_fma_f32 v[32:33], v[32:33], v[54:55], v[54:55] op_sel_hi:[1,0,0]
  v_pk_fma_f32 v[34:35], v[34:35], v[54:55], v[54:55] op_sel_hi:[1,0,0]
  v_rcp_f32 v32, v32
  buffer_load_dwordx4 v19, s[24:27], s98 offen lds
  v_rcp_f32 v33, v33
  v_rcp_f32 v34, v34
  v_rcp_f32 v35, v35
  v_pk_mul_f32 v[104:105], v[104:105], v[32:33] op_sel_hi:[1,1]
  v_pk_mul_f32 v[106:107], v[106:107], v[34:35] op_sel_hi:[1,1]
  v_cvt_pk_bf16_f32 v120, v104, v105
  v_cvt_pk_bf16_f32 v121, v106, v107
  v_pk_fma_f32 v[136:137], v[64:65], v[46:47], v[136:137] op_sel_hi:[1,0,1] neg_lo:[0,1,0] neg_hi:[0,1,0]
  v_pk_fma_f32 v[138:139], v[66:67], v[46:47], v[138:139] op_sel_hi:[1,0,1] neg_lo:[0,1,0] neg_hi:[0,1,0]
  v_pk_mul_f32 v[32:33], v[136:137], v[50:51] op_sel_hi:[1,0]
  v_pk_mul_f32 v[34:35], v[138:139], v[50:51] op_sel_hi:[1,0]
  v_pk_fma_f32 v[152:153], v[68:69], v[46:47], v[152:153] op_sel_hi:[1,0,1] neg_lo:[0,1,0] neg_hi:[0,1,0]
  v_pk_fma_f32 v[154:155], v[70:71], v[46:47], v[154:155] op_sel_hi:[1,0,1] neg_lo:[0,1,0] neg_hi:[0,1,0]
  v_exp_f32 v32, v32
  v_exp_f32 v33, v33
  s_mov_b32 s75, 196608
  v_exp_f32 v34, v34
  v_exp_f32 v35, v35
  v_pk_mul_f32 v[136:137], v[136:137], v[152:153] op_sel_hi:[1,1]
  v_pk_mul_f32 v[138:139], v[138:139], v[154:155] op_sel_hi:[1,1]
  v_pk_fma_f32 v[32:33], v[32:33], v[54:55], v[54:55] op_sel_hi:[1,0,0]
  v_pk_fma_f32 v[34:35], v[34:35], v[54:55], v[54:55] op_sel_hi:[1,0,0]
  v_rcp_f32 v32, v32
  v_rcp_f32 v33, v33
  v_rcp_f32 v34, v34
  v_rcp_f32 v35, v35
  v_pk_mul_f32 v[136:137], v[136:137], v[32:33] op_sel_hi:[1,1]
  v_pk_mul_f32 v[138:139], v[138:139], v[34:35] op_sel_hi:[1,1]
  v_cvt_pk_bf16_f32 v122, v136, v137
  v_cvt_pk_bf16_f32 v123, v138, v139
  buffer_store_dwordx4 v[120:123], v28, s[8:11], s84 offen offset:2048 sc1
  v_pk_fma_f32 v[108:109], v[46:47], v[56:57], v[108:109] op_sel:[1,0,0] op_sel_hi:[1,1,1] neg_lo:[1,0,0] neg_hi:[1,0,0]
  buffer_load_dwordx2 v[10:11], v15, s[8:11], s75 offen sc1
  v_pk_fma_f32 v[110:111], v[46:47], v[58:59], v[110:111] op_sel:[1,0,0] op_sel_hi:[1,1,1] neg_lo:[1,0,0] neg_hi:[1,0,0]
  v_pk_mul_f32 v[32:33], v[50:51], v[108:109] op_sel:[1,0] op_sel_hi:[1,1]
  v_pk_mul_f32 v[34:35], v[50:51], v[110:111] op_sel:[1,0] op_sel_hi:[1,1]
  v_pk_fma_f32 v[124:125], v[46:47], v[60:61], v[124:125] op_sel:[1,0,0] op_sel_hi:[1,1,1] neg_lo:[1,0,0] neg_hi:[1,0,0]
  v_pk_fma_f32 v[126:127], v[46:47], v[62:63], v[126:127] op_sel:[1,0,0] op_sel_hi:[1,1,1] neg_lo:[1,0,0] neg_hi:[1,0,0]
  v_exp_f32 v32, v32
  v_exp_f32 v33, v33
  v_exp_f32 v34, v34
  v_exp_f32 v35, v35
  v_pk_mul_f32 v[108:109], v[108:109], v[124:125] op_sel_hi:[1,1]
  v_pk_mul_f32 v[110:111], v[110:111], v[126:127] op_sel_hi:[1,1]
  v_pk_fma_f32 v[32:33], v[54:55], v[32:33], v[54:55] op_sel:[1,0,1] op_sel_hi:[1,1,1]
  v_pk_fma_f32 v[34:35], v[54:55], v[34:35], v[54:55] op_sel:[1,0,1] op_sel_hi:[1,1,1]
  v_rcp_f32 v32, v32
  s_add_u32 s79, s82, 10240
  v_rcp_f32 v33, v33
  v_rcp_f32 v34, v34
  v_rcp_f32 v35, v35
  v_pk_mul_f32 v[108:109], v[108:109], v[32:33] op_sel_hi:[1,1]
  v_pk_mul_f32 v[110:111], v[110:111], v[34:35] op_sel_hi:[1,1]
  v_cvt_pk_bf16_f32 v124, v108, v109
  v_cvt_pk_bf16_f32 v125, v110, v111
  v_pk_fma_f32 v[140:141], v[46:47], v[64:65], v[140:141] op_sel:[1,0,0] op_sel_hi:[1,1,1] neg_lo:[1,0,0] neg_hi:[1,0,0]
  v_pk_fma_f32 v[142:143], v[46:47], v[66:67], v[142:143] op_sel:[1,0,0] op_sel_hi:[1,1,1] neg_lo:[1,0,0] neg_hi:[1,0,0]
  v_pk_mul_f32 v[32:33], v[50:51], v[140:141] op_sel:[1,0] op_sel_hi:[1,1]
  v_pk_mul_f32 v[34:35], v[50:51], v[142:143] op_sel:[1,0] op_sel_hi:[1,1]
  v_pk_fma_f32 v[156:157], v[46:47], v[68:69], v[156:157] op_sel:[1,0,0] op_sel_hi:[1,1,1] neg_lo:[1,0,0] neg_hi:[1,0,0]
  v_pk_fma_f32 v[158:159], v[46:47], v[70:71], v[158:159] op_sel:[1,0,0] op_sel_hi:[1,1,1] neg_lo:[1,0,0] neg_hi:[1,0,0]
  v_exp_f32 v32, v32
  v_exp_f32 v33, v33
  s_cmp_eq_u32 s3, 3
  s_cselect_b32 s79, 0x7f000000, s79
  v_exp_f32 v34, v34
  v_exp_f32 v35, v35
  v_pk_mul_f32 v[140:141], v[140:141], v[156:157] op_sel_hi:[1,1]
  v_pk_mul_f32 v[142:143], v[142:143], v[158:159] op_sel_hi:[1,1]
  v_pk_fma_f32 v[32:33], v[54:55], v[32:33], v[54:55] op_sel:[1,0,1] op_sel_hi:[1,1,1]
  v_pk_fma_f32 v[34:35], v[54:55], v[34:35], v[54:55] op_sel:[1,0,1] op_sel_hi:[1,1,1]
  v_rcp_f32 v32, v32
  v_rcp_f32 v33, v33
  v_rcp_f32 v34, v34
  v_rcp_f32 v35, v35
  v_pk_mul_f32 v[140:141], v[140:141], v[32:33] op_sel_hi:[1,1]
  v_pk_mul_f32 v[142:143], v[142:143], v[34:35] op_sel_hi:[1,1]
  v_cvt_pk_bf16_f32 v126, v140, v141
  v_cvt_pk_bf16_f32 v127, v142, v143
  buffer_store_dwordx4 v[124:127], v28, s[8:11], s84 offen offset:3072 sc1
  v_pk_fma_f32 v[160:161], v[72:73], v[44:45], v[160:161] op_sel_hi:[1,0,1] neg_lo:[0,1,0] neg_hi:[0,1,0]
  buffer_load_dwordx4 a[96:99], v28, s[8:11], s79 offen offset:0 sc1
  v_pk_fma_f32 v[162:163], v[74:75], v[44:45], v[162:163] op_sel_hi:[1,0,1] neg_lo:[0,1,0] neg_hi:[0,1,0]
  v_pk_mul_f32 v[32:33], v[160:161], v[48:49] op_sel_hi:[1,0]
  v_pk_mul_f32 v[34:35], v[162:163], v[48:49] op_sel_hi:[1,0]
  v_pk_fma_f32 v[176:177], v[76:77], v[44:45], v[176:177] op_sel_hi:[1,0,1] neg_lo:[0,1,0] neg_hi:[0,1,0]
  v_pk_fma_f32 v[178:179], v[78:79], v[44:45], v[178:179] op_sel_hi:[1,0,1] neg_lo:[0,1,0] neg_hi:[0,1,0]
  v_exp_f32 v32, v32
  v_exp_f32 v33, v33
  v_exp_f32 v34, v34
  v_exp_f32 v35, v35
  v_pk_mul_f32 v[160:161], v[160:161], v[176:177] op_sel_hi:[1,1]
  v_pk_mul_f32 v[162:163], v[162:163], v[178:179] op_sel_hi:[1,1]
  v_pk_fma_f32 v[32:33], v[32:33], v[52:53], v[52:53] op_sel_hi:[1,0,0]
  v_pk_fma_f32 v[34:35], v[34:35], v[52:53], v[52:53] op_sel_hi:[1,0,0]
  v_rcp_f32 v32, v32
  buffer_load_dwordx4 a[100:103], v28, s[8:11], s79 offen offset:1024 sc1
  v_rcp_f32 v33, v33
  v_rcp_f32 v34, v34
  v_rcp_f32 v35, v35
  v_pk_mul_f32 v[160:161], v[160:161], v[32:33] op_sel_hi:[1,1]
  v_pk_mul_f32 v[162:163], v[162:163], v[34:35] op_sel_hi:[1,1]
  v_cvt_pk_bf16_f32 v176, v160, v161
  v_cvt_pk_bf16_f32 v177, v162, v163
  v_pk_fma_f32 v[192:193], v[80:81], v[44:45], v[192:193] op_sel_hi:[1,0,1] neg_lo:[0,1,0] neg_hi:[0,1,0]
  v_pk_fma_f32 v[194:195], v[82:83], v[44:45], v[194:195] op_sel_hi:[1,0,1] neg_lo:[0,1,0] neg_hi:[0,1,0]
  v_pk_mul_f32 v[32:33], v[192:193], v[48:49] op_sel_hi:[1,0]
  v_pk_mul_f32 v[34:35], v[194:195], v[48:49] op_sel_hi:[1,0]
  v_pk_fma_f32 v[208:209], v[84:85], v[44:45], v[208:209] op_sel_hi:[1,0,1] neg_lo:[0,1,0] neg_hi:[0,1,0]
  v_pk_fma_f32 v[210:211], v[86:87], v[44:45], v[210:211] op_sel_hi:[1,0,1] neg_lo:[0,1,0] neg_hi:[0,1,0]
  v_exp_f32 v32, v32
  v_exp_f32 v33, v33
  buffer_load_dwordx4 a[104:107], v28, s[8:11], s79 offen offset:2048 sc1
  v_exp_f32 v34, v34
  v_exp_f32 v35, v35
  v_pk_mul_f32 v[192:193], v[192:193], v[208:209] op_sel_hi:[1,1]
  v_pk_mul_f32 v[194:195], v[194:195], v[210:211] op_sel_hi:[1,1]
  v_pk_fma_f32 v[32:33], v[32:33], v[52:53], v[52:53] op_sel_hi:[1,0,0]
  v_pk_fma_f32 v[34:35], v[34:35], v[52:53], v[52:53] op_sel_hi:[1,0,0]
  v_rcp_f32 v32, v32
  v_rcp_f32 v33, v33
  v_rcp_f32 v34, v34
  v_rcp_f32 v35, v35
  v_pk_mul_f32 v[192:193], v[192:193], v[32:33] op_sel_hi:[1,1]
  v_pk_mul_f32 v[194:195], v[194:195], v[34:35] op_sel_hi:[1,1]
  v_cvt_pk_bf16_f32 v178, v192, v193
  v_cvt_pk_bf16_f32 v179, v194, v195
  buffer_store_dwordx4 v[176:179], v28, s[8:11], s85 offen offset:0 sc1
  v_pk_fma_f32 v[164:165], v[44:45], v[72:73], v[164:165] op_sel:[1,0,0] op_sel_hi:[1,1,1] neg_lo:[1,0,0] neg_hi:[1,0,0]
  buffer_load_dwordx4 a[108:111], v28, s[8:11], s79 offen offset:3072 sc1
  v_pk_fma_f32 v[166:167], v[44:45], v[74:75], v[166:167] op_sel:[1,0,0] op_sel_hi:[1,1,1] neg_lo:[1,0,0] neg_hi:[1,0,0]
  v_pk_mul_f32 v[32:33], v[48:49], v[164:165] op_sel:[1,0] op_sel_hi:[1,1]
  v_pk_mul_f32 v[34:35], v[48:49], v[166:167] op_sel:[1,0] op_sel_hi:[1,1]
  v_pk_fma_f32 v[180:181], v[44:45], v[76:77], v[180:181] op_sel:[1,0,0] op_sel_hi:[1,1,1] neg_lo:[1,0,0] neg_hi:[1,0,0]
  v_pk_fma_f32 v[182:183], v[44:45], v[78:79], v[182:183] op_sel:[1,0,0] op_sel_hi:[1,1,1] neg_lo:[1,0,0] neg_hi:[1,0,0]
  v_exp_f32 v32, v32
  v_exp_f32 v33, v33
  v_exp_f32 v34, v34
  v_exp_f32 v35, v35
  v_pk_mul_f32 v[164:165], v[164:165], v[180:181] op_sel_hi:[1,1]
  v_pk_mul_f32 v[166:167], v[166:167], v[182:183] op_sel_hi:[1,1]
  v_pk_fma_f32 v[32:33], v[52:53], v[32:33], v[52:53] op_sel:[1,0,1] op_sel_hi:[1,1,1]
  v_pk_fma_f32 v[34:35], v[52:53], v[34:35], v[52:53] op_sel:[1,0,1] op_sel_hi:[1,1,1]
  v_rcp_f32 v32, v32
  v_rcp_f32 v33, v33
  v_rcp_f32 v34, v34
  v_rcp_f32 v35, v35
  v_pk_mul_f32 v[164:165], v[164:165], v[32:33] op_sel_hi:[1,1]
  v_pk_mul_f32 v[166:167], v[166:167], v[34:35] op_sel_hi:[1,1]
  v_cvt_pk_bf16_f32 v180, v164, v165
  v_cvt_pk_bf16_f32 v181, v166, v167
  v_pk_fma_f32 v[196:197], v[44:45], v[80:81], v[196:197] op_sel:[1,0,0] op_sel_hi:[1,1,1] neg_lo:[1,0,0] neg_hi:[1,0,0]
  buffer_load_dwordx4 a[112:115], v29, s[8:11], s79 offen offset:0 sc1
  v_pk_fma_f32 v[198:199], v[44:45], v[82:83], v[198:199] op_sel:[1,0,0] op_sel_hi:[1,1,1] neg_lo:[1,0,0] neg_hi:[1,0,0]
  v_pk_mul_f32 v[32:33], v[48:49], v[196:197] op_sel:[1,0] op_sel_hi:[1,1]
  v_pk_mul_f32 v[34:35], v[48:49], v[198:199] op_sel:[1,0] op_sel_hi:[1,1]
  v_pk_fma_f32 v[212:213], v[44:45], v[84:85], v[212:213] op_sel:[1,0,0] op_sel_hi:[1,1,1] neg_lo:[1,0,0] neg_hi:[1,0,0]
  v_pk_fma_f32 v[214:215], v[44:45], v[86:87], v[214:215] op_sel:[1,0,0] op_sel_hi:[1,1,1] neg_lo:[1,0,0] neg_hi:[1,0,0]
  v_exp_f32 v32, v32
  v_exp_f32 v33, v33
  v_exp_f32 v34, v34
  v_exp_f32 v35, v35
  v_pk_mul_f32 v[196:197], v[196:197], v[212:213] op_sel_hi:[1,1]
  v_pk_mul_f32 v[198:199], v[198:199], v[214:215] op_sel_hi:[1,1]
  v_pk_fma_f32 v[32:33], v[52:53], v[32:33], v[52:53] op_sel:[1,0,1] op_sel_hi:[1,1,1]
  v_pk_fma_f32 v[34:35], v[52:53], v[34:35], v[52:53] op_sel:[1,0,1] op_sel_hi:[1,1,1]
  v_rcp_f32 v32, v32
  v_rcp_f32 v33, v33
  v_rcp_f32 v34, v34
  v_rcp_f32 v35, v35
  v_pk_mul_f32 v[196:197], v[196:197], v[32:33] op_sel_hi:[1,1]
  v_pk_mul_f32 v[198:199], v[198:199], v[34:35] op_sel_hi:[1,1]
  v_cvt_pk_bf16_f32 v182, v196, v197
  v_cvt_pk_bf16_f32 v183, v198, v199
  buffer_store_dwordx4 v[180:183], v28, s[8:11], s85 offen offset:1024 sc1
  v_pk_fma_f32 v[168:169], v[72:73], v[46:47], v[168:169] op_sel_hi:[1,0,1] neg_lo:[0,1,0] neg_hi:[0,1,0]
  v_pk_fma_f32 v[170:171], v[74:75], v[46:47], v[170:171] op_sel_hi:[1,0,1] neg_lo:[0,1,0] neg_hi:[0,1,0]
  v_pk_mul_f32 v[32:33], v[168:169], v[50:51] op_sel_hi:[1,0]
  v_pk_mul_f32 v[34:35], v[170:171], v[50:51] op_sel_hi:[1,0]
  v_pk_fma_f32 v[184:185], v[76:77], v[46:47], v[184:185] op_sel_hi:[1,0,1] neg_lo:[0,1,0] neg_hi:[0,1,0]
  v_pk_fma_f32 v[186:187], v[78:79], v[46:47], v[186:187] op_sel_hi:[1,0,1] neg_lo:[0,1,0] neg_hi:[0,1,0]
  v_exp_f32 v32, v32
  v_exp_f32 v33, v33
  v_exp_f32 v34, v34
  v_exp_f32 v35, v35
  v_pk_mul_f32 v[168:169], v[168:169], v[184:185] op_sel_hi:[1,1]
  v_pk_mul_f32 v[170:171], v[170:171], v[186:187] op_sel_hi:[1,1]
  v_pk_fma_f32 v[32:33], v[32:33], v[54:55], v[54:55] op_sel_hi:[1,0,0]
  v_pk_fma_f32 v[34:35], v[34:35], v[54:55], v[54:55] op_sel_hi:[1,0,0]
  v_rcp_f32 v32, v32
  v_rcp_f32 v33, v33
  v_rcp_f32 v34, v34
  v_rcp_f32 v35, v35
  v_pk_mul_f32 v[168:169], v[168:169], v[32:33] op_sel_hi:[1,1]
  v_pk_mul_f32 v[170:171], v[170:171], v[34:35] op_sel_hi:[1,1]
  v_cvt_pk_bf16_f32 v184, v168, v169
  v_cvt_pk_bf16_f32 v185, v170, v171
  v_pk_fma_f32 v[200:201], v[80:81], v[46:47], v[200:201] op_sel_hi:[1,0,1] neg_lo:[0,1,0] neg_hi:[0,1,0]
  v_pk_fma_f32 v[202:203], v[82:83], v[46:47], v[202:203] op_sel_hi:[1,0,1] neg_lo:[0,1,0] neg_hi:[0,1,0]
  v_pk_mul_f32 v[32:33], v[200:201], v[50:51] op_sel_hi:[1,0]
  v_pk_mul_f32 v[34:35], v[202:203], v[50:51] op_sel_hi:[1,0]
  v_pk_fma_f32 v[216:217], v[84:85], v[46:47], v[216:217] op_sel_hi:[1,0,1] neg_lo:[0,1,0] neg_hi:[0,1,0]
  v_pk_fma_f32 v[218:219], v[86:87], v[46:47], v[218:219] op_sel_hi:[1,0,1] neg_lo:[0,1,0] neg_hi:[0,1,0]
  v_exp_f32 v32, v32
  v_exp_f32 v33, v33
  v_exp_f32 v34, v34
  v_exp_f32 v35, v35
  v_pk_mul_f32 v[200:201], v[200:201], v[216:217] op_sel_hi:[1,1]
  v_pk_mul_f32 v[202:203], v[202:203], v[218:219] op_sel_hi:[1,1]
  v_pk_fma_f32 v[32:33], v[32:33], v[54:55], v[54:55] op_sel_hi:[1,0,0]
  v_pk_fma_f32 v[34:35], v[34:35], v[54:55], v[54:55] op_sel_hi:[1,0,0]
  v_rcp_f32 v32, v32
  v_rcp_f32 v33, v33
  v_rcp_f32 v34, v34
  v_rcp_f32 v35, v35
  v_pk_mul_f32 v[200:201], v[200:201], v[32:33] op_sel_hi:[1,1]
  v_pk_mul_f32 v[202:203], v[202:203], v[34:35] op_sel_hi:[1,1]
  v_cvt_pk_bf16_f32 v186, v200, v201
  v_cvt_pk_bf16_f32 v187, v202, v203
  buffer_store_dwordx4 v[184:187], v28, s[8:11], s85 offen offset:2048 sc1
  v_pk_fma_f32 v[172:173], v[46:47], v[72:73], v[172:173] op_sel:[1,0,0] op_sel_hi:[1,1,1] neg_lo:[1,0,0] neg_hi:[1,0,0]
  v_pk_fma_f32 v[174:175], v[46:47], v[74:75], v[174:175] op_sel:[1,0,0] op_sel_hi:[1,1,1] neg_lo:[1,0,0] neg_hi:[1,0,0]
  v_pk_mul_f32 v[32:33], v[50:51], v[172:173] op_sel:[1,0] op_sel_hi:[1,1]
  v_pk_mul_f32 v[34:35], v[50:51], v[174:175] op_sel:[1,0] op_sel_hi:[1,1]
  v_pk_fma_f32 v[188:189], v[46:47], v[76:77], v[188:189] op_sel:[1,0,0] op_sel_hi:[1,1,1] neg_lo:[1,0,0] neg_hi:[1,0,0]
  v_pk_fma_f32 v[190:191], v[46:47], v[78:79], v[190:191] op_sel:[1,0,0] op_sel_hi:[1,1,1] neg_lo:[1,0,0] neg_hi:[1,0,0]
  v_exp_f32 v32, v32
  v_exp_f32 v33, v33
  v_exp_f32 v34, v34
  v_exp_f32 v35, v35
  v_pk_mul_f32 v[172:173], v[172:173], v[188:189] op_sel_hi:[1,1]
  v_pk_mul_f32 v[174:175], v[174:175], v[190:191] op_sel_hi:[1,1]
  v_pk_fma_f32 v[32:33], v[54:55], v[32:33], v[54:55] op_sel:[1,0,1] op_sel_hi:[1,1,1]
  v_pk_fma_f32 v[34:35], v[54:55], v[34:35], v[54:55] op_sel:[1,0,1] op_sel_hi:[1,1,1]
  v_rcp_f32 v32, v32
  v_rcp_f32 v33, v33
  v_rcp_f32 v34, v34
  v_rcp_f32 v35, v35
  v_pk_mul_f32 v[172:173], v[172:173], v[32:33] op_sel_hi:[1,1]
  v_pk_mul_f32 v[174:175], v[174:175], v[34:35] op_sel_hi:[1,1]
  v_cvt_pk_bf16_f32 v188, v172, v173
  v_cvt_pk_bf16_f32 v189, v174, v175
  v_pk_fma_f32 v[204:205], v[46:47], v[80:81], v[204:205] op_sel:[1,0,0] op_sel_hi:[1,1,1] neg_lo:[1,0,0] neg_hi:[1,0,0]
  v_pk_fma_f32 v[206:207], v[46:47], v[82:83], v[206:207] op_sel:[1,0,0] op_sel_hi:[1,1,1] neg_lo:[1,0,0] neg_hi:[1,0,0]
  v_pk_mul_f32 v[32:33], v[50:51], v[204:205] op_sel:[1,0] op_sel_hi:[1,1]
  v_pk_mul_f32 v[34:35], v[50:51], v[206:207] op_sel:[1,0] op_sel_hi:[1,1]
  v_pk_fma_f32 v[220:221], v[46:47], v[84:85], v[220:221] op_sel:[1,0,0] op_sel_hi:[1,1,1] neg_lo:[1,0,0] neg_hi:[1,0,0]
  v_pk_fma_f32 v[222:223], v[46:47], v[86:87], v[222:223] op_sel:[1,0,0] op_sel_hi:[1,1,1] neg_lo:[1,0,0] neg_hi:[1,0,0]
  v_exp_f32 v32, v32
  v_exp_f32 v33, v33
  v_exp_f32 v34, v34
  v_exp_f32 v35, v35
  v_pk_mul_f32 v[204:205], v[204:205], v[220:221] op_sel_hi:[1,1]
  v_pk_mul_f32 v[206:207], v[206:207], v[222:223] op_sel_hi:[1,1]
  v_pk_fma_f32 v[32:33], v[54:55], v[32:33], v[54:55] op_sel:[1,0,1] op_sel_hi:[1,1,1]
  v_pk_fma_f32 v[34:35], v[54:55], v[34:35], v[54:55] op_sel:[1,0,1] op_sel_hi:[1,1,1]
  v_rcp_f32 v32, v32
  v_rcp_f32 v33, v33
  v_rcp_f32 v34, v34
  v_rcp_f32 v35, v35
  v_pk_mul_f32 v[204:205], v[204:205], v[32:33] op_sel_hi:[1,1]
  v_pk_mul_f32 v[206:207], v[206:207], v[34:35] op_sel_hi:[1,1]
  v_cvt_pk_bf16_f32 v190, v204, v205
  v_cvt_pk_bf16_f32 v191, v206, v207
  s_waitcnt vmcnt(8)
  buffer_store_dword v31, v8, s[8:11], s87 offen sc1
  buffer_store_dwordx4 v[188:191], v28, s[8:11], s85 offen offset:3072 sc1
  v_pk_fma_f32 v[224:225], v[88:89], v[44:45], v[224:225] op_sel_hi:[1,0,1] neg_lo:[0,1,0] neg_hi:[0,1,0]
  v_pk_fma_f32 v[226:227], v[90:91], v[44:45], v[226:227] op_sel_hi:[1,0,1] neg_lo:[0,1,0] neg_hi:[0,1,0]
  v_pk_mul_f32 v[32:33], v[224:225], v[48:49] op_sel_hi:[1,0]
  v_pk_mul_f32 v[34:35], v[226:227], v[48:49] op_sel_hi:[1,0]
  v_pk_fma_f32 v[240:241], v[92:93], v[44:45], v[240:241] op_sel_hi:[1,0,1] neg_lo:[0,1,0] neg_hi:[0,1,0]
  v_pk_fma_f32 v[242:243], v[94:95], v[44:45], v[242:243] op_sel_hi:[1,0,1] neg_lo:[0,1,0] neg_hi:[0,1,0]
  v_exp_f32 v32, v32
  v_exp_f32 v33, v33
  v_exp_f32 v34, v34
  v_exp_f32 v35, v35
  v_pk_mul_f32 v[224:225], v[224:225], v[240:241] op_sel_hi:[1,1]
  v_pk_mul_f32 v[226:227], v[226:227], v[242:243] op_sel_hi:[1,1]
  v_pk_fma_f32 v[32:33], v[32:33], v[52:53], v[52:53] op_sel_hi:[1,0,0]
  v_pk_fma_f32 v[34:35], v[34:35], v[52:53], v[52:53] op_sel_hi:[1,0,0]
  v_rcp_f32 v32, v32
  v_rcp_f32 v33, v33
  v_rcp_f32 v34, v34
  v_rcp_f32 v35, v35
  v_pk_mul_f32 v[224:225], v[224:225], v[32:33] op_sel_hi:[1,1]
  v_pk_mul_f32 v[226:227], v[226:227], v[34:35] op_sel_hi:[1,1]
  v_cvt_pk_bf16_f32 v240, v224, v225
  v_cvt_pk_bf16_f32 v241, v226, v227
  v_pk_fma_f32 v[228:229], v[44:45], v[88:89], v[228:229] op_sel:[1,0,0] op_sel_hi:[1,1,1] neg_lo:[1,0,0] neg_hi:[1,0,0]
  v_pk_fma_f32 v[230:231], v[44:45], v[90:91], v[230:231] op_sel:[1,0,0] op_sel_hi:[1,1,1] neg_lo:[1,0,0] neg_hi:[1,0,0]
  v_pk_mul_f32 v[32:33], v[48:49], v[228:229] op_sel:[1,0] op_sel_hi:[1,1]
  v_pk_mul_f32 v[34:35], v[48:49], v[230:231] op_sel:[1,0] op_sel_hi:[1,1]
  v_pk_fma_f32 v[244:245], v[44:45], v[92:93], v[244:245] op_sel:[1,0,0] op_sel_hi:[1,1,1] neg_lo:[1,0,0] neg_hi:[1,0,0]
  v_pk_fma_f32 v[246:247], v[44:45], v[94:95], v[246:247] op_sel:[1,0,0] op_sel_hi:[1,1,1] neg_lo:[1,0,0] neg_hi:[1,0,0]
  v_exp_f32 v32, v32
  v_exp_f32 v33, v33
  v_exp_f32 v34, v34
  v_exp_f32 v35, v35
  v_pk_mul_f32 v[228:229], v[228:229], v[244:245] op_sel_hi:[1,1]
  v_pk_mul_f32 v[230:231], v[230:231], v[246:247] op_sel_hi:[1,1]
  v_pk_fma_f32 v[32:33], v[52:53], v[32:33], v[52:53] op_sel:[1,0,1] op_sel_hi:[1,1,1]
  v_pk_fma_f32 v[34:35], v[52:53], v[34:35], v[52:53] op_sel:[1,0,1] op_sel_hi:[1,1,1]
  v_rcp_f32 v32, v32
  v_rcp_f32 v33, v33
  v_rcp_f32 v34, v34
  v_rcp_f32 v35, v35
  v_pk_mul_f32 v[228:229], v[228:229], v[32:33] op_sel_hi:[1,1]
  v_pk_mul_f32 v[230:231], v[230:231], v[34:35] op_sel_hi:[1,1]
  v_cvt_pk_bf16_f32 v242, v228, v229
  v_cvt_pk_bf16_f32 v243, v230, v231
  s_nop 0
  v_permlane16_swap_b32 v240, v242
  v_permlane16_swap_b32 v241, v243
  buffer_store_dwordx4 v[240:243], v30, s[8:11], s86 offen offset:0 sc1
  v_pk_fma_f32 v[232:233], v[88:89], v[46:47], v[232:233] op_sel_hi:[1,0,1] neg_lo:[0,1,0] neg_hi:[0,1,0]
  v_pk_fma_f32 v[234:235], v[90:91], v[46:47], v[234:235] op_sel_hi:[1,0,1] neg_lo:[0,1,0] neg_hi:[0,1,0]
  v_pk_mul_f32 v[32:33], v[232:233], v[50:51] op_sel_hi:[1,0]
  v_pk_mul_f32 v[34:35], v[234:235], v[50:51] op_sel_hi:[1,0]
  v_pk_fma_f32 v[248:249], v[92:93], v[46:47], v[248:249] op_sel_hi:[1,0,1] neg_lo:[0,1,0] neg_hi:[0,1,0]
  v_pk_fma_f32 v[250:251], v[94:95], v[46:47], v[250:251] op_sel_hi:[1,0,1] neg_lo:[0,1,0] neg_hi:[0,1,0]
  v_exp_f32 v32, v32
  v_exp_f32 v33, v33
  v_exp_f32 v34, v34
  v_exp_f32 v35, v35
  v_pk_mul_f32 v[232:233], v[232:233], v[248:249] op_sel_hi:[1,1]
  v_pk_mul_f32 v[234:235], v[234:235], v[250:251] op_sel_hi:[1,1]
  v_pk_fma_f32 v[32:33], v[32:33], v[54:55], v[54:55] op_sel_hi:[1,0,0]
  v_pk_fma_f32 v[34:35], v[34:35], v[54:55], v[54:55] op_sel_hi:[1,0,0]
  v_rcp_f32 v32, v32
  v_rcp_f32 v33, v33
  v_rcp_f32 v34, v34
  v_rcp_f32 v35, v35
  v_pk_mul_f32 v[232:233], v[232:233], v[32:33] op_sel_hi:[1,1]
  v_pk_mul_f32 v[234:235], v[234:235], v[34:35] op_sel_hi:[1,1]
  v_cvt_pk_bf16_f32 v248, v232, v233
  v_cvt_pk_bf16_f32 v249, v234, v235
  v_pk_fma_f32 v[236:237], v[46:47], v[88:89], v[236:237] op_sel:[1,0,0] op_sel_hi:[1,1,1] neg_lo:[1,0,0] neg_hi:[1,0,0]
  v_pk_fma_f32 v[238:239], v[46:47], v[90:91], v[238:239] op_sel:[1,0,0] op_sel_hi:[1,1,1] neg_lo:[1,0,0] neg_hi:[1,0,0]
  v_pk_mul_f32 v[32:33], v[50:51], v[236:237] op_sel:[1,0] op_sel_hi:[1,1]
  v_pk_mul_f32 v[34:35], v[50:51], v[238:239] op_sel:[1,0] op_sel_hi:[1,1]
  v_pk_fma_f32 v[252:253], v[46:47], v[92:93], v[252:253] op_sel:[1,0,0] op_sel_hi:[1,1,1] neg_lo:[1,0,0] neg_hi:[1,0,0]
  v_pk_fma_f32 v[254:255], v[46:47], v[94:95], v[254:255] op_sel:[1,0,0] op_sel_hi:[1,1,1] neg_lo:[1,0,0] neg_hi:[1,0,0]
  v_exp_f32 v32, v32
  v_exp_f32 v33, v33
  v_exp_f32 v34, v34
  v_exp_f32 v35, v35
  v_pk_mul_f32 v[236:237], v[236:237], v[252:253] op_sel_hi:[1,1]
  v_pk_mul_f32 v[238:239], v[238:239], v[254:255] op_sel_hi:[1,1]
  v_pk_fma_f32 v[32:33], v[54:55], v[32:33], v[54:55] op_sel:[1,0,1] op_sel_hi:[1,1,1]
  v_pk_fma_f32 v[34:35], v[54:55], v[34:35], v[54:55] op_sel:[1,0,1] op_sel_hi:[1,1,1]
  v_rcp_f32 v32, v32
  v_rcp_f32 v33, v33
  v_rcp_f32 v34, v34
  v_rcp_f32 v35, v35
  v_pk_mul_f32 v[236:237], v[236:237], v[32:33] op_sel_hi:[1,1]
  v_pk_mul_f32 v[238:239], v[238:239], v[34:35] op_sel_hi:[1,1]
  v_cvt_pk_bf16_f32 v250, v236, v237
  v_cvt_pk_bf16_f32 v251, v238, v239
  s_nop 0
  v_permlane16_swap_b32 v248, v250
  v_permlane16_swap_b32 v249, v251
  buffer_store_dwordx4 v[248:251], v30, s[8:11], s86 offen offset:2048 sc1
  s_add_u32 s79, s82, 15360
  buffer_load_dwordx4 a[0:3], v28, s[8:11], s79 offen offset:0 sc1
  buffer_load_dwordx4 a[4:7], v28, s[8:11], s79 offen offset:1024 sc1
  buffer_load_dwordx4 a[8:11], v28, s[8:11], s79 offen offset:2048 sc1
  buffer_load_dwordx4 a[12:15], v28, s[8:11], s79 offen offset:3072 sc1
  buffer_load_dwordx4 a[16:19], v29, s[8:11], s79 offen offset:0 sc1
  s_add_u32 s79, s82, 20480
  buffer_load_dwordx4 a[20:23], v28, s[8:11], s79 offen offset:0 sc1
  buffer_load_dwordx4 a[24:27], v28, s[8:11], s79 offen offset:1024 sc1
  buffer_load_dwordx4 a[28:31], v28, s[8:11], s79 offen offset:2048 sc1
  buffer_load_dwordx4 a[32:35], v28, s[8:11], s79 offen offset:3072 sc1
  buffer_load_dwordx4 a[36:39], v29, s[8:11], s79 offen offset:0 sc1
  v_xor_b32 v4, s96, v11
  v_cmp_ne_u32 vcc, 0, v4
  s_cbranch_vccz FGF_ok
  s_mov_b32 s7, 0x40000
FGF_l:
  s_mov_b32 s75, 196608
  buffer_load_dwordx2 v[10:11], v15, s[8:11], s75 offen sc1
  s_waitcnt vmcnt(0)
  v_xor_b32 v4, s96, v11
  v_cmp_ne_u32 vcc, 0, v4
  s_sub_u32 s7, s7, 1
  s_cbranch_scc1 FGF_ok
  s_cbranch_vccnz FGF_l
FGF_ok:
  ds_read_b64 v[96:97], v12 offset:0
  ds_read_b64 v[98:99], v14 offset:3072
  ds_read_b64 v[104:105], v12 offset:32
  ds_read_b64 v[106:107], v14 offset:3104
  ds_read_b64 v[112:113], v12 offset:64
  ds_read_b64 v[114:115], v14 offset:3136
  ds_read_b64 v[120:121], v12 offset:96
  ds_read_b64 v[122:123], v14 offset:3168
  ds_read_b64 v[128:129], v12 offset:128
  ds_read_b64 v[130:131], v14 offset:3200
  v_and_b32 v16, 0xffff0000, v10
  v_rcp_f32 v16, v16
  v_lshlrev_b32 v10, 16, v10
  s_waitcnt lgkmcnt(0)
  v_lshlrev_b32 v100, 16, v96
  v_and_b32 v101, 0xffff0000, v96
  v_lshlrev_b32 v18, 16, v98
  v_and_b32 v19, 0xffff0000, v98
  v_pk_add_f32 v[20:21], v[100:101], v[10:11] op_sel_hi:[1,0] neg_lo:[0,1] neg_hi:[0,1]
  v_pk_mul_f32 v[18:19], v[18:19], v[16:17] op_sel_hi:[1,0]
  v_pk_fma_f32 v[100:101], v[20:21], v[18:19], v[100:101] op_sel_hi:[1,1,1]
  v_accvgpr_write_b32 a80, v100
  v_accvgpr_write_b32 a81, v101
  v_lshlrev_b32 v102, 16, v97
  v_and_b32 v103, 0xffff0000, v97
  v_lshlrev_b32 v18, 16, v99
  v_and_b32 v19, 0xffff0000, v99
  v_pk_add_f32 v[20:21], v[102:103], v[10:11] op_sel_hi:[1,0] neg_lo:[0,1] neg_hi:[0,1]
  v_pk_mul_f32 v[18:19], v[18:19], v[16:17] op_sel_hi:[1,0]
  v_pk_fma_f32 v[102:103], v[20:21], v[18:19], v[102:103] op_sel_hi:[1,1,1]
  v_accvgpr_write_b32 a82, v102
  v_accvgpr_write_b32 a83, v103
  v_lshlrev_b32 v108, 16, v104
  v_and_b32 v109, 0xffff0000, v104
  v_lshlrev_b32 v18, 16, v106
  v_and_b32 v19, 0xffff0000, v106
  v_pk_add_f32 v[20:21], v[108:109], v[10:11] op_sel_hi:[1,0] neg_lo:[0,1] neg_hi:[0,1]
  v_pk_mul_f32 v[18:19], v[18:19], v[16:17] op_sel_hi:[1,0]
  v_pk_fma_f32 v[108:109], v[20:21], v[18:19], v[108:109] op_sel_hi:[1,1,1]
  v_accvgpr_write_b32 a84, v108
  v_accvgpr_write_b32 a85, v109
  v_lshlrev_b32 v110, 16, v105
  v_and_b32 v111, 0xffff0000, v105
  v_lshlrev_b32 v18, 16, v107
  v_and_b32 v19, 0xffff0000, v107
  v_pk_add_f32 v[20:21], v[110:111], v[10:11] op_sel_hi:[1,0] neg_lo:[0,1] neg_hi:[0,1]
  v_pk_mul_f32 v[18:19], v[18:19], v[16:17] op_sel_hi:[1,0]
  v_pk_fma_f32 v[110:111], v[20:21], v[18:19], v[110:111] op_sel_hi:[1,1,1]
  v_accvgpr_write_b32 a86, v110
  v_accvgpr_write_b32 a87, v111
  v_lshlrev_b32 v116, 16, v112
  v_and_b32 v117, 0xffff0000, v112
  v_lshlrev_b32 v18, 16, v114
  v_and_b32 v19, 0xffff0000, v114
  v_pk_add_f32 v[20:21], v[116:117], v[10:11] op_sel_hi:[1,0] neg_lo:[0,1] neg_hi:[0,1]
  v_pk_mul_f32 v[18:19], v[18:19], v[16:17] op_sel_hi:[1,0]
  v_pk_fma_f32 v[116:117], v[20:21], v[18:19], v[116:117] op_sel_hi:[1,1,1]
  v_accvgpr_write_b32 a88, v116
  v_accvgpr_write_b32 a89, v117
  v_lshlrev_b32 v118, 16, v113
  v_and_b32 v119, 0xffff0000, v113
  v_lshlrev_b32 v18, 16, v115
  v_and_b32 v19, 0xffff0000, v115
  v_pk_add_f32 v[20:21], v[118:119], v[10:11] op_sel_hi:[1,0] neg_lo:[0,1] neg_hi:[0,1]
  v_pk_mul_f32 v[18:19], v[18:19], v[16:17] op_sel_hi:[1,0]
  v_pk_fma_f32 v[118:119], v[20:21], v[18:19], v[118:119] op_sel_hi:[1,1,1]
  v_accvgpr_write_b32 a90, v118
  v_accvgpr_write_b32 a91, v119
  v_lshlrev_b32 v124, 16, v120
  v_and_b32 v125, 0xffff0000, v120
  v_lshlrev_b32 v18, 16, v122
  v_and_b32 v19, 0xffff0000, v122
  v_pk_add_f32 v[20:21], v[124:125], v[10:11] op_sel_hi:[1,0] neg_lo:[0,1] neg_hi:[0,1]
  v_pk_mul_f32 v[18:19], v[18:19], v[16:17] op_sel_hi:[1,0]
  v_pk_fma_f32 v[124:125], v[20:21], v[18:19], v[124:125] op_sel_hi:[1,1,1]
  v_accvgpr_write_b32 a92, v124
  v_accvgpr_write_b32 a93, v125
  v_lshlrev_b32 v126, 16, v121
  v_and_b32 v127, 0xffff0000, v121
  v_lshlrev_b32 v18, 16, v123
  v_and_b32 v19, 0xffff0000, v123
  v_pk_add_f32 v[20:21], v[126:127], v[10:11] op_sel_hi:[1,0] neg_lo:[0,1] neg_hi:[0,1]
  v_pk_mul_f32 v[18:19], v[18:19], v[16:17] op_sel_hi:[1,0]
  v_pk_fma_f32 v[126:127], v[20:21], v[18:19], v[126:127] op_sel_hi:[1,1,1]
  v_accvgpr_write_b32 a94, v126
  v_accvgpr_write_b32 a95, v127
  v_lshlrev_b32 v132, 16, v128
  v_and_b32 v133, 0xffff0000, v128
  v_lshlrev_b32 v18, 16, v130
  v_and_b32 v19, 0xffff0000, v130
  v_pk_add_f32 v[20:21], v[132:133], v[10:11] op_sel_hi:[1,0] neg_lo:[0,1] neg_hi:[0,1]
  v_pk_mul_f32 v[18:19], v[18:19], v[16:17] op_sel_hi:[1,0]
  v_pk_fma_f32 v[132:133], v[20:21], v[18:19], v[132:133] op_sel_hi:[1,1,1]
  v_mov_b32 v6, v132
  v_mov_b32 v7, v133
  v_lshlrev_b32 v134, 16, v129
  v_and_b32 v135, 0xffff0000, v129
  v_lshlrev_b32 v18, 16, v131
  v_and_b32 v19, 0xffff0000, v131
  v_pk_add_f32 v[20:21], v[134:135], v[10:11] op_sel_hi:[1,0] neg_lo:[0,1] neg_hi:[0,1]
  v_pk_mul_f32 v[18:19], v[18:19], v[16:17] op_sel_hi:[1,0]
  v_pk_fma_f32 v[134:135], v[20:21], v[18:19], v[134:135] op_sel_hi:[1,1,1]
  v_mov_b32 v26, v134
  v_mov_b32 v27, v135
  s_mul_i32 s31, s28, 22
  s_mul_i32 s32, s3, 6
  s_add_u32 s31, s31, s32
  s_min_u32 s31, s31, 38
  s_lshl_b32 s31, s31, 7
  s_add_u32 s31, s31, s93
  v_min_u32 v9, 5, v1
  v_lshlrev_b32 v9, 7, v9
  buffer_load_dword v9, v9, s[8:11], s31 offen sc1
  s_waitcnt vmcnt(11)
  buffer_store_dword v31, v8, s[8:11], s99 offen sc1
  s_add_u32 s79, s82, 25600
  buffer_load_dwordx4 a[40:43], v28, s[8:11], s79 offen offset:0 sc1
  buffer_load_dwordx4 a[44:47], v28, s[8:11], s79 offen offset:1024 sc1
  buffer_load_dwordx4 a[48:51], v28, s[8:11], s79 offen offset:2048 sc1
  buffer_load_dwordx4 a[52:55], v28, s[8:11], s79 offen offset:3072 sc1
  buffer_load_dwordx4 a[56:59], v29, s[8:11], s79 offen offset:0 sc1
  s_add_u32 s79, s82, 30720
  buffer_load_dwordx4 a[60:63], v28, s[8:11], s79 offen offset:0 sc1
  buffer_load_dwordx4 a[64:67], v28, s[8:11], s79 offen offset:1024 sc1
  buffer_load_dwordx4 a[68:71], v28, s[8:11], s79 offen offset:2048 sc1
  buffer_load_dwordx4 a[72:75], v28, s[8:11], s79 offen offset:3072 sc1
  buffer_load_dwordx4 a[76:79], v29, s[8:11], s79 offen offset:0 sc1
  s_waitcnt vmcnt(11)
TS_11:
  s_cbranch_execz TS_19
  v_cmp_ne_u32 vcc, s96, v9
  s_cbranch_vccz FR_ok
  s_mov_b32 s7, 0x40000
FR_l:
  s_mul_i32 s31, s28, 22
  s_mul_i32 s32, s3, 6
  s_add_u32 s31, s31, s32
  s_min_u32 s31, s31, 38
  s_lshl_b32 s31, s31, 7
  s_add_u32 s31, s31, s93
  v_min_u32 v9, 5, v1
  v_lshlrev_b32 v9, 7, v9
  buffer_load_dword v9, v9, s[8:11], s31 offen sc1
  s_waitcnt vmcnt(0)
  v_cmp_ne_u32 vcc, s96, v9
  s_sub_u32 s7, s7, 1
  s_cbranch_scc1 FR_ok
  s_cbranch_vccnz FR_l
FR_ok:
  s_branch PH2
SSM_a:
TS_12:
  s_cbranch_execz TS_16
  s_and_b32 s33, s68, 3
  s_lshl2_add_u32 s33, s69, s33
  s_lshl2_add_u32 s33, s33, s3
  s_lshr_b32 s35, s68, 2
  s_mul_i32 s35, s35, 160
  s_add_u32 s35, s35, s33
  s_mul_i32 s97, s33, 5120
  v_bfe_u32 v2, v1, 2, 2
  v_mul_u32_u24 v2, 1280, v2
  v_and_b32 v3, 3, v1
  v_lshl_add_u32 v2, v3, 4, v2
  v_lshrrev_b32 v4, 4, v1
  v_lshl_add_u32 v67, v4, 6, v2
  s_lshl_b32 s98, s35, 7
  s_add_u32 s98, s98, 786432
  s_cmp_lt_u32 s35, 160
  s_cselect_b32 s24, s42, s44
  s_cselect_b32 s25, s43, s45
  s_mov_b32 s26, 0xc8000
  s_mov_b32 s27, 0x20000
  s_mov_b32 s8, s66
  s_mov_b32 s9, s67
  s_mov_b32 s10, 0x1a00000
  s_mov_b32 s11, 0x20000
  v_lshlrev_b32 v28, 4, v1
  v_add_u32 v29, 4096, v28
  v_lshlrev_b32 v8, 20, v1
  v_and_b32 v8, 0xfe000000, v8
  v_lshl_add_u32 v8, v1, 2, v8
  v_lshrrev_b32 v2, 4, v1
  v_and_b32 v3, 15, v1
  v_lshrrev_b32 v4, 1, v3
  v_xor_b32 v4, v4, v2
  v_lshlrev_b32 v4, 4, v4
  v_lshl_add_u32 v3, v3, 7, v4
  s_lshl_b32 s75, s71, 14
  s_lshl_b32 s76, s72, 12
  s_add_u32 s76, s76, 32768
  v_add_u32 v22, s75, v3
  v_xor_b32 v23, 64, v22
  v_add_u32 v120, s76, v3
  v_xor_b32 v121, 64, v120
  v_add_u32 v24, 49152, v22
  v_add_u32 v122, 49152, v120
  v_add_u32 v25, 49152, v23
  v_add_u32 v123, 49152, v121
  v_add_u32 v26, 98304, v22
  v_add_u32 v124, 98304, v120
  v_add_u32 v27, 98304, v23
  v_add_u32 v125, 98304, v121
  s_waitcnt vmcnt(12)
  v_lshlrev_b32 v42, 16, v32
  buffer_load_dwordx4 a[112:115], v67, s[24:27], s97 offen offset:0
  v_and_b32 v43, 0xffff0000, v32
  v_lshlrev_b32 v44, 16, v33
  v_and_b32 v45, 0xffff0000, v33
  buffer_load_dwordx4 a[116:119], v67, s[24:27], s97 offen offset:256
  v_lshlrev_b32 v46, 16, v34
  v_and_b32 v47, 0xffff0000, v34
  v_lshlrev_b32 v48, 16, v35
  v_and_b32 v49, 0xffff0000, v35
  buffer_load_dwordx4 a[120:123], v67, s[24:27], s97 offen offset:512
  v_lshlrev_b32 v50, 16, v36
  v_and_b32 v51, 0xffff0000, v36
  v_lshlrev_b32 v52, 16, v37
  buffer_load_dwordx4 a[124:127], v67, s[24:27], s97 offen offset:768
  v_and_b32 v53, 0xffff0000, v37
  v_lshlrev_b32 v54, 16, v38
  v_and_b32 v55, 0xffff0000, v38
  v_lshlrev_b32 v56, 16, v39
  buffer_load_dwordx4 a[128:131], v67, s[24:27], s97 offen offset:1024
  v_and_b32 v57, 0xffff0000, v39
  v_lshlrev_b32 v58, 16, v40
  v_and_b32 v59, 0xffff0000, v40
  s_add_u32 m0, s73, 49152
  v_lshlrev_b32 v60, 16, v41
  v_and_b32 v61, 0xffff0000, v41
  v_pk_add_f32 v[62:63], v[42:43], v[44:45] op_sel_hi:[1,1]
  v_pk_add_f32 v[62:63], v[62:63], v[46:47] op_sel_hi:[1,1]
  s_movk_i32 s78, 128
  v_pk_add_f32 v[62:63], v[62:63], v[48:49] op_sel_hi:[1,1]
  v_pk_add_f32 v[62:63], v[62:63], v[50:51] op_sel_hi:[1,1]
  v_pk_add_f32 v[62:63], v[62:63], v[52:53] op_sel_hi:[1,1]
  buffer_load_dwordx4 v10, s[16:19], s78 offen offset:0 lds
  v_pk_add_f32 v[62:63], v[62:63], v[54:55] op_sel_hi:[1,1]
  v_pk_add_f32 v[62:63], v[62:63], v[56:57] op_sel_hi:[1,1]
  v_pk_add_f32 v[62:63], v[62:63], v[58:59] op_sel_hi:[1,1]
  v_pk_add_f32 v[62:63], v[62:63], v[60:61] op_sel_hi:[1,1]
  buffer_load_dwordx4 v11, s[16:19], s78 offen offset:1024 lds
  v_add_f32 v62, v62, v63
  s_nop 1
  v_add_f32_dpp v62, v62, v62 row_ror:8 row_mask:0xf bank_mask:0xf
  s_nop 1
  v_add_f32_dpp v62, v62, v62 row_ror:4 row_mask:0xf bank_mask:0xf
  s_nop 1
  v_add_f32_dpp v62, v62, v62 row_ror:2 row_mask:0xf bank_mask:0xf
  buffer_load_dwordx4 v12, s[16:19], s78 offen offset:2048 lds
  s_nop 0
  v_add_f32_dpp v62, v62, v62 row_ror:1 row_mask:0xf bank_mask:0xf
  v_mov_b32 v63, v62
  s_nop 1
  v_permlane16_swap_b32 v62, v63
  buffer_load_dwordx4 v13, s[16:19], s78 offen offset:3072 lds
  v_add_f32 v62, v62, v63
  v_mul_f32 v62, 0x3acccccd, v62
  v_pk_add_f32 v[42:43], v[42:43], v[62:63] op_sel_hi:[1,0] neg_lo:[0,1] neg_hi:[0,1]
  v_pk_add_f32 v[44:45], v[44:45], v[62:63] op_sel_hi:[1,0] neg_lo:[0,1] neg_hi:[0,1]
  s_add_u32 m0, s74, 49152
  v_pk_add_f32 v[46:47], v[46:47], v[62:63] op_sel_hi:[1,0] neg_lo:[0,1] neg_hi:[0,1]
  v_pk_add_f32 v[48:49], v[48:49], v[62:63] op_sel_hi:[1,0] neg_lo:[0,1] neg_hi:[0,1]
  v_pk_add_f32 v[50:51], v[50:51], v[62:63] op_sel_hi:[1,0] neg_lo:[0,1] neg_hi:[0,1]
  buffer_load_dwordx4 v18, s[12:15], s78 offen offset:0 lds
  v_pk_add_f32 v[52:53], v[52:53], v[62:63] op_sel_hi:[1,0] neg_lo:[0,1] neg_hi:[0,1]
  v_pk_add_f32 v[54:55], v[54:55], v[62:63] op_sel_hi:[1,0] neg_lo:[0,1] neg_hi:[0,1]
  v_pk_add_f32 v[56:57], v[56:57], v[62:63] op_sel_hi:[1,0] neg_lo:[0,1] neg_hi:[0,1]
  v_pk_add_f32 v[58:59], v[58:59], v[62:63] op_sel_hi:[1,0] neg_lo:[0,1] neg_hi:[0,1]
  buffer_load_dwordx4 v19, s[12:15], s78 offen offset:1024 lds
  v_pk_add_f32 v[60:61], v[60:61], v[62:63] op_sel_hi:[1,0] neg_lo:[0,1] neg_hi:[0,1]
  v_pk_mul_f32 v[64:65], v[42:43], v[42:43] op_sel_hi:[1,1]
  v_pk_fma_f32 v[64:65], v[44:45], v[44:45], v[64:65] op_sel_hi:[1,1,1]
  s_add_u32 m0, s73, 53248
  v_pk_fma_f32 v[64:65], v[46:47], v[46:47], v[64:65] op_sel_hi:[1,1,1]
  v_pk_fma_f32 v[64:65], v[48:49], v[48:49], v[64:65] op_sel_hi:[1,1,1]
  v_pk_fma_f32 v[64:65], v[50:51], v[50:51], v[64:65] op_sel_hi:[1,1,1]
  v_pk_fma_f32 v[64:65], v[52:53], v[52:53], v[64:65] op_sel_hi:[1,1,1]
  s_movk_i32 s78, 128
  v_pk_fma_f32 v[64:65], v[54:55], v[54:55], v[64:65] op_sel_hi:[1,1,1]
  v_pk_fma_f32 v[64:65], v[56:57], v[56:57], v[64:65] op_sel_hi:[1,1,1]
  v_pk_fma_f32 v[64:65], v[58:59], v[58:59], v[64:65] op_sel_hi:[1,1,1]
  v_pk_fma_f32 v[64:65], v[60:61], v[60:61], v[64:65] op_sel_hi:[1,1,1]
  buffer_load_dwordx4 v14, s[16:19], s78 offen offset:0 lds
  v_add_f32 v64, v64, v65
  s_nop 1
  v_add_f32_dpp v64, v64, v64 row_ror:8 row_mask:0xf bank_mask:0xf
  s_nop 1
  v_add_f32_dpp v64, v64, v64 row_ror:4 row_mask:0xf bank_mask:0xf
  buffer_load_dwordx4 v15, s[16:19], s78 offen offset:1024 lds
  s_nop 0
  v_add_f32_dpp v64, v64, v64 row_ror:2 row_mask:0xf bank_mask:0xf
  s_nop 1
  v_add_f32_dpp v64, v64, v64 row_ror:1 row_mask:0xf bank_mask:0xf
  v_mov_b32 v65, v64
  s_nop 1
  v_permlane16_swap_b32 v64, v65
  buffer_load_dwordx4 v16, s[16:19], s78 offen offset:2048 lds
  v_add_f32 v64, v64, v65
  v_mul_f32 v64, 0x3acccccd, v64
  v_cvt_pk_bf16_f32 v62, v62, v64
  buffer_load_dwordx4 v17, s[16:19], s78 offen offset:3072 lds
  v_and_b32 v64, 0xffff0000, v62
  v_add_f32 v64, 0x3727c5ac, v64
  v_cvt_pk_bf16_f32 v64, v64, v64
  v_and_b32 v64, 0xffff0000, v64
  s_add_u32 m0, s74, 49152
  v_sqrt_f32 v64, v64
  v_and_b32 v62, 0xffff, v62
  v_cvt_pk_bf16_f32 v64, v64, v64
  buffer_load_dwordx4 v20, s[12:15], s78 offen offset:2048 lds
  v_readfirstlane_b32 s96, v9
  v_and_b32 v64, 0xffff0000, v64
  v_or_b32 v62, v64, v62
  v_lshrrev_b32 v63, 5, v0
  buffer_load_dwordx4 v21, s[12:15], s78 offen offset:3072 lds
  v_lshlrev_b32 v63, 2, v63
  v_add_u32 v63, 147456, v63
  s_add_u32 s96, s96, 1
  ds_write_b32 v63, v62
  s_mov_b64 exec, 0
  s_mov_b32 s92, 1
  s_cmp_eq_u32 s3, 0
  s_cbranch_scc1 TS_18
  s_cmp_eq_u32 s3, 1
  s_cbranch_scc1 TS_19
  s_cmp_eq_u32 s3, 2
  s_cbranch_scc1 TS_20
  s_branch TR_P
TR_P1:
  s_mov_b64 exec, -1
  s_waitcnt vmcnt(17) lgkmcnt(0)
  s_barrier
  ds_read_b128 a[32:35], v120 offset:0
  ds_read_b128 a[36:39], v120 offset:2048
  ds_read_b128 a[40:43], v120 offset:8192
  ds_read_b128 a[44:47], v120 offset:10240
  ds_read_b128 a[0:3], v22 offset:0
  ds_read_b128 a[4:7], v22 offset:2048
  ds_read_b128 a[8:11], v22 offset:4096
  ds_read_b128 a[12:15], v22 offset:6144
  ds_read_b128 a[16:19], v22 offset:8192
  ds_read_b128 a[20:23], v22 offset:10240
  ds_read_b128 a[24:27], v22 offset:12288
  ds_read_b128 a[28:31], v22 offset:14336
  s_waitcnt lgkmcnt(0)
  v_mfma_f32_16x16x32_bf16 v[128:131], a[0:3], a[32:35], 0
  ds_read_b128 a[80:83], v121 offset:0
  s_add_u32 m0, s73, 98304
  v_mfma_f32_16x16x32_bf16 v[160:163], a[0:3], a[36:39], 0
  s_movk_i32 s78, 256
  v_lshlrev_b32 v2, 21, v1
  v_mfma_f32_16x16x32_bf16 v[192:195], a[0:3], a[40:43], 0
  ds_read_b128 a[84:87], v121 offset:2048
  v_mfma_f32_16x16x32_bf16 v[224:227], a[0:3], a[44:47], 0
  buffer_load_dwordx4 v10, s[16:19], s78 offen offset:0 lds
  v_mfma_f32_16x16x32_bf16 v[228:231], a[4:7], a[44:47], 0
  ds_read_b128 a[88:91], v121 offset:8192
  v_and_b32 v2, 0xfe000000, v2
  v_mfma_f32_16x16x32_bf16 v[196:199], a[4:7], a[40:43], 0
  buffer_load_dwordx4 v11, s[16:19], s78 offen offset:1024 lds
  v_mfma_f32_16x16x32_bf16 v[164:167], a[4:7], a[36:39], 0
  buffer_load_dwordx4 v12, s[16:19], s78 offen offset:2048 lds
  v_mfma_f32_16x16x32_bf16 v[132:135], a[4:7], a[32:35], 0
  ds_read_b128 a[92:95], v121 offset:10240
  v_lshl_add_u32 v55, v1, 3, v2
  v_mfma_f32_16x16x32_bf16 v[136:139], a[8:11], a[32:35], 0
  buffer_load_dwordx4 v13, s[16:19], s78 offen offset:3072 lds
  v_mfma_f32_16x16x32_bf16 v[168:171], a[8:11], a[36:39], 0
  ds_read_b128 a[48:51], v23 offset:0
  v_mfma_f32_16x16x32_bf16 v[200:203], a[8:11], a[40:43], 0
  ds_read_b128 a[52:55], v23 offset:2048
  s_add_u32 m0, s74, 98304
  v_mfma_f32_16x16x32_bf16 v[232:235], a[8:11], a[44:47], 0
  v_mov_b32 v68, 0x3f803f80
  v_mfma_f32_16x16x32_bf16 v[236:239], a[12:15], a[44:47], 0
  buffer_load_dwordx4 v18, s[12:15], s78 offen offset:0 lds
  v_mfma_f32_16x16x32_bf16 v[204:207], a[12:15], a[40:43], 0
  buffer_load_dwordx4 v19, s[12:15], s78 offen offset:1024 lds
  v_mfma_f32_16x16x32_bf16 v[172:175], a[12:15], a[36:39], 0
  ds_read_b128 a[56:59], v23 offset:4096
  v_mov_b32 v69, 0x3f803f80
  v_mfma_f32_16x16x32_bf16 v[140:143], a[12:15], a[32:35], 0
  ds_read_b128 a[60:63], v23 offset:6144
  s_add_u32 m0, s73, 102400
  v_mfma_f32_16x16x32_bf16 v[144:147], a[16:19], a[32:35], 0
  ds_read_b128 a[64:67], v23 offset:8192
  v_mov_b32 v70, 0x3f803f80
  v_mfma_f32_16x16x32_bf16 v[176:179], a[16:19], a[36:39], 0
  s_movk_i32 s78, 256
  v_mfma_f32_16x16x32_bf16 v[208:211], a[16:19], a[40:43], 0
  buffer_load_dwordx4 v14, s[16:19], s78 offen offset:0 lds
  v_mfma_f32_16x16x32_bf16 v[240:243], a[16:19], a[44:47], 0
  ds_read_b128 a[68:71], v23 offset:10240
  v_mov_b32 v71, 0x3f803f80
  v_mfma_f32_16x16x32_bf16 v[244:247], a[20:23], a[44:47], 0
  buffer_load_dwordx4 v15, s[16:19], s78 offen offset:1024 lds
  v_mfma_f32_16x16x32_bf16 v[212:215], a[20:23], a[40:43], 0
  ds_read_b128 a[72:75], v23 offset:12288
  v_mfma_f32_16x16x32_bf16 v[180:183], a[20:23], a[36:39], 0
  buffer_load_dwordx4 v16, s[16:19], s78 offen offset:2048 lds
  v_mfma_f32_16x16x32_bf16 v[148:151], a[20:23], a[32:35], 0
  ds_read_b128 a[76:79], v23 offset:14336
  s_lshl_b32 s32, s71, 2
  v_mfma_f32_16x16x32_bf16 v[152:155], a[24:27], a[32:35], 0
  buffer_load_dwordx4 v17, s[16:19], s78 offen offset:3072 lds
  v_mfma_f32_16x16x32_bf16 v[184:187], a[24:27], a[36:39], 0
  s_add_u32 m0, s74, 98304
  v_lshrrev_b32 v31, 4, v1
  v_mfma_f32_16x16x32_bf16 v[216:219], a[24:27], a[40:43], 0
  v_mfma_f32_16x16x32_bf16 v[248:251], a[24:27], a[44:47], 0
  buffer_load_dwordx4 v20, s[12:15], s78 offen offset:2048 lds
  v_mfma_f32_16x16x32_bf16 v[252:255], a[28:31], a[44:47], 0
  v_add_u32 v31, s32, v31
  v_mfma_f32_16x16x32_bf16 v[220:223], a[28:31], a[40:43], 0
  buffer_load_dwordx4 v21, s[12:15], s78 offen offset:3072 lds
  v_mfma_f32_16x16x32_bf16 v[188:191], a[28:31], a[36:39], 0
  v_mfma_f32_16x16x32_bf16 v[156:159], a[28:31], a[32:35], 0
  s_waitcnt vmcnt(12) lgkmcnt(0)
  s_barrier
  v_mfma_f32_16x16x32_bf16 v[128:131], a[48:51], a[80:83], v[128:131]
  ds_read_b128 a[32:35], v122 offset:0
  s_add_u32 m0, s73, 0
  v_mfma_f32_16x16x32_bf16 v[160:163], a[48:51], a[84:87], v[160:163]
  v_and_b32 v63, 7, v1
  v_mfma_f32_16x16x32_bf16 v[192:195], a[48:51], a[88:91], v[192:195]
  ds_read_b128 a[36:39], v122 offset:2048
  v_lshlrev_b32 v63, 2, v63
  v_mfma_f32_16x16x32_bf16 v[224:227], a[48:51], a[92:95], v[224:227]
  s_movk_i32 s78, 384
  v_add_u32 v63, 147456, v63
  v_mfma_f32_16x16x32_bf16 v[228:231], a[52:55], a[92:95], v[228:231]
  ds_read_b128 a[40:43], v122 offset:8192
  ds_read_b32 v62, v63
  v_mfma_f32_16x16x32_bf16 v[196:199], a[52:55], a[88:91], v[196:199]
  v_mfma_f32_16x16x32_bf16 v[164:167], a[52:55], a[84:87], v[164:167]
  buffer_load_dwordx4 v10, s[16:19], s78 offen offset:0 lds
  v_mfma_f32_16x16x32_bf16 v[132:135], a[52:55], a[80:83], v[132:135]
  ds_read_b128 a[44:47], v122 offset:10240
  v_lshlrev_b32 v64, 21, v0
  v_mfma_f32_16x16x32_bf16 v[136:139], a[56:59], a[80:83], v[136:139]
  v_and_b32 v64, 0xfe000000, v64
  ds_read_b128 a[0:3], v24 offset:0
  v_mfma_f32_16x16x32_bf16 v[168:171], a[56:59], a[84:87], v[168:171]
  v_lshl_add_u32 v64, v1, 3, v64
  s_lshl_b32 s75, s31, 7
  v_mfma_f32_16x16x32_bf16 v[200:203], a[56:59], a[88:91], v[200:203]
  buffer_load_dwordx4 v11, s[16:19], s78 offen offset:1024 lds
  v_mfma_f32_16x16x32_bf16 v[232:235], a[56:59], a[92:95], v[232:235]
  ds_read_b128 a[4:7], v24 offset:2048
  s_add_u32 s75, s75, 196608
  v_mfma_f32_16x16x32_bf16 v[236:239], a[60:63], a[92:95], v[236:239]
  ds_read_b128 a[8:11], v24 offset:4096
  s_waitcnt lgkmcnt(4)
  v_mfma_f32_16x16x32_bf16 v[204:207], a[60:63], a[88:91], v[204:207]
  buffer_load_dwordx4 v12, s[16:19], s78 offen offset:2048 lds
  v_mfma_f32_16x16x32_bf16 v[172:175], a[60:63], a[84:87], v[172:175]
  v_mov_b32 v63, s96
  ds_read_b128 a[12:15], v24 offset:6144
  v_mfma_f32_16x16x32_bf16 v[140:143], a[60:63], a[80:83], v[140:143]
  buffer_store_dwordx2 v[62:63], v64, s[8:11], s75 offen sc1
  v_mfma_f32_16x16x32_bf16 v[144:147], a[64:67], a[80:83], v[144:147]
  ds_read_b128 a[16:19], v24 offset:8192
  s_lshl_b32 s32, s69, 6
  v_mfma_f32_16x16x32_bf16 v[176:179], a[64:67], a[84:87], v[176:179]
  buffer_load_dwordx4 v13, s[16:19], s78 offen offset:3072 lds
  v_mfma_f32_16x16x32_bf16 v[208:211], a[64:67], a[88:91], v[208:211]
  s_lshl_b32 s33, s72, 5
  ds_read_b128 a[20:23], v24 offset:10240
  v_mfma_f32_16x16x32_bf16 v[240:243], a[64:67], a[92:95], v[240:243]
  s_add_u32 s32, s32, s33
  v_and_b32 v2, 15, v1
  v_mfma_f32_16x16x32_bf16 v[244:247], a[68:71], a[92:95], v[244:247]
  ds_read_b128 a[24:27], v24 offset:12288
  s_add_u32 m0, s74, 0
  v_mfma_f32_16x16x32_bf16 v[212:215], a[68:71], a[88:91], v[212:215]
  v_add_u32 v30, s32, v2
  v_mfma_f32_16x16x32_bf16 v[180:183], a[68:71], a[84:87], v[180:183]
  ds_read_b128 a[28:31], v24 offset:14336
  v_lshlrev_b32 v2, 1, v30
  v_mfma_f32_16x16x32_bf16 v[148:151], a[68:71], a[80:83], v[148:151]
  global_load_ushort v112, v2, s[38:39] offset:0
  v_mfma_f32_16x16x32_bf16 v[152:155], a[72:75], a[80:83], v[152:155]
  buffer_load_dwordx4 v18, s[12:15], s78 offen offset:0 lds
  v_mfma_f32_16x16x32_bf16 v[184:187], a[72:75], a[84:87], v[184:187]
  global_load_ushort v113, v2, s[40:41] offset:0
  v_mfma_f32_16x16x32_bf16 v[216:219], a[72:75], a[88:91], v[216:219]
  global_load_ushort v114, v2, s[50:51] offset:0
  v_mfma_f32_16x16x32_bf16 v[248:251], a[72:75], a[92:95], v[248:251]
  buffer_load_dwordx4 v19, s[12:15], s78 offen offset:1024 lds
  v_mfma_f32_16x16x32_bf16 v[252:255], a[76:79], a[92:95], v[252:255]
  global_load_ushort v115, v2, s[38:39] offset:32
  v_mfma_f32_16x16x32_bf16 v[220:223], a[76:79], a[88:91], v[220:223]
  global_load_ushort v116, v2, s[40:41] offset:32
  v_mfma_f32_16x16x32_bf16 v[188:191], a[76:79], a[84:87], v[188:191]
  global_load_ushort v117, v2, s[50:51] offset:32
  v_mfma_f32_16x16x32_bf16 v[156:159], a[76:79], a[80:83], v[156:159]
  s_waitcnt lgkmcnt(0)
  v_mfma_f32_16x16x32_bf16 v[128:131], a[0:3], a[32:35], v[128:131]
  ds_read_b128 a[80:83], v123 offset:0
  s_add_u32 m0, s73, 4096
  v_mfma_f32_16x16x32_bf16 v[160:163], a[0:3], a[36:39], v[160:163]
  s_and_b32 s28, s2, 1
  v_mfma_f32_16x16x32_bf16 v[192:195], a[0:3], a[40:43], v[192:195]
  ds_read_b128 a[84:87], v123 offset:2048
  v_mfma_f32_16x16x32_bf16 v[224:227], a[0:3], a[44:47], v[224:227]
  s_movk_i32 s78, 384
  s_bfe_u32 s32, s2, 0x20001
  v_mfma_f32_16x16x32_bf16 v[228:231], a[4:7], a[44:47], v[228:231]
  ds_read_b128 a[88:91], v123 offset:8192
  v_mfma_f32_16x16x32_bf16 v[196:199], a[4:7], a[40:43], v[196:199]
  v_mfma_f32_16x16x32_bf16 v[164:167], a[4:7], a[36:39], v[164:167]
  buffer_load_dwordx4 v14, s[16:19], s78 offen offset:0 lds
  v_mfma_f32_16x16x32_bf16 v[132:135], a[4:7], a[32:35], v[132:135]
  ds_read_b128 a[92:95], v123 offset:10240
  s_lshr_b32 s33, s2, 6
  v_mfma_f32_16x16x32_bf16 v[136:139], a[8:11], a[32:35], v[136:139]
  ds_read_b128 a[48:51], v25 offset:0
  s_lshl2_add_u32 s80, s32, s33
  v_mfma_f32_16x16x32_bf16 v[168:171], a[8:11], a[36:39], v[168:171]
  v_mfma_f32_16x16x32_bf16 v[200:203], a[8:11], a[40:43], v[200:203]
  buffer_load_dwordx4 v15, s[16:19], s78 offen offset:1024 lds
  v_mfma_f32_16x16x32_bf16 v[232:235], a[8:11], a[44:47], v[232:235]
  ds_read_b128 a[52:55], v25 offset:2048
  s_bfe_u32 s81, s2, 0x30003
  v_mfma_f32_16x16x32_bf16 v[236:239], a[12:15], a[44:47], v[236:239]
  ds_read_b128 a[56:59], v25 offset:4096
  v_mfma_f32_16x16x32_bf16 v[204:207], a[12:15], a[40:43], v[204:207]
  buffer_load_dwordx4 v16, s[16:19], s78 offen offset:2048 lds
  v_mfma_f32_16x16x32_bf16 v[172:175], a[12:15], a[36:39], v[172:175]
  s_lshl2_add_u32 s29, s28, s3
  ds_read_b128 a[60:63], v25 offset:6144
  v_mfma_f32_16x16x32_bf16 v[140:143], a[12:15], a[32:35], v[140:143]
  v_mfma_f32_16x16x32_bf16 v[144:147], a[16:19], a[32:35], v[144:147]
  ds_read_b128 a[64:67], v25 offset:8192
  s_mul_i32 s32, s29, 12
  v_mfma_f32_16x16x32_bf16 v[176:179], a[16:19], a[36:39], v[176:179]
  buffer_load_dwordx4 v17, s[16:19], s78 offen offset:3072 lds
  v_mfma_f32_16x16x32_bf16 v[208:211], a[16:19], a[40:43], v[208:211]
  ds_read_b128 a[68:71], v25 offset:10240
  s_mul_i32 s33, s81, 96
  v_mfma_f32_16x16x32_bf16 v[240:243], a[16:19], a[44:47], v[240:243]
  v_mfma_f32_16x16x32_bf16 v[244:247], a[20:23], a[44:47], v[244:247]
  ds_read_b128 a[72:75], v25 offset:12288
  s_add_u32 m0, s74, 0
  v_mfma_f32_16x16x32_bf16 v[212:215], a[20:23], a[40:43], v[212:215]
  s_add_u32 s33, s33, s32
  v_mfma_f32_16x16x32_bf16 v[180:183], a[20:23], a[36:39], v[180:183]
  ds_read_b128 a[76:79], v25 offset:14336
  v_mfma_f32_16x16x32_bf16 v[148:151], a[20:23], a[32:35], v[148:151]
  s_mul_i32 s82, s33, 5120
  v_mfma_f32_16x16x32_bf16 v[152:155], a[24:27], a[32:35], v[152:155]
  buffer_load_dwordx4 v20, s[12:15], s78 offen offset:2048 lds
  v_mfma_f32_16x16x32_bf16 v[184:187], a[24:27], a[36:39], v[184:187]
  v_mfma_f32_16x16x32_bf16 v[216:219], a[24:27], a[40:43], v[216:219]
  s_add_u32 s82, s82, 1048576
  v_mfma_f32_16x16x32_bf16 v[248:251], a[24:27], a[44:47], v[248:251]
  buffer_load_dwordx4 v21, s[12:15], s78 offen offset:3072 lds
  v_mfma_f32_16x16x32_bf16 v[252:255], a[28:31], a[44:47], v[252:255]
  s_lshl1_add_u32 s33, s80, s28
  v_mfma_f32_16x16x32_bf16 v[220:223], a[28:31], a[40:43], v[220:223]
  v_mfma_f32_16x16x32_bf16 v[188:191], a[28:31], a[36:39], v[188:191]
  v_mfma_f32_16x16x32_bf16 v[156:159], a[28:31], a[32:35], v[156:159]
  s_waitcnt vmcnt(19) lgkmcnt(0)
  s_barrier
  v_mfma_f32_16x16x32_bf16 v[128:131], a[48:51], a[80:83], v[128:131]
  ds_read_b128 a[32:35], v124 offset:0
  s_add_u32 m0, s73, 49152
  v_mfma_f32_16x16x32_bf16 v[160:163], a[48:51], a[84:87], v[160:163]
  s_mul_i32 s34, s33, 96
  v_mfma_f32_16x16x32_bf16 v[192:195], a[48:51], a[88:91], v[192:195]
  ds_read_b128 a[36:39], v124 offset:2048
  s_add_u32 s34, s34, s32
  v_mfma_f32_16x16x32_bf16 v[224:227], a[48:51], a[92:95], v[224:227]
  s_movk_i32 s78, 512
  s_mul_i32 s83, s34, 4096
  v_mfma_f32_16x16x32_bf16 v[228:231], a[52:55], a[92:95], v[228:231]
  ds_read_b128 a[40:43], v124 offset:8192
  s_add_u32 s83, s83, 10485760
  v_mfma_f32_16x16x32_bf16 v[196:199], a[52:55], a[88:91], v[196:199]
  v_mfma_f32_16x16x32_bf16 v[164:167], a[52:55], a[84:87], v[164:167]
  buffer_load_dwordx4 v10, s[16:19], s78 offen offset:0 lds
  v_mfma_f32_16x16x32_bf16 v[132:135], a[52:55], a[80:83], v[132:135]
  ds_read_b128 a[44:47], v124 offset:10240
  s_xor_b32 s33, s33, 1
  v_mfma_f32_16x16x32_bf16 v[136:139], a[56:59], a[80:83], v[136:139]
  s_mul_i32 s34, s33, 96
  ds_read_b128 a[0:3], v26 offset:0
  v_mfma_f32_16x16x32_bf16 v[168:171], a[56:59], a[84:87], v[168:171]
  s_add_u32 s34, s34, s32
  s_mul_i32 s30, s34, 4096
  v_mfma_f32_16x16x32_bf16 v[200:203], a[56:59], a[88:91], v[200:203]
  buffer_load_dwordx4 v11, s[16:19], s78 offen offset:1024 lds
  v_mfma_f32_16x16x32_bf16 v[232:235], a[56:59], a[92:95], v[232:235]
  ds_read_b128 a[4:7], v26 offset:2048
  s_add_u32 s30, s30, 10485760
  v_mfma_f32_16x16x32_bf16 v[236:239], a[60:63], a[92:95], v[236:239]
  ds_read_b128 a[8:11], v26 offset:4096
  s_lshl_b32 s93, s80, 14
  v_mfma_f32_16x16x32_bf16 v[204:207], a[60:63], a[88:91], v[204:207]
  buffer_load_dwordx4 v12, s[16:19], s78 offen offset:2048 lds
  v_mfma_f32_16x16x32_bf16 v[172:175], a[60:63], a[84:87], v[172:175]
  s_add_u32 s93, s93, 262144
  ds_read_b128 a[12:15], v26 offset:6144
  v_mfma_f32_16x16x32_bf16 v[140:143], a[60:63], a[80:83], v[140:143]
  v_mfma_f32_16x16x32_bf16 v[144:147], a[64:67], a[80:83], v[144:147]
  ds_read_b128 a[16:19], v26 offset:8192
  v_mfma_f32_16x16x32_bf16 v[56:59], v[68:71], a[112:115], 0
  v_mfma_f32_16x16x32_bf16 v[176:179], a[64:67], a[84:87], v[176:179]
  buffer_load_dwordx4 v13, s[16:19], s78 offen offset:3072 lds
  v_mfma_f32_16x16x32_bf16 v[208:211], a[64:67], a[88:91], v[208:211]
  v_mfma_f32_16x16x32_bf16 v[56:59], v[68:71], a[116:119], v[56:59]
  ds_read_b128 a[20:23], v26 offset:10240
  v_mfma_f32_16x16x32_bf16 v[56:59], v[68:71], a[120:123], v[56:59]
  v_mfma_f32_16x16x32_bf16 v[240:243], a[64:67], a[92:95], v[240:243]
  v_mfma_f32_16x16x32_bf16 v[56:59], v[68:71], a[124:127], v[56:59]
  v_mfma_f32_16x16x32_bf16 v[244:247], a[68:71], a[92:95], v[244:247]
  ds_read_b128 a[24:27], v26 offset:12288
  s_add_u32 m0, s74, 49152
  v_mfma_f32_16x16x32_bf16 v[212:215], a[68:71], a[88:91], v[212:215]
  v_mfma_f32_16x16x32_bf16 v[56:59], v[68:71], a[128:131], v[56:59]
  v_mfma_f32_16x16x32_bf16 v[180:183], a[68:71], a[84:87], v[180:183]
  ds_read_b128 a[28:31], v26 offset:14336
  s_nop 0
  v_mfma_f32_16x16x32_bf16 v[148:151], a[68:71], a[80:83], v[148:151]
  s_nop 0
  v_mfma_f32_16x16x32_bf16 v[152:155], a[72:75], a[80:83], v[152:155]
  buffer_load_dwordx4 v18, s[12:15], s78 offen offset:0 lds
  v_mfma_f32_16x16x32_bf16 v[184:187], a[72:75], a[84:87], v[184:187]
  s_nop 0
  v_mfma_f32_16x16x32_bf16 v[216:219], a[72:75], a[88:91], v[216:219]
  v_add_f32_dpp v56, v56, v56 quad_perm:[1,0,3,2] row_mask:0xf bank_mask:0xf
  v_mfma_f32_16x16x32_bf16 v[248:251], a[72:75], a[92:95], v[248:251]
  buffer_load_dwordx4 v19, s[12:15], s78 offen offset:1024 lds
  v_mfma_f32_16x16x32_bf16 v[252:255], a[76:79], a[92:95], v[252:255]
  v_add_f32_dpp v56, v56, v56 quad_perm:[2,3,0,1] row_mask:0xf bank_mask:0xf
  v_mov_b32 v57, s96
  v_mfma_f32_16x16x32_bf16 v[220:223], a[76:79], a[88:91], v[220:223]
  buffer_store_dwordx2 v[56:57], v55, s[8:11], s98 offen sc1
  v_mfma_f32_16x16x32_bf16 v[188:191], a[76:79], a[84:87], v[188:191]
  v_mfma_f32_16x16x32_bf16 v[156:159], a[76:79], a[80:83], v[156:159]
  s_waitcnt lgkmcnt(0)
  v_mfma_f32_16x16x32_bf16 v[128:131], a[0:3], a[32:35], v[128:131]
  ds_read_b128 a[80:83], v125 offset:0
  s_add_u32 m0, s73, 53248
  v_mfma_f32_16x16x32_bf16 v[160:163], a[0:3], a[36:39], v[160:163]
  s_waitcnt vmcnt(13)
  v_mfma_f32_16x16x32_bf16 v[192:195], a[0:3], a[40:43], v[192:195]
  ds_read_b128 a[84:87], v125 offset:2048
  v_lshrrev_b32 v60, 4, v1
  v_mfma_f32_16x16x32_bf16 v[224:227], a[0:3], a[44:47], v[224:227]
  s_movk_i32 s78, 512
  v_mfma_f32_16x16x32_bf16 v[228:231], a[4:7], a[44:47], v[228:231]
  ds_read_b128 a[88:91], v125 offset:8192
  v_cvt_f32_u32 v60, v60
  v_mfma_f32_16x16x32_bf16 v[196:199], a[4:7], a[40:43], v[196:199]
  v_mfma_f32_16x16x32_bf16 v[164:167], a[4:7], a[36:39], v[164:167]
  buffer_load_dwordx4 v14, s[16:19], s78 offen offset:0 lds
  v_mfma_f32_16x16x32_bf16 v[132:135], a[4:7], a[32:35], v[132:135]
  ds_read_b128 a[92:95], v125 offset:10240
  v_mul_f32 v60, 0x42000000, v60
  v_mfma_f32_16x16x32_bf16 v[136:139], a[8:11], a[32:35], v[136:139]
  v_sub_f32 v61, 0x42c00000, v60
  ds_read_b128 a[48:51], v27 offset:0
  v_mfma_f32_16x16x32_bf16 v[168:171], a[8:11], a[36:39], v[168:171]
  v_mul_f32 v62, 4.0, v60
  v_mfma_f32_16x16x32_bf16 v[200:203], a[8:11], a[40:43], v[200:203]
  buffer_load_dwordx4 v15, s[16:19], s78 offen offset:1024 lds
  v_mfma_f32_16x16x32_bf16 v[232:235], a[8:11], a[44:47], v[232:235]
  ds_read_b128 a[52:55], v27 offset:2048
  v_lshlrev_b32 v114, 16, v114
  v_mfma_f32_16x16x32_bf16 v[236:239], a[12:15], a[44:47], v[236:239]
  ds_read_b128 a[56:59], v27 offset:4096
  v_mul_f32 v90, 0x3fb8aa3b, v114
  v_mfma_f32_16x16x32_bf16 v[204:207], a[12:15], a[40:43], v[204:207]
  buffer_load_dwordx4 v16, s[16:19], s78 offen offset:2048 lds
  v_mfma_f32_16x16x32_bf16 v[172:175], a[12:15], a[36:39], v[172:175]
  ds_read_b128 a[60:63], v27 offset:6144
  v_exp_f32 v90, v90
  v_mfma_f32_16x16x32_bf16 v[140:143], a[12:15], a[32:35], v[140:143]
  v_mfma_f32_16x16x32_bf16 v[144:147], a[16:19], a[32:35], v[144:147]
  ds_read_b128 a[64:67], v27 offset:8192
  v_lshlrev_b32 v112, 16, v112
  v_mfma_f32_16x16x32_bf16 v[176:179], a[16:19], a[36:39], v[176:179]
  buffer_load_dwordx4 v17, s[16:19], s78 offen offset:3072 lds
  v_mfma_f32_16x16x32_bf16 v[208:211], a[16:19], a[40:43], v[208:211]
  v_lshlrev_b32 v113, 16, v113
  ds_read_b128 a[68:71], v27 offset:10240
  v_mfma_f32_16x16x32_bf16 v[240:243], a[16:19], a[44:47], v[240:243]
  v_cvt_pk_bf16_f32 v90, v90, v90
  v_mfma_f32_16x16x32_bf16 v[244:247], a[20:23], a[44:47], v[244:247]
  ds_read_b128 a[72:75], v27 offset:12288
  s_add_u32 m0, s74, 49152
  v_mfma_f32_16x16x32_bf16 v[212:215], a[20:23], a[40:43], v[212:215]
  v_and_b32 v90, 0xffff0000, v90
  v_mfma_f32_16x16x32_bf16 v[180:183], a[20:23], a[36:39], v[180:183]
  ds_read_b128 a[76:79], v27 offset:14336
  v_mul_f32 v88, v90, v112
  v_mfma_f32_16x16x32_bf16 v[148:151], a[20:23], a[32:35], v[148:151]
  v_mfma_f32_16x16x32_bf16 v[152:155], a[24:27], a[32:35], v[152:155]
  buffer_load_dwordx4 v20, s[12:15], s78 offen offset:2048 lds
  v_mfma_f32_16x16x32_bf16 v[184:187], a[24:27], a[36:39], v[184:187]
  v_mul_f32 v89, v90, v113
  v_mfma_f32_16x16x32_bf16 v[216:219], a[24:27], a[40:43], v[216:219]
  v_mul_f32 v88, 0x3fb8aa3b, v88
  v_mfma_f32_16x16x32_bf16 v[248:251], a[24:27], a[44:47], v[248:251]
  buffer_load_dwordx4 v21, s[12:15], s78 offen offset:3072 lds
  v_mfma_f32_16x16x32_bf16 v[252:255], a[28:31], a[44:47], v[252:255]
  v_mul_f32 v89, 0.15915494, v89
  v_mfma_f32_16x16x32_bf16 v[220:223], a[28:31], a[40:43], v[220:223]
  v_exp_f32 v90, v88
  v_mfma_f32_16x16x32_bf16 v[188:191], a[28:31], a[36:39], v[188:191]
  v_mfma_f32_16x16x32_bf16 v[156:159], a[28:31], a[32:35], v[156:159]
  s_waitcnt vmcnt(13) lgkmcnt(0)
  s_barrier
  v_mfma_f32_16x16x32_bf16 v[128:131], a[48:51], a[80:83], v[128:131]
  ds_read_b128 a[32:35], v120 offset:0
  s_add_u32 m0, s73, 98304
  v_mfma_f32_16x16x32_bf16 v[160:163], a[48:51], a[84:87], v[160:163]
  v_fract_f32 v91, v89
  v_mfma_f32_16x16x32_bf16 v[192:195], a[48:51], a[88:91], v[192:195]
  ds_read_b128 a[36:39], v120 offset:2048
  v_cos_f32 v72, v91
  v_mfma_f32_16x16x32_bf16 v[224:227], a[48:51], a[92:95], v[224:227]
TS_13:
  s_cbranch_execz TS_17
  s_movk_i32 s78, 640
  v_mfma_f32_16x16x32_bf16 v[228:231], a[52:55], a[92:95], v[228:231]
  ds_read_b128 a[40:43], v120 offset:8192
  v_sin_f32 v73, v91
  v_mfma_f32_16x16x32_bf16 v[196:199], a[52:55], a[88:91], v[196:199]
  v_mfma_f32_16x16x32_bf16 v[164:167], a[52:55], a[84:87], v[164:167]
  buffer_load_dwordx4 v10, s[16:19], s78 offen offset:0 lds
  v_mfma_f32_16x16x32_bf16 v[132:135], a[52:55], a[80:83], v[132:135]
  ds_read_b128 a[44:47], v120 offset:10240
  v_mul_f32 v72, v72, v90
  v_mfma_f32_16x16x32_bf16 v[136:139], a[56:59], a[80:83], v[136:139]
  v_mul_f32 v73, v73, v90
  ds_read_b128 a[0:3], v22 offset:0
  v_mfma_f32_16x16x32_bf16 v[168:171], a[56:59], a[84:87], v[168:171]
  v_mul_f32 v91, v112, v112
  v_mfma_f32_16x16x32_bf16 v[200:203], a[56:59], a[88:91], v[200:203]
  buffer_load_dwordx4 v11, s[16:19], s78 offen offset:1024 lds
  v_mfma_f32_16x16x32_bf16 v[232:235], a[56:59], a[92:95], v[232:235]
  ds_read_b128 a[4:7], v22 offset:2048
  v_fmac_f32 v91, v113, v113
  v_mfma_f32_16x16x32_bf16 v[236:239], a[60:63], a[92:95], v[236:239]
  ds_read_b128 a[8:11], v22 offset:4096
  v_rcp_f32 v91, v91
  v_mfma_f32_16x16x32_bf16 v[204:207], a[60:63], a[88:91], v[204:207]
  v_mfma_f32_16x16x32_bf16 v[172:175], a[60:63], a[84:87], v[172:175]
  buffer_load_dwordx4 v12, s[16:19], s78 offen offset:2048 lds
  v_mfma_f32_16x16x32_bf16 v[140:143], a[60:63], a[80:83], v[140:143]
  ds_read_b128 a[12:15], v22 offset:6144
  v_add_f32 v90, -1.0, v72
  v_mfma_f32_16x16x32_bf16 v[144:147], a[64:67], a[80:83], v[144:147]
  ds_read_b128 a[16:19], v22 offset:8192
  v_mul_f32 v74, v90, v112
  v_mfma_f32_16x16x32_bf16 v[176:179], a[64:67], a[84:87], v[176:179]
  buffer_load_dwordx4 v13, s[16:19], s78 offen offset:3072 lds
  v_mfma_f32_16x16x32_bf16 v[208:211], a[64:67], a[88:91], v[208:211]
  v_add_f32 v91, v91, v91
  ds_read_b128 a[20:23], v22 offset:10240
  v_mfma_f32_16x16x32_bf16 v[240:243], a[64:67], a[92:95], v[240:243]
  v_fmac_f32 v74, v73, v113
  v_mfma_f32_16x16x32_bf16 v[244:247], a[68:71], a[92:95], v[244:247]
  ds_read_b128 a[24:27], v22 offset:12288
  s_add_u32 m0, s74, 98304
  v_mfma_f32_16x16x32_bf16 v[212:215], a[68:71], a[88:91], v[212:215]
  v_mul_f32 v75, v73, v112
  v_mfma_f32_16x16x32_bf16 v[180:183], a[68:71], a[84:87], v[180:183]
  ds_read_b128 a[28:31], v22 offset:14336
  v_fma_f32 v75, -v90, v113, v75
  v_mfma_f32_16x16x32_bf16 v[148:151], a[68:71], a[80:83], v[148:151]
  v_mfma_f32_16x16x32_bf16 v[152:155], a[72:75], a[80:83], v[152:155]
  buffer_load_dwordx4 v18, s[12:15], s78 offen offset:0 lds
  v_mfma_f32_16x16x32_bf16 v[184:187], a[72:75], a[84:87], v[184:187]
  v_mul_f32 v74, v74, v91
  v_mfma_f32_16x16x32_bf16 v[216:219], a[72:75], a[88:91], v[216:219]
  v_mul_f32 v75, v75, v91
  v_mfma_f32_16x16x32_bf16 v[248:251], a[72:75], a[92:95], v[248:251]
  buffer_load_dwordx4 v19, s[12:15], s78 offen offset:1024 lds
  v_mfma_f32_16x16x32_bf16 v[252:255], a[76:79], a[92:95], v[252:255]
  v_mul_f32 v90, 0x41800000, v88
  v_mfma_f32_16x16x32_bf16 v[220:223], a[76:79], a[88:91], v[220:223]
  v_mul_f32 v91, 0x41800000, v89
  v_mfma_f32_16x16x32_bf16 v[188:191], a[76:79], a[84:87], v[188:191]
  v_mfma_f32_16x16x32_bf16 v[156:159], a[76:79], a[80:83], v[156:159]
  s_waitcnt lgkmcnt(0)
  v_mfma_f32_16x16x32_bf16 v[128:131], a[0:3], a[32:35], v[128:131]
  ds_read_b128 a[80:83], v121 offset:0
  s_add_u32 m0, s73, 102400
  v_mfma_f32_16x16x32_bf16 v[160:163], a[0:3], a[36:39], v[160:163]
  v_exp_f32 v90, v90
  v_mfma_f32_16x16x32_bf16 v[192:195], a[0:3], a[40:43], v[192:195]
  ds_read_b128 a[84:87], v121 offset:2048
  v_fract_f32 v91, v91
  v_mfma_f32_16x16x32_bf16 v[224:227], a[0:3], a[44:47], v[224:227]
  s_movk_i32 s78, 640
  v_mfma_f32_16x16x32_bf16 v[228:231], a[4:7], a[44:47], v[228:231]
  ds_read_b128 a[88:91], v121 offset:8192
  v_cos_f32 v76, v91
  v_mfma_f32_16x16x32_bf16 v[196:199], a[4:7], a[40:43], v[196:199]
  v_mfma_f32_16x16x32_bf16 v[164:167], a[4:7], a[36:39], v[164:167]
  buffer_load_dwordx4 v14, s[16:19], s78 offen offset:0 lds
  v_mfma_f32_16x16x32_bf16 v[132:135], a[4:7], a[32:35], v[132:135]
  ds_read_b128 a[92:95], v121 offset:10240
  v_sin_f32 v77, v91
  v_mfma_f32_16x16x32_bf16 v[136:139], a[8:11], a[32:35], v[136:139]
  v_mul_f32 v76, v76, v90
  v_mfma_f32_16x16x32_bf16 v[168:171], a[8:11], a[36:39], v[168:171]
  ds_read_b128 a[48:51], v23 offset:0
  v_mul_f32 v77, v77, v90
  v_mfma_f32_16x16x32_bf16 v[200:203], a[8:11], a[40:43], v[200:203]
  buffer_load_dwordx4 v15, s[16:19], s78 offen offset:1024 lds
  v_mfma_f32_16x16x32_bf16 v[232:235], a[8:11], a[44:47], v[232:235]
  ds_read_b128 a[52:55], v23 offset:2048
  v_mul_f32 v90, 0x42000000, v88
  v_mfma_f32_16x16x32_bf16 v[236:239], a[12:15], a[44:47], v[236:239]
  ds_read_b128 a[56:59], v23 offset:4096
  v_mul_f32 v91, 0x42000000, v89
  v_mfma_f32_16x16x32_bf16 v[204:207], a[12:15], a[40:43], v[204:207]
  buffer_load_dwordx4 v16, s[16:19], s78 offen offset:2048 lds
  v_mfma_f32_16x16x32_bf16 v[172:175], a[12:15], a[36:39], v[172:175]
  ds_read_b128 a[60:63], v23 offset:6144
  v_exp_f32 v90, v90
  v_mfma_f32_16x16x32_bf16 v[140:143], a[12:15], a[32:35], v[140:143]
  v_mfma_f32_16x16x32_bf16 v[144:147], a[16:19], a[32:35], v[144:147]
  ds_read_b128 a[64:67], v23 offset:8192
  v_fract_f32 v91, v91
  v_mfma_f32_16x16x32_bf16 v[176:179], a[16:19], a[36:39], v[176:179]
  buffer_load_dwordx4 v17, s[16:19], s78 offen offset:3072 lds
  v_mfma_f32_16x16x32_bf16 v[208:211], a[16:19], a[40:43], v[208:211]
  v_cos_f32 v78, v91
  v_mfma_f32_16x16x32_bf16 v[240:243], a[16:19], a[44:47], v[240:243]
  ds_read_b128 a[68:71], v23 offset:10240
  v_sin_f32 v79, v91
  v_mfma_f32_16x16x32_bf16 v[244:247], a[20:23], a[44:47], v[244:247]
  ds_read_b128 a[72:75], v23 offset:12288
  v_mfma_f32_16x16x32_bf16 v[212:215], a[20:23], a[40:43], v[212:215]
  s_add_u32 m0, s74, 98304
  v_mul_f32 v78, v78, v90
  v_mfma_f32_16x16x32_bf16 v[180:183], a[20:23], a[36:39], v[180:183]
  ds_read_b128 a[76:79], v23 offset:14336
  v_mul_f32 v79, v79, v90
  v_mfma_f32_16x16x32_bf16 v[148:151], a[20:23], a[32:35], v[148:151]
  v_mfma_f32_16x16x32_bf16 v[152:155], a[24:27], a[32:35], v[152:155]
  buffer_load_dwordx4 v20, s[12:15], s78 offen offset:2048 lds
  v_mfma_f32_16x16x32_bf16 v[184:187], a[24:27], a[36:39], v[184:187]
  v_mul_f32 v90, 0x44000000, v88
  v_mfma_f32_16x16x32_bf16 v[216:219], a[24:27], a[40:43], v[216:219]
  v_mul_f32 v91, 0x44000000, v89
  v_mfma_f32_16x16x32_bf16 v[248:251], a[24:27], a[44:47], v[248:251]
  buffer_load_dwordx4 v21, s[12:15], s78 offen offset:3072 lds
  v_mfma_f32_16x16x32_bf16 v[252:255], a[28:31], a[44:47], v[252:255]
  v_exp_f32 v90, v90
  v_mfma_f32_16x16x32_bf16 v[220:223], a[28:31], a[40:43], v[220:223]
  v_fract_f32 v91, v91
  v_mfma_f32_16x16x32_bf16 v[188:191], a[28:31], a[36:39], v[188:191]
  v_mfma_f32_16x16x32_bf16 v[156:159], a[28:31], a[32:35], v[156:159]
  s_waitcnt vmcnt(12) lgkmcnt(0)
  s_barrier
  v_mfma_f32_16x16x32_bf16 v[128:131], a[48:51], a[80:83], v[128:131]
  ds_read_b128 a[32:35], v122 offset:0
  s_add_u32 m0, s73, 0
  v_mfma_f32_16x16x32_bf16 v[160:163], a[48:51], a[84:87], v[160:163]
  v_cos_f32 v80, v91
  v_mfma_f32_16x16x32_bf16 v[192:195], a[48:51], a[88:91], v[192:195]
  ds_read_b128 a[36:39], v122 offset:2048
  v_sin_f32 v81, v91
  v_mfma_f32_16x16x32_bf16 v[224:227], a[48:51], a[92:95], v[224:227]
  s_movk_i32 s78, 768
  v_mfma_f32_16x16x32_bf16 v[228:231], a[52:55], a[92:95], v[228:231]
  ds_read_b128 a[40:43], v122 offset:8192
  v_mul_f32 v80, v80, v90
  v_mfma_f32_16x16x32_bf16 v[196:199], a[52:55], a[88:91], v[196:199]
  v_mfma_f32_16x16x32_bf16 v[164:167], a[52:55], a[84:87], v[164:167]
  buffer_load_dwordx4 v10, s[16:19], s78 offen offset:0 lds
  v_mfma_f32_16x16x32_bf16 v[132:135], a[52:55], a[80:83], v[132:135]
  ds_read_b128 a[44:47], v122 offset:10240
  v_mul_f32 v81, v81, v90
  v_mfma_f32_16x16x32_bf16 v[136:139], a[56:59], a[80:83], v[136:139]
  v_mul_f32 v90, v60, v88
  ds_read_b128 a[0:3], v24 offset:0
  v_mfma_f32_16x16x32_bf16 v[168:171], a[56:59], a[84:87], v[168:171]
  v_mul_f32 v91, v60, v89
  v_mfma_f32_16x16x32_bf16 v[200:203], a[56:59], a[88:91], v[200:203]
  buffer_load_dwordx4 v11, s[16:19], s78 offen offset:1024 lds
  v_mfma_f32_16x16x32_bf16 v[232:235], a[56:59], a[92:95], v[232:235]
  ds_read_b128 a[4:7], v24 offset:2048
  v_exp_f32 v90, v90
  v_mfma_f32_16x16x32_bf16 v[236:239], a[60:63], a[92:95], v[236:239]
  ds_read_b128 a[8:11], v24 offset:4096
  v_mfma_f32_16x16x32_bf16 v[204:207], a[60:63], a[88:91], v[204:207]
  buffer_load_dwordx4 v12, s[16:19], s78 offen offset:2048 lds
  v_mfma_f32_16x16x32_bf16 v[172:175], a[60:63], a[84:87], v[172:175]
  v_fract_f32 v91, v91
  ds_read_b128 a[12:15], v24 offset:6144
  v_mfma_f32_16x16x32_bf16 v[140:143], a[60:63], a[80:83], v[140:143]
  v_cos_f32 v82, v91
  v_mfma_f32_16x16x32_bf16 v[144:147], a[64:67], a[80:83], v[144:147]
  ds_read_b128 a[16:19], v24 offset:8192
  v_sin_f32 v83, v91
  v_mfma_f32_16x16x32_bf16 v[176:179], a[64:67], a[84:87], v[176:179]
  v_mul_f32 v82, v82, v90
  v_mfma_f32_16x16x32_bf16 v[208:211], a[64:67], a[88:91], v[208:211]
  buffer_load_dwordx4 v13, s[16:19], s78 offen offset:3072 lds
  v_mfma_f32_16x16x32_bf16 v[240:243], a[64:67], a[92:95], v[240:243]
  ds_read_b128 a[20:23], v24 offset:10240
  v_mul_f32 v83, v83, v90
  v_mfma_f32_16x16x32_bf16 v[244:247], a[68:71], a[92:95], v[244:247]
  ds_read_b128 a[24:27], v24 offset:12288
  s_add_u32 m0, s74, 0
  v_mfma_f32_16x16x32_bf16 v[212:215], a[68:71], a[88:91], v[212:215]
  v_mul_f32 v90, v61, v88
  v_mfma_f32_16x16x32_bf16 v[180:183], a[68:71], a[84:87], v[180:183]
  ds_read_b128 a[28:31], v24 offset:14336
  v_mul_f32 v91, v61, v89
  v_mfma_f32_16x16x32_bf16 v[148:151], a[68:71], a[80:83], v[148:151]
  v_mfma_f32_16x16x32_bf16 v[152:155], a[72:75], a[80:83], v[152:155]
  buffer_load_dwordx4 v18, s[12:15], s78 offen offset:0 lds
  v_mfma_f32_16x16x32_bf16 v[184:187], a[72:75], a[84:87], v[184:187]
  v_exp_f32 v90, v90
  v_mfma_f32_16x16x32_bf16 v[216:219], a[72:75], a[88:91], v[216:219]
  v_fract_f32 v91, v91
  v_mfma_f32_16x16x32_bf16 v[248:251], a[72:75], a[92:95], v[248:251]
  buffer_load_dwordx4 v19, s[12:15], s78 offen offset:1024 lds
  v_mfma_f32_16x16x32_bf16 v[252:255], a[76:79], a[92:95], v[252:255]
  v_cos_f32 v84, v91
  v_mfma_f32_16x16x32_bf16 v[220:223], a[76:79], a[88:91], v[220:223]
  v_sin_f32 v85, v91
  v_mfma_f32_16x16x32_bf16 v[188:191], a[76:79], a[84:87], v[188:191]
  v_mfma_f32_16x16x32_bf16 v[156:159], a[76:79], a[80:83], v[156:159]
  s_waitcnt lgkmcnt(0)
  v_mfma_f32_16x16x32_bf16 v[128:131], a[0:3], a[32:35], v[128:131]
  ds_read_b128 a[80:83], v123 offset:0
  s_add_u32 m0, s73, 4096
  v_mfma_f32_16x16x32_bf16 v[160:163], a[0:3], a[36:39], v[160:163]
  v_mul_f32 v84, v84, v90
  v_mfma_f32_16x16x32_bf16 v[192:195], a[0:3], a[40:43], v[192:195]
  ds_read_b128 a[84:87], v123 offset:2048
  v_mul_f32 v85, v85, v90
  v_mfma_f32_16x16x32_bf16 v[224:227], a[0:3], a[44:47], v[224:227]
  s_movk_i32 s78, 768
  v_mfma_f32_16x16x32_bf16 v[228:231], a[4:7], a[44:47], v[228:231]
  ds_read_b128 a[88:91], v123 offset:8192
  v_mul_f32 v90, v62, v88
  v_mfma_f32_16x16x32_bf16 v[196:199], a[4:7], a[40:43], v[196:199]
  v_mfma_f32_16x16x32_bf16 v[164:167], a[4:7], a[36:39], v[164:167]
  buffer_load_dwordx4 v14, s[16:19], s78 offen offset:0 lds
  v_mfma_f32_16x16x32_bf16 v[132:135], a[4:7], a[32:35], v[132:135]
  ds_read_b128 a[92:95], v123 offset:10240
  v_mul_f32 v91, v62, v89
  v_mfma_f32_16x16x32_bf16 v[136:139], a[8:11], a[32:35], v[136:139]
  v_exp_f32 v90, v90
  v_mfma_f32_16x16x32_bf16 v[168:171], a[8:11], a[36:39], v[168:171]
  ds_read_b128 a[48:51], v25 offset:0
  v_fract_f32 v91, v91
  v_mfma_f32_16x16x32_bf16 v[200:203], a[8:11], a[40:43], v[200:203]
  buffer_load_dwordx4 v15, s[16:19], s78 offen offset:1024 lds
  v_mfma_f32_16x16x32_bf16 v[232:235], a[8:11], a[44:47], v[232:235]
  ds_read_b128 a[52:55], v25 offset:2048
  v_cos_f32 v86, v91
  v_mfma_f32_16x16x32_bf16 v[236:239], a[12:15], a[44:47], v[236:239]
  ds_read_b128 a[56:59], v25 offset:4096
  v_mfma_f32_16x16x32_bf16 v[204:207], a[12:15], a[40:43], v[204:207]
  buffer_load_dwordx4 v16, s[16:19], s78 offen offset:2048 lds
  v_mfma_f32_16x16x32_bf16 v[172:175], a[12:15], a[36:39], v[172:175]
  v_sin_f32 v87, v91
  v_mfma_f32_16x16x32_bf16 v[140:143], a[12:15], a[32:35], v[140:143]
  ds_read_b128 a[60:63], v25 offset:6144
  v_mul_f32 v86, v86, v90
  v_mfma_f32_16x16x32_bf16 v[144:147], a[16:19], a[32:35], v[144:147]
  ds_read_b128 a[64:67], v25 offset:8192
  v_mul_f32 v87, v87, v90
  v_mfma_f32_16x16x32_bf16 v[176:179], a[16:19], a[36:39], v[176:179]
  buffer_load_dwordx4 v17, s[16:19], s78 offen offset:3072 lds
  v_mfma_f32_16x16x32_bf16 v[208:211], a[16:19], a[40:43], v[208:211]
  v_lshlrev_b32 v117, 16, v117
  ds_read_b128 a[68:71], v25 offset:10240
  v_mfma_f32_16x16x32_bf16 v[240:243], a[16:19], a[44:47], v[240:243]
  v_mul_f32 v110, 0x3fb8aa3b, v117
  v_mfma_f32_16x16x32_bf16 v[244:247], a[20:23], a[44:47], v[244:247]
  ds_read_b128 a[72:75], v25 offset:12288
  s_add_u32 m0, s74, 0
  v_mfma_f32_16x16x32_bf16 v[212:215], a[20:23], a[40:43], v[212:215]
  v_exp_f32 v110, v110
  v_mfma_f32_16x16x32_bf16 v[180:183], a[20:23], a[36:39], v[180:183]
  ds_read_b128 a[76:79], v25 offset:14336
  v_lshlrev_b32 v115, 16, v115
  v_mfma_f32_16x16x32_bf16 v[148:151], a[20:23], a[32:35], v[148:151]
  v_mfma_f32_16x16x32_bf16 v[152:155], a[24:27], a[32:35], v[152:155]
  buffer_load_dwordx4 v20, s[12:15], s78 offen offset:2048 lds
  v_mfma_f32_16x16x32_bf16 v[184:187], a[24:27], a[36:39], v[184:187]
  v_lshlrev_b32 v116, 16, v116
  v_mfma_f32_16x16x32_bf16 v[216:219], a[24:27], a[40:43], v[216:219]
  v_cvt_pk_bf16_f32 v110, v110, v110
  v_mfma_f32_16x16x32_bf16 v[248:251], a[24:27], a[44:47], v[248:251]
  buffer_load_dwordx4 v21, s[12:15], s78 offen offset:3072 lds
  v_mfma_f32_16x16x32_bf16 v[252:255], a[28:31], a[44:47], v[252:255]
  v_and_b32 v110, 0xffff0000, v110
  v_mfma_f32_16x16x32_bf16 v[220:223], a[28:31], a[40:43], v[220:223]
  v_mul_f32 v108, v110, v115
  v_mfma_f32_16x16x32_bf16 v[188:191], a[28:31], a[36:39], v[188:191]
  v_mfma_f32_16x16x32_bf16 v[156:159], a[28:31], a[32:35], v[156:159]
  s_waitcnt vmcnt(12) lgkmcnt(0)
  s_barrier
  v_mfma_f32_16x16x32_bf16 v[128:131], a[48:51], a[80:83], v[128:131]
  ds_read_b128 a[32:35], v124 offset:0
  s_add_u32 m0, s73, 49152
  v_mfma_f32_16x16x32_bf16 v[160:163], a[48:51], a[84:87], v[160:163]
  v_mul_f32 v109, v110, v116
  v_mfma_f32_16x16x32_bf16 v[192:195], a[48:51], a[88:91], v[192:195]
  ds_read_b128 a[36:39], v124 offset:2048
  v_mul_f32 v108, 0x3fb8aa3b, v108
  v_mfma_f32_16x16x32_bf16 v[224:227], a[48:51], a[92:95], v[224:227]
  s_movk_i32 s78, 896
  v_mfma_f32_16x16x32_bf16 v[228:231], a[52:55], a[92:95], v[228:231]
  ds_read_b128 a[40:43], v124 offset:8192
  v_mul_f32 v109, 0.15915494, v109
  v_mfma_f32_16x16x32_bf16 v[196:199], a[52:55], a[88:91], v[196:199]
  v_mfma_f32_16x16x32_bf16 v[164:167], a[52:55], a[84:87], v[164:167]
  buffer_load_dwordx4 v10, s[16:19], s78 offen offset:0 lds
  v_mfma_f32_16x16x32_bf16 v[132:135], a[52:55], a[80:83], v[132:135]
  ds_read_b128 a[44:47], v124 offset:10240
  v_exp_f32 v110, v108
  v_mfma_f32_16x16x32_bf16 v[136:139], a[56:59], a[80:83], v[136:139]
  v_fract_f32 v111, v109
  v_mfma_f32_16x16x32_bf16 v[168:171], a[56:59], a[84:87], v[168:171]
  ds_read_b128 a[0:3], v26 offset:0
  v_cos_f32 v92, v111
  v_mfma_f32_16x16x32_bf16 v[200:203], a[56:59], a[88:91], v[200:203]
  ds_read_b128 a[4:7], v26 offset:2048
  v_mfma_f32_16x16x32_bf16 v[232:235], a[56:59], a[92:95], v[232:235]
  buffer_load_dwordx4 v11, s[16:19], s78 offen offset:1024 lds
  v_mfma_f32_16x16x32_bf16 v[236:239], a[60:63], a[92:95], v[236:239]
  v_sin_f32 v93, v111
  v_mfma_f32_16x16x32_bf16 v[204:207], a[60:63], a[88:91], v[204:207]
  buffer_load_dwordx4 v12, s[16:19], s78 offen offset:2048 lds
  v_mfma_f32_16x16x32_bf16 v[172:175], a[60:63], a[84:87], v[172:175]
  ds_read_b128 a[8:11], v26 offset:4096
  v_mul_f32 v92, v92, v110
  v_mfma_f32_16x16x32_bf16 v[140:143], a[60:63], a[80:83], v[140:143]
  ds_read_b128 a[12:15], v26 offset:6144
  v_mul_f32 v93, v93, v110
  v_mfma_f32_16x16x32_bf16 v[144:147], a[64:67], a[80:83], v[144:147]
  ds_read_b128 a[16:19], v26 offset:8192
  v_mul_f32 v111, v115, v115
  v_mfma_f32_16x16x32_bf16 v[176:179], a[64:67], a[84:87], v[176:179]
  buffer_load_dwordx4 v13, s[16:19], s78 offen offset:3072 lds
  v_mfma_f32_16x16x32_bf16 v[208:211], a[64:67], a[88:91], v[208:211]
  v_fmac_f32 v111, v116, v116
  ds_read_b128 a[20:23], v26 offset:10240
  v_mfma_f32_16x16x32_bf16 v[240:243], a[64:67], a[92:95], v[240:243]
  v_rcp_f32 v111, v111
  v_mfma_f32_16x16x32_bf16 v[244:247], a[68:71], a[92:95], v[244:247]
  ds_read_b128 a[24:27], v26 offset:12288
  s_add_u32 m0, s74, 49152
  v_mfma_f32_16x16x32_bf16 v[212:215], a[68:71], a[88:91], v[212:215]
  v_add_f32 v110, -1.0, v92
  v_mfma_f32_16x16x32_bf16 v[180:183], a[68:71], a[84:87], v[180:183]
  ds_read_b128 a[28:31], v26 offset:14336
  v_mul_f32 v94, v110, v115
  v_mfma_f32_16x16x32_bf16 v[148:151], a[68:71], a[80:83], v[148:151]
  v_mfma_f32_16x16x32_bf16 v[152:155], a[72:75], a[80:83], v[152:155]
  buffer_load_dwordx4 v18, s[12:15], s78 offen offset:0 lds
  v_mfma_f32_16x16x32_bf16 v[184:187], a[72:75], a[84:87], v[184:187]
  v_add_f32 v111, v111, v111
  v_mfma_f32_16x16x32_bf16 v[216:219], a[72:75], a[88:91], v[216:219]
  v_fmac_f32 v94, v93, v116
  v_mfma_f32_16x16x32_bf16 v[248:251], a[72:75], a[92:95], v[248:251]
  buffer_load_dwordx4 v19, s[12:15], s78 offen offset:1024 lds
  v_mfma_f32_16x16x32_bf16 v[252:255], a[76:79], a[92:95], v[252:255]
  v_mul_f32 v95, v93, v115
  v_mfma_f32_16x16x32_bf16 v[220:223], a[76:79], a[88:91], v[220:223]
  v_fma_f32 v95, -v110, v116, v95
  v_mfma_f32_16x16x32_bf16 v[188:191], a[76:79], a[84:87], v[188:191]
  v_mfma_f32_16x16x32_bf16 v[156:159], a[76:79], a[80:83], v[156:159]
  s_waitcnt lgkmcnt(0)
  v_mfma_f32_16x16x32_bf16 v[128:131], a[0:3], a[32:35], v[128:131]
  ds_read_b128 a[80:83], v125 offset:0
  s_add_u32 m0, s73, 53248
  v_mfma_f32_16x16x32_bf16 v[160:163], a[0:3], a[36:39], v[160:163]
  v_mul_f32 v94, v94, v111
  v_mfma_f32_16x16x32_bf16 v[192:195], a[0:3], a[40:43], v[192:195]
  ds_read_b128 a[84:87], v125 offset:2048
  v_mul_f32 v95, v95, v111
  v_mfma_f32_16x16x32_bf16 v[224:227], a[0:3], a[44:47], v[224:227]
  s_movk_i32 s78, 896
  v_mfma_f32_16x16x32_bf16 v[228:231], a[4:7], a[44:47], v[228:231]
  ds_read_b128 a[88:91], v125 offset:8192
  v_mul_f32 v110, 0x41800000, v108
  v_mfma_f32_16x16x32_bf16 v[196:199], a[4:7], a[40:43], v[196:199]
  v_mfma_f32_16x16x32_bf16 v[164:167], a[4:7], a[36:39], v[164:167]
  buffer_load_dwordx4 v14, s[16:19], s78 offen offset:0 lds
  v_mfma_f32_16x16x32_bf16 v[132:135], a[4:7], a[32:35], v[132:135]
  ds_read_b128 a[92:95], v125 offset:10240
  v_mul_f32 v111, 0x41800000, v109
  v_mfma_f32_16x16x32_bf16 v[136:139], a[8:11], a[32:35], v[136:139]
  v_exp_f32 v110, v110
  v_mfma_f32_16x16x32_bf16 v[168:171], a[8:11], a[36:39], v[168:171]
  ds_read_b128 a[48:51], v27 offset:0
  v_fract_f32 v111, v111
  v_mfma_f32_16x16x32_bf16 v[200:203], a[8:11], a[40:43], v[200:203]
  buffer_load_dwordx4 v15, s[16:19], s78 offen offset:1024 lds
  v_mfma_f32_16x16x32_bf16 v[232:235], a[8:11], a[44:47], v[232:235]
  ds_read_b128 a[52:55], v27 offset:2048
  v_cos_f32 v96, v111
  v_mfma_f32_16x16x32_bf16 v[236:239], a[12:15], a[44:47], v[236:239]
  ds_read_b128 a[56:59], v27 offset:4096
  v_mfma_f32_16x16x32_bf16 v[204:207], a[12:15], a[40:43], v[204:207]
  buffer_load_dwordx4 v16, s[16:19], s78 offen offset:2048 lds
  v_mfma_f32_16x16x32_bf16 v[172:175], a[12:15], a[36:39], v[172:175]
  v_sin_f32 v97, v111
  v_mfma_f32_16x16x32_bf16 v[140:143], a[12:15], a[32:35], v[140:143]
  ds_read_b128 a[60:63], v27 offset:6144
  v_mul_f32 v96, v96, v110
  v_mfma_f32_16x16x32_bf16 v[144:147], a[16:19], a[32:35], v[144:147]
  ds_read_b128 a[64:67], v27 offset:8192
  v_mul_f32 v97, v97, v110
  v_mfma_f32_16x16x32_bf16 v[176:179], a[16:19], a[36:39], v[176:179]
  buffer_load_dwordx4 v17, s[16:19], s78 offen offset:3072 lds
  v_mfma_f32_16x16x32_bf16 v[208:211], a[16:19], a[40:43], v[208:211]
  v_mul_f32 v110, 0x42000000, v108
  ds_read_b128 a[68:71], v27 offset:10240
  v_mfma_f32_16x16x32_bf16 v[240:243], a[16:19], a[44:47], v[240:243]
  v_mul_f32 v111, 0x42000000, v109
  v_mfma_f32_16x16x32_bf16 v[244:247], a[20:23], a[44:47], v[244:247]
  ds_read_b128 a[72:75], v27 offset:12288
  s_add_u32 m0, s74, 49152
  v_mfma_f32_16x16x32_bf16 v[212:215], a[20:23], a[40:43], v[212:215]
  v_exp_f32 v110, v110
  v_mfma_f32_16x16x32_bf16 v[180:183], a[20:23], a[36:39], v[180:183]
  ds_read_b128 a[76:79], v27 offset:14336
  v_fract_f32 v111, v111
  v_mfma_f32_16x16x32_bf16 v[148:151], a[20:23], a[32:35], v[148:151]
  v_mfma_f32_16x16x32_bf16 v[152:155], a[24:27], a[32:35], v[152:155]
  buffer_load_dwordx4 v20, s[12:15], s78 offen offset:2048 lds
  v_mfma_f32_16x16x32_bf16 v[184:187], a[24:27], a[36:39], v[184:187]
  v_cos_f32 v98, v111
  v_mfma_f32_16x16x32_bf16 v[216:219], a[24:27], a[40:43], v[216:219]
  v_sin_f32 v99, v111
  v_mfma_f32_16x16x32_bf16 v[248:251], a[24:27], a[44:47], v[248:251]
  buffer_load_dwordx4 v21, s[12:15], s78 offen offset:3072 lds
  v_mfma_f32_16x16x32_bf16 v[252:255], a[28:31], a[44:47], v[252:255]
  v_mul_f32 v98, v98, v110
  v_mfma_f32_16x16x32_bf16 v[220:223], a[28:31], a[40:43], v[220:223]
  v_mul_f32 v99, v99, v110
  v_mfma_f32_16x16x32_bf16 v[188:191], a[28:31], a[36:39], v[188:191]
  v_mfma_f32_16x16x32_bf16 v[156:159], a[28:31], a[32:35], v[156:159]
  s_waitcnt vmcnt(12) lgkmcnt(0)
  s_barrier
  v_mfma_f32_16x16x32_bf16 v[128:131], a[48:51], a[80:83], v[128:131]
  ds_read_b128 a[32:35], v120 offset:0
  s_add_u32 m0, s73, 98304
  v_mfma_f32_16x16x32_bf16 v[160:163], a[48:51], a[84:87], v[160:163]
  v_mul_f32 v110, 0x44000000, v108
  v_mfma_f32_16x16x32_bf16 v[192:195], a[48:51], a[88:91], v[192:195]
  ds_read_b128 a[36:39], v120 offset:2048
  v_mul_f32 v111, 0x44000000, v109
  v_mfma_f32_16x16x32_bf16 v[224:227], a[48:51], a[92:95], v[224:227]
  s_movk_i32 s78, 1024
  v_mfma_f32_16x16x32_bf16 v[228:231], a[52:55], a[92:95], v[228:231]
  ds_read_b128 a[40:43], v120 offset:8192
  v_exp_f32 v110, v110
  v_mfma_f32_16x16x32_bf16 v[196:199], a[52:55], a[88:91], v[196:199]
  v_mfma_f32_16x16x32_bf16 v[164:167], a[52:55], a[84:87], v[164:167]
  buffer_load_dwordx4 v10, s[16:19], s78 offen offset:0 lds
  v_mfma_f32_16x16x32_bf16 v[132:135], a[52:55], a[80:83], v[132:135]
  ds_read_b128 a[44:47], v120 offset:10240
  v_fract_f32 v111, v111
  v_mfma_f32_16x16x32_bf16 v[136:139], a[56:59], a[80:83], v[136:139]
  v_cos_f32 v100, v111
  v_mfma_f32_16x16x32_bf16 v[168:171], a[56:59], a[84:87], v[168:171]
  ds_read_b128 a[0:3], v22 offset:0
  v_sin_f32 v101, v111
  v_mfma_f32_16x16x32_bf16 v[200:203], a[56:59], a[88:91], v[200:203]
  ds_read_b128 a[4:7], v22 offset:2048
  v_mfma_f32_16x16x32_bf16 v[232:235], a[56:59], a[92:95], v[232:235]
  buffer_load_dwordx4 v11, s[16:19], s78 offen offset:1024 lds
  v_mfma_f32_16x16x32_bf16 v[236:239], a[60:63], a[92:95], v[236:239]
  v_mul_f32 v100, v100, v110
  ds_read_b128 a[8:11], v22 offset:4096
  v_mfma_f32_16x16x32_bf16 v[204:207], a[60:63], a[88:91], v[204:207]
  buffer_load_dwordx4 v12, s[16:19], s78 offen offset:2048 lds
  v_mfma_f32_16x16x32_bf16 v[172:175], a[60:63], a[84:87], v[172:175]
  v_mul_f32 v101, v101, v110
  ds_read_b128 a[12:15], v22 offset:6144
  v_mfma_f32_16x16x32_bf16 v[140:143], a[60:63], a[80:83], v[140:143]
  v_mul_f32 v110, v60, v108
  v_mfma_f32_16x16x32_bf16 v[144:147], a[64:67], a[80:83], v[144:147]
  ds_read_b128 a[16:19], v22 offset:8192
  v_mul_f32 v111, v60, v109
  v_mfma_f32_16x16x32_bf16 v[176:179], a[64:67], a[84:87], v[176:179]
  buffer_load_dwordx4 v13, s[16:19], s78 offen offset:3072 lds
  v_mfma_f32_16x16x32_bf16 v[208:211], a[64:67], a[88:91], v[208:211]
  v_exp_f32 v110, v110
  v_mfma_f32_16x16x32_bf16 v[240:243], a[64:67], a[92:95], v[240:243]
  ds_read_b128 a[20:23], v22 offset:10240
  v_fract_f32 v111, v111
  v_mfma_f32_16x16x32_bf16 v[244:247], a[68:71], a[92:95], v[244:247]
  ds_read_b128 a[24:27], v22 offset:12288
  s_add_u32 m0, s74, 98304
  v_mfma_f32_16x16x32_bf16 v[212:215], a[68:71], a[88:91], v[212:215]
  v_cos_f32 v102, v111
  v_mfma_f32_16x16x32_bf16 v[180:183], a[68:71], a[84:87], v[180:183]
  ds_read_b128 a[28:31], v22 offset:14336
  v_sin_f32 v103, v111
  v_mfma_f32_16x16x32_bf16 v[148:151], a[68:71], a[80:83], v[148:151]
  v_mfma_f32_16x16x32_bf16 v[152:155], a[72:75], a[80:83], v[152:155]
  buffer_load_dwordx4 v18, s[12:15], s78 offen offset:0 lds
  v_mfma_f32_16x16x32_bf16 v[184:187], a[72:75], a[84:87], v[184:187]
  v_mul_f32 v102, v102, v110
  v_mfma_f32_16x16x32_bf16 v[216:219], a[72:75], a[88:91], v[216:219]
  v_mul_f32 v103, v103, v110
  v_mfma_f32_16x16x32_bf16 v[248:251], a[72:75], a[92:95], v[248:251]
  buffer_load_dwordx4 v19, s[12:15], s78 offen offset:1024 lds
  v_mfma_f32_16x16x32_bf16 v[252:255], a[76:79], a[92:95], v[252:255]
  v_mul_f32 v110, v61, v108
  v_mfma_f32_16x16x32_bf16 v[220:223], a[76:79], a[88:91], v[220:223]
  v_mul_f32 v111, v61, v109
  v_mfma_f32_16x16x32_bf16 v[188:191], a[76:79], a[84:87], v[188:191]
  v_mfma_f32_16x16x32_bf16 v[156:159], a[76:79], a[80:83], v[156:159]
  s_waitcnt lgkmcnt(0)
  v_mfma_f32_16x16x32_bf16 v[128:131], a[0:3], a[32:35], v[128:131]
  ds_read_b128 a[80:83], v121 offset:0
  s_add_u32 m0, s73, 102400
  v_mfma_f32_16x16x32_bf16 v[160:163], a[0:3], a[36:39], v[160:163]
  v_exp_f32 v110, v110
  v_mfma_f32_16x16x32_bf16 v[192:195], a[0:3], a[40:43], v[192:195]
  ds_read_b128 a[84:87], v121 offset:2048
  v_mfma_f32_16x16x32_bf16 v[224:227], a[0:3], a[44:47], v[224:227]
  s_movk_i32 s78, 1024
  v_fract_f32 v111, v111
  v_mfma_f32_16x16x32_bf16 v[228:231], a[4:7], a[44:47], v[228:231]
  ds_read_b128 a[88:91], v121 offset:8192
  v_mfma_f32_16x16x32_bf16 v[196:199], a[4:7], a[40:43], v[196:199]
  v_cos_f32 v104, v111
  v_mfma_f32_16x16x32_bf16 v[164:167], a[4:7], a[36:39], v[164:167]
  buffer_load_dwordx4 v14, s[16:19], s78 offen offset:0 lds
  v_mfma_f32_16x16x32_bf16 v[132:135], a[4:7], a[32:35], v[132:135]
  ds_read_b128 a[92:95], v121 offset:10240
  v_sin_f32 v105, v111
  v_mfma_f32_16x16x32_bf16 v[136:139], a[8:11], a[32:35], v[136:139]
  ds_read_b128 a[48:51], v23 offset:0
  v_mfma_f32_16x16x32_bf16 v[168:171], a[8:11], a[36:39], v[168:171]
  v_mul_f32 v104, v104, v110
  v_mfma_f32_16x16x32_bf16 v[200:203], a[8:11], a[40:43], v[200:203]
  buffer_load_dwordx4 v15, s[16:19], s78 offen offset:1024 lds
  v_mfma_f32_16x16x32_bf16 v[232:235], a[8:11], a[44:47], v[232:235]
  ds_read_b128 a[52:55], v23 offset:2048
  v_mul_f32 v105, v105, v110
  v_mfma_f32_16x16x32_bf16 v[236:239], a[12:15], a[44:47], v[236:239]
  ds_read_b128 a[56:59], v23 offset:4096
  v_mfma_f32_16x16x32_bf16 v[204:207], a[12:15], a[40:43], v[204:207]
  buffer_load_dwordx4 v16, s[16:19], s78 offen offset:2048 lds
  v_mfma_f32_16x16x32_bf16 v[172:175], a[12:15], a[36:39], v[172:175]
  v_mul_f32 v110, v62, v108
  ds_read_b128 a[60:63], v23 offset:6144
  v_mfma_f32_16x16x32_bf16 v[140:143], a[12:15], a[32:35], v[140:143]
  v_mfma_f32_16x16x32_bf16 v[144:147], a[16:19], a[32:35], v[144:147]
  ds_read_b128 a[64:67], v23 offset:8192
  v_mul_f32 v111, v62, v109
  v_mfma_f32_16x16x32_bf16 v[176:179], a[16:19], a[36:39], v[176:179]
  buffer_load_dwordx4 v17, s[16:19], s78 offen offset:3072 lds
  v_mfma_f32_16x16x32_bf16 v[208:211], a[16:19], a[40:43], v[208:211]
  ds_read_b128 a[68:71], v23 offset:10240
  v_exp_f32 v110, v110
  v_mfma_f32_16x16x32_bf16 v[240:243], a[16:19], a[44:47], v[240:243]
  v_mfma_f32_16x16x32_bf16 v[244:247], a[20:23], a[44:47], v[244:247]
  ds_read_b128 a[72:75], v23 offset:12288
  s_add_u32 m0, s74, 98304
  v_mfma_f32_16x16x32_bf16 v[212:215], a[20:23], a[40:43], v[212:215]
  v_fract_f32 v111, v111
  v_mfma_f32_16x16x32_bf16 v[180:183], a[20:23], a[36:39], v[180:183]
  ds_read_b128 a[76:79], v23 offset:14336
  v_cos_f32 v106, v111
  v_mfma_f32_16x16x32_bf16 v[148:151], a[20:23], a[32:35], v[148:151]
  v_mfma_f32_16x16x32_bf16 v[152:155], a[24:27], a[32:35], v[152:155]
  buffer_load_dwordx4 v20, s[12:15], s78 offen offset:2048 lds
  v_mfma_f32_16x16x32_bf16 v[184:187], a[24:27], a[36:39], v[184:187]
  v_sin_f32 v107, v111
  v_mfma_f32_16x16x32_bf16 v[216:219], a[24:27], a[40:43], v[216:219]
  v_mul_f32 v106, v106, v110
  v_mfma_f32_16x16x32_bf16 v[248:251], a[24:27], a[44:47], v[248:251]
  buffer_load_dwordx4 v21, s[12:15], s78 offen offset:3072 lds
  v_mfma_f32_16x16x32_bf16 v[252:255], a[28:31], a[44:47], v[252:255]
  v_mul_f32 v107, v107, v110
  v_mfma_f32_16x16x32_bf16 v[220:223], a[28:31], a[40:43], v[220:223]
  v_mfma_f32_16x16x32_bf16 v[188:191], a[28:31], a[36:39], v[188:191]
  v_mfma_f32_16x16x32_bf16 v[156:159], a[28:31], a[32:35], v[156:159]
  s_waitcnt vmcnt(12) lgkmcnt(0)
  s_barrier
  v_mfma_f32_16x16x32_bf16 v[128:131], a[48:51], a[80:83], v[128:131]
  ds_read_b128 a[32:35], v122 offset:0
  s_add_u32 m0, s73, 0
  v_mfma_f32_16x16x32_bf16 v[160:163], a[48:51], a[84:87], v[160:163]
  v_lshrrev_b32 v2, 3, v0
  v_mfma_f32_16x16x32_bf16 v[192:195], a[48:51], a[88:91], v[192:195]
  ds_read_b128 a[36:39], v122 offset:2048
  v_lshlrev_b32 v2, 7, v2
  v_mfma_f32_16x16x32_bf16 v[224:227], a[48:51], a[92:95], v[224:227]
  s_movk_i32 s78, 1152
  v_mfma_f32_16x16x32_bf16 v[228:231], a[52:55], a[92:95], v[228:231]
  ds_read_b128 a[40:43], v122 offset:8192
  v_and_b32 v3, 7, v0
  v_mfma_f32_16x16x32_bf16 v[196:199], a[52:55], a[88:91], v[196:199]
  v_mfma_f32_16x16x32_bf16 v[164:167], a[52:55], a[84:87], v[164:167]
  buffer_load_dwordx4 v10, s[16:19], s78 offen offset:0 lds
  v_mfma_f32_16x16x32_bf16 v[132:135], a[52:55], a[80:83], v[132:135]
  ds_read_b128 a[44:47], v122 offset:10240
TS_14:
  s_cbranch_execz TR_S
  v_lshl_add_u32 v2, v3, 3, v2
  v_mfma_f32_16x16x32_bf16 v[136:139], a[56:59], a[80:83], v[136:139]
  ds_read_b128 a[0:3], v24 offset:0
  s_lshl_b32 s75, s68, 12
  v_mfma_f32_16x16x32_bf16 v[168:171], a[56:59], a[84:87], v[168:171]
  s_add_u32 s75, s75, 196608
  v_mfma_f32_16x16x32_bf16 v[200:203], a[56:59], a[88:91], v[200:203]
  buffer_load_dwordx4 v11, s[16:19], s78 offen offset:1024 lds
  v_mfma_f32_16x16x32_bf16 v[232:235], a[56:59], a[92:95], v[232:235]
  buffer_load_dwordx2 v[52:53], v2, s[8:11], s75 offen sc1
  v_mfma_f32_16x16x32_bf16 v[236:239], a[60:63], a[92:95], v[236:239]
  ds_read_b128 a[4:7], v24 offset:2048
  ds_read_b128 a[8:11], v24 offset:4096
  v_mfma_f32_16x16x32_bf16 v[204:207], a[60:63], a[88:91], v[204:207]
  buffer_load_dwordx4 v12, s[16:19], s78 offen offset:2048 lds
  v_mfma_f32_16x16x32_bf16 v[172:175], a[60:63], a[84:87], v[172:175]
  v_lshrrev_b32 v2, 2, v30
  ds_read_b128 a[12:15], v24 offset:6144
  v_mfma_f32_16x16x32_bf16 v[140:143], a[60:63], a[80:83], v[140:143]
  v_lshlrev_b32 v2, 7, v2
  v_mfma_f32_16x16x32_bf16 v[144:147], a[64:67], a[80:83], v[144:147]
  ds_read_b128 a[16:19], v24 offset:8192
  v_and_b32 v3, 3, v30
  v_mfma_f32_16x16x32_bf16 v[176:179], a[64:67], a[84:87], v[176:179]
  buffer_load_dwordx4 v13, s[16:19], s78 offen offset:3072 lds
  v_mfma_f32_16x16x32_bf16 v[208:211], a[64:67], a[88:91], v[208:211]
  ds_read_b128 a[20:23], v24 offset:10240
  v_lshl_add_u32 v2, v3, 5, v2
  v_mfma_f32_16x16x32_bf16 v[240:243], a[64:67], a[92:95], v[240:243]
  v_mfma_f32_16x16x32_bf16 v[244:247], a[68:71], a[92:95], v[244:247]
  ds_read_b128 a[24:27], v24 offset:12288
  s_add_u32 m0, s74, 0
  v_mfma_f32_16x16x32_bf16 v[212:215], a[68:71], a[88:91], v[212:215]
  s_mov_b32 s75, 786432
  v_mfma_f32_16x16x32_bf16 v[180:183], a[68:71], a[84:87], v[180:183]
  ds_read_b128 a[28:31], v24 offset:14336
  s_mov_b32 s76, 806912
  v_mfma_f32_16x16x32_bf16 v[148:151], a[68:71], a[80:83], v[148:151]
  buffer_load_dwordx2 v[112:113], v2, s[8:11], s75 offen offset:0 sc1
  v_mfma_f32_16x16x32_bf16 v[152:155], a[72:75], a[80:83], v[152:155]
  buffer_load_dwordx4 v18, s[12:15], s78 offen offset:0 lds
  v_mfma_f32_16x16x32_bf16 v[184:187], a[72:75], a[84:87], v[184:187]
  buffer_load_dwordx2 v[114:115], v2, s[8:11], s76 offen offset:0 sc1
  v_mfma_f32_16x16x32_bf16 v[216:219], a[72:75], a[88:91], v[216:219]
  v_mfma_f32_16x16x32_bf16 v[248:251], a[72:75], a[92:95], v[248:251]
  buffer_load_dwordx4 v19, s[12:15], s78 offen offset:1024 lds
  v_mfma_f32_16x16x32_bf16 v[252:255], a[76:79], a[92:95], v[252:255]
  buffer_load_dwordx2 v[116:117], v2, s[8:11], s75 offen offset:512 sc1
  v_mfma_f32_16x16x32_bf16 v[220:223], a[76:79], a[88:91], v[220:223]
  buffer_load_dwordx2 v[118:119], v2, s[8:11], s76 offen offset:512 sc1
  v_mfma_f32_16x16x32_bf16 v[188:191], a[76:79], a[84:87], v[188:191]
  v_mfma_f32_16x16x32_bf16 v[156:159], a[76:79], a[80:83], v[156:159]
  s_waitcnt lgkmcnt(0)
  v_mfma_f32_16x16x32_bf16 v[128:131], a[0:3], a[32:35], v[128:131]
  ds_read_b128 a[80:83], v123 offset:0
  s_add_u32 m0, s73, 4096
  v_mfma_f32_16x16x32_bf16 v[160:163], a[0:3], a[36:39], v[160:163]
  s_lshl_b32 s31, s81, 3
  v_mfma_f32_16x16x32_bf16 v[192:195], a[0:3], a[40:43], v[192:195]
  ds_read_b128 a[84:87], v123 offset:2048
  v_mfma_f32_16x16x32_bf16 v[224:227], a[0:3], a[44:47], v[224:227]
  s_movk_i32 s78, 1152
  v_mfma_f32_16x16x32_bf16 v[228:231], a[4:7], a[44:47], v[228:231]
  ds_read_b128 a[88:91], v123 offset:8192
  v_mfma_f32_16x16x32_bf16 v[196:199], a[4:7], a[40:43], v[196:199]
  s_add_u32 s31, s31, s29
  v_mfma_f32_16x16x32_bf16 v[164:167], a[4:7], a[36:39], v[164:167]
  buffer_load_dwordx4 v14, s[16:19], s78 offen offset:0 lds
  v_mfma_f32_16x16x32_bf16 v[132:135], a[4:7], a[32:35], v[132:135]
  ds_read_b128 a[92:95], v123 offset:10240
  v_mfma_f32_16x16x32_bf16 v[136:139], a[8:11], a[32:35], v[136:139]
  ds_read_b128 a[48:51], v25 offset:0
  v_mfma_f32_16x16x32_bf16 v[168:171], a[8:11], a[36:39], v[168:171]
  s_mul_i32 s31, s31, 640
  v_mfma_f32_16x16x32_bf16 v[200:203], a[8:11], a[40:43], v[200:203]
  buffer_load_dwordx4 v15, s[16:19], s78 offen offset:1024 lds
  v_mfma_f32_16x16x32_bf16 v[232:235], a[8:11], a[44:47], v[232:235]
  ds_read_b128 a[52:55], v25 offset:2048
  v_mfma_f32_16x16x32_bf16 v[236:239], a[12:15], a[44:47], v[236:239]
  ds_read_b128 a[56:59], v25 offset:4096
  v_mfma_f32_16x16x32_bf16 v[204:207], a[12:15], a[40:43], v[204:207]
  buffer_load_dwordx4 v16, s[16:19], s78 offen offset:2048 lds
  v_mfma_f32_16x16x32_bf16 v[172:175], a[12:15], a[36:39], v[172:175]
  s_add_u32 s31, s31, 655360
  ds_read_b128 a[60:63], v25 offset:6144
  v_mfma_f32_16x16x32_bf16 v[140:143], a[12:15], a[32:35], v[140:143]
  v_mfma_f32_16x16x32_bf16 v[144:147], a[16:19], a[32:35], v[144:147]
  ds_read_b128 a[64:67], v25 offset:8192
  v_mfma_f32_16x16x32_bf16 v[176:179], a[16:19], a[36:39], v[176:179]
  buffer_load_dwordx4 v17, s[16:19], s78 offen offset:3072 lds
  v_mfma_f32_16x16x32_bf16 v[208:211], a[16:19], a[40:43], v[208:211]
  ds_read_b128 a[68:71], v25 offset:10240
  v_min_u32 v9, 4, v1
  v_mfma_f32_16x16x32_bf16 v[240:243], a[16:19], a[44:47], v[240:243]
  v_mfma_f32_16x16x32_bf16 v[244:247], a[20:23], a[44:47], v[244:247]
  ds_read_b128 a[72:75], v25 offset:12288
  s_add_u32 m0, s74, 0
  v_mfma_f32_16x16x32_bf16 v[212:215], a[20:23], a[40:43], v[212:215]
  v_mfma_f32_16x16x32_bf16 v[180:183], a[20:23], a[36:39], v[180:183]
  ds_read_b128 a[76:79], v25 offset:14336
  v_lshlrev_b32 v9, 7, v9
  v_mfma_f32_16x16x32_bf16 v[148:151], a[20:23], a[32:35], v[148:151]
  v_mfma_f32_16x16x32_bf16 v[152:155], a[24:27], a[32:35], v[152:155]
  buffer_load_dwordx4 v20, s[12:15], s78 offen offset:2048 lds
  v_mfma_f32_16x16x32_bf16 v[184:187], a[24:27], a[36:39], v[184:187]
  v_mfma_f32_16x16x32_bf16 v[216:219], a[24:27], a[40:43], v[216:219]
  buffer_load_dword v9, v9, s[8:11], s31 offen sc1
  v_mfma_f32_16x16x32_bf16 v[248:251], a[24:27], a[44:47], v[248:251]
  buffer_load_dwordx4 v21, s[12:15], s78 offen offset:3072 lds
  v_mfma_f32_16x16x32_bf16 v[252:255], a[28:31], a[44:47], v[252:255]
  v_mfma_f32_16x16x32_bf16 v[220:223], a[28:31], a[40:43], v[220:223]
  v_mfma_f32_16x16x32_bf16 v[188:191], a[28:31], a[36:39], v[188:191]
  v_mfma_f32_16x16x32_bf16 v[156:159], a[28:31], a[32:35], v[156:159]
  s_waitcnt vmcnt(18) lgkmcnt(0)
  s_barrier
  v_mfma_f32_16x16x32_bf16 v[128:131], a[48:51], a[80:83], v[128:131]
  ds_read_b128 a[32:35], v124 offset:0
  v_mfma_f32_16x16x32_bf16 v[160:163], a[48:51], a[84:87], v[160:163]
  s_lshl1_add_u32 s32, s69, s72
  v_mfma_f32_16x16x32_bf16 v[192:195], a[48:51], a[88:91], v[192:195]
  ds_read_b128 a[36:39], v124 offset:2048
  s_lshl_b32 s84, s32, 1
  v_mfma_f32_16x16x32_bf16 v[224:227], a[48:51], a[92:95], v[224:227]
  s_add_u32 s85, s84, 1
  v_mfma_f32_16x16x32_bf16 v[228:231], a[52:55], a[92:95], v[228:231]
  ds_read_b128 a[40:43], v124 offset:8192
  s_mul_i32 s33, s84, 52429
  v_mfma_f32_16x16x32_bf16 v[196:199], a[52:55], a[88:91], v[196:199]
  s_lshr_b32 s33, s33, 18
  v_mfma_f32_16x16x32_bf16 v[164:167], a[52:55], a[84:87], v[164:167]
  ds_read_b128 a[44:47], v124 offset:10240
  s_mul_i32 s33, s33, 7
  v_mfma_f32_16x16x32_bf16 v[132:135], a[52:55], a[80:83], v[132:135]
  s_add_u32 s84, s84, s33
  v_mfma_f32_16x16x32_bf16 v[136:139], a[56:59], a[80:83], v[136:139]
  ds_read_b128 a[0:3], v26 offset:0
  s_add_u32 s84, s84, 7
  v_mfma_f32_16x16x32_bf16 v[168:171], a[56:59], a[84:87], v[168:171]
  s_mul_i32 s33, s85, 52429
  v_mfma_f32_16x16x32_bf16 v[200:203], a[56:59], a[88:91], v[200:203]
  ds_read_b128 a[4:7], v26 offset:2048
  v_mfma_f32_16x16x32_bf16 v[232:235], a[56:59], a[92:95], v[232:235]
  s_lshr_b32 s33, s33, 18
  v_mfma_f32_16x16x32_bf16 v[236:239], a[60:63], a[92:95], v[236:239]
  ds_read_b128 a[8:11], v26 offset:4096
  s_mul_i32 s33, s33, 7
  v_mfma_f32_16x16x32_bf16 v[204:207], a[60:63], a[88:91], v[204:207]
  s_add_u32 s85, s85, s33
  v_mfma_f32_16x16x32_bf16 v[172:175], a[60:63], a[84:87], v[172:175]
  ds_read_b128 a[12:15], v26 offset:6144
  s_add_u32 s85, s85, 7
  v_mfma_f32_16x16x32_bf16 v[140:143], a[60:63], a[80:83], v[140:143]
  s_lshl1_add_u32 s34, s68, s71
  v_mfma_f32_16x16x32_bf16 v[144:147], a[64:67], a[80:83], v[144:147]
  ds_read_b128 a[16:19], v26 offset:8192
  s_mul_i32 s35, s34, 192
  v_mfma_f32_16x16x32_bf16 v[176:179], a[64:67], a[84:87], v[176:179]
  s_add_u32 s84, s84, s35
  v_mfma_f32_16x16x32_bf16 v[208:211], a[64:67], a[88:91], v[208:211]
  ds_read_b128 a[20:23], v26 offset:10240
  s_mul_i32 s84, s84, 4096
  v_mfma_f32_16x16x32_bf16 v[240:243], a[64:67], a[92:95], v[240:243]
  s_add_u32 s84, s84, 10485760
  v_mfma_f32_16x16x32_bf16 v[244:247], a[68:71], a[92:95], v[244:247]
  ds_read_b128 a[24:27], v26 offset:12288
  v_mfma_f32_16x16x32_bf16 v[212:215], a[68:71], a[88:91], v[212:215]
  s_add_u32 s85, s85, s35
  v_mfma_f32_16x16x32_bf16 v[180:183], a[68:71], a[84:87], v[180:183]
  ds_read_b128 a[28:31], v26 offset:14336
  s_mul_i32 s85, s85, 4096
  v_mfma_f32_16x16x32_bf16 v[148:151], a[68:71], a[80:83], v[148:151]
  s_add_u32 s85, s85, 10485760
  v_mfma_f32_16x16x32_bf16 v[152:155], a[72:75], a[80:83], v[152:155]
  s_lshl_b32 s87, s34, 7
  v_mfma_f32_16x16x32_bf16 v[184:187], a[72:75], a[84:87], v[184:187]
  s_add_u32 s87, s87, s32
  v_mfma_f32_16x16x32_bf16 v[216:219], a[72:75], a[88:91], v[216:219]
  s_lshl_b32 s87, s87, 7
  v_mfma_f32_16x16x32_bf16 v[248:251], a[72:75], a[92:95], v[248:251]
  s_add_u32 s87, s87, 273408
  v_mfma_f32_16x16x32_bf16 v[252:255], a[76:79], a[92:95], v[252:255]
  s_add_u32 s86, s84, 393216
  v_mfma_f32_16x16x32_bf16 v[220:223], a[76:79], a[88:91], v[220:223]
  s_add_u32 s78, s85, 393216
  v_mfma_f32_16x16x32_bf16 v[188:191], a[76:79], a[84:87], v[188:191]
  v_mfma_f32_16x16x32_bf16 v[156:159], a[76:79], a[80:83], v[156:159]
  s_waitcnt vmcnt(1)
  v_cmp_ne_u32 vcc, s96, v9
  s_nop 0
  s_cmp_eq_u64 vcc, 0
  s_cselect_b32 s99, s82, 0x7f000000
  s_waitcnt lgkmcnt(0)
  v_mfma_f32_16x16x32_bf16 v[128:131], a[0:3], a[32:35], v[128:131]
  ds_read_b128 a[80:83], v125 offset:0
  s_add_u32 s79, s99, 35840
  v_mfma_f32_16x16x32_bf16 v[160:163], a[0:3], a[36:39], v[160:163]
  v_mfma_f32_16x16x32_bf16 v[192:195], a[0:3], a[40:43], v[192:195]
  ds_read_b128 a[84:87], v125 offset:2048
  v_mfma_f32_16x16x32_bf16 v[224:227], a[0:3], a[44:47], v[224:227]
  buffer_load_dwordx4 a[116:119], v28, s[8:11], s79 offen offset:0 sc1
  v_mfma_f32_16x16x32_bf16 v[228:231], a[4:7], a[44:47], v[228:231]
  v_xor_b32 v4, s96, v53
  ds_read_b128 a[88:91], v125 offset:8192
  v_mfma_f32_16x16x32_bf16 v[196:199], a[4:7], a[40:43], v[196:199]
  v_mfma_f32_16x16x32_bf16 v[164:167], a[4:7], a[36:39], v[164:167]
  buffer_load_dwordx4 a[120:123], v28, s[8:11], s79 offen offset:1024 sc1
  v_mfma_f32_16x16x32_bf16 v[132:135], a[4:7], a[32:35], v[132:135]
  ds_read_b128 a[92:95], v125 offset:10240
  v_xor_b32 v5, s96, v113
  v_mfma_f32_16x16x32_bf16 v[136:139], a[8:11], a[32:35], v[136:139]
  ds_read_b128 a[48:51], v27 offset:0
  v_mfma_f32_16x16x32_bf16 v[168:171], a[8:11], a[36:39], v[168:171]
  buffer_load_dwordx4 a[124:127], v28, s[8:11], s79 offen offset:2048 sc1
  v_mfma_f32_16x16x32_bf16 v[200:203], a[8:11], a[40:43], v[200:203]
  v_or_b32 v4, v4, v5
  ds_read_b128 a[52:55], v27 offset:2048
  v_mfma_f32_16x16x32_bf16 v[232:235], a[8:11], a[44:47], v[232:235]
  v_xor_b32 v5, s96, v115
  v_mfma_f32_16x16x32_bf16 v[236:239], a[12:15], a[44:47], v[236:239]
  buffer_load_dwordx4 a[128:131], v28, s[8:11], s79 offen offset:3072 sc1
  v_mfma_f32_16x16x32_bf16 v[204:207], a[12:15], a[40:43], v[204:207]
  ds_read_b128 a[56:59], v27 offset:4096
  v_mfma_f32_16x16x32_bf16 v[172:175], a[12:15], a[36:39], v[172:175]
  ds_read_b128 a[60:63], v27 offset:6144
  v_or_b32 v4, v4, v5
  v_mfma_f32_16x16x32_bf16 v[140:143], a[12:15], a[32:35], v[140:143]
  buffer_load_dwordx4 a[132:135], v29, s[8:11], s79 offen offset:0 sc1
  v_mfma_f32_16x16x32_bf16 v[144:147], a[16:19], a[32:35], v[144:147]
  ds_read_b128 a[64:67], v27 offset:8192
  v_mfma_f32_16x16x32_bf16 v[176:179], a[16:19], a[36:39], v[176:179]
  v_xor_b32 v5, s96, v117
  v_mfma_f32_16x16x32_bf16 v[208:211], a[16:19], a[40:43], v[208:211]
  ds_read_b128 a[68:71], v27 offset:10240
  s_add_u32 s79, s99, 40960
  v_mfma_f32_16x16x32_bf16 v[240:243], a[16:19], a[44:47], v[240:243]
  v_mfma_f32_16x16x32_bf16 v[244:247], a[20:23], a[44:47], v[244:247]
  ds_read_b128 a[72:75], v27 offset:12288
  v_or_b32 v4, v4, v5
  v_mfma_f32_16x16x32_bf16 v[212:215], a[20:23], a[40:43], v[212:215]
  buffer_load_dwordx4 a[136:139], v28, s[8:11], s79 offen offset:0 sc1
  v_mfma_f32_16x16x32_bf16 v[180:183], a[20:23], a[36:39], v[180:183]
  ds_read_b128 a[76:79], v27 offset:14336
  v_xor_b32 v5, s96, v119
  v_mfma_f32_16x16x32_bf16 v[148:151], a[20:23], a[32:35], v[148:151]
  v_mfma_f32_16x16x32_bf16 v[152:155], a[24:27], a[32:35], v[152:155]
  buffer_load_dwordx4 a[140:143], v28, s[8:11], s79 offen offset:1024 sc1
  v_mfma_f32_16x16x32_bf16 v[184:187], a[24:27], a[36:39], v[184:187]
  v_or_b32 v4, v4, v5
  v_mfma_f32_16x16x32_bf16 v[216:219], a[24:27], a[40:43], v[216:219]
  v_mfma_f32_16x16x32_bf16 v[248:251], a[24:27], a[44:47], v[248:251]
  buffer_load_dwordx4 a[144:147], v28, s[8:11], s79 offen offset:2048 sc1
  v_mfma_f32_16x16x32_bf16 v[252:255], a[28:31], a[44:47], v[252:255]
  v_cmp_ne_u32 vcc, 0, v4
  v_mfma_f32_16x16x32_bf16 v[220:223], a[28:31], a[40:43], v[220:223]
  v_mfma_f32_16x16x32_bf16 v[188:191], a[28:31], a[36:39], v[188:191]
  v_mfma_f32_16x16x32_bf16 v[156:159], a[28:31], a[32:35], v[156:159]
  s_cbranch_vccz SG_ok
  s_mov_b32 s7, 0x40000
SG_l:
  v_lshrrev_b32 v2, 3, v0
  v_lshlrev_b32 v2, 7, v2
  v_and_b32 v3, 7, v0
  v_lshl_add_u32 v2, v3, 3, v2
  s_lshl_b32 s75, s68, 12
  s_add_u32 s75, s75, 196608
  buffer_load_dwordx2 v[52:53], v2, s[8:11], s75 offen sc1
  v_lshrrev_b32 v2, 2, v30
  v_lshlrev_b32 v2, 7, v2
  v_and_b32 v3, 3, v30
  v_lshl_add_u32 v2, v3, 5, v2
  s_mov_b32 s75, 786432
  s_mov_b32 s76, 806912
  buffer_load_dwordx2 v[112:113], v2, s[8:11], s75 offen offset:0 sc1
  buffer_load_dwordx2 v[114:115], v2, s[8:11], s76 offen offset:0 sc1
  buffer_load_dwordx2 v[116:117], v2, s[8:11], s75 offen offset:512 sc1
  buffer_load_dwordx2 v[118:119], v2, s[8:11], s76 offen offset:512 sc1
  s_waitcnt vmcnt(0)
  v_xor_b32 v4, s96, v53
  v_xor_b32 v5, s96, v113
  v_or_b32 v4, v4, v5
  v_xor_b32 v5, s96, v115
  v_or_b32 v4, v4, v5
  v_xor_b32 v5, s96, v117
  v_or_b32 v4, v4, v5
  v_xor_b32 v5, s96, v119
  v_or_b32 v4, v4, v5
  v_cmp_ne_u32 vcc, 0, v4
  s_sub_u32 s7, s7, 1
  s_cbranch_scc1 SG_ok
  s_cbranch_vccnz SG_l
SG_ok:
  s_waitcnt vmcnt(8) lgkmcnt(0)
  s_barrier
  v_mfma_f32_16x16x32_bf16 v[128:131], a[48:51], a[80:83], v[128:131]
  buffer_load_dwordx4 a[148:151], v28, s[8:11], s79 offen offset:3072 sc1
  v_mfma_f32_16x16x32_bf16 v[160:163], a[48:51], a[84:87], v[160:163]
  ds_read_b128 a[32:35], v120 offset:0
  s_mul_i32 s31, s29, 7680
  v_mfma_f32_16x16x32_bf16 v[192:195], a[48:51], a[88:91], v[192:195]
  ds_read_b128 a[36:39], v120 offset:2048
  s_add_u32 s31, s31, 720896
  v_mfma_f32_16x16x32_bf16 v[224:227], a[48:51], a[92:95], v[224:227]
  buffer_load_dwordx4 a[152:155], v29, s[8:11], s79 offen offset:0 sc1
  v_mfma_f32_16x16x32_bf16 v[228:231], a[52:55], a[92:95], v[228:231]
  s_mul_i32 s32, s81, 5
  ds_read_b128 a[40:43], v120 offset:8192
  v_mfma_f32_16x16x32_bf16 v[196:199], a[52:55], a[88:91], v[196:199]
  s_cmp_eq_u32 s3, 3
  s_cselect_b32 s33, 2, 63
  v_mfma_f32_16x16x32_bf16 v[164:167], a[52:55], a[84:87], v[164:167]
  v_lshrrev_b32 v9, 1, v1
  ds_read_b128 a[44:47], v120 offset:10240
  v_mfma_f32_16x16x32_bf16 v[132:135], a[52:55], a[80:83], v[132:135]
  s_add_u32 s79, s99, 46080
  v_min_u32 v9, 6, v9
  v_mfma_f32_16x16x32_bf16 v[136:139], a[56:59], a[80:83], v[136:139]
  v_cmp_eq_u32 vcc, s33, v9
  ds_read_b128 a[0:3], v22 offset:0
  v_mfma_f32_16x16x32_bf16 v[168:171], a[56:59], a[84:87], v[168:171]
  buffer_load_dwordx4 a[156:159], v28, s[8:11], s79 offen offset:0 sc1
  v_mfma_f32_16x16x32_bf16 v[200:203], a[56:59], a[88:91], v[200:203]
  v_and_b32 v2, 1, v1
  v_lshl_add_u32 v2, v2, 2, s32
  v_mfma_f32_16x16x32_bf16 v[232:235], a[56:59], a[92:95], v[232:235]
  ds_read_b128 a[4:7], v22 offset:2048
  v_cndmask_b32 v9, v9, 1, vcc
  v_mfma_f32_16x16x32_bf16 v[236:239], a[60:63], a[92:95], v[236:239]
  buffer_load_dwordx4 a[160:163], v28, s[8:11], s79 offen offset:1024 sc1
  v_mfma_f32_16x16x32_bf16 v[204:207], a[60:63], a[88:91], v[204:207]
  ds_read_b128 a[8:11], v22 offset:4096
  v_lshrrev_b32 v2, 3, v2
  v_mfma_f32_16x16x32_bf16 v[172:175], a[60:63], a[84:87], v[172:175]
  v_mad_u32_u24 v9, v9, 5, v2
  ds_read_b128 a[12:15], v22 offset:6144
  v_mfma_f32_16x16x32_bf16 v[140:143], a[60:63], a[80:83], v[140:143]
  buffer_load_dwordx4 a[164:167], v28, s[8:11], s79 offen offset:2048 sc1
  v_mfma_f32_16x16x32_bf16 v[144:147], a[64:67], a[80:83], v[144:147]
  v_lshlrev_b32 v9, 7, v9
  ds_read_b128 a[16:19], v22 offset:8192
  v_mfma_f32_16x16x32_bf16 v[176:179], a[64:67], a[84:87], v[176:179]
  buffer_load_dword v9, v9, s[8:11], s31 offen sc1
  v_mfma_f32_16x16x32_bf16 v[208:211], a[64:67], a[88:91], v[208:211]
  buffer_load_dwordx4 a[168:171], v28, s[8:11], s79 offen offset:3072 sc1
  v_mfma_f32_16x16x32_bf16 v[240:243], a[64:67], a[92:95], v[240:243]
  v_and_b32 v53, 0xffff0000, v52
  v_rcp_f32 v53, v53
  v_mfma_f32_16x16x32_bf16 v[244:247], a[68:71], a[92:95], v[244:247]
  ds_read_b128 a[20:23], v22 offset:10240
  v_mfma_f32_16x16x32_bf16 v[212:215], a[68:71], a[88:91], v[212:215]
  buffer_load_dwordx4 a[172:175], v29, s[8:11], s79 offen offset:0 sc1
  v_mfma_f32_16x16x32_bf16 v[180:183], a[68:71], a[84:87], v[180:183]
  v_lshlrev_b32 v52, 16, v52
  v_and_b32 v2, 15, v0
  v_mfma_f32_16x16x32_bf16 v[148:151], a[68:71], a[80:83], v[148:151]
  ds_read_b128 a[24:27], v22 offset:12288
  v_bfe_u32 v3, v0, 4, 1
  v_mfma_f32_16x16x32_bf16 v[152:155], a[72:75], a[80:83], v[152:155]
  ds_read_b128 a[28:31], v22 offset:14336
  v_lshl_add_u32 v2, v2, 1, v3
  v_mfma_f32_16x16x32_bf16 v[184:187], a[72:75], a[84:87], v[184:187]
  v_and_b32 v3, 0xe0, v0
  s_add_u32 s79, s99, 51200
  v_mfma_f32_16x16x32_bf16 v[216:219], a[72:75], a[88:91], v[216:219]
  v_add_u32 v2, v2, v3
  v_mul_f32 v52, v52, v53
  v_mfma_f32_16x16x32_bf16 v[248:251], a[72:75], a[92:95], v[248:251]
  buffer_load_dwordx4 a[176:179], v28, s[8:11], s79 offen offset:0 sc1
  v_mfma_f32_16x16x32_bf16 v[252:255], a[76:79], a[92:95], v[252:255]
  v_lshlrev_b32 v2, 2, v2
  v_add_u32 v2, 147456, v2
  v_mfma_f32_16x16x32_bf16 v[220:223], a[76:79], a[88:91], v[220:223]
  ds_write_b32 v2, v53
  ds_write_b32 v2, v52 offset:1024
  v_mfma_f32_16x16x32_bf16 v[188:191], a[76:79], a[84:87], v[188:191]
  v_mfma_f32_16x16x32_bf16 v[156:159], a[76:79], a[80:83], v[156:159]
  s_waitcnt lgkmcnt(0)
  v_mfma_f32_16x16x32_bf16 v[128:131], a[0:3], a[32:35], v[128:131]
  buffer_load_dwordx4 a[180:183], v28, s[8:11], s79 offen offset:1024 sc1
  v_mfma_f32_16x16x32_bf16 v[160:163], a[0:3], a[36:39], v[160:163]
  ds_read_b128 a[80:83], v121 offset:0
  s_mul_i32 s75, s3, 20480
  v_mfma_f32_16x16x32_bf16 v[192:195], a[0:3], a[40:43], v[192:195]
  ds_read_b128 a[84:87], v121 offset:2048
  v_and_b32 v2, 15, v1
  v_mfma_f32_16x16x32_bf16 v[224:227], a[0:3], a[44:47], v[224:227]
  buffer_load_dwordx4 a[184:187], v28, s[8:11], s79 offen offset:2048 sc1
  v_mfma_f32_16x16x32_bf16 v[228:231], a[4:7], a[44:47], v[228:231]
  v_bfe_u32 v3, v2, 2, 1
  ds_read_b128 a[88:91], v121 offset:8192
  v_mfma_f32_16x16x32_bf16 v[196:199], a[4:7], a[40:43], v[196:199]
  v_and_b32 v4, 3, v2
  v_mfma_f32_16x16x32_bf16 v[164:167], a[4:7], a[36:39], v[164:167]
  buffer_load_dwordx4 a[188:191], v28, s[8:11], s79 offen offset:3072 sc1
  v_mfma_f32_16x16x32_bf16 v[132:135], a[4:7], a[32:35], v[132:135]
  ds_read_b128 a[92:95], v121 offset:10240
  v_lshl_add_u32 v3, v4, 1, v3
  v_mfma_f32_16x16x32_bf16 v[136:139], a[8:11], a[32:35], v[136:139]
  v_and_b32 v4, 8, v2
  ds_read_b128 a[48:51], v23 offset:0
  v_mfma_f32_16x16x32_bf16 v[168:171], a[8:11], a[36:39], v[168:171]
  buffer_load_dwordx4 a[192:195], v29, s[8:11], s79 offen offset:0 sc1
  v_mfma_f32_16x16x32_bf16 v[200:203], a[8:11], a[40:43], v[200:203]
  v_or_b32 v3, v3, v4
  ds_read_b128 a[52:55], v23 offset:2048
  v_mfma_f32_16x16x32_bf16 v[232:235], a[8:11], a[44:47], v[232:235]
  v_lshrrev_b32 v4, 4, v1
  v_lshlrev_b32 v5, 2, v4
  v_mfma_f32_16x16x32_bf16 v[236:239], a[12:15], a[44:47], v[236:239]
  ds_read_b128 a[56:59], v23 offset:4096
  s_add_u32 s79, s99, 56320
  v_mfma_f32_16x16x32_bf16 v[204:207], a[12:15], a[40:43], v[204:207]
  v_xor_b32 v3, v3, v5
  v_mfma_f32_16x16x32_bf16 v[172:175], a[12:15], a[36:39], v[172:175]
  ds_read_b128 a[60:63], v23 offset:6144
  v_lshlrev_b32 v3, 4, v3
  v_mfma_f32_16x16x32_bf16 v[140:143], a[12:15], a[32:35], v[140:143]
  buffer_load_dwordx4 a[196:199], v28, s[8:11], s79 offen offset:0 sc1
  v_mfma_f32_16x16x32_bf16 v[144:147], a[16:19], a[32:35], v[144:147]
  ds_read_b128 a[64:67], v23 offset:8192
  v_lshl_add_u32 v3, v2, 8, v3
  v_mfma_f32_16x16x32_bf16 v[176:179], a[16:19], a[36:39], v[176:179]
  v_add_u32 v10, s75, v3
  v_mfma_f32_16x16x32_bf16 v[208:211], a[16:19], a[40:43], v[208:211]
  buffer_load_dwordx4 a[200:203], v28, s[8:11], s79 offen offset:1024 sc1
  v_mfma_f32_16x16x32_bf16 v[240:243], a[16:19], a[44:47], v[240:243]
  ds_read_b128 a[68:71], v23 offset:10240
  v_bfe_u32 v2, v1, 2, 2
  v_mfma_f32_16x16x32_bf16 v[244:247], a[20:23], a[44:47], v[244:247]
  ds_read_b128 a[72:75], v23 offset:12288
  v_lshlrev_b32 v3, 5, v2
  v_mfma_f32_16x16x32_bf16 v[212:215], a[20:23], a[40:43], v[212:215]
  buffer_load_dwordx4 a[204:207], v28, s[8:11], s79 offen offset:2048 sc1
  v_mfma_f32_16x16x32_bf16 v[180:183], a[20:23], a[36:39], v[180:183]
  v_and_b32 v5, 1, v4
  ds_read_b128 a[76:79], v23 offset:14336
  v_mfma_f32_16x16x32_bf16 v[148:151], a[20:23], a[32:35], v[148:151]
  v_lshl_add_u32 v3, v5, 7, v3
  v_mfma_f32_16x16x32_bf16 v[152:155], a[24:27], a[32:35], v[152:155]
  buffer_load_dwordx4 a[208:211], v28, s[8:11], s79 offen offset:3072 sc1
  v_mfma_f32_16x16x32_bf16 v[184:187], a[24:27], a[36:39], v[184:187]
  v_and_b32 v5, 3, v1
  v_lshl_add_u32 v3, v5, 3, v3
  v_mfma_f32_16x16x32_bf16 v[216:219], a[24:27], a[40:43], v[216:219]
  v_lshl_add_u32 v2, v4, 3, v2
  v_mfma_f32_16x16x32_bf16 v[248:251], a[24:27], a[44:47], v[248:251]
  buffer_load_dwordx4 a[212:215], v29, s[8:11], s79 offen offset:0 sc1
  v_mfma_f32_16x16x32_bf16 v[252:255], a[28:31], a[44:47], v[252:255]
  v_lshl_add_u32 v3, v2, 8, v3
  v_mfma_f32_16x16x32_bf16 v[220:223], a[28:31], a[40:43], v[220:223]
  v_add_u32 v11, s75, v3
  v_mfma_f32_16x16x32_bf16 v[188:191], a[28:31], a[36:39], v[188:191]
  v_mfma_f32_16x16x32_bf16 v[156:159], a[28:31], a[32:35], v[156:159]
  s_waitcnt vmcnt(12)
  v_cmp_ne_u32 vcc, s96, v9
  s_nop 0
  s_cmp_eq_u64 vcc, 0
  s_cselect_b32 s98, s82, 0x7f000000
  s_waitcnt lgkmcnt(0)
  s_barrier
  v_mfma_f32_16x16x32_bf16 v[128:131], a[48:51], a[80:83], v[128:131]
  s_add_u32 s79, s98, 0
  v_mfma_f32_16x16x32_bf16 v[160:163], a[48:51], a[84:87], v[160:163]
  v_lshlrev_b32 v3, 4, v30
  v_mfma_f32_16x16x32_bf16 v[192:195], a[48:51], a[88:91], v[192:195]
  buffer_load_dwordx4 a[216:219], v28, s[8:11], s79 offen offset:0 sc1
  v_mfma_f32_16x16x32_bf16 v[224:227], a[48:51], a[92:95], v[224:227]
  v_lshlrev_b32 v2, 21, v1
  v_and_b32 v2, 0xfe000000, v2
  v_mfma_f32_16x16x32_bf16 v[228:231], a[52:55], a[92:95], v[228:231]
  v_add_u32 v12, v2, v3
  v_mfma_f32_16x16x32_bf16 v[196:199], a[52:55], a[88:91], v[196:199]
  buffer_load_dwordx4 a[220:223], v28, s[8:11], s79 offen offset:1024 sc1
  v_mfma_f32_16x16x32_bf16 v[164:167], a[52:55], a[84:87], v[164:167]
  s_lshl1_add_u32 s76, s68, s71
  s_mul_i32 s97, s76, 10240
  v_mfma_f32_16x16x32_bf16 v[132:135], a[52:55], a[80:83], v[132:135]
  buffer_load_dwordx4 a[224:227], v28, s[8:11], s79 offen offset:2048 sc1
  v_mfma_f32_16x16x32_bf16 v[136:139], a[56:59], a[80:83], v[136:139]
  v_lshrrev_b32 v2, 4, v1
  v_mfma_f32_16x16x32_bf16 v[168:171], a[56:59], a[84:87], v[168:171]
  v_mul_u32_u24 v13, 10240, v2
  v_mfma_f32_16x16x32_bf16 v[200:203], a[56:59], a[88:91], v[200:203]
  buffer_load_dwordx4 a[228:231], v28, s[8:11], s79 offen offset:3072 sc1
  v_mfma_f32_16x16x32_bf16 v[232:235], a[56:59], a[92:95], v[232:235]
  s_sub_u32 s75, s97, 10240
  v_sub_u32 v13, s75, v13
  v_mfma_f32_16x16x32_bf16 v[236:239], a[60:63], a[92:95], v[236:239]
  buffer_load_dwordx4 a[232:235], v29, s[8:11], s79 offen offset:0 sc1
  v_mfma_f32_16x16x32_bf16 v[204:207], a[60:63], a[88:91], v[204:207]
  v_add_u32 v13, v13, v3
  v_mov_b32 v21, s96
  v_mfma_f32_16x16x32_bf16 v[172:175], a[60:63], a[84:87], v[172:175]
  v_cmp_gt_u32 vcc, s76, v2
  v_mfma_f32_16x16x32_bf16 v[140:143], a[60:63], a[80:83], v[140:143]
  s_add_u32 s79, s98, 5120
  v_mfma_f32_16x16x32_bf16 v[144:147], a[64:67], a[80:83], v[144:147]
  v_cndmask_b32 v17, 0, v21, vcc
  v_mfma_f32_16x16x32_bf16 v[176:179], a[64:67], a[84:87], v[176:179]
  v_subrev_u32 v14, 40960, v13
  v_mfma_f32_16x16x32_bf16 v[208:211], a[64:67], a[88:91], v[208:211]
  buffer_load_dwordx4 a[236:239], v28, s[8:11], s79 offen offset:0 sc1
  v_mfma_f32_16x16x32_bf16 v[240:243], a[64:67], a[92:95], v[240:243]
  v_add_u32 v2, 4, v2
  v_cmp_gt_u32 vcc, s76, v2
  v_mfma_f32_16x16x32_bf16 v[244:247], a[68:71], a[92:95], v[244:247]
  buffer_load_dwordx4 a[240:243], v28, s[8:11], s79 offen offset:1024 sc1
  v_mfma_f32_16x16x32_bf16 v[212:215], a[68:71], a[88:91], v[212:215]
  v_cndmask_b32 v18, 0, v21, vcc
  v_subrev_u32 v15, 81920, v13
  v_mfma_f32_16x16x32_bf16 v[180:183], a[68:71], a[84:87], v[180:183]
  v_add_u32 v2, 4, v2
  v_mfma_f32_16x16x32_bf16 v[148:151], a[68:71], a[80:83], v[148:151]
  buffer_load_dwordx4 a[244:247], v28, s[8:11], s79 offen offset:2048 sc1
  v_mfma_f32_16x16x32_bf16 v[152:155], a[72:75], a[80:83], v[152:155]
  v_cmp_gt_u32 vcc, s76, v2
  v_mfma_f32_16x16x32_bf16 v[184:187], a[72:75], a[84:87], v[184:187]
  buffer_load_dwordx4 a[248:251], v28, s[8:11], s79 offen offset:3072 sc1
  v_mfma_f32_16x16x32_bf16 v[216:219], a[72:75], a[88:91], v[216:219]
  v_cndmask_b32 v19, 0, v21, vcc
  v_subrev_u32 v16, 122880, v13
  v_mfma_f32_16x16x32_bf16 v[248:251], a[72:75], a[92:95], v[248:251]
  v_add_u32 v2, 4, v2
  v_mfma_f32_16x16x32_bf16 v[252:255], a[76:79], a[92:95], v[252:255]
  buffer_load_dwordx4 a[252:255], v29, s[8:11], s79 offen offset:0 sc1
  v_mfma_f32_16x16x32_bf16 v[220:223], a[76:79], a[88:91], v[220:223]
  v_cmp_gt_u32 vcc, s76, v2
  s_nop 1
  v_cndmask_b32 v20, 0, v21, vcc
  v_mfma_f32_16x16x32_bf16 v[188:191], a[76:79], a[84:87], v[188:191]
  v_mfma_f32_16x16x32_bf16 v[156:159], a[76:79], a[80:83], v[156:159]
  s_waitcnt lgkmcnt(0)
  v_lshlrev_b32 v22, 7, v31
  v_add_u32 v22, 147456, v22
  v_mov_b32 v31, s96
  s_cmp_lg_u32 s95, 0
  s_cbranch_scc1 EP_no
  v_lshlrev_b32 v2, 7, v1
  s_mov_b32 s75, 196612
  buffer_load_dword a80, v2, s[8:11], s75 offen sc1
  s_mov_b32 s75, 204804
  buffer_load_dword a81, v2, s[8:11], s75 offen sc1
  s_mov_b32 s75, 212996
  buffer_load_dword a82, v2, s[8:11], s75 offen sc1
  s_mov_b32 s75, 221188
  buffer_load_dword a83, v2, s[8:11], s75 offen sc1
EP_no:
  ds_read_b128 v[32:35], v22 offset:0
  ds_read_b128 v[36:39], v22 offset:16
  ds_read_b128 v[40:43], v22 offset:1024
  ds_read_b128 v[44:47], v22 offset:1040
  ds_read_b128 v[48:51], v22 offset:32
  ds_read_b128 v[52:55], v22 offset:48
  ds_read_b128 v[56:59], v22 offset:1056
  ds_read_b128 v[60:63], v22 offset:1072
  s_waitcnt lgkmcnt(4)
  v_pk_mul_f32 v[128:129], v[128:129], v[32:33] op_sel_hi:[1,1]
  v_pk_mul_f32 v[192:193], v[192:193], v[32:33] op_sel_hi:[1,1]
  v_pk_fma_f32 v[128:129], v[40:41], v[112:113], v[128:129] op_sel_hi:[1,0,1] neg_lo:[1,0,0] neg_hi:[1,0,0]
  v_pk_fma_f32 v[192:193], v[40:41], v[114:115], v[192:193] op_sel_hi:[1,0,1] neg_lo:[1,0,0] neg_hi:[1,0,0]
  v_pk_mul_f32 v[130:131], v[130:131], v[34:35] op_sel_hi:[1,1]
  v_pk_mul_f32 v[194:195], v[194:195], v[34:35] op_sel_hi:[1,1]
  v_pk_fma_f32 v[130:131], v[42:43], v[112:113], v[130:131] op_sel_hi:[1,0,1] neg_lo:[1,0,0] neg_hi:[1,0,0]
  v_pk_fma_f32 v[194:195], v[42:43], v[114:115], v[194:195] op_sel_hi:[1,0,1] neg_lo:[1,0,0] neg_hi:[1,0,0]
  v_pk_fma_f32 v[130:131], v[128:129], v[72:73], v[130:131] op_sel_hi:[1,0,1]
  v_pk_fma_f32 v[194:195], v[192:193], v[72:73], v[194:195] op_sel_hi:[1,0,1]
  v_pk_fma_f32 v[130:131], v[72:73], v[192:193], v[130:131] op_sel:[1,0,0] op_sel_hi:[1,1,1] neg_lo:[1,0,0] neg_hi:[1,0,0]
  v_pk_fma_f32 v[194:195], v[72:73], v[128:129], v[194:195] op_sel:[1,0,0] op_sel_hi:[1,1,1]
  v_pk_mul_f32 v[132:133], v[132:133], v[36:37] op_sel_hi:[1,1]
  v_pk_mul_f32 v[196:197], v[196:197], v[36:37] op_sel_hi:[1,1]
  v_pk_fma_f32 v[132:133], v[44:45], v[112:113], v[132:133] op_sel_hi:[1,0,1] neg_lo:[1,0,0] neg_hi:[1,0,0]
  v_pk_fma_f32 v[196:197], v[44:45], v[114:115], v[196:197] op_sel_hi:[1,0,1] neg_lo:[1,0,0] neg_hi:[1,0,0]
  v_pk_fma_f32 v[132:133], v[130:131], v[72:73], v[132:133] op_sel_hi:[1,0,1]
  v_pk_fma_f32 v[196:197], v[194:195], v[72:73], v[196:197] op_sel_hi:[1,0,1]
  v_pk_fma_f32 v[132:133], v[72:73], v[194:195], v[132:133] op_sel:[1,0,0] op_sel_hi:[1,1,1] neg_lo:[1,0,0] neg_hi:[1,0,0]
  v_pk_fma_f32 v[196:197], v[72:73], v[130:131], v[196:197] op_sel:[1,0,0] op_sel_hi:[1,1,1]
  v_pk_mul_f32 v[134:135], v[134:135], v[38:39] op_sel_hi:[1,1]
  v_pk_mul_f32 v[198:199], v[198:199], v[38:39] op_sel_hi:[1,1]
  v_pk_fma_f32 v[134:135], v[46:47], v[112:113], v[134:135] op_sel_hi:[1,0,1] neg_lo:[1,0,0] neg_hi:[1,0,0]
  v_pk_fma_f32 v[198:199], v[46:47], v[114:115], v[198:199] op_sel_hi:[1,0,1] neg_lo:[1,0,0] neg_hi:[1,0,0]
  ds_read_b128 v[32:35], v22 offset:64
  ds_read_b128 v[36:39], v22 offset:80
TS_15:
  s_cbranch_execz TR_S
  ds_read_b128 v[40:43], v22 offset:1088
  ds_read_b128 v[44:47], v22 offset:1104
  v_pk_fma_f32 v[134:135], v[132:133], v[72:73], v[134:135] op_sel_hi:[1,0,1]
  v_pk_fma_f32 v[198:199], v[196:197], v[72:73], v[198:199] op_sel_hi:[1,0,1]
  v_pk_fma_f32 v[134:135], v[72:73], v[196:197], v[134:135] op_sel:[1,0,0] op_sel_hi:[1,1,1] neg_lo:[1,0,0] neg_hi:[1,0,0]
  v_pk_fma_f32 v[198:199], v[72:73], v[132:133], v[198:199] op_sel:[1,0,0] op_sel_hi:[1,1,1]
  s_waitcnt lgkmcnt(4)
  v_pk_mul_f32 v[136:137], v[136:137], v[48:49] op_sel_hi:[1,1]
  v_pk_mul_f32 v[200:201], v[200:201], v[48:49] op_sel_hi:[1,1]
  v_pk_fma_f32 v[136:137], v[56:57], v[112:113], v[136:137] op_sel_hi:[1,0,1] neg_lo:[1,0,0] neg_hi:[1,0,0]
  v_pk_fma_f32 v[200:201], v[56:57], v[114:115], v[200:201] op_sel_hi:[1,0,1] neg_lo:[1,0,0] neg_hi:[1,0,0]
  v_pk_fma_f32 v[136:137], v[134:135], v[72:73], v[136:137] op_sel_hi:[1,0,1]
  v_pk_fma_f32 v[200:201], v[198:199], v[72:73], v[200:201] op_sel_hi:[1,0,1]
  v_pk_fma_f32 v[136:137], v[72:73], v[198:199], v[136:137] op_sel:[1,0,0] op_sel_hi:[1,1,1] neg_lo:[1,0,0] neg_hi:[1,0,0]
  v_pk_fma_f32 v[200:201], v[72:73], v[134:135], v[200:201] op_sel:[1,0,0] op_sel_hi:[1,1,1]
  v_pk_mul_f32 v[138:139], v[138:139], v[50:51] op_sel_hi:[1,1]
  v_pk_mul_f32 v[202:203], v[202:203], v[50:51] op_sel_hi:[1,1]
  v_pk_fma_f32 v[138:139], v[58:59], v[112:113], v[138:139] op_sel_hi:[1,0,1] neg_lo:[1,0,0] neg_hi:[1,0,0]
  v_pk_fma_f32 v[202:203], v[58:59], v[114:115], v[202:203] op_sel_hi:[1,0,1] neg_lo:[1,0,0] neg_hi:[1,0,0]
  v_pk_fma_f32 v[138:139], v[136:137], v[72:73], v[138:139] op_sel_hi:[1,0,1]
  v_pk_fma_f32 v[202:203], v[200:201], v[72:73], v[202:203] op_sel_hi:[1,0,1]
  v_pk_fma_f32 v[138:139], v[72:73], v[200:201], v[138:139] op_sel:[1,0,0] op_sel_hi:[1,1,1] neg_lo:[1,0,0] neg_hi:[1,0,0]
  v_pk_fma_f32 v[202:203], v[72:73], v[136:137], v[202:203] op_sel:[1,0,0] op_sel_hi:[1,1,1]
  v_pk_mul_f32 v[140:141], v[140:141], v[52:53] op_sel_hi:[1,1]
  v_pk_mul_f32 v[204:205], v[204:205], v[52:53] op_sel_hi:[1,1]
  v_pk_fma_f32 v[140:141], v[60:61], v[112:113], v[140:141] op_sel_hi:[1,0,1] neg_lo:[1,0,0] neg_hi:[1,0,0]
  v_pk_fma_f32 v[204:205], v[60:61], v[114:115], v[204:205] op_sel_hi:[1,0,1] neg_lo:[1,0,0] neg_hi:[1,0,0]
  v_pk_fma_f32 v[140:141], v[138:139], v[72:73], v[140:141] op_sel_hi:[1,0,1]
  v_pk_fma_f32 v[204:205], v[202:203], v[72:73], v[204:205] op_sel_hi:[1,0,1]
  v_pk_fma_f32 v[140:141], v[72:73], v[202:203], v[140:141] op_sel:[1,0,0] op_sel_hi:[1,1,1] neg_lo:[1,0,0] neg_hi:[1,0,0]
  v_pk_fma_f32 v[204:205], v[72:73], v[138:139], v[204:205] op_sel:[1,0,0] op_sel_hi:[1,1,1]
  v_pk_mul_f32 v[142:143], v[142:143], v[54:55] op_sel_hi:[1,1]
  v_pk_mul_f32 v[206:207], v[206:207], v[54:55] op_sel_hi:[1,1]
  v_pk_fma_f32 v[142:143], v[62:63], v[112:113], v[142:143] op_sel_hi:[1,0,1] neg_lo:[1,0,0] neg_hi:[1,0,0]
  v_pk_fma_f32 v[206:207], v[62:63], v[114:115], v[206:207] op_sel_hi:[1,0,1] neg_lo:[1,0,0] neg_hi:[1,0,0]
  ds_read_b128 v[48:51], v22 offset:96
  ds_read_b128 v[52:55], v22 offset:112
  ds_read_b128 v[56:59], v22 offset:1120
  ds_read_b128 v[60:63], v22 offset:1136
  v_pk_fma_f32 v[142:143], v[140:141], v[72:73], v[142:143] op_sel_hi:[1,0,1]
  v_pk_fma_f32 v[206:207], v[204:205], v[72:73], v[206:207] op_sel_hi:[1,0,1]
  v_pk_fma_f32 v[142:143], v[72:73], v[204:205], v[142:143] op_sel:[1,0,0] op_sel_hi:[1,1,1] neg_lo:[1,0,0] neg_hi:[1,0,0]
  v_pk_fma_f32 v[206:207], v[72:73], v[140:141], v[206:207] op_sel:[1,0,0] op_sel_hi:[1,1,1]
  s_waitcnt lgkmcnt(4)
  v_pk_mul_f32 v[144:145], v[144:145], v[32:33] op_sel_hi:[1,1]
  v_pk_mul_f32 v[208:209], v[208:209], v[32:33] op_sel_hi:[1,1]
  v_pk_fma_f32 v[144:145], v[40:41], v[112:113], v[144:145] op_sel_hi:[1,0,1] neg_lo:[1,0,0] neg_hi:[1,0,0]
  v_pk_fma_f32 v[208:209], v[40:41], v[114:115], v[208:209] op_sel_hi:[1,0,1] neg_lo:[1,0,0] neg_hi:[1,0,0]
  v_pk_fma_f32 v[144:145], v[142:143], v[72:73], v[144:145] op_sel_hi:[1,0,1]
  v_pk_fma_f32 v[208:209], v[206:207], v[72:73], v[208:209] op_sel_hi:[1,0,1]
  v_pk_fma_f32 v[144:145], v[72:73], v[206:207], v[144:145] op_sel:[1,0,0] op_sel_hi:[1,1,1] neg_lo:[1,0,0] neg_hi:[1,0,0]
  v_pk_fma_f32 v[208:209], v[72:73], v[142:143], v[208:209] op_sel:[1,0,0] op_sel_hi:[1,1,1]
  v_pk_mul_f32 v[146:147], v[146:147], v[34:35] op_sel_hi:[1,1]
  v_pk_mul_f32 v[210:211], v[210:211], v[34:35] op_sel_hi:[1,1]
  v_pk_fma_f32 v[146:147], v[42:43], v[112:113], v[146:147] op_sel_hi:[1,0,1] neg_lo:[1,0,0] neg_hi:[1,0,0]
  v_pk_fma_f32 v[210:211], v[42:43], v[114:115], v[210:211] op_sel_hi:[1,0,1] neg_lo:[1,0,0] neg_hi:[1,0,0]
  v_pk_fma_f32 v[146:147], v[144:145], v[72:73], v[146:147] op_sel_hi:[1,0,1]
  v_pk_fma_f32 v[210:211], v[208:209], v[72:73], v[210:211] op_sel_hi:[1,0,1]
  v_pk_fma_f32 v[146:147], v[72:73], v[208:209], v[146:147] op_sel:[1,0,0] op_sel_hi:[1,1,1] neg_lo:[1,0,0] neg_hi:[1,0,0]
  v_pk_fma_f32 v[210:211], v[72:73], v[144:145], v[210:211] op_sel:[1,0,0] op_sel_hi:[1,1,1]
  v_pk_mul_f32 v[148:149], v[148:149], v[36:37] op_sel_hi:[1,1]
  v_pk_mul_f32 v[212:213], v[212:213], v[36:37] op_sel_hi:[1,1]
  v_pk_fma_f32 v[148:149], v[44:45], v[112:113], v[148:149] op_sel_hi:[1,0,1] neg_lo:[1,0,0] neg_hi:[1,0,0]
  v_pk_fma_f32 v[212:213], v[44:45], v[114:115], v[212:213] op_sel_hi:[1,0,1] neg_lo:[1,0,0] neg_hi:[1,0,0]
  v_pk_fma_f32 v[148:149], v[146:147], v[72:73], v[148:149] op_sel_hi:[1,0,1]
  v_pk_fma_f32 v[212:213], v[210:211], v[72:73], v[212:213] op_sel_hi:[1,0,1]
  v_pk_fma_f32 v[148:149], v[72:73], v[210:211], v[148:149] op_sel:[1,0,0] op_sel_hi:[1,1,1] neg_lo:[1,0,0] neg_hi:[1,0,0]
  v_pk_fma_f32 v[212:213], v[72:73], v[146:147], v[212:213] op_sel:[1,0,0] op_sel_hi:[1,1,1]
  v_pk_mul_f32 v[150:151], v[150:151], v[38:39] op_sel_hi:[1,1]
  v_pk_mul_f32 v[214:215], v[214:215], v[38:39] op_sel_hi:[1,1]
  v_pk_fma_f32 v[150:151], v[46:47], v[112:113], v[150:151] op_sel_hi:[1,0,1] neg_lo:[1,0,0] neg_hi:[1,0,0]
  v_pk_fma_f32 v[214:215], v[46:47], v[114:115], v[214:215] op_sel_hi:[1,0,1] neg_lo:[1,0,0] neg_hi:[1,0,0]
  ds_read_b128 v[32:35], v22 offset:0
  ds_read_b128 v[36:39], v22 offset:16
  ds_read_b128 v[40:43], v22 offset:1024
  ds_read_b128 v[44:47], v22 offset:1040
  v_pk_fma_f32 v[150:151], v[148:149], v[72:73], v[150:151] op_sel_hi:[1,0,1]
  v_pk_fma_f32 v[214:215], v[212:213], v[72:73], v[214:215] op_sel_hi:[1,0,1]
  v_pk_fma_f32 v[150:151], v[72:73], v[212:213], v[150:151] op_sel:[1,0,0] op_sel_hi:[1,1,1] neg_lo:[1,0,0] neg_hi:[1,0,0]
  v_pk_fma_f32 v[214:215], v[72:73], v[148:149], v[214:215] op_sel:[1,0,0] op_sel_hi:[1,1,1]
  s_waitcnt lgkmcnt(4)
  v_pk_mul_f32 v[152:153], v[152:153], v[48:49] op_sel_hi:[1,1]
  v_pk_mul_f32 v[216:217], v[216:217], v[48:49] op_sel_hi:[1,1]
  v_pk_fma_f32 v[152:153], v[56:57], v[112:113], v[152:153] op_sel_hi:[1,0,1] neg_lo:[1,0,0] neg_hi:[1,0,0]
  v_pk_fma_f32 v[216:217], v[56:57], v[114:115], v[216:217] op_sel_hi:[1,0,1] neg_lo:[1,0,0] neg_hi:[1,0,0]
  v_pk_fma_f32 v[152:153], v[150:151], v[72:73], v[152:153] op_sel_hi:[1,0,1]
  v_pk_fma_f32 v[216:217], v[214:215], v[72:73], v[216:217] op_sel_hi:[1,0,1]
  v_pk_fma_f32 v[152:153], v[72:73], v[214:215], v[152:153] op_sel:[1,0,0] op_sel_hi:[1,1,1] neg_lo:[1,0,0] neg_hi:[1,0,0]
  v_pk_fma_f32 v[216:217], v[72:73], v[150:151], v[216:217] op_sel:[1,0,0] op_sel_hi:[1,1,1]
  v_pk_mul_f32 v[154:155], v[154:155], v[50:51] op_sel_hi:[1,1]
  v_pk_mul_f32 v[218:219], v[218:219], v[50:51] op_sel_hi:[1,1]
  v_pk_fma_f32 v[154:155], v[58:59], v[112:113], v[154:155] op_sel_hi:[1,0,1] neg_lo:[1,0,0] neg_hi:[1,0,0]
  v_pk_fma_f32 v[218:219], v[58:59], v[114:115], v[218:219] op_sel_hi:[1,0,1] neg_lo:[1,0,0] neg_hi:[1,0,0]
  v_pk_fma_f32 v[154:155], v[152:153], v[72:73], v[154:155] op_sel_hi:[1,0,1]
  v_pk_fma_f32 v[218:219], v[216:217], v[72:73], v[218:219] op_sel_hi:[1,0,1]
  v_pk_fma_f32 v[154:155], v[72:73], v[216:217], v[154:155] op_sel:[1,0,0] op_sel_hi:[1,1,1] neg_lo:[1,0,0] neg_hi:[1,0,0]
  v_pk_fma_f32 v[218:219], v[72:73], v[152:153], v[218:219] op_sel:[1,0,0] op_sel_hi:[1,1,1]
  v_pk_mul_f32 v[156:157], v[156:157], v[52:53] op_sel_hi:[1,1]
  v_pk_mul_f32 v[220:221], v[220:221], v[52:53] op_sel_hi:[1,1]
  v_pk_fma_f32 v[156:157], v[60:61], v[112:113], v[156:157] op_sel_hi:[1,0,1] neg_lo:[1,0,0] neg_hi:[1,0,0]
  v_pk_fma_f32 v[220:221], v[60:61], v[114:115], v[220:221] op_sel_hi:[1,0,1] neg_lo:[1,0,0] neg_hi:[1,0,0]
  v_pk_fma_f32 v[156:157], v[154:155], v[72:73], v[156:157] op_sel_hi:[1,0,1]
  v_pk_fma_f32 v[220:221], v[218:219], v[72:73], v[220:221] op_sel_hi:[1,0,1]
  v_pk_fma_f32 v[156:157], v[72:73], v[218:219], v[156:157] op_sel:[1,0,0] op_sel_hi:[1,1,1] neg_lo:[1,0,0] neg_hi:[1,0,0]
  v_pk_fma_f32 v[220:221], v[72:73], v[154:155], v[220:221] op_sel:[1,0,0] op_sel_hi:[1,1,1]
  v_pk_mul_f32 v[158:159], v[158:159], v[54:55] op_sel_hi:[1,1]
  v_pk_mul_f32 v[222:223], v[222:223], v[54:55] op_sel_hi:[1,1]
  v_pk_fma_f32 v[158:159], v[62:63], v[112:113], v[158:159] op_sel_hi:[1,0,1] neg_lo:[1,0,0] neg_hi:[1,0,0]
  v_pk_fma_f32 v[222:223], v[62:63], v[114:115], v[222:223] op_sel_hi:[1,0,1] neg_lo:[1,0,0] neg_hi:[1,0,0]
  ds_read_b128 v[48:51], v22 offset:32
  ds_read_b128 v[52:55], v22 offset:48
  ds_read_b128 v[56:59], v22 offset:1056
  ds_read_b128 v[60:63], v22 offset:1072
  v_pk_fma_f32 v[158:159], v[156:157], v[72:73], v[158:159] op_sel_hi:[1,0,1]
  v_pk_fma_f32 v[222:223], v[220:221], v[72:73], v[222:223] op_sel_hi:[1,0,1]
  v_pk_fma_f32 v[158:159], v[72:73], v[220:221], v[158:159] op_sel:[1,0,0] op_sel_hi:[1,1,1] neg_lo:[1,0,0] neg_hi:[1,0,0]
  v_pk_fma_f32 v[222:223], v[72:73], v[156:157], v[222:223] op_sel:[1,0,0] op_sel_hi:[1,1,1]
  v_fma_f32 v64, v76, v158, v159
  v_fma_f32 v65, v76, v222, v223
  v_fma_f32 v64, -v77, v222, v64
  v_fma_f32 v65, v77, v158, v65
  v_mul_f32 v120, v84, v64
  v_mul_f32 v122, v84, v65
  v_fma_f32 v120, -v85, v65, v120
  v_fmac_f32 v122, v85, v64
  v_mov_b32 v4, v120
  v_mov_b32 v5, v122
  s_nop 0
  v_permlane16_swap_b32 v120, v4
  v_permlane16_swap_b32 v122, v5
  v_add_f32 v120, v120, v4
  v_add_f32 v122, v122, v5
  v_mov_b32 v4, v120
  v_mov_b32 v5, v122
  s_nop 0
  v_permlane32_swap_b32 v120, v4
  v_permlane32_swap_b32 v122, v5
  v_add_f32 v120, v120, v4
  v_add_f32 v122, v122, v5
  v_mov_b32 v121, s96
  v_mov_b32 v123, s96
  buffer_store_dwordx4 v[120:123], v12, s[8:11], s97 offen offset:0 sc1
  s_waitcnt lgkmcnt(4)
  v_pk_mul_f32 v[160:161], v[160:161], v[32:33] op_sel_hi:[1,1]
  v_pk_mul_f32 v[224:225], v[224:225], v[32:33] op_sel_hi:[1,1]
  v_pk_fma_f32 v[160:161], v[40:41], v[116:117], v[160:161] op_sel_hi:[1,0,1] neg_lo:[1,0,0] neg_hi:[1,0,0]
  v_pk_fma_f32 v[224:225], v[40:41], v[118:119], v[224:225] op_sel_hi:[1,0,1] neg_lo:[1,0,0] neg_hi:[1,0,0]
  v_pk_mul_f32 v[162:163], v[162:163], v[34:35] op_sel_hi:[1,1]
  v_pk_mul_f32 v[226:227], v[226:227], v[34:35] op_sel_hi:[1,1]
  v_pk_fma_f32 v[162:163], v[42:43], v[116:117], v[162:163] op_sel_hi:[1,0,1] neg_lo:[1,0,0] neg_hi:[1,0,0]
  v_pk_fma_f32 v[226:227], v[42:43], v[118:119], v[226:227] op_sel_hi:[1,0,1] neg_lo:[1,0,0] neg_hi:[1,0,0]
  v_pk_fma_f32 v[162:163], v[160:161], v[92:93], v[162:163] op_sel_hi:[1,0,1]
  v_pk_fma_f32 v[226:227], v[224:225], v[92:93], v[226:227] op_sel_hi:[1,0,1]
  v_pk_fma_f32 v[162:163], v[92:93], v[224:225], v[162:163] op_sel:[1,0,0] op_sel_hi:[1,1,1] neg_lo:[1,0,0] neg_hi:[1,0,0]
  v_pk_fma_f32 v[226:227], v[92:93], v[160:161], v[226:227] op_sel:[1,0,0] op_sel_hi:[1,1,1]
  v_pk_mul_f32 v[164:165], v[164:165], v[36:37] op_sel_hi:[1,1]
  v_pk_mul_f32 v[228:229], v[228:229], v[36:37] op_sel_hi:[1,1]
  v_pk_fma_f32 v[164:165], v[44:45], v[116:117], v[164:165] op_sel_hi:[1,0,1] neg_lo:[1,0,0] neg_hi:[1,0,0]
  v_pk_fma_f32 v[228:229], v[44:45], v[118:119], v[228:229] op_sel_hi:[1,0,1] neg_lo:[1,0,0] neg_hi:[1,0,0]
  v_pk_fma_f32 v[164:165], v[162:163], v[92:93], v[164:165] op_sel_hi:[1,0,1]
  v_pk_fma_f32 v[228:229], v[226:227], v[92:93], v[228:229] op_sel_hi:[1,0,1]
  v_pk_fma_f32 v[164:165], v[92:93], v[226:227], v[164:165] op_sel:[1,0,0] op_sel_hi:[1,1,1] neg_lo:[1,0,0] neg_hi:[1,0,0]
  v_pk_fma_f32 v[228:229], v[92:93], v[162:163], v[228:229] op_sel:[1,0,0] op_sel_hi:[1,1,1]
  v_pk_mul_f32 v[166:167], v[166:167], v[38:39] op_sel_hi:[1,1]
  v_pk_mul_f32 v[230:231], v[230:231], v[38:39] op_sel_hi:[1,1]
  v_pk_fma_f32 v[166:167], v[46:47], v[116:117], v[166:167] op_sel_hi:[1,0,1] neg_lo:[1,0,0] neg_hi:[1,0,0]
  v_pk_fma_f32 v[230:231], v[46:47], v[118:119], v[230:231] op_sel_hi:[1,0,1] neg_lo:[1,0,0] neg_hi:[1,0,0]
  ds_read_b128 v[32:35], v22 offset:64
  ds_read_b128 v[36:39], v22 offset:80
  ds_read_b128 v[40:43], v22 offset:1088
  ds_read_b128 v[44:47], v22 offset:1104
  v_pk_fma_f32 v[166:167], v[164:165], v[92:93], v[166:167] op_sel_hi:[1,0,1]
  v_pk_fma_f32 v[230:231], v[228:229], v[92:93], v[230:231] op_sel_hi:[1,0,1]
  v_pk_fma_f32 v[166:167], v[92:93], v[228:229], v[166:167] op_sel:[1,0,0] op_sel_hi:[1,1,1] neg_lo:[1,0,0] neg_hi:[1,0,0]
  v_pk_fma_f32 v[230:231], v[92:93], v[164:165], v[230:231] op_sel:[1,0,0] op_sel_hi:[1,1,1]
  s_waitcnt lgkmcnt(4)
  v_pk_mul_f32 v[168:169], v[168:169], v[48:49] op_sel_hi:[1,1]
  v_pk_mul_f32 v[232:233], v[232:233], v[48:49] op_sel_hi:[1,1]
  v_pk_fma_f32 v[168:169], v[56:57], v[116:117], v[168:169] op_sel_hi:[1,0,1] neg_lo:[1,0,0] neg_hi:[1,0,0]
  v_pk_fma_f32 v[232:233], v[56:57], v[118:119], v[232:233] op_sel_hi:[1,0,1] neg_lo:[1,0,0] neg_hi:[1,0,0]
  v_pk_fma_f32 v[168:169], v[166:167], v[92:93], v[168:169] op_sel_hi:[1,0,1]
  v_pk_fma_f32 v[232:233], v[230:231], v[92:93], v[232:233] op_sel_hi:[1,0,1]
  v_pk_fma_f32 v[168:169], v[92:93], v[230:231], v[168:169] op_sel:[1,0,0] op_sel_hi:[1,1,1] neg_lo:[1,0,0] neg_hi:[1,0,0]
  v_pk_fma_f32 v[232:233], v[92:93], v[166:167], v[232:233] op_sel:[1,0,0] op_sel_hi:[1,1,1]
  v_pk_mul_f32 v[170:171], v[170:171], v[50:51] op_sel_hi:[1,1]
  v_pk_mul_f32 v[234:235], v[234:235], v[50:51] op_sel_hi:[1,1]
  v_pk_fma_f32 v[170:171], v[58:59], v[116:117], v[170:171] op_sel_hi:[1,0,1] neg_lo:[1,0,0] neg_hi:[1,0,0]
  v_pk_fma_f32 v[234:235], v[58:59], v[118:119], v[234:235] op_sel_hi:[1,0,1] neg_lo:[1,0,0] neg_hi:[1,0,0]
  v_pk_fma_f32 v[170:171], v[168:169], v[92:93], v[170:171] op_sel_hi:[1,0,1]
  v_pk_fma_f32 v[234:235], v[232:233], v[92:93], v[234:235] op_sel_hi:[1,0,1]
  v_pk_fma_f32 v[170:171], v[92:93], v[232:233], v[170:171] op_sel:[1,0,0] op_sel_hi:[1,1,1] neg_lo:[1,0,0] neg_hi:[1,0,0]
  v_pk_fma_f32 v[234:235], v[92:93], v[168:169], v[234:235] op_sel:[1,0,0] op_sel_hi:[1,1,1]
  v_pk_mul_f32 v[172:173], v[172:173], v[52:53] op_sel_hi:[1,1]
  v_pk_mul_f32 v[236:237], v[236:237], v[52:53] op_sel_hi:[1,1]
  v_pk_fma_f32 v[172:173], v[60:61], v[116:117], v[172:173] op_sel_hi:[1,0,1] neg_lo:[1,0,0] neg_hi:[1,0,0]
  v_pk_fma_f32 v[236:237], v[60:61], v[118:119], v[236:237] op_sel_hi:[1,0,1] neg_lo:[1,0,0] neg_hi:[1,0,0]
  v_pk_fma_f32 v[172:173], v[170:171], v[92:93], v[172:173] op_sel_hi:[1,0,1]
  v_pk_fma_f32 v[236:237], v[234:235], v[92:93], v[236:237] op_sel_hi:[1,0,1]
  v_pk_fma_f32 v[172:173], v[92:93], v[234:235], v[172:173] op_sel:[1,0,0] op_sel_hi:[1,1,1] neg_lo:[1,0,0] neg_hi:[1,0,0]
  v_pk_fma_f32 v[236:237], v[92:93], v[170:171], v[236:237] op_sel:[1,0,0] op_sel_hi:[1,1,1]
  v_pk_mul_f32 v[174:175], v[174:175], v[54:55] op_sel_hi:[1,1]
  v_pk_mul_f32 v[238:239], v[238:239], v[54:55] op_sel_hi:[1,1]
  v_pk_fma_f32 v[174:175], v[62:63], v[116:117], v[174:175] op_sel_hi:[1,0,1] neg_lo:[1,0,0] neg_hi:[1,0,0]
  v_pk_fma_f32 v[238:239], v[62:63], v[118:119], v[238:239] op_sel_hi:[1,0,1] neg_lo:[1,0,0] neg_hi:[1,0,0]
  ds_read_b128 v[48:51], v22 offset:96
  ds_read_b128 v[52:55], v22 offset:112
  ds_read_b128 v[56:59], v22 offset:1120
  ds_read_b128 v[60:63], v22 offset:1136
  v_pk_fma_f32 v[174:175], v[172:173], v[92:93], v[174:175] op_sel_hi:[1,0,1]
  v_pk_fma_f32 v[238:239], v[236:237], v[92:93], v[238:239] op_sel_hi:[1,0,1]
  v_pk_fma_f32 v[174:175], v[92:93], v[236:237], v[174:175] op_sel:[1,0,0] op_sel_hi:[1,1,1] neg_lo:[1,0,0] neg_hi:[1,0,0]
  v_pk_fma_f32 v[238:239], v[92:93], v[172:173], v[238:239] op_sel:[1,0,0] op_sel_hi:[1,1,1]
  s_waitcnt lgkmcnt(4)
  v_pk_mul_f32 v[176:177], v[176:177], v[32:33] op_sel_hi:[1,1]
  v_pk_mul_f32 v[240:241], v[240:241], v[32:33] op_sel_hi:[1,1]
  v_pk_fma_f32 v[176:177], v[40:41], v[116:117], v[176:177] op_sel_hi:[1,0,1] neg_lo:[1,0,0] neg_hi:[1,0,0]
  v_pk_fma_f32 v[240:241], v[40:41], v[118:119], v[240:241] op_sel_hi:[1,0,1] neg_lo:[1,0,0] neg_hi:[1,0,0]
  v_pk_fma_f32 v[176:177], v[174:175], v[92:93], v[176:177] op_sel_hi:[1,0,1]
  v_pk_fma_f32 v[240:241], v[238:239], v[92:93], v[240:241] op_sel_hi:[1,0,1]
  v_pk_fma_f32 v[176:177], v[92:93], v[238:239], v[176:177] op_sel:[1,0,0] op_sel_hi:[1,1,1] neg_lo:[1,0,0] neg_hi:[1,0,0]
  v_pk_fma_f32 v[240:241], v[92:93], v[174:175], v[240:241] op_sel:[1,0,0] op_sel_hi:[1,1,1]
  v_pk_mul_f32 v[178:179], v[178:179], v[34:35] op_sel_hi:[1,1]
  v_pk_mul_f32 v[242:243], v[242:243], v[34:35] op_sel_hi:[1,1]
  v_pk_fma_f32 v[178:179], v[42:43], v[116:117], v[178:179] op_sel_hi:[1,0,1] neg_lo:[1,0,0] neg_hi:[1,0,0]
  v_pk_fma_f32 v[242:243], v[42:43], v[118:119], v[242:243] op_sel_hi:[1,0,1] neg_lo:[1,0,0] neg_hi:[1,0,0]
  v_pk_fma_f32 v[178:179], v[176:177], v[92:93], v[178:179] op_sel_hi:[1,0,1]
  v_pk_fma_f32 v[242:243], v[240:241], v[92:93], v[242:243] op_sel_hi:[1,0,1]
  v_pk_fma_f32 v[178:179], v[92:93], v[240:241], v[178:179] op_sel:[1,0,0] op_sel_hi:[1,1,1] neg_lo:[1,0,0] neg_hi:[1,0,0]
  v_pk_fma_f32 v[242:243], v[92:93], v[176:177], v[242:243] op_sel:[1,0,0] op_sel_hi:[1,1,1]
  v_pk_mul_f32 v[180:181], v[180:181], v[36:37] op_sel_hi:[1,1]
  v_pk_mul_f32 v[244:245], v[244:245], v[36:37] op_sel_hi:[1,1]
  v_pk_fma_f32 v[180:181], v[44:45], v[116:117], v[180:181] op_sel_hi:[1,0,1] neg_lo:[1,0,0] neg_hi:[1,0,0]
  v_pk_fma_f32 v[244:245], v[44:45], v[118:119], v[244:245] op_sel_hi:[1,0,1] neg_lo:[1,0,0] neg_hi:[1,0,0]
  v_pk_fma_f32 v[180:181], v[178:179], v[92:93], v[180:181] op_sel_hi:[1,0,1]
  v_pk_fma_f32 v[244:245], v[242:243], v[92:93], v[244:245] op_sel_hi:[1,0,1]
  v_pk_fma_f32 v[180:181], v[92:93], v[242:243], v[180:181] op_sel:[1,0,0] op_sel_hi:[1,1,1] neg_lo:[1,0,0] neg_hi:[1,0,0]
  v_pk_fma_f32 v[244:245], v[92:93], v[178:179], v[244:245] op_sel:[1,0,0] op_sel_hi:[1,1,1]
  v_pk_mul_f32 v[182:183], v[182:183], v[38:39] op_sel_hi:[1,1]
  v_pk_mul_f32 v[246:247], v[246:247], v[38:39] op_sel_hi:[1,1]
  v_pk_fma_f32 v[182:183], v[46:47], v[116:117], v[182:183] op_sel_hi:[1,0,1] neg_lo:[1,0,0] neg_hi:[1,0,0]
  v_pk_fma_f32 v[246:247], v[46:47], v[118:119], v[246:247] op_sel_hi:[1,0,1] neg_lo:[1,0,0] neg_hi:[1,0,0]
  v_pk_fma_f32 v[182:183], v[180:181], v[92:93], v[182:183] op_sel_hi:[1,0,1]
  v_pk_fma_f32 v[246:247], v[244:245], v[92:93], v[246:247] op_sel_hi:[1,0,1]
  v_pk_fma_f32 v[182:183], v[92:93], v[244:245], v[182:183] op_sel:[1,0,0] op_sel_hi:[1,1,1] neg_lo:[1,0,0] neg_hi:[1,0,0]
  v_pk_fma_f32 v[246:247], v[92:93], v[180:181], v[246:247] op_sel:[1,0,0] op_sel_hi:[1,1,1]
  s_waitcnt lgkmcnt(0)
  v_pk_mul_f32 v[184:185], v[184:185], v[48:49] op_sel_hi:[1,1]
  v_pk_mul_f32 v[248:249], v[248:249], v[48:49] op_sel_hi:[1,1]
  v_pk_fma_f32 v[184:185], v[56:57], v[116:117], v[184:185] op_sel_hi:[1,0,1] neg_lo:[1,0,0] neg_hi:[1,0,0]
  v_pk_fma_f32 v[248:249], v[56:57], v[118:119], v[248:249] op_sel_hi:[1,0,1] neg_lo:[1,0,0] neg_hi:[1,0,0]
  v_pk_fma_f32 v[184:185], v[182:183], v[92:93], v[184:185] op_sel_hi:[1,0,1]
  v_pk_fma_f32 v[248:249], v[246:247], v[92:93], v[248:249] op_sel_hi:[1,0,1]
  v_pk_fma_f32 v[184:185], v[92:93], v[246:247], v[184:185] op_sel:[1,0,0] op_sel_hi:[1,1,1] neg_lo:[1,0,0] neg_hi:[1,0,0]
  v_pk_fma_f32 v[248:249], v[92:93], v[182:183], v[248:249] op_sel:[1,0,0] op_sel_hi:[1,1,1]
  v_pk_mul_f32 v[186:187], v[186:187], v[50:51] op_sel_hi:[1,1]
  v_pk_mul_f32 v[250:251], v[250:251], v[50:51] op_sel_hi:[1,1]
  v_pk_fma_f32 v[186:187], v[58:59], v[116:117], v[186:187] op_sel_hi:[1,0,1] neg_lo:[1,0,0] neg_hi:[1,0,0]
  v_pk_fma_f32 v[250:251], v[58:59], v[118:119], v[250:251] op_sel_hi:[1,0,1] neg_lo:[1,0,0] neg_hi:[1,0,0]
  v_pk_fma_f32 v[186:187], v[184:185], v[92:93], v[186:187] op_sel_hi:[1,0,1]
  v_pk_fma_f32 v[250:251], v[248:249], v[92:93], v[250:251] op_sel_hi:[1,0,1]
  v_pk_fma_f32 v[186:187], v[92:93], v[248:249], v[186:187] op_sel:[1,0,0] op_sel_hi:[1,1,1] neg_lo:[1,0,0] neg_hi:[1,0,0]
  v_pk_fma_f32 v[250:251], v[92:93], v[184:185], v[250:251] op_sel:[1,0,0] op_sel_hi:[1,1,1]
  v_pk_mul_f32 v[188:189], v[188:189], v[52:53] op_sel_hi:[1,1]
  v_pk_mul_f32 v[252:253], v[252:253], v[52:53] op_sel_hi:[1,1]
  v_pk_fma_f32 v[188:189], v[60:61], v[116:117], v[188:189] op_sel_hi:[1,0,1] neg_lo:[1,0,0] neg_hi:[1,0,0]
  v_pk_fma_f32 v[252:253], v[60:61], v[118:119], v[252:253] op_sel_hi:[1,0,1] neg_lo:[1,0,0] neg_hi:[1,0,0]
  v_pk_fma_f32 v[188:189], v[186:187], v[92:93], v[188:189] op_sel_hi:[1,0,1]
  v_pk_fma_f32 v[252:253], v[250:251], v[92:93], v[252:253] op_sel_hi:[1,0,1]
  v_pk_fma_f32 v[188:189], v[92:93], v[250:251], v[188:189] op_sel:[1,0,0] op_sel_hi:[1,1,1] neg_lo:[1,0,0] neg_hi:[1,0,0]
  v_pk_fma_f32 v[252:253], v[92:93], v[186:187], v[252:253] op_sel:[1,0,0] op_sel_hi:[1,1,1]
  v_pk_mul_f32 v[190:191], v[190:191], v[54:55] op_sel_hi:[1,1]
  v_pk_mul_f32 v[254:255], v[254:255], v[54:55] op_sel_hi:[1,1]
  v_pk_fma_f32 v[190:191], v[62:63], v[116:117], v[190:191] op_sel_hi:[1,0,1] neg_lo:[1,0,0] neg_hi:[1,0,0]
  v_pk_fma_f32 v[254:255], v[62:63], v[118:119], v[254:255] op_sel_hi:[1,0,1] neg_lo:[1,0,0] neg_hi:[1,0,0]
  v_pk_fma_f32 v[190:191], v[188:189], v[92:93], v[190:191] op_sel_hi:[1,0,1]
  v_pk_fma_f32 v[254:255], v[252:253], v[92:93], v[254:255] op_sel_hi:[1,0,1]
  v_pk_fma_f32 v[190:191], v[92:93], v[252:253], v[190:191] op_sel:[1,0,0] op_sel_hi:[1,1,1] neg_lo:[1,0,0] neg_hi:[1,0,0]
  v_pk_fma_f32 v[254:255], v[92:93], v[188:189], v[254:255] op_sel:[1,0,0] op_sel_hi:[1,1,1]
  v_fma_f32 v66, v96, v190, v191
  v_fma_f32 v67, v96, v254, v255
  v_fma_f32 v66, -v97, v254, v66
  v_fma_f32 v67, v97, v190, v67
  v_mul_f32 v124, v104, v66
  v_mul_f32 v126, v104, v67
  v_fma_f32 v124, -v105, v67, v124
  v_fmac_f32 v126, v105, v66
  v_mov_b32 v4, v124
  v_mov_b32 v5, v126
  s_nop 0
  v_permlane16_swap_b32 v124, v4
  v_permlane16_swap_b32 v126, v5
  v_add_f32 v124, v124, v4
  v_add_f32 v126, v126, v5
  v_mov_b32 v4, v124
  v_mov_b32 v5, v126
  s_nop 0
  v_permlane32_swap_b32 v124, v4
  v_permlane32_swap_b32 v126, v5
  v_add_f32 v124, v124, v4
  v_add_f32 v126, v126, v5
  v_mov_b32 v125, s96
  v_mov_b32 v127, s96
  buffer_store_dwordx4 v[124:127], v12, s[8:11], s97 offen offset:256 sc1
  s_mul_i32 s31, s29, 7680
  s_add_u32 s31, s31, 720896
  s_mul_i32 s32, s81, 5
  s_cmp_eq_u32 s3, 3
  s_cselect_b32 s33, 2, 63
  v_lshrrev_b32 v9, 1, v1
  v_min_u32 v9, 6, v9
  v_cmp_eq_u32 vcc, s33, v9
  v_and_b32 v2, 1, v1
  v_lshl_add_u32 v2, v2, 2, s32
  v_cndmask_b32 v9, v9, 1, vcc
  v_lshrrev_b32 v2, 3, v2
  v_mad_u32_u24 v9, v9, 5, v2
  v_lshlrev_b32 v9, 7, v9
  buffer_load_dword v9, v9, s[8:11], s31 offen sc1
  buffer_load_dwordx4 v[32:35], v13, s[8:11], 0 offen offset:0 sc1
  buffer_load_dwordx4 v[36:39], v14, s[8:11], 0 offen offset:0 sc1
  buffer_load_dwordx4 v[40:43], v15, s[8:11], 0 offen offset:0 sc1
  buffer_load_dwordx4 v[44:47], v16, s[8:11], 0 offen offset:0 sc1
  v_subrev_u32 v2, 16, v1
  v_lshlrev_b32 v2, 2, v2
  ds_bpermute_b32 v48, v2, v64
  ds_bpermute_b32 v49, v2, v65
  ds_bpermute_b32 v50, v2, v66
  ds_bpermute_b32 v51, v2, v67
  v_subrev_u32 v2, 32, v1
  v_lshlrev_b32 v2, 2, v2
  ds_bpermute_b32 v52, v2, v64
  ds_bpermute_b32 v53, v2, v65
  ds_bpermute_b32 v54, v2, v66
  ds_bpermute_b32 v55, v2, v67
  v_subrev_u32 v2, 48, v1
  v_lshlrev_b32 v2, 2, v2
  ds_bpermute_b32 v56, v2, v64
  ds_bpermute_b32 v57, v2, v65
  ds_bpermute_b32 v58, v2, v66
  ds_bpermute_b32 v59, v2, v67
  v_mov_b32 v88, 0
  v_mov_b32 v89, 0
  v_mov_b32 v108, 0
  v_mov_b32 v109, 0
  v_xor_b32 v68, 0, v10
  v_xor_b32 v69, 32, v10
  v_xor_b32 v70, 16, v10
  v_xor_b32 v71, 48, v10
  s_waitcnt lgkmcnt(0)
  s_lshl_b64 exec, -1, 48
  v_mov_b32 v88, v56
  v_mov_b32 v89, v57
  v_mov_b32 v108, v58
  v_mov_b32 v109, v59
  s_lshl_b64 exec, -1, 32
  v_fma_f32 v52, v78, v88, v52
  v_fma_f32 v53, v78, v89, v53
  v_fma_f32 v52, -v79, v89, v52
  v_fma_f32 v53, v79, v88, v53
  v_mov_b32 v88, v52
  v_mov_b32 v89, v53
  v_fma_f32 v54, v98, v108, v54
  v_fma_f32 v55, v98, v109, v55
  v_fma_f32 v54, -v99, v109, v54
  v_fma_f32 v55, v99, v108, v55
  v_mov_b32 v108, v54
  v_mov_b32 v109, v55
  s_lshl_b64 exec, -1, 16
  v_fma_f32 v48, v78, v88, v48
  v_fma_f32 v49, v78, v89, v49
  v_fma_f32 v48, -v79, v89, v48
  v_fma_f32 v49, v79, v88, v49
  v_mov_b32 v88, v48
  v_mov_b32 v89, v49
  v_fma_f32 v50, v98, v108, v50
  v_fma_f32 v51, v98, v109, v51
  v_fma_f32 v50, -v99, v109, v50
  v_fma_f32 v51, v99, v108, v51
  v_mov_b32 v108, v50
  v_mov_b32 v109, v51
  s_mov_b64 exec, -1
  v_mov_b32 v64, v158
  v_mov_b32 v65, v222
  v_pk_mul_f32 v[112:113], v[74:75], v[192:193] op_sel:[1,0] op_sel_hi:[1,1]
  v_pk_mul_f32 v[114:115], v[74:75], v[128:129] op_sel:[1,0] op_sel_hi:[1,1]
  v_pk_fma_f32 v[128:129], v[128:129], v[74:75], v[112:113] op_sel_hi:[1,0,1] neg_lo:[0,0,1] neg_hi:[0,0,1]
  v_pk_fma_f32 v[192:193], v[192:193], v[74:75], v[114:115] op_sel_hi:[1,0,1] neg_lo:[0,1,1] neg_hi:[0,1,1]
  v_pk_mul_f32 v[112:113], v[74:75], v[194:195] op_sel:[1,0] op_sel_hi:[1,1]
  v_pk_mul_f32 v[114:115], v[74:75], v[130:131] op_sel:[1,0] op_sel_hi:[1,1]
  v_pk_fma_f32 v[130:131], v[130:131], v[74:75], v[112:113] op_sel_hi:[1,0,1] neg_lo:[0,0,1] neg_hi:[0,0,1]
  v_pk_fma_f32 v[194:195], v[194:195], v[74:75], v[114:115] op_sel_hi:[1,0,1] neg_lo:[0,1,1] neg_hi:[0,1,1]
  v_pk_mul_f32 v[112:113], v[74:75], v[196:197] op_sel:[1,0] op_sel_hi:[1,1]
  v_pk_mul_f32 v[114:115], v[74:75], v[132:133] op_sel:[1,0] op_sel_hi:[1,1]
  v_pk_fma_f32 v[132:133], v[132:133], v[74:75], v[112:113] op_sel_hi:[1,0,1] neg_lo:[0,0,1] neg_hi:[0,0,1]
  v_pk_fma_f32 v[196:197], v[196:197], v[74:75], v[114:115] op_sel_hi:[1,0,1] neg_lo:[0,1,1] neg_hi:[0,1,1]
  v_pk_mul_f32 v[112:113], v[74:75], v[198:199] op_sel:[1,0] op_sel_hi:[1,1]
  v_pk_mul_f32 v[114:115], v[74:75], v[134:135] op_sel:[1,0] op_sel_hi:[1,1]
  v_pk_fma_f32 v[134:135], v[134:135], v[74:75], v[112:113] op_sel_hi:[1,0,1] neg_lo:[0,0,1] neg_hi:[0,0,1]
  v_pk_fma_f32 v[198:199], v[198:199], v[74:75], v[114:115] op_sel_hi:[1,0,1] neg_lo:[0,1,1] neg_hi:[0,1,1]
  v_pk_mul_f32 v[112:113], v[74:75], v[200:201] op_sel:[1,0] op_sel_hi:[1,1]
  v_pk_mul_f32 v[114:115], v[74:75], v[136:137] op_sel:[1,0] op_sel_hi:[1,1]
  v_pk_fma_f32 v[136:137], v[136:137], v[74:75], v[112:113] op_sel_hi:[1,0,1] neg_lo:[0,0,1] neg_hi:[0,0,1]
  v_pk_fma_f32 v[200:201], v[200:201], v[74:75], v[114:115] op_sel_hi:[1,0,1] neg_lo:[0,1,1] neg_hi:[0,1,1]
  v_pk_mul_f32 v[112:113], v[74:75], v[202:203] op_sel:[1,0] op_sel_hi:[1,1]
  v_pk_mul_f32 v[114:115], v[74:75], v[138:139] op_sel:[1,0] op_sel_hi:[1,1]
  v_pk_fma_f32 v[138:139], v[138:139], v[74:75], v[112:113] op_sel_hi:[1,0,1] neg_lo:[0,0,1] neg_hi:[0,0,1]
  v_pk_fma_f32 v[202:203], v[202:203], v[74:75], v[114:115] op_sel_hi:[1,0,1] neg_lo:[0,1,1] neg_hi:[0,1,1]
  v_pk_mul_f32 v[112:113], v[74:75], v[204:205] op_sel:[1,0] op_sel_hi:[1,1]
  v_pk_mul_f32 v[114:115], v[74:75], v[140:141] op_sel:[1,0] op_sel_hi:[1,1]
  v_pk_fma_f32 v[140:141], v[140:141], v[74:75], v[112:113] op_sel_hi:[1,0,1] neg_lo:[0,0,1] neg_hi:[0,0,1]
  v_pk_fma_f32 v[204:205], v[204:205], v[74:75], v[114:115] op_sel_hi:[1,0,1] neg_lo:[0,1,1] neg_hi:[0,1,1]
  v_pk_mul_f32 v[112:113], v[74:75], v[206:207] op_sel:[1,0] op_sel_hi:[1,1]
  v_pk_mul_f32 v[114:115], v[74:75], v[142:143] op_sel:[1,0] op_sel_hi:[1,1]
  v_pk_fma_f32 v[142:143], v[142:143], v[74:75], v[112:113] op_sel_hi:[1,0,1] neg_lo:[0,0,1] neg_hi:[0,0,1]
  v_pk_fma_f32 v[206:207], v[206:207], v[74:75], v[114:115] op_sel_hi:[1,0,1] neg_lo:[0,1,1] neg_hi:[0,1,1]
  v_pk_mul_f32 v[112:113], v[74:75], v[208:209] op_sel:[1,0] op_sel_hi:[1,1]
  v_pk_mul_f32 v[114:115], v[74:75], v[144:145] op_sel:[1,0] op_sel_hi:[1,1]
  v_pk_fma_f32 v[144:145], v[144:145], v[74:75], v[112:113] op_sel_hi:[1,0,1] neg_lo:[0,0,1] neg_hi:[0,0,1]
  v_pk_fma_f32 v[208:209], v[208:209], v[74:75], v[114:115] op_sel_hi:[1,0,1] neg_lo:[0,1,1] neg_hi:[0,1,1]
  v_pk_mul_f32 v[112:113], v[74:75], v[210:211] op_sel:[1,0] op_sel_hi:[1,1]
  v_pk_mul_f32 v[114:115], v[74:75], v[146:147] op_sel:[1,0] op_sel_hi:[1,1]
  v_pk_fma_f32 v[146:147], v[146:147], v[74:75], v[112:113] op_sel_hi:[1,0,1] neg_lo:[0,0,1] neg_hi:[0,0,1]
  v_pk_fma_f32 v[210:211], v[210:211], v[74:75], v[114:115] op_sel_hi:[1,0,1] neg_lo:[0,1,1] neg_hi:[0,1,1]
  v_pk_mul_f32 v[112:113], v[74:75], v[212:213] op_sel:[1,0] op_sel_hi:[1,1]
  v_pk_mul_f32 v[114:115], v[74:75], v[148:149] op_sel:[1,0] op_sel_hi:[1,1]
  v_pk_fma_f32 v[148:149], v[148:149], v[74:75], v[112:113] op_sel_hi:[1,0,1] neg_lo:[0,0,1] neg_hi:[0,0,1]
  v_pk_fma_f32 v[212:213], v[212:213], v[74:75], v[114:115] op_sel_hi:[1,0,1] neg_lo:[0,1,1] neg_hi:[0,1,1]
  v_pk_mul_f32 v[112:113], v[74:75], v[214:215] op_sel:[1,0] op_sel_hi:[1,1]
  v_pk_mul_f32 v[114:115], v[74:75], v[150:151] op_sel:[1,0] op_sel_hi:[1,1]
  v_pk_fma_f32 v[150:151], v[150:151], v[74:75], v[112:113] op_sel_hi:[1,0,1] neg_lo:[0,0,1] neg_hi:[0,0,1]
  v_pk_fma_f32 v[214:215], v[214:215], v[74:75], v[114:115] op_sel_hi:[1,0,1] neg_lo:[0,1,1] neg_hi:[0,1,1]
  v_pk_mul_f32 v[112:113], v[74:75], v[216:217] op_sel:[1,0] op_sel_hi:[1,1]
  v_pk_mul_f32 v[114:115], v[74:75], v[152:153] op_sel:[1,0] op_sel_hi:[1,1]
  v_pk_fma_f32 v[152:153], v[152:153], v[74:75], v[112:113] op_sel_hi:[1,0,1] neg_lo:[0,0,1] neg_hi:[0,0,1]
  v_pk_fma_f32 v[216:217], v[216:217], v[74:75], v[114:115] op_sel_hi:[1,0,1] neg_lo:[0,1,1] neg_hi:[0,1,1]
  v_pk_mul_f32 v[112:113], v[74:75], v[218:219] op_sel:[1,0] op_sel_hi:[1,1]
  v_pk_mul_f32 v[114:115], v[74:75], v[154:155] op_sel:[1,0] op_sel_hi:[1,1]
  v_pk_fma_f32 v[154:155], v[154:155], v[74:75], v[112:113] op_sel_hi:[1,0,1] neg_lo:[0,0,1] neg_hi:[0,0,1]
  v_pk_fma_f32 v[218:219], v[218:219], v[74:75], v[114:115] op_sel_hi:[1,0,1] neg_lo:[0,1,1] neg_hi:[0,1,1]
  v_pk_mul_f32 v[112:113], v[74:75], v[220:221] op_sel:[1,0] op_sel_hi:[1,1]
  v_pk_mul_f32 v[114:115], v[74:75], v[156:157] op_sel:[1,0] op_sel_hi:[1,1]
  v_pk_fma_f32 v[156:157], v[156:157], v[74:75], v[112:113] op_sel_hi:[1,0,1] neg_lo:[0,0,1] neg_hi:[0,0,1]
  v_pk_fma_f32 v[220:221], v[220:221], v[74:75], v[114:115] op_sel_hi:[1,0,1] neg_lo:[0,1,1] neg_hi:[0,1,1]
  v_pk_mul_f32 v[112:113], v[74:75], v[222:223] op_sel:[1,0] op_sel_hi:[1,1]
  v_pk_mul_f32 v[114:115], v[74:75], v[158:159] op_sel:[1,0] op_sel_hi:[1,1]
  v_pk_fma_f32 v[158:159], v[158:159], v[74:75], v[112:113] op_sel_hi:[1,0,1] neg_lo:[0,0,1] neg_hi:[0,0,1]
  v_pk_fma_f32 v[222:223], v[222:223], v[74:75], v[114:115] op_sel_hi:[1,0,1] neg_lo:[0,1,1] neg_hi:[0,1,1]
  s_waitcnt vmcnt(0)
  v_xor_b32 v4, v17, v33
  v_xor_b32 v5, v17, v35
  v_or_b32 v4, v4, v5
  v_xor_b32 v5, v18, v37
  v_or_b32 v4, v4, v5
  v_xor_b32 v5, v18, v39
  v_or_b32 v4, v4, v5
  v_xor_b32 v5, v19, v41
  v_or_b32 v4, v4, v5
  v_xor_b32 v5, v19, v43
  v_or_b32 v4, v4, v5
  v_xor_b32 v5, v20, v45
  v_or_b32 v4, v4, v5
  v_xor_b32 v5, v20, v47
  v_or_b32 v4, v4, v5
  v_cmp_ne_u32 vcc, 0, v4
  s_cbranch_vccz SSM_go0
  s_mov_b32 s7, 0x40000
SSM_poll0:
  buffer_load_dwordx4 v[32:35], v13, s[8:11], 0 offen offset:0 sc1
  buffer_load_dwordx4 v[36:39], v14, s[8:11], 0 offen offset:0 sc1
  buffer_load_dwordx4 v[40:43], v15, s[8:11], 0 offen offset:0 sc1
  buffer_load_dwordx4 v[44:47], v16, s[8:11], 0 offen offset:0 sc1
  s_waitcnt vmcnt(0)
  v_xor_b32 v4, v17, v33
  v_xor_b32 v5, v17, v35
  v_or_b32 v4, v4, v5
  v_xor_b32 v5, v18, v37
  v_or_b32 v4, v4, v5
  v_xor_b32 v5, v18, v39
  v_or_b32 v4, v4, v5
  v_xor_b32 v5, v19, v41
  v_or_b32 v4, v4, v5
  v_xor_b32 v5, v19, v43
  v_or_b32 v4, v4, v5
  v_xor_b32 v5, v20, v45
  v_or_b32 v4, v4, v5
  v_xor_b32 v5, v20, v47
  v_or_b32 v4, v4, v5
  v_cmp_ne_u32 vcc, 0, v4
  s_sub_u32 s7, s7, 1
  s_cbranch_scc1 SSM_go0
  s_cbranch_vccnz SSM_poll0
SSM_go0:
  v_cmp_ne_u32 vcc, s96, v9
  s_cbranch_vccz SC5a_ok
  s_mov_b32 s7, 0x40000
SC5a_l:
  s_mul_i32 s31, s29, 7680
  s_add_u32 s31, s31, 720896
  s_mul_i32 s32, s81, 5
  s_cmp_eq_u32 s3, 3
  s_cselect_b32 s33, 2, 63
  v_lshrrev_b32 v9, 1, v1
  v_min_u32 v9, 6, v9
  v_cmp_eq_u32 vcc, s33, v9
  v_and_b32 v2, 1, v1
  v_lshl_add_u32 v2, v2, 2, s32
  v_cndmask_b32 v9, v9, 1, vcc
  v_lshrrev_b32 v2, 3, v2
  v_mad_u32_u24 v9, v9, 5, v2
  v_lshlrev_b32 v9, 7, v9
  buffer_load_dword v9, v9, s[8:11], s31 offen sc1
  s_waitcnt vmcnt(0)
  v_cmp_ne_u32 vcc, s96, v9
  s_sub_u32 s7, s7, 1
  s_cbranch_scc1 SC5a_ok
  s_cbranch_vccnz SC5a_l
SC5a_ok:
  s_mov_b32 s35, s98
  v_fma_f32 v40, v80, v44, v40
  v_fma_f32 v42, v80, v46, v42
  v_fma_f32 v40, -v81, v46, v40
  v_fma_f32 v42, v81, v44, v42
  v_fma_f32 v36, v80, v40, v36
  v_fma_f32 v38, v80, v42, v38
  v_fma_f32 v36, -v81, v42, v36
  v_fma_f32 v38, v81, v40, v38
  v_fma_f32 v32, v80, v36, v32
  v_fma_f32 v34, v80, v38, v34
  v_fma_f32 v32, -v81, v38, v32
  v_fma_f32 v34, v81, v36, v34
  v_mul_f32 v36, v86, v32
  v_mul_f32 v37, v86, v34
  v_fma_f32 v36, -v87, v34, v36
  v_fmac_f32 v37, v87, v32
  v_mov_b32 v4, v36
  v_mov_b32 v5, v37
  s_nop 0
  v_permlane16_swap_b32 v36, v4
  v_permlane16_swap_b32 v37, v5
  v_add_f32 v36, v36, v4
  v_add_f32 v37, v37, v5
  v_mov_b32 v4, v36
  v_mov_b32 v5, v37
  s_nop 0
  v_permlane32_swap_b32 v36, v4
  v_permlane32_swap_b32 v37, v5
  v_add_f32 v36, v36, v4
  v_add_f32 v37, v37, v5
  v_fma_f32 v88, v82, v36, v88
  v_fma_f32 v89, v82, v37, v89
  v_fma_f32 v88, -v83, v37, v88
  v_fma_f32 v89, v83, v36, v89
  v_fma_f32 v64, v76, v88, v64
  v_fma_f32 v65, v76, v89, v65
  v_fma_f32 v64, -v77, v89, v64
  v_fma_f32 v65, v77, v88, v65
  v_mul_f32 v90, v75, v89
  v_mul_f32 v91, v75, v88
  v_fma_f32 v112, v74, v88, -v90
  v_fma_f32 v114, -v74, v89, -v91
  v_mul_f32 v90, v75, v65
  v_mul_f32 v91, v75, v64
  v_fma_f32 v113, v74, v64, -v90
  v_fma_f32 v115, -v74, v65, -v91
  v_pk_mul_f32 v[116:117], v[112:113], v[72:73] op_sel_hi:[1,0]
  v_pk_mul_f32 v[118:119], v[114:115], v[72:73] op_sel_hi:[1,0]
  v_pk_fma_f32 v[116:117], v[72:73], v[114:115], v[116:117] op_sel:[1,0,0] op_sel_hi:[1,1,1]
  v_pk_fma_f32 v[118:119], v[72:73], v[112:113], v[118:119] op_sel:[1,0,0] op_sel_hi:[1,1,1] neg_lo:[1,0,0] neg_hi:[1,0,0]
  v_pk_add_f32 v[128:129], v[128:129], v[116:117] op_sel_hi:[1,1]
  v_pk_add_f32 v[192:193], v[192:193], v[118:119] op_sel_hi:[1,1]
  v_pk_mul_f32 v[112:113], v[116:117], v[72:73] op_sel_hi:[1,0]
  v_pk_mul_f32 v[114:115], v[118:119], v[72:73] op_sel_hi:[1,0]
  v_pk_fma_f32 v[112:113], v[72:73], v[118:119], v[112:113] op_sel:[1,0,0] op_sel_hi:[1,1,1]
  v_pk_fma_f32 v[114:115], v[72:73], v[116:117], v[114:115] op_sel:[1,0,0] op_sel_hi:[1,1,1] neg_lo:[1,0,0] neg_hi:[1,0,0]
  v_pk_add_f32 v[130:131], v[130:131], v[112:113] op_sel_hi:[1,1]
  v_pk_add_f32 v[194:195], v[194:195], v[114:115] op_sel_hi:[1,1]
  v_cvt_pk_bf16_f32 v32, v128, v130
  v_cvt_pk_bf16_f32 v36, v129, v131
  v_cvt_pk_bf16_f32 v40, v192, v194
  v_cvt_pk_bf16_f32 v44, v193, v195
  buffer_load_dwordx4 v[48:51], v13, s[8:11], 0 offen offset:256 sc1
  buffer_load_dwordx4 v[52:55], v14, s[8:11], 0 offen offset:256 sc1
  buffer_load_dwordx4 v[56:59], v15, s[8:11], 0 offen offset:256 sc1
  buffer_load_dwordx4 v[60:63], v16, s[8:11], 0 offen offset:256 sc1
  v_pk_mul_f32 v[116:117], v[112:113], v[72:73] op_sel_hi:[1,0]
  s_add_u32 s79, s82, 10240
  v_pk_mul_f32 v[118:119], v[114:115], v[72:73] op_sel_hi:[1,0]
  v_pk_fma_f32 v[116:117], v[72:73], v[114:115], v[116:117] op_sel:[1,0,0] op_sel_hi:[1,1,1]
  v_pk_fma_f32 v[118:119], v[72:73], v[112:113], v[118:119] op_sel:[1,0,0] op_sel_hi:[1,1,1] neg_lo:[1,0,0] neg_hi:[1,0,0]
  v_pk_add_f32 v[132:133], v[132:133], v[116:117] op_sel_hi:[1,1]
  v_pk_add_f32 v[196:197], v[196:197], v[118:119] op_sel_hi:[1,1]
  v_pk_mul_f32 v[112:113], v[116:117], v[72:73] op_sel_hi:[1,0]
  s_cmp_eq_u32 s3, 3
  s_cselect_b32 s79, 0x7f000000, s79
  v_pk_mul_f32 v[114:115], v[118:119], v[72:73] op_sel_hi:[1,0]
  v_pk_fma_f32 v[112:113], v[72:73], v[118:119], v[112:113] op_sel:[1,0,0] op_sel_hi:[1,1,1]
  v_pk_fma_f32 v[114:115], v[72:73], v[116:117], v[114:115] op_sel:[1,0,0] op_sel_hi:[1,1,1] neg_lo:[1,0,0] neg_hi:[1,0,0]
  v_pk_add_f32 v[134:135], v[134:135], v[112:113] op_sel_hi:[1,1]
TS_16:
  s_cbranch_execz TR_S
  v_pk_add_f32 v[198:199], v[198:199], v[114:115] op_sel_hi:[1,1]
  v_cvt_pk_bf16_f32 v33, v132, v134
  buffer_load_dwordx4 a[96:99], v28, s[8:11], s79 offen offset:0 sc1
  v_cvt_pk_bf16_f32 v37, v133, v135
  v_cvt_pk_bf16_f32 v41, v196, v198
  v_cvt_pk_bf16_f32 v45, v197, v199
  v_pk_mul_f32 v[116:117], v[112:113], v[72:73] op_sel_hi:[1,0]
  v_pk_mul_f32 v[118:119], v[114:115], v[72:73] op_sel_hi:[1,0]
  v_pk_fma_f32 v[116:117], v[72:73], v[114:115], v[116:117] op_sel:[1,0,0] op_sel_hi:[1,1,1]
  buffer_load_dwordx4 a[100:103], v28, s[8:11], s79 offen offset:1024 sc1
  v_pk_fma_f32 v[118:119], v[72:73], v[112:113], v[118:119] op_sel:[1,0,0] op_sel_hi:[1,1,1] neg_lo:[1,0,0] neg_hi:[1,0,0]
  v_pk_add_f32 v[136:137], v[136:137], v[116:117] op_sel_hi:[1,1]
  v_pk_add_f32 v[200:201], v[200:201], v[118:119] op_sel_hi:[1,1]
  v_pk_mul_f32 v[112:113], v[116:117], v[72:73] op_sel_hi:[1,0]
  v_pk_mul_f32 v[114:115], v[118:119], v[72:73] op_sel_hi:[1,0]
  v_pk_fma_f32 v[112:113], v[72:73], v[118:119], v[112:113] op_sel:[1,0,0] op_sel_hi:[1,1,1]
  v_pk_fma_f32 v[114:115], v[72:73], v[116:117], v[114:115] op_sel:[1,0,0] op_sel_hi:[1,1,1] neg_lo:[1,0,0] neg_hi:[1,0,0]
  buffer_load_dwordx4 a[104:107], v28, s[8:11], s79 offen offset:2048 sc1
  v_pk_add_f32 v[138:139], v[138:139], v[112:113] op_sel_hi:[1,1]
  v_pk_add_f32 v[202:203], v[202:203], v[114:115] op_sel_hi:[1,1]
  v_cvt_pk_bf16_f32 v34, v136, v138
  v_cvt_pk_bf16_f32 v38, v137, v139
  v_cvt_pk_bf16_f32 v42, v200, v202
  v_cvt_pk_bf16_f32 v46, v201, v203
  buffer_load_dwordx4 a[108:111], v28, s[8:11], s79 offen offset:3072 sc1
  v_pk_mul_f32 v[116:117], v[112:113], v[72:73] op_sel_hi:[1,0]
  v_pk_mul_f32 v[118:119], v[114:115], v[72:73] op_sel_hi:[1,0]
  v_pk_fma_f32 v[116:117], v[72:73], v[114:115], v[116:117] op_sel:[1,0,0] op_sel_hi:[1,1,1]
  v_pk_fma_f32 v[118:119], v[72:73], v[112:113], v[118:119] op_sel:[1,0,0] op_sel_hi:[1,1,1] neg_lo:[1,0,0] neg_hi:[1,0,0]
  v_pk_add_f32 v[140:141], v[140:141], v[116:117] op_sel_hi:[1,1]
  v_pk_add_f32 v[204:205], v[204:205], v[118:119] op_sel_hi:[1,1]
  buffer_load_dwordx4 a[112:115], v29, s[8:11], s79 offen offset:0 sc1
  v_pk_mul_f32 v[112:113], v[116:117], v[72:73] op_sel_hi:[1,0]
  v_pk_mul_f32 v[114:115], v[118:119], v[72:73] op_sel_hi:[1,0]
  v_pk_fma_f32 v[112:113], v[72:73], v[118:119], v[112:113] op_sel:[1,0,0] op_sel_hi:[1,1,1]
  v_pk_fma_f32 v[114:115], v[72:73], v[116:117], v[114:115] op_sel:[1,0,0] op_sel_hi:[1,1,1] neg_lo:[1,0,0] neg_hi:[1,0,0]
  v_pk_add_f32 v[142:143], v[142:143], v[112:113] op_sel_hi:[1,1]
  v_pk_add_f32 v[206:207], v[206:207], v[114:115] op_sel_hi:[1,1]
  v_cvt_pk_bf16_f32 v35, v140, v142
  s_add_u32 s79, s82, 15360
  v_cvt_pk_bf16_f32 v39, v141, v143
  v_cvt_pk_bf16_f32 v43, v204, v206
  v_cvt_pk_bf16_f32 v47, v205, v207
  v_pk_mul_f32 v[116:117], v[112:113], v[72:73] op_sel_hi:[1,0]
  v_pk_mul_f32 v[118:119], v[114:115], v[72:73] op_sel_hi:[1,0]
  v_pk_fma_f32 v[116:117], v[72:73], v[114:115], v[116:117] op_sel:[1,0,0] op_sel_hi:[1,1,1]
  buffer_load_dwordx4 a[0:3], v28, s[8:11], s79 offen offset:0 sc1
  v_pk_fma_f32 v[118:119], v[72:73], v[112:113], v[118:119] op_sel:[1,0,0] op_sel_hi:[1,1,1] neg_lo:[1,0,0] neg_hi:[1,0,0]
  v_pk_add_f32 v[144:145], v[144:145], v[116:117] op_sel_hi:[1,1]
  v_pk_add_f32 v[208:209], v[208:209], v[118:119] op_sel_hi:[1,1]
  ds_write_b128 v68, v[32:35] offset:0
  v_pk_mul_f32 v[112:113], v[116:117], v[72:73] op_sel_hi:[1,0]
  v_pk_mul_f32 v[114:115], v[118:119], v[72:73] op_sel_hi:[1,0]
  buffer_load_dwordx4 a[4:7], v28, s[8:11], s79 offen offset:1024 sc1
  v_pk_fma_f32 v[112:113], v[72:73], v[118:119], v[112:113] op_sel:[1,0,0] op_sel_hi:[1,1,1]
  v_pk_fma_f32 v[114:115], v[72:73], v[116:117], v[114:115] op_sel:[1,0,0] op_sel_hi:[1,1,1] neg_lo:[1,0,0] neg_hi:[1,0,0]
  v_pk_add_f32 v[146:147], v[146:147], v[112:113] op_sel_hi:[1,1]
  v_pk_add_f32 v[210:211], v[210:211], v[114:115] op_sel_hi:[1,1]
  v_cvt_pk_bf16_f32 v128, v144, v146
  v_cvt_pk_bf16_f32 v132, v145, v147
  v_cvt_pk_bf16_f32 v192, v208, v210
  buffer_load_dwordx4 a[8:11], v28, s[8:11], s79 offen offset:2048 sc1
  v_cvt_pk_bf16_f32 v196, v209, v211
  v_pk_mul_f32 v[116:117], v[112:113], v[72:73] op_sel_hi:[1,0]
  v_pk_mul_f32 v[118:119], v[114:115], v[72:73] op_sel_hi:[1,0]
  v_pk_fma_f32 v[116:117], v[72:73], v[114:115], v[116:117] op_sel:[1,0,0] op_sel_hi:[1,1,1]
  v_pk_fma_f32 v[118:119], v[72:73], v[112:113], v[118:119] op_sel:[1,0,0] op_sel_hi:[1,1,1] neg_lo:[1,0,0] neg_hi:[1,0,0]
  v_pk_add_f32 v[148:149], v[148:149], v[116:117] op_sel_hi:[1,1]
  buffer_load_dwordx4 a[12:15], v28, s[8:11], s79 offen offset:3072 sc1
  v_pk_add_f32 v[212:213], v[212:213], v[118:119] op_sel_hi:[1,1]
  ds_write_b128 v69, v[36:39] offset:0
  v_pk_mul_f32 v[112:113], v[116:117], v[72:73] op_sel_hi:[1,0]
  v_pk_mul_f32 v[114:115], v[118:119], v[72:73] op_sel_hi:[1,0]
  v_pk_fma_f32 v[112:113], v[72:73], v[118:119], v[112:113] op_sel:[1,0,0] op_sel_hi:[1,1,1]
  v_pk_fma_f32 v[114:115], v[72:73], v[116:117], v[114:115] op_sel:[1,0,0] op_sel_hi:[1,1,1] neg_lo:[1,0,0] neg_hi:[1,0,0]
  buffer_load_dwordx4 a[16:19], v29, s[8:11], s79 offen offset:0 sc1
  v_pk_add_f32 v[150:151], v[150:151], v[112:113] op_sel_hi:[1,1]
  v_pk_add_f32 v[214:215], v[214:215], v[114:115] op_sel_hi:[1,1]
  v_cvt_pk_bf16_f32 v129, v148, v150
  v_cvt_pk_bf16_f32 v133, v149, v151
  v_cvt_pk_bf16_f32 v193, v212, v214
  v_cvt_pk_bf16_f32 v197, v213, v215
  v_pk_mul_f32 v[116:117], v[112:113], v[72:73] op_sel_hi:[1,0]
  s_add_u32 s79, s82, 20480
  v_pk_mul_f32 v[118:119], v[114:115], v[72:73] op_sel_hi:[1,0]
  v_pk_fma_f32 v[116:117], v[72:73], v[114:115], v[116:117] op_sel:[1,0,0] op_sel_hi:[1,1,1]
  v_pk_fma_f32 v[118:119], v[72:73], v[112:113], v[118:119] op_sel:[1,0,0] op_sel_hi:[1,1,1] neg_lo:[1,0,0] neg_hi:[1,0,0]
  v_pk_add_f32 v[152:153], v[152:153], v[116:117] op_sel_hi:[1,1]
  v_pk_add_f32 v[216:217], v[216:217], v[118:119] op_sel_hi:[1,1]
  ds_write_b128 v68, v[40:43] offset:4096
  buffer_load_dwordx4 a[20:23], v28, s[8:11], s79 offen offset:0 sc1
  v_pk_mul_f32 v[112:113], v[116:117], v[72:73] op_sel_hi:[1,0]
  v_pk_mul_f32 v[114:115], v[118:119], v[72:73] op_sel_hi:[1,0]
  v_pk_fma_f32 v[112:113], v[72:73], v[118:119], v[112:113] op_sel:[1,0,0] op_sel_hi:[1,1,1]
  v_pk_fma_f32 v[114:115], v[72:73], v[116:117], v[114:115] op_sel:[1,0,0] op_sel_hi:[1,1,1] neg_lo:[1,0,0] neg_hi:[1,0,0]
  v_pk_add_f32 v[154:155], v[154:155], v[112:113] op_sel_hi:[1,1]
  v_pk_add_f32 v[218:219], v[218:219], v[114:115] op_sel_hi:[1,1]
  buffer_load_dwordx4 a[24:27], v28, s[8:11], s79 offen offset:1024 sc1
  v_cvt_pk_bf16_f32 v130, v152, v154
  v_cvt_pk_bf16_f32 v134, v153, v155
  v_cvt_pk_bf16_f32 v194, v216, v218
  v_cvt_pk_bf16_f32 v198, v217, v219
  v_pk_mul_f32 v[116:117], v[112:113], v[72:73] op_sel_hi:[1,0]
  v_pk_mul_f32 v[118:119], v[114:115], v[72:73] op_sel_hi:[1,0]
  v_pk_fma_f32 v[116:117], v[72:73], v[114:115], v[116:117] op_sel:[1,0,0] op_sel_hi:[1,1,1]
  buffer_load_dwordx4 a[28:31], v28, s[8:11], s79 offen offset:2048 sc1
  v_pk_fma_f32 v[118:119], v[72:73], v[112:113], v[118:119] op_sel:[1,0,0] op_sel_hi:[1,1,1] neg_lo:[1,0,0] neg_hi:[1,0,0]
  v_pk_add_f32 v[156:157], v[156:157], v[116:117] op_sel_hi:[1,1]
  v_pk_add_f32 v[220:221], v[220:221], v[118:119] op_sel_hi:[1,1]
  ds_write_b128 v69, v[44:47] offset:4096
  v_pk_mul_f32 v[112:113], v[116:117], v[72:73] op_sel_hi:[1,0]
  v_pk_mul_f32 v[114:115], v[118:119], v[72:73] op_sel_hi:[1,0]
  buffer_load_dwordx4 a[32:35], v28, s[8:11], s79 offen offset:3072 sc1
  v_pk_fma_f32 v[112:113], v[72:73], v[118:119], v[112:113] op_sel:[1,0,0] op_sel_hi:[1,1,1]
  v_pk_fma_f32 v[114:115], v[72:73], v[116:117], v[114:115] op_sel:[1,0,0] op_sel_hi:[1,1,1] neg_lo:[1,0,0] neg_hi:[1,0,0]
  v_pk_add_f32 v[158:159], v[158:159], v[112:113] op_sel_hi:[1,1]
  v_pk_add_f32 v[222:223], v[222:223], v[114:115] op_sel_hi:[1,1]
  v_cvt_pk_bf16_f32 v131, v156, v158
  ds_write_b128 v70, v[128:131] offset:0
  buffer_load_dwordx4 a[36:39], v29, s[8:11], s79 offen offset:0 sc1
  v_cvt_pk_bf16_f32 v135, v157, v159
  ds_write_b128 v71, v[132:135] offset:0
  v_cvt_pk_bf16_f32 v195, v220, v222
  ds_write_b128 v70, v[192:195] offset:4096
  v_cvt_pk_bf16_f32 v199, v221, v223
  ds_write_b128 v71, v[196:199] offset:4096
  s_waitcnt lgkmcnt(0)
  v_xor_b32 v2, 0, v11
  ds_read_b64_tr_b16 v[192:193], v2 offset:0
  v_xor_b32 v3, 16, v11
  ds_read_b64_tr_b16 v[194:195], v3 offset:1024
  v_xor_b32 v2, 32, v11
  ds_read_b64_tr_b16 v[196:197], v2 offset:0
  v_xor_b32 v3, 48, v11
  ds_read_b64_tr_b16 v[198:199], v3 offset:1024
  v_xor_b32 v2, 64, v11
  ds_read_b64_tr_b16 v[200:201], v2 offset:0
  v_xor_b32 v3, 80, v11
  ds_read_b64_tr_b16 v[202:203], v3 offset:1024
  v_xor_b32 v2, 96, v11
  ds_read_b64_tr_b16 v[204:205], v2 offset:0
  v_xor_b32 v3, 112, v11
  ds_read_b64_tr_b16 v[206:207], v3 offset:1024
  v_xor_b32 v2, 128, v11
  ds_read_b64_tr_b16 v[208:209], v2 offset:0
  v_xor_b32 v3, 144, v11
  ds_read_b64_tr_b16 v[210:211], v3 offset:1024
  v_xor_b32 v2, 160, v11
  ds_read_b64_tr_b16 v[212:213], v2 offset:0
  v_xor_b32 v3, 176, v11
  ds_read_b64_tr_b16 v[214:215], v3 offset:1024
  v_xor_b32 v2, 192, v11
  ds_read_b64_tr_b16 v[216:217], v2 offset:0
  v_xor_b32 v3, 208, v11
  ds_read_b64_tr_b16 v[218:219], v3 offset:1024
  v_xor_b32 v2, 224, v11
  ds_read_b64_tr_b16 v[220:221], v2 offset:0
  v_xor_b32 v3, 240, v11
  ds_read_b64_tr_b16 v[222:223], v3 offset:1024
  s_waitcnt vmcnt(15)
  v_xor_b32 v4, v17, v49
  v_xor_b32 v5, v17, v51
  v_or_b32 v4, v4, v5
  v_xor_b32 v5, v18, v53
  v_or_b32 v4, v4, v5
  v_xor_b32 v5, v18, v55
  v_or_b32 v4, v4, v5
  v_xor_b32 v5, v19, v57
  v_or_b32 v4, v4, v5
  v_xor_b32 v5, v19, v59
  v_or_b32 v4, v4, v5
  v_xor_b32 v5, v20, v61
  v_or_b32 v4, v4, v5
  v_xor_b32 v5, v20, v63
  v_or_b32 v4, v4, v5
  v_cmp_ne_u32 vcc, 0, v4
  s_cbranch_vccz SSM_go1
  s_mov_b32 s7, 0x40000
SSM_poll1:
  buffer_load_dwordx4 v[48:51], v13, s[8:11], 0 offen offset:256 sc1
  buffer_load_dwordx4 v[52:55], v14, s[8:11], 0 offen offset:256 sc1
  buffer_load_dwordx4 v[56:59], v15, s[8:11], 0 offen offset:256 sc1
  buffer_load_dwordx4 v[60:63], v16, s[8:11], 0 offen offset:256 sc1
  s_waitcnt vmcnt(0)
  v_xor_b32 v4, v17, v49
  v_xor_b32 v5, v17, v51
  v_or_b32 v4, v4, v5
  v_xor_b32 v5, v18, v53
  v_or_b32 v4, v4, v5
  v_xor_b32 v5, v18, v55
  v_or_b32 v4, v4, v5
  v_xor_b32 v5, v19, v57
  v_or_b32 v4, v4, v5
  v_xor_b32 v5, v19, v59
  v_or_b32 v4, v4, v5
  v_xor_b32 v5, v20, v61
  v_or_b32 v4, v4, v5
  v_xor_b32 v5, v20, v63
  v_or_b32 v4, v4, v5
  v_cmp_ne_u32 vcc, 0, v4
  s_sub_u32 s7, s7, 1
  s_cbranch_scc1 SSM_go1
  s_cbranch_vccnz SSM_poll1
SSM_go1:
  s_waitcnt lgkmcnt(14)
  buffer_store_dwordx4 v[192:195], v28, s[8:11], s84 offen offset:0 sc1
  v_mov_b32 v66, v190
  v_mov_b32 v67, v254
  v_pk_mul_f32 v[112:113], v[94:95], v[224:225] op_sel:[1,0] op_sel_hi:[1,1]
  v_pk_mul_f32 v[114:115], v[94:95], v[160:161] op_sel:[1,0] op_sel_hi:[1,1]
  v_pk_fma_f32 v[160:161], v[160:161], v[94:95], v[112:113] op_sel_hi:[1,0,1] neg_lo:[0,0,1] neg_hi:[0,0,1]
  v_pk_fma_f32 v[224:225], v[224:225], v[94:95], v[114:115] op_sel_hi:[1,0,1] neg_lo:[0,1,1] neg_hi:[0,1,1]
  v_pk_mul_f32 v[112:113], v[94:95], v[226:227] op_sel:[1,0] op_sel_hi:[1,1]
  v_pk_mul_f32 v[114:115], v[94:95], v[162:163] op_sel:[1,0] op_sel_hi:[1,1]
  v_pk_fma_f32 v[162:163], v[162:163], v[94:95], v[112:113] op_sel_hi:[1,0,1] neg_lo:[0,0,1] neg_hi:[0,0,1]
  v_pk_fma_f32 v[226:227], v[226:227], v[94:95], v[114:115] op_sel_hi:[1,0,1] neg_lo:[0,1,1] neg_hi:[0,1,1]
  v_pk_mul_f32 v[112:113], v[94:95], v[228:229] op_sel:[1,0] op_sel_hi:[1,1]
  v_pk_mul_f32 v[114:115], v[94:95], v[164:165] op_sel:[1,0] op_sel_hi:[1,1]
  v_pk_fma_f32 v[164:165], v[164:165], v[94:95], v[112:113] op_sel_hi:[1,0,1] neg_lo:[0,0,1] neg_hi:[0,0,1]
  v_pk_fma_f32 v[228:229], v[228:229], v[94:95], v[114:115] op_sel_hi:[1,0,1] neg_lo:[0,1,1] neg_hi:[0,1,1]
  v_pk_mul_f32 v[112:113], v[94:95], v[230:231] op_sel:[1,0] op_sel_hi:[1,1]
  v_pk_mul_f32 v[114:115], v[94:95], v[166:167] op_sel:[1,0] op_sel_hi:[1,1]
  v_pk_fma_f32 v[166:167], v[166:167], v[94:95], v[112:113] op_sel_hi:[1,0,1] neg_lo:[0,0,1] neg_hi:[0,0,1]
  v_pk_fma_f32 v[230:231], v[230:231], v[94:95], v[114:115] op_sel_hi:[1,0,1] neg_lo:[0,1,1] neg_hi:[0,1,1]
  v_pk_mul_f32 v[112:113], v[94:95], v[232:233] op_sel:[1,0] op_sel_hi:[1,1]
  v_pk_mul_f32 v[114:115], v[94:95], v[168:169] op_sel:[1,0] op_sel_hi:[1,1]
  v_pk_fma_f32 v[168:169], v[168:169], v[94:95], v[112:113] op_sel_hi:[1,0,1] neg_lo:[0,0,1] neg_hi:[0,0,1]
  v_pk_fma_f32 v[232:233], v[232:233], v[94:95], v[114:115] op_sel_hi:[1,0,1] neg_lo:[0,1,1] neg_hi:[0,1,1]
  v_pk_mul_f32 v[112:113], v[94:95], v[234:235] op_sel:[1,0] op_sel_hi:[1,1]
  v_pk_mul_f32 v[114:115], v[94:95], v[170:171] op_sel:[1,0] op_sel_hi:[1,1]
  v_pk_fma_f32 v[170:171], v[170:171], v[94:95], v[112:113] op_sel_hi:[1,0,1] neg_lo:[0,0,1] neg_hi:[0,0,1]
  v_pk_fma_f32 v[234:235], v[234:235], v[94:95], v[114:115] op_sel_hi:[1,0,1] neg_lo:[0,1,1] neg_hi:[0,1,1]
  v_pk_mul_f32 v[112:113], v[94:95], v[236:237] op_sel:[1,0] op_sel_hi:[1,1]
  v_pk_mul_f32 v[114:115], v[94:95], v[172:173] op_sel:[1,0] op_sel_hi:[1,1]
  v_pk_fma_f32 v[172:173], v[172:173], v[94:95], v[112:113] op_sel_hi:[1,0,1] neg_lo:[0,0,1] neg_hi:[0,0,1]
  s_waitcnt lgkmcnt(12)
  buffer_store_dwordx4 v[196:199], v28, s[8:11], s84 offen offset:1024 sc1
  v_pk_fma_f32 v[236:237], v[236:237], v[94:95], v[114:115] op_sel_hi:[1,0,1] neg_lo:[0,1,1] neg_hi:[0,1,1]
  v_pk_mul_f32 v[112:113], v[94:95], v[238:239] op_sel:[1,0] op_sel_hi:[1,1]
  v_pk_mul_f32 v[114:115], v[94:95], v[174:175] op_sel:[1,0] op_sel_hi:[1,1]
  v_pk_fma_f32 v[174:175], v[174:175], v[94:95], v[112:113] op_sel_hi:[1,0,1] neg_lo:[0,0,1] neg_hi:[0,0,1]
  v_pk_fma_f32 v[238:239], v[238:239], v[94:95], v[114:115] op_sel_hi:[1,0,1] neg_lo:[0,1,1] neg_hi:[0,1,1]
  v_pk_mul_f32 v[112:113], v[94:95], v[240:241] op_sel:[1,0] op_sel_hi:[1,1]
  v_pk_mul_f32 v[114:115], v[94:95], v[176:177] op_sel:[1,0] op_sel_hi:[1,1]
  v_pk_fma_f32 v[176:177], v[176:177], v[94:95], v[112:113] op_sel_hi:[1,0,1] neg_lo:[0,0,1] neg_hi:[0,0,1]
  v_pk_fma_f32 v[240:241], v[240:241], v[94:95], v[114:115] op_sel_hi:[1,0,1] neg_lo:[0,1,1] neg_hi:[0,1,1]
  v_pk_mul_f32 v[112:113], v[94:95], v[242:243] op_sel:[1,0] op_sel_hi:[1,1]
  v_pk_mul_f32 v[114:115], v[94:95], v[178:179] op_sel:[1,0] op_sel_hi:[1,1]
  v_pk_fma_f32 v[178:179], v[178:179], v[94:95], v[112:113] op_sel_hi:[1,0,1] neg_lo:[0,0,1] neg_hi:[0,0,1]
  v_pk_fma_f32 v[242:243], v[242:243], v[94:95], v[114:115] op_sel_hi:[1,0,1] neg_lo:[0,1,1] neg_hi:[0,1,1]
  v_pk_mul_f32 v[112:113], v[94:95], v[244:245] op_sel:[1,0] op_sel_hi:[1,1]
  v_pk_mul_f32 v[114:115], v[94:95], v[180:181] op_sel:[1,0] op_sel_hi:[1,1]
  v_pk_fma_f32 v[180:181], v[180:181], v[94:95], v[112:113] op_sel_hi:[1,0,1] neg_lo:[0,0,1] neg_hi:[0,0,1]
  v_pk_fma_f32 v[244:245], v[244:245], v[94:95], v[114:115] op_sel_hi:[1,0,1] neg_lo:[0,1,1] neg_hi:[0,1,1]
  v_pk_mul_f32 v[112:113], v[94:95], v[246:247] op_sel:[1,0] op_sel_hi:[1,1]
  v_pk_mul_f32 v[114:115], v[94:95], v[182:183] op_sel:[1,0] op_sel_hi:[1,1]
  v_pk_fma_f32 v[182:183], v[182:183], v[94:95], v[112:113] op_sel_hi:[1,0,1] neg_lo:[0,0,1] neg_hi:[0,0,1]
  v_pk_fma_f32 v[246:247], v[246:247], v[94:95], v[114:115] op_sel_hi:[1,0,1] neg_lo:[0,1,1] neg_hi:[0,1,1]
  v_pk_mul_f32 v[112:113], v[94:95], v[248:249] op_sel:[1,0] op_sel_hi:[1,1]
  v_pk_mul_f32 v[114:115], v[94:95], v[184:185] op_sel:[1,0] op_sel_hi:[1,1]
  v_pk_fma_f32 v[184:185], v[184:185], v[94:95], v[112:113] op_sel_hi:[1,0,1] neg_lo:[0,0,1] neg_hi:[0,0,1]
  v_pk_fma_f32 v[248:249], v[248:249], v[94:95], v[114:115] op_sel_hi:[1,0,1] neg_lo:[0,1,1] neg_hi:[0,1,1]
  v_pk_mul_f32 v[112:113], v[94:95], v[250:251] op_sel:[1,0] op_sel_hi:[1,1]
  v_pk_mul_f32 v[114:115], v[94:95], v[186:187] op_sel:[1,0] op_sel_hi:[1,1]
  v_pk_fma_f32 v[186:187], v[186:187], v[94:95], v[112:113] op_sel_hi:[1,0,1] neg_lo:[0,0,1] neg_hi:[0,0,1]
  v_pk_fma_f32 v[250:251], v[250:251], v[94:95], v[114:115] op_sel_hi:[1,0,1] neg_lo:[0,1,1] neg_hi:[0,1,1]
  v_pk_mul_f32 v[112:113], v[94:95], v[252:253] op_sel:[1,0] op_sel_hi:[1,1]
  s_waitcnt lgkmcnt(10)
  buffer_store_dwordx4 v[200:203], v28, s[8:11], s84 offen offset:2048 sc1
  v_pk_mul_f32 v[114:115], v[94:95], v[188:189] op_sel:[1,0] op_sel_hi:[1,1]
  v_pk_fma_f32 v[188:189], v[188:189], v[94:95], v[112:113] op_sel_hi:[1,0,1] neg_lo:[0,0,1] neg_hi:[0,0,1]
  v_pk_fma_f32 v[252:253], v[252:253], v[94:95], v[114:115] op_sel_hi:[1,0,1] neg_lo:[0,1,1] neg_hi:[0,1,1]
  v_pk_mul_f32 v[112:113], v[94:95], v[254:255] op_sel:[1,0] op_sel_hi:[1,1]
  v_pk_mul_f32 v[114:115], v[94:95], v[190:191] op_sel:[1,0] op_sel_hi:[1,1]
  v_pk_fma_f32 v[190:191], v[190:191], v[94:95], v[112:113] op_sel_hi:[1,0,1] neg_lo:[0,0,1] neg_hi:[0,0,1]
  v_pk_fma_f32 v[254:255], v[254:255], v[94:95], v[114:115] op_sel_hi:[1,0,1] neg_lo:[0,1,1] neg_hi:[0,1,1]
  v_fma_f32 v56, v100, v60, v56
  v_fma_f32 v58, v100, v62, v58
  v_fma_f32 v56, -v101, v62, v56
  v_fma_f32 v58, v101, v60, v58
  v_fma_f32 v52, v100, v56, v52
  v_fma_f32 v54, v100, v58, v54
  v_fma_f32 v52, -v101, v58, v52
  v_fma_f32 v54, v101, v56, v54
  v_fma_f32 v48, v100, v52, v48
  v_fma_f32 v50, v100, v54, v50
  v_fma_f32 v48, -v101, v54, v48
  v_fma_f32 v50, v101, v52, v50
  v_mul_f32 v52, v106, v48
  v_mul_f32 v53, v106, v50
  v_fma_f32 v52, -v107, v50, v52
  v_fmac_f32 v53, v107, v48
  v_mov_b32 v4, v52
  v_mov_b32 v5, v53
  s_nop 0
  v_permlane16_swap_b32 v52, v4
  v_permlane16_swap_b32 v53, v5
  v_add_f32 v52, v52, v4
  v_add_f32 v53, v53, v5
  v_mov_b32 v4, v52
  s_waitcnt lgkmcnt(8)
  buffer_store_dwordx4 v[204:207], v28, s[8:11], s84 offen offset:3072 sc1
  v_mov_b32 v5, v53
  v_permlane32_swap_b32 v52, v4
  s_nop 0
  v_permlane32_swap_b32 v53, v5
  v_add_f32 v52, v52, v4
  v_add_f32 v53, v53, v5
  v_fma_f32 v108, v102, v52, v108
  v_fma_f32 v109, v102, v53, v109
  v_fma_f32 v108, -v103, v53, v108
  v_fma_f32 v109, v103, v52, v109
  v_fma_f32 v66, v96, v108, v66
  v_fma_f32 v67, v96, v109, v67
  v_fma_f32 v66, -v97, v109, v66
  v_fma_f32 v67, v97, v108, v67
  v_mul_f32 v110, v95, v109
  v_mul_f32 v111, v95, v108
  v_fma_f32 v112, v94, v108, -v110
  v_fma_f32 v114, -v94, v109, -v111
  v_mul_f32 v110, v95, v67
  v_mul_f32 v111, v95, v66
  v_fma_f32 v113, v94, v66, -v110
  v_fma_f32 v115, -v94, v67, -v111
  v_pk_mul_f32 v[116:117], v[112:113], v[92:93] op_sel_hi:[1,0]
  v_pk_mul_f32 v[118:119], v[114:115], v[92:93] op_sel_hi:[1,0]
  v_pk_fma_f32 v[116:117], v[92:93], v[114:115], v[116:117] op_sel:[1,0,0] op_sel_hi:[1,1,1]
  v_pk_fma_f32 v[118:119], v[92:93], v[112:113], v[118:119] op_sel:[1,0,0] op_sel_hi:[1,1,1] neg_lo:[1,0,0] neg_hi:[1,0,0]
  v_pk_add_f32 v[160:161], v[160:161], v[116:117] op_sel_hi:[1,1]
  v_pk_add_f32 v[224:225], v[224:225], v[118:119] op_sel_hi:[1,1]
  v_pk_mul_f32 v[112:113], v[116:117], v[92:93] op_sel_hi:[1,0]
  v_pk_mul_f32 v[114:115], v[118:119], v[92:93] op_sel_hi:[1,0]
  v_pk_fma_f32 v[112:113], v[92:93], v[118:119], v[112:113] op_sel:[1,0,0] op_sel_hi:[1,1,1]
  s_waitcnt lgkmcnt(6)
  buffer_store_dwordx4 v[208:211], v28, s[8:11], s86 offen offset:0 sc1
  v_pk_fma_f32 v[114:115], v[92:93], v[116:117], v[114:115] op_sel:[1,0,0] op_sel_hi:[1,1,1] neg_lo:[1,0,0] neg_hi:[1,0,0]
  v_pk_add_f32 v[162:163], v[162:163], v[112:113] op_sel_hi:[1,1]
  v_pk_add_f32 v[226:227], v[226:227], v[114:115] op_sel_hi:[1,1]
  v_cvt_pk_bf16_f32 v48, v160, v162
  v_cvt_pk_bf16_f32 v52, v161, v163
  v_cvt_pk_bf16_f32 v56, v224, v226
  v_cvt_pk_bf16_f32 v60, v225, v227
  v_pk_mul_f32 v[116:117], v[112:113], v[92:93] op_sel_hi:[1,0]
  v_pk_mul_f32 v[118:119], v[114:115], v[92:93] op_sel_hi:[1,0]
  v_pk_fma_f32 v[116:117], v[92:93], v[114:115], v[116:117] op_sel:[1,0,0] op_sel_hi:[1,1,1]
  v_pk_fma_f32 v[118:119], v[92:93], v[112:113], v[118:119] op_sel:[1,0,0] op_sel_hi:[1,1,1] neg_lo:[1,0,0] neg_hi:[1,0,0]
  v_pk_add_f32 v[164:165], v[164:165], v[116:117] op_sel_hi:[1,1]
  v_pk_add_f32 v[228:229], v[228:229], v[118:119] op_sel_hi:[1,1]
  v_pk_mul_f32 v[112:113], v[116:117], v[92:93] op_sel_hi:[1,0]
  v_pk_mul_f32 v[114:115], v[118:119], v[92:93] op_sel_hi:[1,0]
  v_pk_fma_f32 v[112:113], v[92:93], v[118:119], v[112:113] op_sel:[1,0,0] op_sel_hi:[1,1,1]
  v_pk_fma_f32 v[114:115], v[92:93], v[116:117], v[114:115] op_sel:[1,0,0] op_sel_hi:[1,1,1] neg_lo:[1,0,0] neg_hi:[1,0,0]
  v_pk_add_f32 v[166:167], v[166:167], v[112:113] op_sel_hi:[1,1]
  v_pk_add_f32 v[230:231], v[230:231], v[114:115] op_sel_hi:[1,1]
  v_cvt_pk_bf16_f32 v49, v164, v166
  v_cvt_pk_bf16_f32 v53, v165, v167
  v_cvt_pk_bf16_f32 v57, v228, v230
  v_cvt_pk_bf16_f32 v61, v229, v231
  v_pk_mul_f32 v[116:117], v[112:113], v[92:93] op_sel_hi:[1,0]
  v_pk_mul_f32 v[118:119], v[114:115], v[92:93] op_sel_hi:[1,0]
  v_pk_fma_f32 v[116:117], v[92:93], v[114:115], v[116:117] op_sel:[1,0,0] op_sel_hi:[1,1,1]
  v_pk_fma_f32 v[118:119], v[92:93], v[112:113], v[118:119] op_sel:[1,0,0] op_sel_hi:[1,1,1] neg_lo:[1,0,0] neg_hi:[1,0,0]
  v_pk_add_f32 v[168:169], v[168:169], v[116:117] op_sel_hi:[1,1]
  v_pk_add_f32 v[232:233], v[232:233], v[118:119] op_sel_hi:[1,1]
  v_pk_mul_f32 v[112:113], v[116:117], v[92:93] op_sel_hi:[1,0]
  s_waitcnt lgkmcnt(4)
  buffer_store_dwordx4 v[212:215], v28, s[8:11], s86 offen offset:1024 sc1
  v_pk_mul_f32 v[114:115], v[118:119], v[92:93] op_sel_hi:[1,0]
  v_pk_fma_f32 v[112:113], v[92:93], v[118:119], v[112:113] op_sel:[1,0,0] op_sel_hi:[1,1,1]
  v_pk_fma_f32 v[114:115], v[92:93], v[116:117], v[114:115] op_sel:[1,0,0] op_sel_hi:[1,1,1] neg_lo:[1,0,0] neg_hi:[1,0,0]
  v_pk_add_f32 v[170:171], v[170:171], v[112:113] op_sel_hi:[1,1]
  v_pk_add_f32 v[234:235], v[234:235], v[114:115] op_sel_hi:[1,1]
  v_cvt_pk_bf16_f32 v50, v168, v170
  v_cvt_pk_bf16_f32 v54, v169, v171
  v_cvt_pk_bf16_f32 v58, v232, v234
  v_cvt_pk_bf16_f32 v62, v233, v235
  v_pk_mul_f32 v[116:117], v[112:113], v[92:93] op_sel_hi:[1,0]
  v_pk_mul_f32 v[118:119], v[114:115], v[92:93] op_sel_hi:[1,0]
  v_pk_fma_f32 v[116:117], v[92:93], v[114:115], v[116:117] op_sel:[1,0,0] op_sel_hi:[1,1,1]
  v_pk_fma_f32 v[118:119], v[92:93], v[112:113], v[118:119] op_sel:[1,0,0] op_sel_hi:[1,1,1] neg_lo:[1,0,0] neg_hi:[1,0,0]
  v_pk_add_f32 v[172:173], v[172:173], v[116:117] op_sel_hi:[1,1]
  v_pk_add_f32 v[236:237], v[236:237], v[118:119] op_sel_hi:[1,1]
  v_pk_mul_f32 v[112:113], v[116:117], v[92:93] op_sel_hi:[1,0]
  v_pk_mul_f32 v[114:115], v[118:119], v[92:93] op_sel_hi:[1,0]
  v_pk_fma_f32 v[112:113], v[92:93], v[118:119], v[112:113] op_sel:[1,0,0] op_sel_hi:[1,1,1]
  v_pk_fma_f32 v[114:115], v[92:93], v[116:117], v[114:115] op_sel:[1,0,0] op_sel_hi:[1,1,1] neg_lo:[1,0,0] neg_hi:[1,0,0]
  v_pk_add_f32 v[174:175], v[174:175], v[112:113] op_sel_hi:[1,1]
  v_pk_add_f32 v[238:239], v[238:239], v[114:115] op_sel_hi:[1,1]
  v_cvt_pk_bf16_f32 v51, v172, v174
  v_cvt_pk_bf16_f32 v55, v173, v175
  v_cvt_pk_bf16_f32 v59, v236, v238
  v_cvt_pk_bf16_f32 v63, v237, v239
  v_pk_mul_f32 v[116:117], v[112:113], v[92:93] op_sel_hi:[1,0]
  v_pk_mul_f32 v[118:119], v[114:115], v[92:93] op_sel_hi:[1,0]
  v_pk_fma_f32 v[116:117], v[92:93], v[114:115], v[116:117] op_sel:[1,0,0] op_sel_hi:[1,1,1]
  v_pk_fma_f32 v[118:119], v[92:93], v[112:113], v[118:119] op_sel:[1,0,0] op_sel_hi:[1,1,1] neg_lo:[1,0,0] neg_hi:[1,0,0]
  v_pk_add_f32 v[176:177], v[176:177], v[116:117] op_sel_hi:[1,1]
  s_waitcnt lgkmcnt(2)
  buffer_store_dwordx4 v[216:219], v28, s[8:11], s86 offen offset:2048 sc1
  v_pk_add_f32 v[240:241], v[240:241], v[118:119] op_sel_hi:[1,1]
  ds_write_b128 v68, v[48:51] offset:8192
  v_pk_mul_f32 v[112:113], v[116:117], v[92:93] op_sel_hi:[1,0]
  v_pk_mul_f32 v[114:115], v[118:119], v[92:93] op_sel_hi:[1,0]
  v_pk_fma_f32 v[112:113], v[92:93], v[118:119], v[112:113] op_sel:[1,0,0] op_sel_hi:[1,1,1]
  v_pk_fma_f32 v[114:115], v[92:93], v[116:117], v[114:115] op_sel:[1,0,0] op_sel_hi:[1,1,1] neg_lo:[1,0,0] neg_hi:[1,0,0]
  v_pk_add_f32 v[178:179], v[178:179], v[112:113] op_sel_hi:[1,1]
  v_pk_add_f32 v[242:243], v[242:243], v[114:115] op_sel_hi:[1,1]
  v_cvt_pk_bf16_f32 v160, v176, v178
  v_cvt_pk_bf16_f32 v164, v177, v179
  v_cvt_pk_bf16_f32 v224, v240, v242
  v_cvt_pk_bf16_f32 v228, v241, v243
  v_pk_mul_f32 v[116:117], v[112:113], v[92:93] op_sel_hi:[1,0]
  v_pk_mul_f32 v[118:119], v[114:115], v[92:93] op_sel_hi:[1,0]
  v_pk_fma_f32 v[116:117], v[92:93], v[114:115], v[116:117] op_sel:[1,0,0] op_sel_hi:[1,1,1]
  v_pk_fma_f32 v[118:119], v[92:93], v[112:113], v[118:119] op_sel:[1,0,0] op_sel_hi:[1,1,1] neg_lo:[1,0,0] neg_hi:[1,0,0]
  v_pk_add_f32 v[180:181], v[180:181], v[116:117] op_sel_hi:[1,1]
  v_pk_add_f32 v[244:245], v[244:245], v[118:119] op_sel_hi:[1,1]
  ds_write_b128 v69, v[52:55] offset:8192
  v_pk_mul_f32 v[112:113], v[116:117], v[92:93] op_sel_hi:[1,0]
  v_pk_mul_f32 v[114:115], v[118:119], v[92:93] op_sel_hi:[1,0]
  v_pk_fma_f32 v[112:113], v[92:93], v[118:119], v[112:113] op_sel:[1,0,0] op_sel_hi:[1,1,1]
  v_pk_fma_f32 v[114:115], v[92:93], v[116:117], v[114:115] op_sel:[1,0,0] op_sel_hi:[1,1,1] neg_lo:[1,0,0] neg_hi:[1,0,0]
  v_pk_add_f32 v[182:183], v[182:183], v[112:113] op_sel_hi:[1,1]
  v_pk_add_f32 v[246:247], v[246:247], v[114:115] op_sel_hi:[1,1]
  v_cvt_pk_bf16_f32 v161, v180, v182
  v_cvt_pk_bf16_f32 v165, v181, v183
  v_cvt_pk_bf16_f32 v225, v244, v246
  v_cvt_pk_bf16_f32 v229, v245, v247
  v_pk_mul_f32 v[116:117], v[112:113], v[92:93] op_sel_hi:[1,0]
  s_waitcnt lgkmcnt(2)
  buffer_store_dwordx4 v[220:223], v28, s[8:11], s86 offen offset:3072 sc1
  v_pk_mul_f32 v[118:119], v[114:115], v[92:93] op_sel_hi:[1,0]
  v_pk_fma_f32 v[116:117], v[92:93], v[114:115], v[116:117] op_sel:[1,0,0] op_sel_hi:[1,1,1]
  v_pk_fma_f32 v[118:119], v[92:93], v[112:113], v[118:119] op_sel:[1,0,0] op_sel_hi:[1,1,1] neg_lo:[1,0,0] neg_hi:[1,0,0]
  v_pk_add_f32 v[184:185], v[184:185], v[116:117] op_sel_hi:[1,1]
  v_pk_add_f32 v[248:249], v[248:249], v[118:119] op_sel_hi:[1,1]
  ds_write_b128 v68, v[56:59] offset:12288
  v_pk_mul_f32 v[112:113], v[116:117], v[92:93] op_sel_hi:[1,0]
  v_pk_mul_f32 v[114:115], v[118:119], v[92:93] op_sel_hi:[1,0]
  v_pk_fma_f32 v[112:113], v[92:93], v[118:119], v[112:113] op_sel:[1,0,0] op_sel_hi:[1,1,1]
  v_pk_fma_f32 v[114:115], v[92:93], v[116:117], v[114:115] op_sel:[1,0,0] op_sel_hi:[1,1,1] neg_lo:[1,0,0] neg_hi:[1,0,0]
  v_pk_add_f32 v[186:187], v[186:187], v[112:113] op_sel_hi:[1,1]
  v_pk_add_f32 v[250:251], v[250:251], v[114:115] op_sel_hi:[1,1]
  v_cvt_pk_bf16_f32 v162, v184, v186
  v_cvt_pk_bf16_f32 v166, v185, v187
  v_cvt_pk_bf16_f32 v226, v248, v250
  v_cvt_pk_bf16_f32 v230, v249, v251
  v_pk_mul_f32 v[116:117], v[112:113], v[92:93] op_sel_hi:[1,0]
  v_pk_mul_f32 v[118:119], v[114:115], v[92:93] op_sel_hi:[1,0]
  v_pk_fma_f32 v[116:117], v[92:93], v[114:115], v[116:117] op_sel:[1,0,0] op_sel_hi:[1,1,1]
  v_pk_fma_f32 v[118:119], v[92:93], v[112:113], v[118:119] op_sel:[1,0,0] op_sel_hi:[1,1,1] neg_lo:[1,0,0] neg_hi:[1,0,0]
  v_pk_add_f32 v[188:189], v[188:189], v[116:117] op_sel_hi:[1,1]
  v_pk_add_f32 v[252:253], v[252:253], v[118:119] op_sel_hi:[1,1]
  ds_write_b128 v69, v[60:63] offset:12288
  v_pk_mul_f32 v[112:113], v[116:117], v[92:93] op_sel_hi:[1,0]
  v_pk_mul_f32 v[114:115], v[118:119], v[92:93] op_sel_hi:[1,0]
  v_pk_fma_f32 v[112:113], v[92:93], v[118:119], v[112:113] op_sel:[1,0,0] op_sel_hi:[1,1,1]
  v_pk_fma_f32 v[114:115], v[92:93], v[116:117], v[114:115] op_sel:[1,0,0] op_sel_hi:[1,1,1] neg_lo:[1,0,0] neg_hi:[1,0,0]
  v_pk_add_f32 v[190:191], v[190:191], v[112:113] op_sel_hi:[1,1]
  v_pk_add_f32 v[254:255], v[254:255], v[114:115] op_sel_hi:[1,1]
  v_cvt_pk_bf16_f32 v163, v188, v190
  ds_write_b128 v70, v[160:163] offset:8192
  v_cvt_pk_bf16_f32 v167, v189, v191
  ds_write_b128 v71, v[164:167] offset:8192
  v_cvt_pk_bf16_f32 v227, v252, v254
  ds_write_b128 v70, v[224:227] offset:12288
  v_cvt_pk_bf16_f32 v231, v253, v255
  ds_write_b128 v71, v[228:231] offset:12288
  s_waitcnt lgkmcnt(0)
  v_xor_b32 v2, 0, v11
  ds_read_b64_tr_b16 v[224:225], v2 offset:8192
  v_xor_b32 v3, 16, v11
  ds_read_b64_tr_b16 v[226:227], v3 offset:9216
  v_xor_b32 v2, 32, v11
  ds_read_b64_tr_b16 v[228:229], v2 offset:8192
  v_xor_b32 v3, 48, v11
  ds_read_b64_tr_b16 v[230:231], v3 offset:9216
  v_xor_b32 v2, 64, v11
  ds_read_b64_tr_b16 v[232:233], v2 offset:8192
  v_xor_b32 v3, 80, v11
  ds_read_b64_tr_b16 v[234:235], v3 offset:9216
  v_xor_b32 v2, 96, v11
  ds_read_b64_tr_b16 v[236:237], v2 offset:8192
  v_xor_b32 v3, 112, v11
  ds_read_b64_tr_b16 v[238:239], v3 offset:9216
  v_xor_b32 v2, 128, v11
  ds_read_b64_tr_b16 v[240:241], v2 offset:8192
  v_xor_b32 v3, 144, v11
  ds_read_b64_tr_b16 v[242:243], v3 offset:9216
  v_xor_b32 v2, 160, v11
  ds_read_b64_tr_b16 v[244:245], v2 offset:8192
  v_xor_b32 v3, 176, v11
  ds_read_b64_tr_b16 v[246:247], v3 offset:9216
  v_xor_b32 v2, 192, v11
  ds_read_b64_tr_b16 v[248:249], v2 offset:8192
  v_xor_b32 v3, 208, v11
  ds_read_b64_tr_b16 v[250:251], v3 offset:9216
  v_xor_b32 v2, 224, v11
  ds_read_b64_tr_b16 v[252:253], v2 offset:8192
  v_xor_b32 v3, 240, v11
  ds_read_b64_tr_b16 v[254:255], v3 offset:9216
  s_waitcnt lgkmcnt(14)
  buffer_store_dwordx4 v[224:227], v28, s[8:11], s85 offen offset:0 sc1
  s_waitcnt lgkmcnt(12)
  buffer_store_dwordx4 v[228:231], v28, s[8:11], s85 offen offset:1024 sc1
  s_waitcnt lgkmcnt(10)
  buffer_store_dwordx4 v[232:235], v28, s[8:11], s85 offen offset:2048 sc1
  s_waitcnt lgkmcnt(8)
  buffer_store_dwordx4 v[236:239], v28, s[8:11], s85 offen offset:3072 sc1
  s_waitcnt lgkmcnt(6)
  buffer_store_dwordx4 v[240:243], v28, s[8:11], s78 offen offset:0 sc1
  s_waitcnt lgkmcnt(4)
  buffer_store_dwordx4 v[244:247], v28, s[8:11], s78 offen offset:1024 sc1
  s_waitcnt lgkmcnt(2)
  buffer_store_dwordx4 v[248:251], v28, s[8:11], s78 offen offset:2048 sc1
  s_waitcnt lgkmcnt(0)
  buffer_store_dwordx4 v[252:255], v28, s[8:11], s78 offen offset:3072 sc1
  s_mov_b32 s24, s52
  s_mov_b32 s25, s53
  s_mov_b32 s26, 0x500
  s_mov_b32 s27, 0x20000
  s_mov_b32 s20, s62
  s_mov_b32 s21, s63
  s_mov_b32 s22, 0x500000
  s_mov_b32 s23, 0x20000
  s_lshl1_add_u32 s32, s80, s28
  s_lshl_b32 s32, s32, 6
  s_lshl_b32 s33, s3, 4
  s_add_u32 s32, s32, s33
  v_and_b32 v2, 12, v1
  v_lshrrev_b32 v3, 4, v1
  v_add_u32 v2, v2, v3
  v_mul_u32_u24 v12, 160, v2
  v_add_u32 v2, s32, v2
  v_lshrrev_b32 v15, 3, v2
  v_lshlrev_b32 v15, 7, v15
  v_and_b32 v3, 7, v2
  v_lshl_add_u32 v15, v3, 3, v15
  v_mul_u32_u24 v2, 2560, v2
  s_mul_i32 s98, s81, 160
  s_mul_i32 s97, s32, 1280
  s_add_u32 s97, s97, s98
  s_lshl_b32 s33, s98, 1
  v_and_b32 v3, 3, v1
  v_lshl_add_u32 v13, v3, 4, v2
  v_add_u32 v13, s33, v13
  s_mul_i32 s101, s3, 20480
  s_add_u32 s100, s101, 81920
  v_lshl_add_u32 v14, v3, 3, s100
  v_add_u32 v12, v12, v14
  s_movk_i32 s33, 6554
  v_add_u32 v2, 0, v1
  v_min_u32 v2, 159, v2
  v_mul_u32_u24 v3, s33, v2
  v_lshrrev_b32 v3, 16, v3
  v_mul_u32_u24 v3, 1120, v3
  v_lshl_add_u32 v16, v2, 4, v3
  v_add_u32 v2, 64, v1
  v_min_u32 v2, 159, v2
  v_mul_u32_u24 v3, s33, v2
  v_lshrrev_b32 v3, 16, v3
  v_mul_u32_u24 v3, 1120, v3
  v_lshl_add_u32 v17, v2, 4, v3
  v_add_u32 v2, 128, v1
  v_min_u32 v2, 159, v2
  v_mul_u32_u24 v3, s33, v2
  v_lshrrev_b32 v3, 16, v3
  v_mul_u32_u24 v3, 1120, v3
  v_lshl_add_u32 v18, v2, 4, v3
  v_min_u32 v19, 144, v28
  s_mul_i32 s75, s3, 5120
  v_add_u32 v23, s75, v28
  v_add_u32 v24, 40960, v23
TS_17:
  s_cbranch_execz TR_S
  s_mul_i32 s4, s95, 5120
  s_add_u32 s4, s4, 5242880
  s_xor_b32 s5, s95, 4
  s_mul_i32 s5, s5, 5120
  s_add_u32 s5, s5, 5242880
  s_lshl_b32 s6, s95, 7
  s_add_u32 s6, s6, 524288
  s_add_u32 m0, s100, 0
  s_nop 0
  buffer_load_dwordx4 v16, s[16:19], s97 offen lds
  s_add_u32 m0, s100, 1024
  s_nop 0
  buffer_load_dwordx4 v17, s[16:19], s97 offen lds
  s_add_u32 m0, s100, 2048
  s_nop 0
  buffer_load_dwordx4 v18, s[16:19], s97 offen lds
  s_add_u32 m0, s100, 3072
  s_nop 0
  buffer_load_dwordx4 v19, s[24:27], s98 offen lds
  s_mov_b32 s75, 196608
  buffer_load_dwordx2 v[10:11], v15, s[8:11], s75 offen sc1
  s_add_u32 s79, s82, 25600
  buffer_load_dwordx4 a[40:43], v28, s[8:11], s79 offen offset:0 sc1
  buffer_load_dwordx4 a[44:47], v28, s[8:11], s79 offen offset:1024 sc1
  buffer_load_dwordx4 a[48:51], v28, s[8:11], s79 offen offset:2048 sc1
  buffer_load_dwordx4 a[52:55], v28, s[8:11], s79 offen offset:3072 sc1
  buffer_load_dwordx4 a[56:59], v29, s[8:11], s79 offen offset:0 sc1
  s_add_u32 s79, s82, 30720
  buffer_load_dwordx4 a[60:63], v28, s[8:11], s79 offen offset:0 sc1
  buffer_load_dwordx4 a[64:67], v28, s[8:11], s79 offen offset:1024 sc1
  buffer_load_dwordx4 a[68:71], v28, s[8:11], s79 offen offset:2048 sc1
  buffer_load_dwordx4 a[72:75], v28, s[8:11], s79 offen offset:3072 sc1
  buffer_load_dwordx4 a[76:79], v29, s[8:11], s79 offen offset:0 sc1
  s_mul_i32 s31, s28, 22
  s_mul_i32 s32, s3, 6
  s_add_u32 s31, s31, s32
  s_min_u32 s31, s31, 38
  s_lshl_b32 s31, s31, 7
  s_add_u32 s31, s31, s93
  v_min_u32 v9, 5, v1
  v_lshlrev_b32 v9, 7, v9
  buffer_load_dword v9, v9, s[8:11], s31 offen sc1
  s_waitcnt vmcnt(16)
  buffer_store_dword v31, v8, s[8:11], s87 offen sc1
  s_waitcnt vmcnt(12)
  s_cmp_lg_u32 s95, 0
  s_cbranch_scc1 EP_end
  v_accvgpr_read_b32 v68, a80
  v_accvgpr_read_b32 v69, a81
  v_accvgpr_read_b32 v70, a82
  v_accvgpr_read_b32 v71, a83
  v_xor_b32 v4, s96, v68
  v_xor_b32 v5, s96, v69
  v_or_b32 v4, v4, v5
  v_xor_b32 v5, s96, v70
  v_or_b32 v4, v4, v5
  v_xor_b32 v5, s96, v71
  v_or_b32 v4, v4, v5
  v_cmp_ne_u32 vcc, 0, v4
  s_cbranch_vccz EP_ok
  v_lshlrev_b32 v2, 7, v1
  s_mov_b32 s7, 0x40000
EP_l:
  s_mov_b32 s75, 196612
  buffer_load_dword v68, v2, s[8:11], s75 offen sc1
  s_mov_b32 s75, 204804
  buffer_load_dword v69, v2, s[8:11], s75 offen sc1
  s_mov_b32 s75, 212996
  buffer_load_dword v70, v2, s[8:11], s75 offen sc1
  s_mov_b32 s75, 221188
  buffer_load_dword v71, v2, s[8:11], s75 offen sc1
  s_waitcnt vmcnt(0)
  v_xor_b32 v4, s96, v68
  v_xor_b32 v5, s96, v69
  v_or_b32 v4, v4, v5
  v_xor_b32 v5, s96, v70
  v_or_b32 v4, v4, v5
  v_xor_b32 v5, s96, v71
  v_or_b32 v4, v4, v5
  v_cmp_ne_u32 vcc, 0, v4
  s_sub_u32 s7, s7, 1
  s_cbranch_scc1 EP_ok
  s_cbranch_vccnz EP_l
EP_ok:
  s_mov_b32 s75, 163840
  buffer_store_dword v31, v8, s[8:11], s75 offen sc1
EP_end:
  v_xor_b32 v4, s96, v11
  v_cmp_ne_u32 vcc, 0, v4
  s_cbranch_vccz FGS_ok
  s_mov_b32 s7, 0x40000
FGS_l:
  s_mov_b32 s75, 196608
  buffer_load_dwordx2 v[10:11], v15, s[8:11], s75 offen sc1
  s_waitcnt vmcnt(0)
  v_xor_b32 v4, s96, v11
  v_cmp_ne_u32 vcc, 0, v4
  s_sub_u32 s7, s7, 1
  s_cbranch_scc1 FGS_ok
  s_cbranch_vccnz FGS_l
FGS_ok:
  ds_read_b64 v[96:97], v12 offset:0
  ds_read_b64 v[98:99], v14 offset:3072
  ds_read_b64 v[104:105], v12 offset:32
  ds_read_b64 v[106:107], v14 offset:3104
  ds_read_b64 v[112:113], v12 offset:64
  ds_read_b64 v[114:115], v14 offset:3136
  ds_read_b64 v[120:121], v12 offset:96
  ds_read_b64 v[122:123], v14 offset:3168
  ds_read_b64 v[128:129], v12 offset:128
  ds_read_b64 v[130:131], v14 offset:3200
  v_and_b32 v16, 0xffff0000, v10
  v_rcp_f32 v16, v16
  v_lshlrev_b32 v10, 16, v10
  s_waitcnt lgkmcnt(0)
  v_lshlrev_b32 v100, 16, v96
  v_and_b32 v101, 0xffff0000, v96
  v_lshlrev_b32 v18, 16, v98
  v_and_b32 v19, 0xffff0000, v98
  v_pk_add_f32 v[20:21], v[100:101], v[10:11] op_sel_hi:[1,0] neg_lo:[0,1] neg_hi:[0,1]
  v_pk_mul_f32 v[18:19], v[18:19], v[16:17] op_sel_hi:[1,0]
  v_pk_fma_f32 v[100:101], v[20:21], v[18:19], v[100:101] op_sel_hi:[1,1,1]
  v_accvgpr_write_b32 a80, v100
  v_accvgpr_write_b32 a81, v101
  v_lshlrev_b32 v102, 16, v97
  v_and_b32 v103, 0xffff0000, v97
  v_lshlrev_b32 v18, 16, v99
  v_and_b32 v19, 0xffff0000, v99
  v_pk_add_f32 v[20:21], v[102:103], v[10:11] op_sel_hi:[1,0] neg_lo:[0,1] neg_hi:[0,1]
  v_pk_mul_f32 v[18:19], v[18:19], v[16:17] op_sel_hi:[1,0]
  v_pk_fma_f32 v[102:103], v[20:21], v[18:19], v[102:103] op_sel_hi:[1,1,1]
  v_accvgpr_write_b32 a82, v102
  v_accvgpr_write_b32 a83, v103
  v_lshlrev_b32 v108, 16, v104
  v_and_b32 v109, 0xffff0000, v104
  v_lshlrev_b32 v18, 16, v106
  v_and_b32 v19, 0xffff0000, v106
  v_pk_add_f32 v[20:21], v[108:109], v[10:11] op_sel_hi:[1,0] neg_lo:[0,1] neg_hi:[0,1]
  v_pk_mul_f32 v[18:19], v[18:19], v[16:17] op_sel_hi:[1,0]
  v_pk_fma_f32 v[108:109], v[20:21], v[18:19], v[108:109] op_sel_hi:[1,1,1]
  v_accvgpr_write_b32 a84, v108
  v_accvgpr_write_b32 a85, v109
  v_lshlrev_b32 v110, 16, v105
  v_and_b32 v111, 0xffff0000, v105
  v_lshlrev_b32 v18, 16, v107
  v_and_b32 v19, 0xffff0000, v107
  v_pk_add_f32 v[20:21], v[110:111], v[10:11] op_sel_hi:[1,0] neg_lo:[0,1] neg_hi:[0,1]
  v_pk_mul_f32 v[18:19], v[18:19], v[16:17] op_sel_hi:[1,0]
  v_pk_fma_f32 v[110:111], v[20:21], v[18:19], v[110:111] op_sel_hi:[1,1,1]
  v_accvgpr_write_b32 a86, v110
  v_accvgpr_write_b32 a87, v111
  v_lshlrev_b32 v116, 16, v112
  v_and_b32 v117, 0xffff0000, v112
  v_lshlrev_b32 v18, 16, v114
  v_and_b32 v19, 0xffff0000, v114
  v_pk_add_f32 v[20:21], v[116:117], v[10:11] op_sel_hi:[1,0] neg_lo:[0,1] neg_hi:[0,1]
  v_pk_mul_f32 v[18:19], v[18:19], v[16:17] op_sel_hi:[1,0]
  v_pk_fma_f32 v[116:117], v[20:21], v[18:19], v[116:117] op_sel_hi:[1,1,1]
  v_accvgpr_write_b32 a88, v116
  v_accvgpr_write_b32 a89, v117
  v_lshlrev_b32 v118, 16, v113
  v_and_b32 v119, 0xffff0000, v113
  v_lshlrev_b32 v18, 16, v115
  v_and_b32 v19, 0xffff0000, v115
  v_pk_add_f32 v[20:21], v[118:119], v[10:11] op_sel_hi:[1,0] neg_lo:[0,1] neg_hi:[0,1]
  v_pk_mul_f32 v[18:19], v[18:19], v[16:17] op_sel_hi:[1,0]
  v_pk_fma_f32 v[118:119], v[20:21], v[18:19], v[118:119] op_sel_hi:[1,1,1]
  v_accvgpr_write_b32 a90, v118
  v_accvgpr_write_b32 a91, v119
  v_lshlrev_b32 v124, 16, v120
  v_and_b32 v125, 0xffff0000, v120
  v_lshlrev_b32 v18, 16, v122
  v_and_b32 v19, 0xffff0000, v122
  v_pk_add_f32 v[20:21], v[124:125], v[10:11] op_sel_hi:[1,0] neg_lo:[0,1] neg_hi:[0,1]
  v_pk_mul_f32 v[18:19], v[18:19], v[16:17] op_sel_hi:[1,0]
  v_pk_fma_f32 v[124:125], v[20:21], v[18:19], v[124:125] op_sel_hi:[1,1,1]
  v_accvgpr_write_b32 a92, v124
  v_accvgpr_write_b32 a93, v125
  v_lshlrev_b32 v126, 16, v121
  v_and_b32 v127, 0xffff0000, v121
  v_lshlrev_b32 v18, 16, v123
  v_and_b32 v19, 0xffff0000, v123
  v_pk_add_f32 v[20:21], v[126:127], v[10:11] op_sel_hi:[1,0] neg_lo:[0,1] neg_hi:[0,1]
  v_pk_mul_f32 v[18:19], v[18:19], v[16:17] op_sel_hi:[1,0]
  v_pk_fma_f32 v[126:127], v[20:21], v[18:19], v[126:127] op_sel_hi:[1,1,1]
  v_accvgpr_write_b32 a94, v126
  v_accvgpr_write_b32 a95, v127
  v_lshlrev_b32 v132, 16, v128
  v_and_b32 v133, 0xffff0000, v128
  v_lshlrev_b32 v18, 16, v130
  v_and_b32 v19, 0xffff0000, v130
  v_pk_add_f32 v[20:21], v[132:133], v[10:11] op_sel_hi:[1,0] neg_lo:[0,1] neg_hi:[0,1]
  v_pk_mul_f32 v[18:19], v[18:19], v[16:17] op_sel_hi:[1,0]
  v_pk_fma_f32 v[132:133], v[20:21], v[18:19], v[132:133] op_sel_hi:[1,1,1]
  v_mov_b32 v6, v132
  v_mov_b32 v7, v133
  v_lshlrev_b32 v134, 16, v129
  v_and_b32 v135, 0xffff0000, v129
  v_lshlrev_b32 v18, 16, v131
  v_and_b32 v19, 0xffff0000, v131
  v_pk_add_f32 v[20:21], v[134:135], v[10:11] op_sel_hi:[1,0] neg_lo:[0,1] neg_hi:[0,1]
  v_pk_mul_f32 v[18:19], v[18:19], v[16:17] op_sel_hi:[1,0]
  v_pk_fma_f32 v[134:135], v[20:21], v[18:19], v[134:135] op_sel_hi:[1,1,1]
  v_mov_b32 v26, v134
  v_mov_b32 v27, v135
  s_waitcnt vmcnt(1)
  v_cmp_ne_u32 vcc, s96, v9
  s_cbranch_vccz SC2_ok
  s_mov_b32 s7, 0x40000
SC2_l:
  s_mul_i32 s31, s28, 22
  s_mul_i32 s32, s3, 6
  s_add_u32 s31, s31, s32
  s_min_u32 s31, s31, 38
  s_lshl_b32 s31, s31, 7
  s_add_u32 s31, s31, s93
  v_min_u32 v9, 5, v1
  v_lshlrev_b32 v9, 7, v9
  buffer_load_dword v9, v9, s[8:11], s31 offen sc1
  s_waitcnt vmcnt(0)
  v_cmp_ne_u32 vcc, s96, v9
  s_sub_u32 s7, s7, 1
  s_cbranch_scc1 SC2_ok
  s_cbranch_vccnz SC2_l
SC2_ok:
  s_cmp_eq_u32 s99, s82
  s_cbranch_scc1 SR_done
  s_mov_b32 s7, 0x40000
SR_l:
  s_lshl_b32 s31, s81, 3
  s_add_u32 s31, s31, s29
  s_mul_i32 s31, s31, 640
  s_add_u32 s31, s31, 655360
  v_min_u32 v9, 4, v1
  v_lshlrev_b32 v9, 7, v9
  buffer_load_dword v9, v9, s[8:11], s31 offen sc1
  s_waitcnt vmcnt(0)
  v_cmp_ne_u32 vcc, s96, v9
  s_sub_u32 s7, s7, 1
  s_cbranch_scc1 SR_ok
  s_cbranch_vccnz SR_l
SR_ok:
  s_add_u32 s79, s82, 35840
  buffer_load_dwordx4 a[116:119], v28, s[8:11], s79 offen offset:0 sc1
  buffer_load_dwordx4 a[120:123], v28, s[8:11], s79 offen offset:1024 sc1
  buffer_load_dwordx4 a[124:127], v28, s[8:11], s79 offen offset:2048 sc1
  buffer_load_dwordx4 a[128:131], v28, s[8:11], s79 offen offset:3072 sc1
  buffer_load_dwordx4 a[132:135], v29, s[8:11], s79 offen offset:0 sc1
  s_add_u32 s79, s82, 40960
  buffer_load_dwordx4 a[136:139], v28, s[8:11], s79 offen offset:0 sc1
  buffer_load_dwordx4 a[140:143], v28, s[8:11], s79 offen offset:1024 sc1
  buffer_load_dwordx4 a[144:147], v28, s[8:11], s79 offen offset:2048 sc1
  buffer_load_dwordx4 a[148:151], v28, s[8:11], s79 offen offset:3072 sc1
  buffer_load_dwordx4 a[152:155], v29, s[8:11], s79 offen offset:0 sc1
  s_add_u32 s79, s82, 46080
  buffer_load_dwordx4 a[156:159], v28, s[8:11], s79 offen offset:0 sc1
  buffer_load_dwordx4 a[160:163], v28, s[8:11], s79 offen offset:1024 sc1
  buffer_load_dwordx4 a[164:167], v28, s[8:11], s79 offen offset:2048 sc1
  buffer_load_dwordx4 a[168:171], v28, s[8:11], s79 offen offset:3072 sc1
  buffer_load_dwordx4 a[172:175], v29, s[8:11], s79 offen offset:0 sc1
  s_add_u32 s79, s82, 51200
  buffer_load_dwordx4 a[176:179], v28, s[8:11], s79 offen offset:0 sc1
  buffer_load_dwordx4 a[180:183], v28, s[8:11], s79 offen offset:1024 sc1
  buffer_load_dwordx4 a[184:187], v28, s[8:11], s79 offen offset:2048 sc1
  buffer_load_dwordx4 a[188:191], v28, s[8:11], s79 offen offset:3072 sc1
  buffer_load_dwordx4 a[192:195], v29, s[8:11], s79 offen offset:0 sc1
  s_add_u32 s79, s82, 56320
  buffer_load_dwordx4 a[196:199], v28, s[8:11], s79 offen offset:0 sc1
  buffer_load_dwordx4 a[200:203], v28, s[8:11], s79 offen offset:1024 sc1
  buffer_load_dwordx4 a[204:207], v28, s[8:11], s79 offen offset:2048 sc1
  buffer_load_dwordx4 a[208:211], v28, s[8:11], s79 offen offset:3072 sc1
  buffer_load_dwordx4 a[212:215], v29, s[8:11], s79 offen offset:0 sc1
SR_done:
  s_cmp_eq_u32 s35, s82
  s_cbranch_scc1 SR5_done
  s_mov_b32 s7, 0x40000
SR5_l:
  s_mul_i32 s31, s29, 7680
  s_add_u32 s31, s31, 720896
  s_mul_i32 s32, s81, 5
  s_cmp_eq_u32 s3, 3
  s_cselect_b32 s33, 2, 63
  v_lshrrev_b32 v9, 1, v1
  v_min_u32 v9, 6, v9
  v_cmp_eq_u32 vcc, s33, v9
  v_and_b32 v2, 1, v1
  v_lshl_add_u32 v2, v2, 2, s32
  v_cndmask_b32 v9, v9, 1, vcc
  v_lshrrev_b32 v2, 3, v2
  v_mad_u32_u24 v9, v9, 5, v2
  v_lshlrev_b32 v9, 7, v9
  buffer_load_dword v9, v9, s[8:11], s31 offen sc1
  s_waitcnt vmcnt(0)
  v_cmp_ne_u32 vcc, s96, v9
  s_sub_u32 s7, s7, 1
  s_cbranch_scc1 SR5_ok
  s_cbranch_vccnz SR5_l
SR5_ok:
  s_add_u32 s79, s82, 0
  buffer_load_dwordx4 a[216:219], v28, s[8:11], s79 offen offset:0 sc1
  buffer_load_dwordx4 a[220:223], v28, s[8:11], s79 offen offset:1024 sc1
  buffer_load_dwordx4 a[224:227], v28, s[8:11], s79 offen offset:2048 sc1
  buffer_load_dwordx4 a[228:231], v28, s[8:11], s79 offen offset:3072 sc1
  buffer_load_dwordx4 a[232:235], v29, s[8:11], s79 offen offset:0 sc1
  s_add_u32 s79, s82, 5120
  buffer_load_dwordx4 a[236:239], v28, s[8:11], s79 offen offset:0 sc1
  buffer_load_dwordx4 a[240:243], v28, s[8:11], s79 offen offset:1024 sc1
  buffer_load_dwordx4 a[244:247], v28, s[8:11], s79 offen offset:2048 sc1
  buffer_load_dwordx4 a[248:251], v28, s[8:11], s79 offen offset:3072 sc1
  buffer_load_dwordx4 a[252:255], v29, s[8:11], s79 offen offset:0 sc1
SR5_done:
PH2:
TS_18:
  s_cbranch_execz TR_P
  s_add_u32 s77, s30, 0
  buffer_load_dwordx4 v[32:35], v28, s[8:11], s77 offen offset:0 sc1
  buffer_load_dwordx4 v[36:39], v28, s[8:11], s77 offen offset:1024 sc1
  buffer_load_dwordx4 v[40:43], v28, s[8:11], s77 offen offset:2048 sc1
  buffer_load_dwordx4 v[44:47], v28, s[8:11], s77 offen offset:3072 sc1
  s_add_u32 s77, s30, 4096
  buffer_load_dwordx4 v[48:51], v28, s[8:11], s77 offen offset:0 sc1
  buffer_load_dwordx4 v[52:55], v28, s[8:11], s77 offen offset:1024 sc1
  buffer_load_dwordx4 v[56:59], v28, s[8:11], s77 offen offset:2048 sc1
  buffer_load_dwordx4 v[60:63], v28, s[8:11], s77 offen offset:3072 sc1
  s_add_u32 s77, s30, 8192
  s_cmp_eq_u32 s3, 3
  s_cselect_b32 s77, 0x7f000000, s77
  buffer_load_dwordx4 v[64:67], v28, s[8:11], s77 offen offset:0 sc1
  buffer_load_dwordx4 v[68:71], v28, s[8:11], s77 offen offset:1024 sc1
  buffer_load_dwordx4 v[72:75], v28, s[8:11], s77 offen offset:2048 sc1
  buffer_load_dwordx4 v[76:79], v28, s[8:11], s77 offen offset:3072 sc1
  s_waitcnt vmcnt(8)
  v_mfma_f32_16x16x32_bf16 v[96:99], v[32:35], a[216:219], 0
  s_add_u32 s77, s83, 0
  v_mfma_f32_16x16x32_bf16 v[116:119], v[36:39], a[216:219], 0
  s_mul_i32 s31, s29, 172
  v_mfma_f32_16x16x32_bf16 v[136:139], v[40:43], a[216:219], 0
  buffer_load_dwordx4 v[80:83], v28, s[8:11], s77 offen offset:0 sc1
  v_mfma_f32_16x16x32_bf16 v[156:159], v[44:47], a[216:219], 0
  s_lshr_b32 s31, s31, 7
  v_mfma_f32_16x16x32_bf16 v[160:163], v[44:47], a[220:223], 0
  buffer_load_dwordx4 v[84:87], v28, s[8:11], s77 offen offset:1024 sc1
  v_mfma_f32_16x16x32_bf16 v[140:143], v[40:43], a[220:223], 0
  v_mfma_f32_16x16x32_bf16 v[120:123], v[36:39], a[220:223], 0
  s_lshl_b32 s31, s31, 9
  v_mfma_f32_16x16x32_bf16 v[100:103], v[32:35], a[220:223], 0
  buffer_load_dwordx4 v[88:91], v28, s[8:11], s77 offen offset:2048 sc1
  v_mfma_f32_16x16x32_bf16 v[104:107], v[32:35], a[224:227], 0
  s_add_u32 s31, s31, s93
  v_mfma_f32_16x16x32_bf16 v[124:127], v[36:39], a[224:227], 0
  buffer_load_dwordx4 v[92:95], v28, s[8:11], s77 offen offset:3072 sc1
  v_mfma_f32_16x16x32_bf16 v[144:147], v[40:43], a[224:227], 0
  v_mfma_f32_16x16x32_bf16 v[164:167], v[44:47], a[224:227], 0
  s_add_u32 s31, s31, 5632
  v_mfma_f32_16x16x32_bf16 v[168:171], v[44:47], a[228:231], 0
  v_mfma_f32_16x16x32_bf16 v[148:151], v[40:43], a[228:231], 0
  v_min_u32 v9, 7, v1
  v_mfma_f32_16x16x32_bf16 v[128:131], v[36:39], a[228:231], 0
  v_mfma_f32_16x16x32_bf16 v[108:111], v[32:35], a[228:231], 0
  v_mfma_f32_16x16x32_bf16 v[112:115], v[32:35], a[232:235], 0
  v_lshlrev_b32 v9, 7, v9
  v_mfma_f32_16x16x32_bf16 v[132:135], v[36:39], a[232:235], 0
  v_mfma_f32_16x16x32_bf16 v[152:155], v[40:43], a[232:235], 0
  v_mfma_f32_16x16x32_bf16 v[172:175], v[44:47], a[232:235], 0
  s_waitcnt vmcnt(8)
  v_mfma_f32_16x16x32_bf16 v[96:99], v[48:51], a[236:239], v[96:99]
  buffer_load_dword v9, v9, s[8:11], s31 offen sc1
  v_mfma_f32_16x16x32_bf16 v[116:119], v[52:55], a[236:239], v[116:119]
  v_mfma_f32_16x16x32_bf16 v[136:139], v[56:59], a[236:239], v[136:139]
  s_add_u32 s77, s83, 4096
  v_mfma_f32_16x16x32_bf16 v[156:159], v[60:63], a[236:239], v[156:159]
  v_mfma_f32_16x16x32_bf16 v[160:163], v[60:63], a[240:243], v[160:163]
  buffer_load_dwordx4 v[32:35], v28, s[8:11], s77 offen offset:0 sc1
  v_mfma_f32_16x16x32_bf16 v[140:143], v[56:59], a[240:243], v[140:143]
  v_mfma_f32_16x16x32_bf16 v[120:123], v[52:55], a[240:243], v[120:123]
  buffer_load_dwordx4 v[36:39], v28, s[8:11], s77 offen offset:1024 sc1
  v_mfma_f32_16x16x32_bf16 v[100:103], v[48:51], a[240:243], v[100:103]
  v_mfma_f32_16x16x32_bf16 v[104:107], v[48:51], a[244:247], v[104:107]
  buffer_load_dwordx4 v[40:43], v28, s[8:11], s77 offen offset:2048 sc1
  v_mfma_f32_16x16x32_bf16 v[124:127], v[52:55], a[244:247], v[124:127]
  v_mfma_f32_16x16x32_bf16 v[144:147], v[56:59], a[244:247], v[144:147]
  buffer_load_dwordx4 v[44:47], v28, s[8:11], s77 offen offset:3072 sc1
  v_mfma_f32_16x16x32_bf16 v[164:167], v[60:63], a[244:247], v[164:167]
  v_mfma_f32_16x16x32_bf16 v[168:171], v[60:63], a[248:251], v[168:171]
  v_mfma_f32_16x16x32_bf16 v[148:151], v[56:59], a[248:251], v[148:151]
  v_mfma_f32_16x16x32_bf16 v[128:131], v[52:55], a[248:251], v[128:131]
  v_mfma_f32_16x16x32_bf16 v[108:111], v[48:51], a[248:251], v[108:111]
  v_mfma_f32_16x16x32_bf16 v[112:115], v[48:51], a[252:255], v[112:115]
  v_mfma_f32_16x16x32_bf16 v[132:135], v[52:55], a[252:255], v[132:135]
  v_mfma_f32_16x16x32_bf16 v[152:155], v[56:59], a[252:255], v[152:155]
  v_mfma_f32_16x16x32_bf16 v[172:175], v[60:63], a[252:255], v[172:175]
  s_waitcnt vmcnt(9)
  v_mfma_f32_16x16x32_bf16 v[96:99], v[64:67], a[96:99], v[96:99]
  s_add_u32 s77, s83, 8192
  v_mfma_f32_16x16x32_bf16 v[116:119], v[68:71], a[96:99], v[116:119]
  v_mfma_f32_16x16x32_bf16 v[136:139], v[72:75], a[96:99], v[136:139]
  s_cmp_eq_u32 s3, 3
  s_cselect_b32 s77, 0x7f000000, s77
  v_mfma_f32_16x16x32_bf16 v[156:159], v[76:79], a[96:99], v[156:159]
  v_mfma_f32_16x16x32_bf16 v[160:163], v[76:79], a[100:103], v[160:163]
  buffer_load_dwordx4 v[48:51], v28, s[8:11], s77 offen offset:0 sc1
  v_mfma_f32_16x16x32_bf16 v[140:143], v[72:75], a[100:103], v[140:143]
  v_mfma_f32_16x16x32_bf16 v[120:123], v[68:71], a[100:103], v[120:123]
  buffer_load_dwordx4 v[52:55], v28, s[8:11], s77 offen offset:1024 sc1
  v_mfma_f32_16x16x32_bf16 v[100:103], v[64:67], a[100:103], v[100:103]
  v_mfma_f32_16x16x32_bf16 v[104:107], v[64:67], a[104:107], v[104:107]
  buffer_load_dwordx4 v[56:59], v28, s[8:11], s77 offen offset:2048 sc1
  v_mfma_f32_16x16x32_bf16 v[124:127], v[68:71], a[104:107], v[124:127]
  v_mfma_f32_16x16x32_bf16 v[144:147], v[72:75], a[104:107], v[144:147]
  buffer_load_dwordx4 v[60:63], v28, s[8:11], s77 offen offset:3072 sc1
  v_mfma_f32_16x16x32_bf16 v[164:167], v[76:79], a[104:107], v[164:167]
  v_mfma_f32_16x16x32_bf16 v[168:171], v[76:79], a[108:111], v[168:171]
  v_mfma_f32_16x16x32_bf16 v[148:151], v[72:75], a[108:111], v[148:151]
  v_mfma_f32_16x16x32_bf16 v[128:131], v[68:71], a[108:111], v[128:131]
  v_mfma_f32_16x16x32_bf16 v[108:111], v[64:67], a[108:111], v[108:111]
  v_mfma_f32_16x16x32_bf16 v[112:115], v[64:67], a[112:115], v[112:115]
  v_mfma_f32_16x16x32_bf16 v[132:135], v[68:71], a[112:115], v[132:135]
  v_mfma_f32_16x16x32_bf16 v[152:155], v[72:75], a[112:115], v[152:155]
  v_mfma_f32_16x16x32_bf16 v[172:175], v[76:79], a[112:115], v[172:175]
  s_waitcnt vmcnt(9)
  s_waitcnt vmcnt(8)
  v_cmp_ne_u32 vcc, s96, v9
  s_cbranch_vccz CK3_ok
  s_mov_b32 s7, 0x40000
CK3_l:
  s_mul_i32 s31, s29, 172
  s_lshr_b32 s31, s31, 7
  s_lshl_b32 s31, s31, 9
  s_add_u32 s31, s31, s93
  s_add_u32 s31, s31, 5632
  v_min_u32 v9, 7, v1
  v_lshlrev_b32 v9, 7, v9
  buffer_load_dword v9, v9, s[8:11], s31 offen sc1
  s_waitcnt vmcnt(0)
  v_cmp_ne_u32 vcc, s96, v9
  s_sub_u32 s7, s7, 1
  s_cbranch_scc1 CK3_ok
  s_cbranch_vccnz CK3_l
CK3_ok:
  v_mfma_f32_16x16x32_bf16 v[176:179], v[80:83], a[216:219], 0
  s_add_u32 s77, s30, 12288
  v_mfma_f32_16x16x32_bf16 v[196:199], v[84:87], a[216:219], 0
  v_mfma_f32_16x16x32_bf16 v[216:219], v[88:91], a[216:219], 0
  buffer_load_dwordx4 v[64:67], v28, s[8:11], s77 offen offset:0 sc1
  v_mfma_f32_16x16x32_bf16 v[236:239], v[92:95], a[216:219], 0
  v_mfma_f32_16x16x32_bf16 v[240:243], v[92:95], a[220:223], 0
  buffer_load_dwordx4 v[68:71], v28, s[8:11], s77 offen offset:1024 sc1
  v_mfma_f32_16x16x32_bf16 v[220:223], v[88:91], a[220:223], 0
  v_mfma_f32_16x16x32_bf16 v[200:203], v[84:87], a[220:223], 0
  v_mfma_f32_16x16x32_bf16 v[180:183], v[80:83], a[220:223], 0
  buffer_load_dwordx4 v[72:75], v28, s[8:11], s77 offen offset:2048 sc1
  v_mfma_f32_16x16x32_bf16 v[184:187], v[80:83], a[224:227], 0
  v_mfma_f32_16x16x32_bf16 v[204:207], v[84:87], a[224:227], 0
  buffer_load_dwordx4 v[76:79], v28, s[8:11], s77 offen offset:3072 sc1
  v_mfma_f32_16x16x32_bf16 v[224:227], v[88:91], a[224:227], 0
  v_mfma_f32_16x16x32_bf16 v[244:247], v[92:95], a[224:227], 0
  v_mfma_f32_16x16x32_bf16 v[248:251], v[92:95], a[228:231], 0
  v_mfma_f32_16x16x32_bf16 v[228:231], v[88:91], a[228:231], 0
  v_mfma_f32_16x16x32_bf16 v[208:211], v[84:87], a[228:231], 0
  v_mfma_f32_16x16x32_bf16 v[188:191], v[80:83], a[228:231], 0
  v_mfma_f32_16x16x32_bf16 v[192:195], v[80:83], a[232:235], 0
  v_mfma_f32_16x16x32_bf16 v[212:215], v[84:87], a[232:235], 0
  v_mfma_f32_16x16x32_bf16 v[232:235], v[88:91], a[232:235], 0
  v_mfma_f32_16x16x32_bf16 v[252:255], v[92:95], a[232:235], 0
  s_waitcnt vmcnt(8)
  v_mfma_f32_16x16x32_bf16 v[176:179], v[32:35], a[236:239], v[176:179]
  s_add_u32 s77, s30, 16384
  v_mfma_f32_16x16x32_bf16 v[196:199], v[36:39], a[236:239], v[196:199]
  s_mul_i32 s31, s29, 5
  v_mfma_f32_16x16x32_bf16 v[216:219], v[40:43], a[236:239], v[216:219]
  buffer_load_dwordx4 v[80:83], v28, s[8:11], s77 offen offset:0 sc1
  v_mfma_f32_16x16x32_bf16 v[236:239], v[44:47], a[236:239], v[236:239]
  s_lshr_b32 s31, s31, 1
  v_mfma_f32_16x16x32_bf16 v[240:243], v[44:47], a[240:243], v[240:243]
  buffer_load_dwordx4 v[84:87], v28, s[8:11], s77 offen offset:1024 sc1
  v_mfma_f32_16x16x32_bf16 v[220:223], v[40:43], a[240:243], v[220:223]
  v_mfma_f32_16x16x32_bf16 v[200:203], v[36:39], a[240:243], v[200:203]
  s_lshl_b32 s31, s31, 7
  v_mfma_f32_16x16x32_bf16 v[180:183], v[32:35], a[240:243], v[180:183]
  buffer_load_dwordx4 v[88:91], v28, s[8:11], s77 offen offset:2048 sc1
  v_mfma_f32_16x16x32_bf16 v[184:187], v[32:35], a[244:247], v[184:187]
  s_add_u32 s31, s31, s93
  v_mfma_f32_16x16x32_bf16 v[204:207], v[36:39], a[244:247], v[204:207]
  buffer_load_dwordx4 v[92:95], v28, s[8:11], s77 offen offset:3072 sc1
  v_mfma_f32_16x16x32_bf16 v[224:227], v[40:43], a[244:247], v[224:227]
  v_mfma_f32_16x16x32_bf16 v[244:247], v[44:47], a[244:247], v[244:247]
  s_add_u32 s31, s31, 11264
  v_mfma_f32_16x16x32_bf16 v[248:251], v[44:47], a[248:251], v[248:251]
  v_mfma_f32_16x16x32_bf16 v[228:231], v[40:43], a[248:251], v[228:231]
  v_min_u32 v9, 2, v1
  v_mfma_f32_16x16x32_bf16 v[208:211], v[36:39], a[248:251], v[208:211]
  v_mfma_f32_16x16x32_bf16 v[188:191], v[32:35], a[248:251], v[188:191]
  v_mfma_f32_16x16x32_bf16 v[192:195], v[32:35], a[252:255], v[192:195]
  v_lshlrev_b32 v9, 7, v9
  v_mfma_f32_16x16x32_bf16 v[212:215], v[36:39], a[252:255], v[212:215]
  v_mfma_f32_16x16x32_bf16 v[232:235], v[40:43], a[252:255], v[232:235]
  v_mfma_f32_16x16x32_bf16 v[252:255], v[44:47], a[252:255], v[252:255]
  s_waitcnt vmcnt(8)
  v_mfma_f32_16x16x32_bf16 v[176:179], v[48:51], a[96:99], v[176:179]
  buffer_load_dword v9, v9, s[8:11], s31 offen sc1
  v_mfma_f32_16x16x32_bf16 v[196:199], v[52:55], a[96:99], v[196:199]
  v_mfma_f32_16x16x32_bf16 v[216:219], v[56:59], a[96:99], v[216:219]
  s_add_u32 s77, s30, 20480
  v_mfma_f32_16x16x32_bf16 v[236:239], v[60:63], a[96:99], v[236:239]
  v_mfma_f32_16x16x32_bf16 v[240:243], v[60:63], a[100:103], v[240:243]
  buffer_load_dwordx4 v[32:35], v28, s[8:11], s77 offen offset:0 sc1
  v_mfma_f32_16x16x32_bf16 v[220:223], v[56:59], a[100:103], v[220:223]
  v_mfma_f32_16x16x32_bf16 v[200:203], v[52:55], a[100:103], v[200:203]
  buffer_load_dwordx4 v[36:39], v28, s[8:11], s77 offen offset:1024 sc1
  v_mfma_f32_16x16x32_bf16 v[180:183], v[48:51], a[100:103], v[180:183]
  v_mfma_f32_16x16x32_bf16 v[184:187], v[48:51], a[104:107], v[184:187]
  buffer_load_dwordx4 v[40:43], v28, s[8:11], s77 offen offset:2048 sc1
  v_mfma_f32_16x16x32_bf16 v[204:207], v[52:55], a[104:107], v[204:207]
  v_mfma_f32_16x16x32_bf16 v[224:227], v[56:59], a[104:107], v[224:227]
  buffer_load_dwordx4 v[44:47], v28, s[8:11], s77 offen offset:3072 sc1
  v_mfma_f32_16x16x32_bf16 v[244:247], v[60:63], a[104:107], v[244:247]
  v_mfma_f32_16x16x32_bf16 v[248:251], v[60:63], a[108:111], v[248:251]
  v_mfma_f32_16x16x32_bf16 v[228:231], v[56:59], a[108:111], v[228:231]
  v_mfma_f32_16x16x32_bf16 v[208:211], v[52:55], a[108:111], v[208:211]
  v_mfma_f32_16x16x32_bf16 v[188:191], v[48:51], a[108:111], v[188:191]
  v_mfma_f32_16x16x32_bf16 v[192:195], v[48:51], a[112:115], v[192:195]
  v_mfma_f32_16x16x32_bf16 v[212:215], v[52:55], a[112:115], v[212:215]
  v_mfma_f32_16x16x32_bf16 v[232:235], v[56:59], a[112:115], v[232:235]
  v_mfma_f32_16x16x32_bf16 v[252:255], v[60:63], a[112:115], v[252:255]
  s_waitcnt vmcnt(9)
  v_mfma_f32_16x16x32_bf16 v[96:99], v[64:67], a[0:3], v[96:99]
  s_add_u32 s77, s30, 24576
  v_mfma_f32_16x16x32_bf16 v[116:119], v[68:71], a[0:3], v[116:119]
  v_mfma_f32_16x16x32_bf16 v[136:139], v[72:75], a[0:3], v[136:139]
  buffer_load_dwordx4 v[48:51], v28, s[8:11], s77 offen offset:0 sc1
  v_mfma_f32_16x16x32_bf16 v[156:159], v[76:79], a[0:3], v[156:159]
  v_mfma_f32_16x16x32_bf16 v[160:163], v[76:79], a[4:7], v[160:163]
  buffer_load_dwordx4 v[52:55], v28, s[8:11], s77 offen offset:1024 sc1
  v_mfma_f32_16x16x32_bf16 v[140:143], v[72:75], a[4:7], v[140:143]
  v_mfma_f32_16x16x32_bf16 v[120:123], v[68:71], a[4:7], v[120:123]
  v_mfma_f32_16x16x32_bf16 v[100:103], v[64:67], a[4:7], v[100:103]
  buffer_load_dwordx4 v[56:59], v28, s[8:11], s77 offen offset:2048 sc1
  v_mfma_f32_16x16x32_bf16 v[104:107], v[64:67], a[8:11], v[104:107]
  v_mfma_f32_16x16x32_bf16 v[124:127], v[68:71], a[8:11], v[124:127]
  buffer_load_dwordx4 v[60:63], v28, s[8:11], s77 offen offset:3072 sc1
  v_mfma_f32_16x16x32_bf16 v[144:147], v[72:75], a[8:11], v[144:147]
  v_mfma_f32_16x16x32_bf16 v[164:167], v[76:79], a[8:11], v[164:167]
  v_mfma_f32_16x16x32_bf16 v[168:171], v[76:79], a[12:15], v[168:171]
  v_mfma_f32_16x16x32_bf16 v[148:151], v[72:75], a[12:15], v[148:151]
  v_mfma_f32_16x16x32_bf16 v[128:131], v[68:71], a[12:15], v[128:131]
  v_mfma_f32_16x16x32_bf16 v[108:111], v[64:67], a[12:15], v[108:111]
  v_mfma_f32_16x16x32_bf16 v[112:115], v[64:67], a[16:19], v[112:115]
  v_mfma_f32_16x16x32_bf16 v[132:135], v[68:71], a[16:19], v[132:135]
  v_mfma_f32_16x16x32_bf16 v[152:155], v[72:75], a[16:19], v[152:155]
  v_mfma_f32_16x16x32_bf16 v[172:175], v[76:79], a[16:19], v[172:175]
  s_waitcnt vmcnt(9)
  s_waitcnt vmcnt(8)
  v_cmp_ne_u32 vcc, s96, v9
  s_cbranch_vccz CK7_ok
  s_mov_b32 s7, 0x40000
CK7_l:
  s_mul_i32 s31, s29, 5
  s_lshr_b32 s31, s31, 1
  s_lshl_b32 s31, s31, 7
  s_add_u32 s31, s31, s93
  s_add_u32 s31, s31, 11264
  v_min_u32 v9, 2, v1
  v_lshlrev_b32 v9, 7, v9
  buffer_load_dword v9, v9, s[8:11], s31 offen sc1
  s_waitcnt vmcnt(0)
  v_cmp_ne_u32 vcc, s96, v9
  s_sub_u32 s7, s7, 1
  s_cbranch_scc1 CK7_ok
  s_cbranch_vccnz CK7_l
CK7_ok:
  v_mfma_f32_16x16x32_bf16 v[96:99], v[80:83], a[20:23], v[96:99]
  s_add_u32 s77, s30, 28672
  v_mfma_f32_16x16x32_bf16 v[116:119], v[84:87], a[20:23], v[116:119]
  v_mfma_f32_16x16x32_bf16 v[136:139], v[88:91], a[20:23], v[136:139]
  buffer_load_dwordx4 v[64:67], v28, s[8:11], s77 offen offset:0 sc1
  v_mfma_f32_16x16x32_bf16 v[156:159], v[92:95], a[20:23], v[156:159]
  v_mfma_f32_16x16x32_bf16 v[160:163], v[92:95], a[24:27], v[160:163]
  buffer_load_dwordx4 v[68:71], v28, s[8:11], s77 offen offset:1024 sc1
  v_mfma_f32_16x16x32_bf16 v[140:143], v[88:91], a[24:27], v[140:143]
  v_mfma_f32_16x16x32_bf16 v[120:123], v[84:87], a[24:27], v[120:123]
  v_mfma_f32_16x16x32_bf16 v[100:103], v[80:83], a[24:27], v[100:103]
  buffer_load_dwordx4 v[72:75], v28, s[8:11], s77 offen offset:2048 sc1
  v_mfma_f32_16x16x32_bf16 v[104:107], v[80:83], a[28:31], v[104:107]
  v_mfma_f32_16x16x32_bf16 v[124:127], v[84:87], a[28:31], v[124:127]
  buffer_load_dwordx4 v[76:79], v28, s[8:11], s77 offen offset:3072 sc1
  v_mfma_f32_16x16x32_bf16 v[144:147], v[88:91], a[28:31], v[144:147]
  v_mfma_f32_16x16x32_bf16 v[164:167], v[92:95], a[28:31], v[164:167]
  v_mfma_f32_16x16x32_bf16 v[168:171], v[92:95], a[32:35], v[168:171]
  v_mfma_f32_16x16x32_bf16 v[148:151], v[88:91], a[32:35], v[148:151]
  v_mfma_f32_16x16x32_bf16 v[128:131], v[84:87], a[32:35], v[128:131]
  v_mfma_f32_16x16x32_bf16 v[108:111], v[80:83], a[32:35], v[108:111]
  v_mfma_f32_16x16x32_bf16 v[112:115], v[80:83], a[36:39], v[112:115]
  v_mfma_f32_16x16x32_bf16 v[132:135], v[84:87], a[36:39], v[132:135]
  v_mfma_f32_16x16x32_bf16 v[152:155], v[88:91], a[36:39], v[152:155]
  v_mfma_f32_16x16x32_bf16 v[172:175], v[92:95], a[36:39], v[172:175]
  s_waitcnt vmcnt(8)
  v_mfma_f32_16x16x32_bf16 v[96:99], v[32:35], a[40:43], v[96:99]
  s_add_u32 s77, s30, 32768
  v_mfma_f32_16x16x32_bf16 v[116:119], v[36:39], a[40:43], v[116:119]
  buffer_load_dwordx4 a[216:219], v28, s[8:11], s77 offen offset:0 sc1
  v_mfma_f32_16x16x32_bf16 v[136:139], v[40:43], a[40:43], v[136:139]
  buffer_load_dwordx4 a[220:223], v28, s[8:11], s77 offen offset:1024 sc1
  v_mfma_f32_16x16x32_bf16 v[156:159], v[44:47], a[40:43], v[156:159]
  buffer_load_dwordx4 a[224:227], v28, s[8:11], s77 offen offset:2048 sc1
  v_mfma_f32_16x16x32_bf16 v[160:163], v[44:47], a[44:47], v[160:163]
  buffer_load_dwordx4 a[228:231], v28, s[8:11], s77 offen offset:3072 sc1
  v_mfma_f32_16x16x32_bf16 v[140:143], v[40:43], a[44:47], v[140:143]
  v_mfma_f32_16x16x32_bf16 v[120:123], v[36:39], a[44:47], v[120:123]
  s_add_u32 s77, s30, 36864
  v_mfma_f32_16x16x32_bf16 v[100:103], v[32:35], a[44:47], v[100:103]
  buffer_load_dwordx4 a[232:235], v28, s[8:11], s77 offen offset:0 sc1
  v_mfma_f32_16x16x32_bf16 v[104:107], v[32:35], a[48:51], v[104:107]
  buffer_load_dwordx4 a[236:239], v28, s[8:11], s77 offen offset:1024 sc1
  v_mfma_f32_16x16x32_bf16 v[124:127], v[36:39], a[48:51], v[124:127]
  buffer_load_dwordx4 a[240:243], v28, s[8:11], s77 offen offset:2048 sc1
  v_mfma_f32_16x16x32_bf16 v[144:147], v[40:43], a[48:51], v[144:147]
  buffer_load_dwordx4 a[244:247], v28, s[8:11], s77 offen offset:3072 sc1
TS_19:
  s_cbranch_execz TR_P
  v_mfma_f32_16x16x32_bf16 v[164:167], v[44:47], a[48:51], v[164:167]
  v_mfma_f32_16x16x32_bf16 v[168:171], v[44:47], a[52:55], v[168:171]
  v_mfma_f32_16x16x32_bf16 v[148:151], v[40:43], a[52:55], v[148:151]
  v_mfma_f32_16x16x32_bf16 v[128:131], v[36:39], a[52:55], v[128:131]
  v_mfma_f32_16x16x32_bf16 v[108:111], v[32:35], a[52:55], v[108:111]
  v_mfma_f32_16x16x32_bf16 v[112:115], v[32:35], a[56:59], v[112:115]
  v_mfma_f32_16x16x32_bf16 v[132:135], v[36:39], a[56:59], v[132:135]
  v_mfma_f32_16x16x32_bf16 v[152:155], v[40:43], a[56:59], v[152:155]
  v_mfma_f32_16x16x32_bf16 v[172:175], v[44:47], a[56:59], v[172:175]
  s_waitcnt vmcnt(12)
  v_mfma_f32_16x16x32_bf16 v[96:99], v[48:51], a[60:63], v[96:99]
  s_add_u32 s77, s30, 40960
  v_mfma_f32_16x16x32_bf16 v[116:119], v[52:55], a[60:63], v[116:119]
  v_mfma_f32_16x16x32_bf16 v[136:139], v[56:59], a[60:63], v[136:139]
  buffer_load_dwordx4 a[96:99], v28, s[8:11], s77 offen offset:0 sc1
  v_mfma_f32_16x16x32_bf16 v[156:159], v[60:63], a[60:63], v[156:159]
  v_mfma_f32_16x16x32_bf16 v[160:163], v[60:63], a[64:67], v[160:163]
  buffer_load_dwordx4 a[100:103], v28, s[8:11], s77 offen offset:1024 sc1
  v_mfma_f32_16x16x32_bf16 v[140:143], v[56:59], a[64:67], v[140:143]
  v_mfma_f32_16x16x32_bf16 v[120:123], v[52:55], a[64:67], v[120:123]
  v_mfma_f32_16x16x32_bf16 v[100:103], v[48:51], a[64:67], v[100:103]
  buffer_load_dwordx4 a[104:107], v28, s[8:11], s77 offen offset:2048 sc1
  v_mfma_f32_16x16x32_bf16 v[104:107], v[48:51], a[68:71], v[104:107]
  v_mfma_f32_16x16x32_bf16 v[124:127], v[52:55], a[68:71], v[124:127]
  buffer_load_dwordx4 a[108:111], v28, s[8:11], s77 offen offset:3072 sc1
  v_mfma_f32_16x16x32_bf16 v[144:147], v[56:59], a[68:71], v[144:147]
  v_mfma_f32_16x16x32_bf16 v[164:167], v[60:63], a[68:71], v[164:167]
  v_mfma_f32_16x16x32_bf16 v[168:171], v[60:63], a[72:75], v[168:171]
  v_mfma_f32_16x16x32_bf16 v[148:151], v[56:59], a[72:75], v[148:151]
  v_mfma_f32_16x16x32_bf16 v[128:131], v[52:55], a[72:75], v[128:131]
  v_mfma_f32_16x16x32_bf16 v[108:111], v[48:51], a[72:75], v[108:111]
  v_mfma_f32_16x16x32_bf16 v[112:115], v[48:51], a[76:79], v[112:115]
  v_mfma_f32_16x16x32_bf16 v[132:135], v[52:55], a[76:79], v[132:135]
  v_mfma_f32_16x16x32_bf16 v[152:155], v[56:59], a[76:79], v[152:155]
  v_mfma_f32_16x16x32_bf16 v[172:175], v[60:63], a[76:79], v[172:175]
  s_waitcnt vmcnt(12)
  v_mfma_f32_16x16x32_bf16 v[96:99], v[64:67], a[116:119], v[96:99]
  s_add_u32 s77, s30, 45056
  v_mfma_f32_16x16x32_bf16 v[116:119], v[68:71], a[116:119], v[116:119]
  v_mfma_f32_16x16x32_bf16 v[136:139], v[72:75], a[116:119], v[136:139]
  buffer_load_dwordx4 v[80:83], v28, s[8:11], s77 offen offset:0 sc1
  v_mfma_f32_16x16x32_bf16 v[156:159], v[76:79], a[116:119], v[156:159]
  v_mfma_f32_16x16x32_bf16 v[160:163], v[76:79], a[120:123], v[160:163]
  buffer_load_dwordx4 v[84:87], v28, s[8:11], s77 offen offset:1024 sc1
  v_mfma_f32_16x16x32_bf16 v[140:143], v[72:75], a[120:123], v[140:143]
  v_mfma_f32_16x16x32_bf16 v[120:123], v[68:71], a[120:123], v[120:123]
  v_mfma_f32_16x16x32_bf16 v[100:103], v[64:67], a[120:123], v[100:103]
  buffer_load_dwordx4 v[88:91], v28, s[8:11], s77 offen offset:2048 sc1
  v_mfma_f32_16x16x32_bf16 v[104:107], v[64:67], a[124:127], v[104:107]
  v_mfma_f32_16x16x32_bf16 v[124:127], v[68:71], a[124:127], v[124:127]
  buffer_load_dwordx4 v[92:95], v28, s[8:11], s77 offen offset:3072 sc1
  v_mfma_f32_16x16x32_bf16 v[144:147], v[72:75], a[124:127], v[144:147]
  v_mfma_f32_16x16x32_bf16 v[164:167], v[76:79], a[124:127], v[164:167]
  v_mfma_f32_16x16x32_bf16 v[168:171], v[76:79], a[128:131], v[168:171]
  v_mfma_f32_16x16x32_bf16 v[148:151], v[72:75], a[128:131], v[148:151]
  v_mfma_f32_16x16x32_bf16 v[128:131], v[68:71], a[128:131], v[128:131]
  v_mfma_f32_16x16x32_bf16 v[108:111], v[64:67], a[128:131], v[108:111]
  v_mfma_f32_16x16x32_bf16 v[112:115], v[64:67], a[132:135], v[112:115]
  v_mfma_f32_16x16x32_bf16 v[132:135], v[68:71], a[132:135], v[132:135]
  v_mfma_f32_16x16x32_bf16 v[152:155], v[72:75], a[132:135], v[152:155]
  v_mfma_f32_16x16x32_bf16 v[172:175], v[76:79], a[132:135], v[172:175]
  s_waitcnt vmcnt(12)
  v_mfma_f32_16x16x32_bf16 v[96:99], a[216:219], a[136:139], v[96:99]
  s_add_u32 s77, s83, 12288
  v_mfma_f32_16x16x32_bf16 v[116:119], a[220:223], a[136:139], v[116:119]
  v_mfma_f32_16x16x32_bf16 v[136:139], a[224:227], a[136:139], v[136:139]
  buffer_load_dwordx4 v[32:35], v28, s[8:11], s77 offen offset:0 sc1
  v_mfma_f32_16x16x32_bf16 v[156:159], a[228:231], a[136:139], v[156:159]
  v_mfma_f32_16x16x32_bf16 v[160:163], a[228:231], a[140:143], v[160:163]
  buffer_load_dwordx4 v[36:39], v28, s[8:11], s77 offen offset:1024 sc1
  v_mfma_f32_16x16x32_bf16 v[140:143], a[224:227], a[140:143], v[140:143]
  v_mfma_f32_16x16x32_bf16 v[120:123], a[220:223], a[140:143], v[120:123]
  v_mfma_f32_16x16x32_bf16 v[100:103], a[216:219], a[140:143], v[100:103]
  buffer_load_dwordx4 v[40:43], v28, s[8:11], s77 offen offset:2048 sc1
  v_mfma_f32_16x16x32_bf16 v[104:107], a[216:219], a[144:147], v[104:107]
  v_mfma_f32_16x16x32_bf16 v[124:127], a[220:223], a[144:147], v[124:127]
  buffer_load_dwordx4 v[44:47], v28, s[8:11], s77 offen offset:3072 sc1
  v_mfma_f32_16x16x32_bf16 v[144:147], a[224:227], a[144:147], v[144:147]
  v_mfma_f32_16x16x32_bf16 v[164:167], a[228:231], a[144:147], v[164:167]
  v_mfma_f32_16x16x32_bf16 v[168:171], a[228:231], a[148:151], v[168:171]
  v_mfma_f32_16x16x32_bf16 v[148:151], a[224:227], a[148:151], v[148:151]
  v_mfma_f32_16x16x32_bf16 v[128:131], a[220:223], a[148:151], v[128:131]
  v_mfma_f32_16x16x32_bf16 v[108:111], a[216:219], a[148:151], v[108:111]
  v_mfma_f32_16x16x32_bf16 v[112:115], a[216:219], a[152:155], v[112:115]
  v_mfma_f32_16x16x32_bf16 v[132:135], a[220:223], a[152:155], v[132:135]
  v_mfma_f32_16x16x32_bf16 v[152:155], a[224:227], a[152:155], v[152:155]
  v_mfma_f32_16x16x32_bf16 v[172:175], a[228:231], a[152:155], v[172:175]
  s_waitcnt vmcnt(12)
  v_mfma_f32_16x16x32_bf16 v[96:99], a[232:235], a[156:159], v[96:99]
  s_add_u32 s77, s83, 16384
  v_mfma_f32_16x16x32_bf16 v[116:119], a[236:239], a[156:159], v[116:119]
  s_mov_b32 m0, s101
  v_mfma_f32_16x16x32_bf16 v[136:139], a[240:243], a[156:159], v[136:139]
  buffer_load_dwordx4 v[48:51], v28, s[8:11], s77 offen offset:0 sc1
  v_mfma_f32_16x16x32_bf16 v[156:159], a[244:247], a[156:159], v[156:159]
  v_mfma_f32_16x16x32_bf16 v[160:163], a[244:247], a[160:163], v[160:163]
  buffer_load_dwordx4 v[52:55], v28, s[8:11], s77 offen offset:1024 sc1
  v_mfma_f32_16x16x32_bf16 v[140:143], a[240:243], a[160:163], v[140:143]
  v_mfma_f32_16x16x32_bf16 v[120:123], a[236:239], a[160:163], v[120:123]
  v_mfma_f32_16x16x32_bf16 v[100:103], a[232:235], a[160:163], v[100:103]
  buffer_load_dwordx4 v[56:59], v28, s[8:11], s77 offen offset:2048 sc1
  v_mfma_f32_16x16x32_bf16 v[104:107], a[232:235], a[164:167], v[104:107]
  v_mfma_f32_16x16x32_bf16 v[124:127], a[236:239], a[164:167], v[124:127]
  buffer_load_dwordx4 v[60:63], v28, s[8:11], s77 offen offset:3072 sc1
  v_mfma_f32_16x16x32_bf16 v[144:147], a[240:243], a[164:167], v[144:147]
  v_mfma_f32_16x16x32_bf16 v[164:167], a[244:247], a[164:167], v[164:167]
  v_mfma_f32_16x16x32_bf16 v[168:171], a[244:247], a[168:171], v[168:171]
  v_mfma_f32_16x16x32_bf16 v[148:151], a[240:243], a[168:171], v[148:151]
  v_mfma_f32_16x16x32_bf16 v[128:131], a[236:239], a[168:171], v[128:131]
  v_mfma_f32_16x16x32_bf16 v[108:111], a[232:235], a[168:171], v[108:111]
  v_mfma_f32_16x16x32_bf16 v[112:115], a[232:235], a[172:175], v[112:115]
  v_mfma_f32_16x16x32_bf16 v[132:135], a[236:239], a[172:175], v[132:135]
  v_mfma_f32_16x16x32_bf16 v[152:155], a[240:243], a[172:175], v[152:155]
  v_mfma_f32_16x16x32_bf16 v[172:175], a[244:247], a[172:175], v[172:175]
  s_waitcnt vmcnt(8)
  v_mfma_f32_16x16x32_bf16 v[96:99], a[96:99], a[176:179], v[96:99]
  s_add_u32 s77, s83, 20480
  v_mfma_f32_16x16x32_bf16 v[96:99], v[80:83], a[196:199], v[96:99]
  v_mfma_f32_16x16x32_bf16 v[116:119], a[100:103], a[176:179], v[116:119]
  buffer_load_dwordx4 v[64:67], v28, s[8:11], s77 offen offset:0 sc1
  v_mfma_f32_16x16x32_bf16 v[116:119], v[84:87], a[196:199], v[116:119]
  v_mfma_f32_16x16x32_bf16 v[136:139], a[104:107], a[176:179], v[136:139]
  buffer_load_dwordx4 v[68:71], v28, s[8:11], s77 offen offset:1024 sc1
  v_mfma_f32_16x16x32_bf16 v[136:139], v[88:91], a[196:199], v[136:139]
  v_mfma_f32_16x16x32_bf16 v[156:159], a[108:111], a[176:179], v[156:159]
  s_nop 0
  ds_write_addtid_b32 v96 offset:0
  ds_write_addtid_b32 v97 offset:256
  v_mfma_f32_16x16x32_bf16 v[156:159], v[92:95], a[196:199], v[156:159]
  ds_write_addtid_b32 v98 offset:512
  v_mfma_f32_16x16x32_bf16 v[100:103], a[96:99], a[180:183], v[100:103]
  ds_write_addtid_b32 v99 offset:768
  ds_write_addtid_b32 v116 offset:5120
  v_mfma_f32_16x16x32_bf16 v[100:103], v[80:83], a[200:203], v[100:103]
  ds_write_addtid_b32 v117 offset:5376
  v_mfma_f32_16x16x32_bf16 v[120:123], a[100:103], a[180:183], v[120:123]
  ds_write_addtid_b32 v118 offset:5632
  ds_write_addtid_b32 v119 offset:5888
  v_mfma_f32_16x16x32_bf16 v[120:123], v[84:87], a[200:203], v[120:123]
  ds_write_addtid_b32 v136 offset:10240
  v_mfma_f32_16x16x32_bf16 v[140:143], a[104:107], a[180:183], v[140:143]
  ds_write_addtid_b32 v137 offset:10496
  ds_write_addtid_b32 v138 offset:10752
  v_mfma_f32_16x16x32_bf16 v[140:143], v[88:91], a[200:203], v[140:143]
  ds_write_addtid_b32 v139 offset:11008
  v_mfma_f32_16x16x32_bf16 v[160:163], a[108:111], a[180:183], v[160:163]
  ds_write_addtid_b32 v156 offset:15360
  ds_write_addtid_b32 v157 offset:15616
  v_mfma_f32_16x16x32_bf16 v[160:163], v[92:95], a[200:203], v[160:163]
  ds_write_addtid_b32 v158 offset:15872
  v_mfma_f32_16x16x32_bf16 v[104:107], a[96:99], a[184:187], v[104:107]
  ds_write_addtid_b32 v159 offset:16128
  v_mfma_f32_16x16x32_bf16 v[104:107], v[80:83], a[204:207], v[104:107]
  ds_write_addtid_b32 v100 offset:1024
  ds_write_addtid_b32 v101 offset:1280
  v_mfma_f32_16x16x32_bf16 v[124:127], a[100:103], a[184:187], v[124:127]
  ds_write_addtid_b32 v102 offset:1536
  v_mfma_f32_16x16x32_bf16 v[124:127], v[84:87], a[204:207], v[124:127]
  ds_write_addtid_b32 v103 offset:1792
  ds_write_addtid_b32 v120 offset:6144
  v_mfma_f32_16x16x32_bf16 v[144:147], a[104:107], a[184:187], v[144:147]
  ds_write_addtid_b32 v121 offset:6400
  v_mfma_f32_16x16x32_bf16 v[144:147], v[88:91], a[204:207], v[144:147]
  ds_write_addtid_b32 v122 offset:6656
  ds_write_addtid_b32 v123 offset:6912
  v_mfma_f32_16x16x32_bf16 v[164:167], a[108:111], a[184:187], v[164:167]
  ds_write_addtid_b32 v140 offset:11264
  v_mfma_f32_16x16x32_bf16 v[164:167], v[92:95], a[204:207], v[164:167]
  ds_write_addtid_b32 v141 offset:11520
  ds_write_addtid_b32 v142 offset:11776
  v_mfma_f32_16x16x32_bf16 v[108:111], a[96:99], a[188:191], v[108:111]
  ds_write_addtid_b32 v143 offset:12032
  v_mfma_f32_16x16x32_bf16 v[108:111], v[80:83], a[208:211], v[108:111]
  ds_write_addtid_b32 v160 offset:16384
  ds_write_addtid_b32 v161 offset:16640
  v_mfma_f32_16x16x32_bf16 v[128:131], a[100:103], a[188:191], v[128:131]
  ds_write_addtid_b32 v162 offset:16896
  v_mfma_f32_16x16x32_bf16 v[128:131], v[84:87], a[208:211], v[128:131]
  ds_write_addtid_b32 v163 offset:17152
  v_mfma_f32_16x16x32_bf16 v[148:151], a[104:107], a[188:191], v[148:151]
  ds_write_addtid_b32 v104 offset:2048
  ds_write_addtid_b32 v105 offset:2304
  v_mfma_f32_16x16x32_bf16 v[148:151], v[88:91], a[208:211], v[148:151]
  ds_write_addtid_b32 v106 offset:2560
  buffer_load_dwordx4 v[72:75], v28, s[8:11], s77 offen offset:2048 sc1
  v_mfma_f32_16x16x32_bf16 v[168:171], a[108:111], a[188:191], v[168:171]
  ds_write_addtid_b32 v107 offset:2816
  ds_write_addtid_b32 v124 offset:7168
  buffer_load_dwordx4 v[76:79], v28, s[8:11], s77 offen offset:3072 sc1
  v_mfma_f32_16x16x32_bf16 v[168:171], v[92:95], a[208:211], v[168:171]
  ds_write_addtid_b32 v125 offset:7424
  s_add_u32 s77, s83, 24576
  buffer_load_dwordx4 a[216:219], v28, s[8:11], s77 offen offset:0 sc1
  v_mfma_f32_16x16x32_bf16 v[112:115], a[96:99], a[192:195], v[112:115]
  ds_write_addtid_b32 v126 offset:7680
  ds_write_addtid_b32 v127 offset:7936
  buffer_load_dwordx4 a[220:223], v28, s[8:11], s77 offen offset:1024 sc1
  v_mfma_f32_16x16x32_bf16 v[112:115], v[80:83], a[212:215], v[112:115]
  ds_write_addtid_b32 v144 offset:12288
  buffer_load_dwordx4 a[224:227], v28, s[8:11], s77 offen offset:2048 sc1
  v_mfma_f32_16x16x32_bf16 v[132:135], a[100:103], a[192:195], v[132:135]
  ds_write_addtid_b32 v145 offset:12544
  ds_write_addtid_b32 v146 offset:12800
  buffer_load_dwordx4 a[228:231], v28, s[8:11], s77 offen offset:3072 sc1
  v_mfma_f32_16x16x32_bf16 v[132:135], v[84:87], a[212:215], v[132:135]
  ds_write_addtid_b32 v147 offset:13056
  s_add_u32 s77, s83, 28672
  v_mfma_f32_16x16x32_bf16 v[152:155], a[104:107], a[192:195], v[152:155]
  ds_write_addtid_b32 v164 offset:17408
  ds_write_addtid_b32 v165 offset:17664
  buffer_load_dwordx4 a[232:235], v28, s[8:11], s77 offen offset:0 sc1
  v_mfma_f32_16x16x32_bf16 v[152:155], v[88:91], a[212:215], v[152:155]
  ds_write_addtid_b32 v166 offset:17920
  buffer_load_dwordx4 a[236:239], v28, s[8:11], s77 offen offset:1024 sc1
  v_mfma_f32_16x16x32_bf16 v[172:175], a[108:111], a[192:195], v[172:175]
  ds_write_addtid_b32 v167 offset:18176
  buffer_load_dwordx4 a[240:243], v28, s[8:11], s77 offen offset:2048 sc1
  v_mfma_f32_16x16x32_bf16 v[172:175], v[92:95], a[212:215], v[172:175]
  ds_write_addtid_b32 v108 offset:3072
  ds_write_addtid_b32 v109 offset:3328
  buffer_load_dwordx4 a[244:247], v28, s[8:11], s77 offen offset:3072 sc1
  s_waitcnt vmcnt(16)
  v_mfma_f32_16x16x32_bf16 v[176:179], v[32:35], a[0:3], v[176:179]
  ds_write_addtid_b32 v110 offset:3584
  ds_write_addtid_b32 v111 offset:3840
  v_mfma_f32_16x16x32_bf16 v[196:199], v[36:39], a[0:3], v[196:199]
  ds_write_addtid_b32 v128 offset:8192
  ds_write_addtid_b32 v129 offset:8448
  v_mfma_f32_16x16x32_bf16 v[216:219], v[40:43], a[0:3], v[216:219]
  ds_write_addtid_b32 v130 offset:8704
  s_add_u32 s77, s83, 32768
  v_mfma_f32_16x16x32_bf16 v[236:239], v[44:47], a[0:3], v[236:239]
  ds_write_addtid_b32 v131 offset:8960
  ds_write_addtid_b32 v148 offset:13312
  v_mfma_f32_16x16x32_bf16 v[240:243], v[44:47], a[4:7], v[240:243]
  ds_write_addtid_b32 v149 offset:13568
  ds_write_addtid_b32 v150 offset:13824
  v_mfma_f32_16x16x32_bf16 v[220:223], v[40:43], a[4:7], v[220:223]
  ds_write_addtid_b32 v151 offset:14080
  v_mfma_f32_16x16x32_bf16 v[200:203], v[36:39], a[4:7], v[200:203]
  ds_write_addtid_b32 v168 offset:18432
  ds_write_addtid_b32 v169 offset:18688
  v_mfma_f32_16x16x32_bf16 v[180:183], v[32:35], a[4:7], v[180:183]
  ds_write_addtid_b32 v170 offset:18944
  ds_write_addtid_b32 v171 offset:19200
  v_mfma_f32_16x16x32_bf16 v[184:187], v[32:35], a[8:11], v[184:187]
  ds_write_addtid_b32 v112 offset:4096
  v_mfma_f32_16x16x32_bf16 v[204:207], v[36:39], a[8:11], v[204:207]
  ds_write_addtid_b32 v113 offset:4352
  ds_write_addtid_b32 v114 offset:4608
  v_mfma_f32_16x16x32_bf16 v[224:227], v[40:43], a[8:11], v[224:227]
  ds_write_addtid_b32 v115 offset:4864
  ds_write_addtid_b32 v132 offset:9216
  v_mfma_f32_16x16x32_bf16 v[244:247], v[44:47], a[8:11], v[244:247]
  ds_write_addtid_b32 v133 offset:9472
  buffer_load_dwordx4 a[96:99], v28, s[8:11], s77 offen offset:0 sc1
  v_mfma_f32_16x16x32_bf16 v[248:251], v[44:47], a[12:15], v[248:251]
  ds_write_addtid_b32 v134 offset:9728
  ds_write_addtid_b32 v135 offset:9984
  buffer_load_dwordx4 a[100:103], v28, s[8:11], s77 offen offset:1024 sc1
  v_mfma_f32_16x16x32_bf16 v[228:231], v[40:43], a[12:15], v[228:231]
  ds_write_addtid_b32 v152 offset:14336
  ds_write_addtid_b32 v153 offset:14592
  buffer_load_dwordx4 a[104:107], v28, s[8:11], s77 offen offset:2048 sc1
  v_mfma_f32_16x16x32_bf16 v[208:211], v[36:39], a[12:15], v[208:211]
  ds_write_addtid_b32 v154 offset:14848
  buffer_load_dwordx4 a[108:111], v28, s[8:11], s77 offen offset:3072 sc1
  v_mfma_f32_16x16x32_bf16 v[188:191], v[32:35], a[12:15], v[188:191]
  ds_write_addtid_b32 v155 offset:15104
  ds_write_addtid_b32 v172 offset:19456
  s_add_u32 s77, s83, 36864
  v_mfma_f32_16x16x32_bf16 v[192:195], v[32:35], a[16:19], v[192:195]
  ds_write_addtid_b32 v173 offset:19712
  ds_write_addtid_b32 v174 offset:19968
  buffer_load_dwordx4 v[80:83], v28, s[8:11], s77 offen offset:0 sc1
  v_mfma_f32_16x16x32_bf16 v[212:215], v[36:39], a[16:19], v[212:215]
  ds_write_addtid_b32 v175 offset:20224
  buffer_load_dwordx4 v[84:87], v28, s[8:11], s77 offen offset:1024 sc1
  v_mfma_f32_16x16x32_bf16 v[232:235], v[40:43], a[16:19], v[232:235]
  buffer_load_dwordx4 v[88:91], v28, s[8:11], s77 offen offset:2048 sc1
  v_mfma_f32_16x16x32_bf16 v[252:255], v[44:47], a[16:19], v[252:255]
  buffer_load_dwordx4 v[92:95], v28, s[8:11], s77 offen offset:3072 sc1
  s_waitcnt vmcnt(20) lgkmcnt(0)
  s_barrier
  v_mfma_f32_16x16x32_bf16 v[176:179], v[48:51], a[20:23], v[176:179]
  s_add_u32 s77, s83, 40960
  v_mfma_f32_16x16x32_bf16 v[196:199], v[52:55], a[20:23], v[196:199]
  ds_read_b128 v[96:99], v23 offset:0
  ds_read_b128 v[100:103], v23 offset:20480
  v_mfma_f32_16x16x32_bf16 v[216:219], v[56:59], a[20:23], v[216:219]
  buffer_load_dwordx4 v[32:35], v28, s[8:11], s77 offen offset:0 sc1
  ds_read_b128 v[104:107], v24 offset:0
  v_mfma_f32_16x16x32_bf16 v[236:239], v[60:63], a[20:23], v[236:239]
  ds_read_b128 v[108:111], v24 offset:20480
  ds_read_b128 v[112:115], v23 offset:1024
  ds_read_b128 v[116:119], v23 offset:21504
  v_mfma_f32_16x16x32_bf16 v[240:243], v[60:63], a[24:27], v[240:243]
  buffer_load_dwordx4 v[36:39], v28, s[8:11], s77 offen offset:1024 sc1
  ds_read_b128 v[120:123], v24 offset:1024
  v_mfma_f32_16x16x32_bf16 v[220:223], v[56:59], a[24:27], v[220:223]
  ds_read_b128 v[124:127], v24 offset:21504
  ds_read_b128 v[128:131], v23 offset:2048
  v_mfma_f32_16x16x32_bf16 v[200:203], v[52:55], a[24:27], v[200:203]
  ds_read_b128 v[132:135], v23 offset:22528
  ds_read_b128 v[136:139], v24 offset:2048
  v_mfma_f32_16x16x32_bf16 v[180:183], v[48:51], a[24:27], v[180:183]
  buffer_load_dwordx4 v[40:43], v28, s[8:11], s77 offen offset:2048 sc1
  v_mfma_f32_16x16x32_bf16 v[184:187], v[48:51], a[28:31], v[184:187]
  ds_read_b128 v[140:143], v24 offset:22528
  ds_read_b128 v[144:147], v23 offset:3072
  v_mfma_f32_16x16x32_bf16 v[204:207], v[52:55], a[28:31], v[204:207]
  ds_read_b128 v[148:151], v23 offset:23552
  ds_read_b128 v[152:155], v24 offset:3072
  v_mfma_f32_16x16x32_bf16 v[224:227], v[56:59], a[28:31], v[224:227]
  buffer_load_dwordx4 v[44:47], v28, s[8:11], s77 offen offset:3072 sc1
  v_mfma_f32_16x16x32_bf16 v[244:247], v[60:63], a[28:31], v[244:247]
  ds_read_b128 v[156:159], v24 offset:23552
  ds_read_b128 v[160:163], v23 offset:4096
  v_mfma_f32_16x16x32_bf16 v[248:251], v[60:63], a[32:35], v[248:251]
  ds_read_b128 v[164:167], v23 offset:24576
  ds_read_b128 v[168:171], v24 offset:4096
  v_mfma_f32_16x16x32_bf16 v[228:231], v[56:59], a[32:35], v[228:231]
  ds_read_b128 v[172:175], v24 offset:24576
  s_waitcnt lgkmcnt(15)
  v_mfma_f32_16x16x32_bf16 v[208:211], v[52:55], a[32:35], v[208:211]
  v_add_f32 v96, v96, v100
  v_add_f32 v104, v104, v108
  v_mfma_f32_16x16x32_bf16 v[188:191], v[48:51], a[32:35], v[188:191]
  v_add_f32 v97, v97, v101
  v_add_f32 v105, v105, v109
  v_mfma_f32_16x16x32_bf16 v[192:195], v[48:51], a[36:39], v[192:195]
  v_add_f32 v98, v98, v102
  v_add_f32 v106, v106, v110
  v_mfma_f32_16x16x32_bf16 v[212:215], v[52:55], a[36:39], v[212:215]
  v_add_f32 v99, v99, v103
  v_add_f32 v107, v107, v111
  v_mfma_f32_16x16x32_bf16 v[232:235], v[56:59], a[36:39], v[232:235]
  v_add_f32 v96, v96, v104
  v_add_f32 v97, v97, v105
  v_mfma_f32_16x16x32_bf16 v[252:255], v[60:63], a[36:39], v[252:255]
  v_add_f32 v98, v98, v106
  v_add_f32 v99, v99, v107
  s_waitcnt vmcnt(20)
  v_mfma_f32_16x16x32_bf16 v[176:179], v[64:67], a[40:43], v[176:179]
  s_add_u32 s77, s83, 45056
  v_mfma_f32_16x16x32_bf16 v[196:199], v[68:71], a[40:43], v[196:199]
  s_waitcnt lgkmcnt(12)
  v_add_f32 v112, v112, v116
  v_mfma_f32_16x16x32_bf16 v[216:219], v[72:75], a[40:43], v[216:219]
  buffer_load_dwordx4 v[48:51], v28, s[8:11], s77 offen offset:0 sc1
  v_mfma_f32_16x16x32_bf16 v[236:239], v[76:79], a[40:43], v[236:239]
  v_add_f32 v120, v120, v124
  v_add_f32 v113, v113, v117
  v_mfma_f32_16x16x32_bf16 v[240:243], v[76:79], a[44:47], v[240:243]
  v_add_f32 v121, v121, v125
  buffer_load_dwordx4 v[52:55], v28, s[8:11], s77 offen offset:1024 sc1
  v_mfma_f32_16x16x32_bf16 v[220:223], v[72:75], a[44:47], v[220:223]
  v_add_f32 v114, v114, v118
  v_mfma_f32_16x16x32_bf16 v[200:203], v[68:71], a[44:47], v[200:203]
  v_add_f32 v122, v122, v126
  v_add_f32 v115, v115, v119
  v_mfma_f32_16x16x32_bf16 v[180:183], v[64:67], a[44:47], v[180:183]
  v_add_f32 v123, v123, v127
  v_add_f32 v112, v112, v120
  v_mfma_f32_16x16x32_bf16 v[184:187], v[64:67], a[48:51], v[184:187]
  buffer_load_dwordx4 v[56:59], v28, s[8:11], s77 offen offset:2048 sc1
  v_mfma_f32_16x16x32_bf16 v[204:207], v[68:71], a[48:51], v[204:207]
  v_add_f32 v113, v113, v121
  v_add_f32 v114, v114, v122
  v_mfma_f32_16x16x32_bf16 v[224:227], v[72:75], a[48:51], v[224:227]
  v_add_f32 v115, v115, v123
  buffer_load_dwordx4 v[60:63], v28, s[8:11], s77 offen offset:3072 sc1
  v_mfma_f32_16x16x32_bf16 v[244:247], v[76:79], a[48:51], v[244:247]
  s_waitcnt lgkmcnt(8)
  v_add_f32 v128, v128, v132
  v_mfma_f32_16x16x32_bf16 v[248:251], v[76:79], a[52:55], v[248:251]
  v_add_f32 v136, v136, v140
  v_add_f32 v129, v129, v133
  v_mfma_f32_16x16x32_bf16 v[228:231], v[72:75], a[52:55], v[228:231]
  v_add_f32 v137, v137, v141
  v_add_f32 v130, v130, v134
  v_mfma_f32_16x16x32_bf16 v[208:211], v[68:71], a[52:55], v[208:211]
  v_add_f32 v138, v138, v142
  v_add_f32 v131, v131, v135
  v_mfma_f32_16x16x32_bf16 v[188:191], v[64:67], a[52:55], v[188:191]
  v_add_f32 v139, v139, v143
  v_add_f32 v128, v128, v136
  v_mfma_f32_16x16x32_bf16 v[192:195], v[64:67], a[56:59], v[192:195]
  v_add_f32 v129, v129, v137
  v_add_f32 v130, v130, v138
  v_mfma_f32_16x16x32_bf16 v[212:215], v[68:71], a[56:59], v[212:215]
  v_add_f32 v131, v131, v139
  buffer_store_dwordx4 v[96:99], v28, s[8:11], s4 offen offset:0 sc1
  v_mfma_f32_16x16x32_bf16 v[232:235], v[72:75], a[56:59], v[232:235]
  v_mfma_f32_16x16x32_bf16 v[252:255], v[76:79], a[56:59], v[252:255]
  buffer_store_dwordx4 v[112:115], v28, s[8:11], s4 offen offset:1024 sc1
  s_waitcnt vmcnt(22)
  v_mfma_f32_16x16x32_bf16 v[176:179], a[216:219], a[60:63], v[176:179]
  v_mfma_f32_16x16x32_bf16 v[196:199], a[220:223], a[60:63], v[196:199]
  s_waitcnt lgkmcnt(4)
  v_add_f32 v144, v144, v148
  v_mfma_f32_16x16x32_bf16 v[216:219], a[224:227], a[60:63], v[216:219]
  v_add_f32 v152, v152, v156
  v_add_f32 v145, v145, v149
  v_mfma_f32_16x16x32_bf16 v[236:239], a[228:231], a[60:63], v[236:239]
  v_add_f32 v153, v153, v157
  v_mfma_f32_16x16x32_bf16 v[240:243], a[228:231], a[64:67], v[240:243]
  v_add_f32 v146, v146, v150
  v_add_f32 v154, v154, v158
  v_mfma_f32_16x16x32_bf16 v[220:223], a[224:227], a[64:67], v[220:223]
  v_add_f32 v147, v147, v151
  v_add_f32 v155, v155, v159
  v_mfma_f32_16x16x32_bf16 v[200:203], a[220:223], a[64:67], v[200:203]
  v_add_f32 v144, v144, v152
  v_mfma_f32_16x16x32_bf16 v[180:183], a[216:219], a[64:67], v[180:183]
  v_add_f32 v145, v145, v153
  v_add_f32 v146, v146, v154
  v_mfma_f32_16x16x32_bf16 v[184:187], a[216:219], a[68:71], v[184:187]
  v_add_f32 v147, v147, v155
  v_mfma_f32_16x16x32_bf16 v[204:207], a[220:223], a[68:71], v[204:207]
  buffer_store_dwordx4 v[128:131], v28, s[8:11], s4 offen offset:2048 sc1
  v_mfma_f32_16x16x32_bf16 v[224:227], a[224:227], a[68:71], v[224:227]
  s_waitcnt lgkmcnt(0)
  v_add_f32 v160, v160, v164
  v_add_f32 v168, v168, v172
  v_mfma_f32_16x16x32_bf16 v[244:247], a[228:231], a[68:71], v[244:247]
  v_add_f32 v161, v161, v165
  v_mfma_f32_16x16x32_bf16 v[248:251], a[228:231], a[72:75], v[248:251]
  v_add_f32 v169, v169, v173
  v_add_f32 v162, v162, v166
  v_mfma_f32_16x16x32_bf16 v[228:231], a[224:227], a[72:75], v[228:231]
  v_add_f32 v170, v170, v174
  v_mfma_f32_16x16x32_bf16 v[208:211], a[220:223], a[72:75], v[208:211]
  v_add_f32 v163, v163, v167
  v_add_f32 v171, v171, v175
  v_mfma_f32_16x16x32_bf16 v[188:191], a[216:219], a[72:75], v[188:191]
  v_add_f32 v160, v160, v168
  v_add_f32 v161, v161, v169
  v_mfma_f32_16x16x32_bf16 v[192:195], a[216:219], a[76:79], v[192:195]
  v_add_f32 v162, v162, v170
  v_mfma_f32_16x16x32_bf16 v[212:215], a[220:223], a[76:79], v[212:215]
  v_add_f32 v163, v163, v171
  buffer_store_dwordx4 v[144:147], v28, s[8:11], s4 offen offset:3072 sc1
  v_mfma_f32_16x16x32_bf16 v[232:235], a[224:227], a[76:79], v[232:235]
  v_mfma_f32_16x16x32_bf16 v[252:255], a[228:231], a[76:79], v[252:255]
  buffer_store_dwordx4 v[160:163], v29, s[8:11], s4 offen offset:0 sc1
  s_waitcnt vmcnt(21)
  v_mfma_f32_16x16x32_bf16 v[176:179], a[232:235], a[116:119], v[176:179]
  v_mfma_f32_16x16x32_bf16 v[196:199], a[236:239], a[116:119], v[196:199]
  v_add_u32 v23, 81920, v23
  v_add_u32 v24, 81920, v24
  v_mfma_f32_16x16x32_bf16 v[216:219], a[240:243], a[116:119], v[216:219]
  s_mov_b32 m0, s100
  v_mfma_f32_16x16x32_bf16 v[236:239], a[244:247], a[116:119], v[236:239]
  v_accvgpr_read_b32 v104, a80
  v_mfma_f32_16x16x32_bf16 v[240:243], a[244:247], a[120:123], v[240:243]
  v_accvgpr_read_b32 v105, a81
  v_accvgpr_read_b32 v106, a82
  v_mfma_f32_16x16x32_bf16 v[220:223], a[240:243], a[120:123], v[220:223]
  v_accvgpr_read_b32 v107, a83
  v_mfma_f32_16x16x32_bf16 v[200:203], a[236:239], a[120:123], v[200:203]
  v_accvgpr_read_b32 v120, a84
  v_mfma_f32_16x16x32_bf16 v[180:183], a[232:235], a[120:123], v[180:183]
  v_accvgpr_read_b32 v121, a85
  v_mfma_f32_16x16x32_bf16 v[184:187], a[232:235], a[124:127], v[184:187]
  v_accvgpr_read_b32 v122, a86
  v_accvgpr_read_b32 v123, a87
  v_mfma_f32_16x16x32_bf16 v[204:207], a[236:239], a[124:127], v[204:207]
  v_accvgpr_read_b32 v136, a88
  v_mfma_f32_16x16x32_bf16 v[224:227], a[240:243], a[124:127], v[224:227]
  v_accvgpr_read_b32 v137, a89
  v_mfma_f32_16x16x32_bf16 v[244:247], a[244:247], a[124:127], v[244:247]
  v_accvgpr_read_b32 v138, a90
  v_accvgpr_read_b32 v139, a91
  v_mfma_f32_16x16x32_bf16 v[248:251], a[244:247], a[128:131], v[248:251]
  v_accvgpr_read_b32 v152, a92
  v_mfma_f32_16x16x32_bf16 v[228:231], a[240:243], a[128:131], v[228:231]
  v_accvgpr_read_b32 v153, a93
  v_mfma_f32_16x16x32_bf16 v[208:211], a[236:239], a[128:131], v[208:211]
  v_accvgpr_read_b32 v154, a94
  v_mfma_f32_16x16x32_bf16 v[188:191], a[232:235], a[128:131], v[188:191]
  v_accvgpr_read_b32 v155, a95
  v_mov_b32 v168, v6
  v_mfma_f32_16x16x32_bf16 v[192:195], a[232:235], a[132:135], v[192:195]
  v_mov_b32 v169, v7
  v_mfma_f32_16x16x32_bf16 v[212:215], a[236:239], a[132:135], v[212:215]
  v_mov_b32 v170, v26
  v_mfma_f32_16x16x32_bf16 v[232:235], a[240:243], a[132:135], v[232:235]
  v_mov_b32 v171, v27
  v_mfma_f32_16x16x32_bf16 v[252:255], a[244:247], a[132:135], v[252:255]
  s_waitcnt vmcnt(17)
  v_mfma_f32_16x16x32_bf16 v[176:179], a[96:99], a[136:139], v[176:179]
  v_mfma_f32_16x16x32_bf16 v[196:199], a[100:103], a[136:139], v[196:199]
  s_xor_b32 s31, s95, 4
  v_mfma_f32_16x16x32_bf16 v[216:219], a[104:107], a[136:139], v[216:219]
  v_mfma_f32_16x16x32_bf16 v[236:239], a[108:111], a[136:139], v[236:239]
  v_mfma_f32_16x16x32_bf16 v[240:243], a[108:111], a[140:143], v[240:243]
  s_lshl_b32 s31, s31, 7
  v_mfma_f32_16x16x32_bf16 v[220:223], a[104:107], a[140:143], v[220:223]
  v_mfma_f32_16x16x32_bf16 v[200:203], a[100:103], a[140:143], v[200:203]
  v_mfma_f32_16x16x32_bf16 v[180:183], a[96:99], a[140:143], v[180:183]
  v_mfma_f32_16x16x32_bf16 v[184:187], a[96:99], a[144:147], v[184:187]
  s_add_u32 s31, s31, 524288
  v_mfma_f32_16x16x32_bf16 v[204:207], a[100:103], a[144:147], v[204:207]
  v_mfma_f32_16x16x32_bf16 v[224:227], a[104:107], a[144:147], v[224:227]
  v_mfma_f32_16x16x32_bf16 v[244:247], a[108:111], a[144:147], v[244:247]
  v_min_u32 v9, 0, v1
  v_mfma_f32_16x16x32_bf16 v[248:251], a[108:111], a[148:151], v[248:251]
  v_mfma_f32_16x16x32_bf16 v[228:231], a[104:107], a[148:151], v[228:231]
  v_mfma_f32_16x16x32_bf16 v[208:211], a[100:103], a[148:151], v[208:211]
  v_mfma_f32_16x16x32_bf16 v[188:191], a[96:99], a[148:151], v[188:191]
  v_lshlrev_b32 v9, 7, v9
  v_mfma_f32_16x16x32_bf16 v[192:195], a[96:99], a[152:155], v[192:195]
  v_mfma_f32_16x16x32_bf16 v[212:215], a[100:103], a[152:155], v[212:215]
  v_mfma_f32_16x16x32_bf16 v[232:235], a[104:107], a[152:155], v[232:235]
  v_mfma_f32_16x16x32_bf16 v[252:255], a[108:111], a[152:155], v[252:255]
  s_waitcnt vmcnt(5)
  v_mfma_f32_16x16x32_bf16 v[176:179], v[80:83], a[156:159], v[176:179]
  v_mfma_f32_16x16x32_bf16 v[176:179], v[32:35], a[176:179], v[176:179]
  v_mfma_f32_16x16x32_bf16 v[176:179], v[48:51], a[196:199], v[176:179]
  v_mfma_f32_16x16x32_bf16 v[196:199], v[84:87], a[156:159], v[196:199]
  v_mfma_f32_16x16x32_bf16 v[196:199], v[36:39], a[176:179], v[196:199]
  v_mfma_f32_16x16x32_bf16 v[196:199], v[52:55], a[196:199], v[196:199]
  v_mfma_f32_16x16x32_bf16 v[216:219], v[88:91], a[156:159], v[216:219]
  s_nop 3
  ds_write_addtid_b32 v176 offset:0
  ds_write_addtid_b32 v177 offset:256
  v_mfma_f32_16x16x32_bf16 v[216:219], v[40:43], a[176:179], v[216:219]
  ds_write_addtid_b32 v178 offset:512
  v_mfma_f32_16x16x32_bf16 v[216:219], v[56:59], a[196:199], v[216:219]
  ds_write_addtid_b32 v179 offset:768
  v_mfma_f32_16x16x32_bf16 v[236:239], v[92:95], a[156:159], v[236:239]
  ds_write_addtid_b32 v196 offset:5120
  ds_write_addtid_b32 v197 offset:5376
  v_mfma_f32_16x16x32_bf16 v[236:239], v[44:47], a[176:179], v[236:239]
  ds_write_addtid_b32 v198 offset:5632
  v_mfma_f32_16x16x32_bf16 v[236:239], v[60:63], a[196:199], v[236:239]
  ds_write_addtid_b32 v199 offset:5888
  v_mfma_f32_16x16x32_bf16 v[180:183], v[80:83], a[160:163], v[180:183]
  ds_write_addtid_b32 v216 offset:10240
  ds_write_addtid_b32 v217 offset:10496
  s_waitcnt vmcnt(0)
  buffer_store_dword v31, v8, s[8:11], s6 offen sc1
  v_mfma_f32_16x16x32_bf16 v[180:183], v[32:35], a[180:183], v[180:183]
  ds_write_addtid_b32 v218 offset:10752
  v_mfma_f32_16x16x32_bf16 v[180:183], v[48:51], a[200:203], v[180:183]
  ds_write_addtid_b32 v219 offset:11008
  v_mfma_f32_16x16x32_bf16 v[200:203], v[84:87], a[160:163], v[200:203]
  ds_write_addtid_b32 v236 offset:15360
  ds_write_addtid_b32 v237 offset:15616
  v_mfma_f32_16x16x32_bf16 v[200:203], v[36:39], a[180:183], v[200:203]
  ds_write_addtid_b32 v238 offset:15872
  v_mfma_f32_16x16x32_bf16 v[200:203], v[52:55], a[200:203], v[200:203]
  ds_write_addtid_b32 v239 offset:16128
  v_mfma_f32_16x16x32_bf16 v[220:223], v[88:91], a[160:163], v[220:223]
  ds_write_addtid_b32 v180 offset:1024
  ds_write_addtid_b32 v181 offset:1280
TS_20:
  s_cbranch_execz TR_P
  v_mfma_f32_16x16x32_bf16 v[220:223], v[40:43], a[180:183], v[220:223]
  ds_write_addtid_b32 v182 offset:1536
  v_mfma_f32_16x16x32_bf16 v[220:223], v[56:59], a[200:203], v[220:223]
  ds_write_addtid_b32 v183 offset:1792
  v_mfma_f32_16x16x32_bf16 v[240:243], v[92:95], a[160:163], v[240:243]
  ds_write_addtid_b32 v200 offset:6144
  ds_write_addtid_b32 v201 offset:6400
  v_mfma_f32_16x16x32_bf16 v[240:243], v[44:47], a[180:183], v[240:243]
  ds_write_addtid_b32 v202 offset:6656
  v_mfma_f32_16x16x32_bf16 v[240:243], v[60:63], a[200:203], v[240:243]
  ds_write_addtid_b32 v203 offset:6912
  v_mfma_f32_16x16x32_bf16 v[184:187], v[80:83], a[164:167], v[184:187]
  ds_write_addtid_b32 v220 offset:11264
  ds_write_addtid_b32 v221 offset:11520
  v_mfma_f32_16x16x32_bf16 v[184:187], v[32:35], a[184:187], v[184:187]
  ds_write_addtid_b32 v222 offset:11776
  v_mfma_f32_16x16x32_bf16 v[184:187], v[48:51], a[204:207], v[184:187]
  ds_write_addtid_b32 v223 offset:12032
  v_mfma_f32_16x16x32_bf16 v[204:207], v[84:87], a[164:167], v[204:207]
  ds_write_addtid_b32 v240 offset:16384
  ds_write_addtid_b32 v241 offset:16640
  v_mfma_f32_16x16x32_bf16 v[204:207], v[36:39], a[184:187], v[204:207]
  ds_write_addtid_b32 v242 offset:16896
  v_mfma_f32_16x16x32_bf16 v[204:207], v[52:55], a[204:207], v[204:207]
  ds_write_addtid_b32 v243 offset:17152
  v_mfma_f32_16x16x32_bf16 v[224:227], v[88:91], a[164:167], v[224:227]
  ds_write_addtid_b32 v184 offset:2048
  ds_write_addtid_b32 v185 offset:2304
  v_mfma_f32_16x16x32_bf16 v[224:227], v[40:43], a[184:187], v[224:227]
  ds_write_addtid_b32 v186 offset:2560
  v_mfma_f32_16x16x32_bf16 v[224:227], v[56:59], a[204:207], v[224:227]
  ds_write_addtid_b32 v187 offset:2816
  v_mfma_f32_16x16x32_bf16 v[244:247], v[92:95], a[164:167], v[244:247]
  ds_write_addtid_b32 v204 offset:7168
  ds_write_addtid_b32 v205 offset:7424
  v_mfma_f32_16x16x32_bf16 v[244:247], v[44:47], a[184:187], v[244:247]
  ds_write_addtid_b32 v206 offset:7680
  v_mfma_f32_16x16x32_bf16 v[244:247], v[60:63], a[204:207], v[244:247]
  ds_write_addtid_b32 v207 offset:7936
  v_mfma_f32_16x16x32_bf16 v[188:191], v[80:83], a[168:171], v[188:191]
  ds_write_addtid_b32 v224 offset:12288
  ds_write_addtid_b32 v225 offset:12544
  v_mfma_f32_16x16x32_bf16 v[188:191], v[32:35], a[188:191], v[188:191]
  ds_write_addtid_b32 v226 offset:12800
  v_mfma_f32_16x16x32_bf16 v[188:191], v[48:51], a[208:211], v[188:191]
  ds_write_addtid_b32 v227 offset:13056
  v_mfma_f32_16x16x32_bf16 v[208:211], v[84:87], a[168:171], v[208:211]
  ds_write_addtid_b32 v244 offset:17408
  ds_write_addtid_b32 v245 offset:17664
  v_mfma_f32_16x16x32_bf16 v[208:211], v[36:39], a[188:191], v[208:211]
  ds_write_addtid_b32 v246 offset:17920
  v_mfma_f32_16x16x32_bf16 v[208:211], v[52:55], a[208:211], v[208:211]
  ds_write_addtid_b32 v247 offset:18176
  v_mfma_f32_16x16x32_bf16 v[228:231], v[88:91], a[168:171], v[228:231]
  ds_write_addtid_b32 v188 offset:3072
  ds_write_addtid_b32 v189 offset:3328
  v_mfma_f32_16x16x32_bf16 v[228:231], v[40:43], a[188:191], v[228:231]
  ds_write_addtid_b32 v190 offset:3584
  v_mfma_f32_16x16x32_bf16 v[228:231], v[56:59], a[208:211], v[228:231]
  ds_write_addtid_b32 v191 offset:3840
  v_mfma_f32_16x16x32_bf16 v[248:251], v[92:95], a[168:171], v[248:251]
  ds_write_addtid_b32 v208 offset:8192
  ds_write_addtid_b32 v209 offset:8448
  v_mfma_f32_16x16x32_bf16 v[248:251], v[44:47], a[188:191], v[248:251]
  ds_write_addtid_b32 v210 offset:8704
  v_mfma_f32_16x16x32_bf16 v[248:251], v[60:63], a[208:211], v[248:251]
  ds_write_addtid_b32 v211 offset:8960
  v_mfma_f32_16x16x32_bf16 v[192:195], v[80:83], a[172:175], v[192:195]
  ds_write_addtid_b32 v228 offset:13312
  ds_write_addtid_b32 v229 offset:13568
  v_mfma_f32_16x16x32_bf16 v[192:195], v[32:35], a[192:195], v[192:195]
  ds_write_addtid_b32 v230 offset:13824
  v_mfma_f32_16x16x32_bf16 v[192:195], v[48:51], a[212:215], v[192:195]
  ds_write_addtid_b32 v231 offset:14080
  v_mfma_f32_16x16x32_bf16 v[212:215], v[84:87], a[172:175], v[212:215]
  ds_write_addtid_b32 v248 offset:18432
  ds_write_addtid_b32 v249 offset:18688
  v_mfma_f32_16x16x32_bf16 v[212:215], v[36:39], a[192:195], v[212:215]
  ds_write_addtid_b32 v250 offset:18944
  v_mfma_f32_16x16x32_bf16 v[212:215], v[52:55], a[212:215], v[212:215]
  ds_write_addtid_b32 v251 offset:19200
  v_mfma_f32_16x16x32_bf16 v[232:235], v[88:91], a[172:175], v[232:235]
  ds_write_addtid_b32 v192 offset:4096
  ds_write_addtid_b32 v193 offset:4352
  v_mfma_f32_16x16x32_bf16 v[232:235], v[40:43], a[192:195], v[232:235]
  ds_write_addtid_b32 v194 offset:4608
  v_mfma_f32_16x16x32_bf16 v[232:235], v[56:59], a[212:215], v[232:235]
  ds_write_addtid_b32 v195 offset:4864
  buffer_load_dword v9, v9, s[8:11], s31 offen sc1
  v_mfma_f32_16x16x32_bf16 v[252:255], v[92:95], a[172:175], v[252:255]
  ds_write_addtid_b32 v212 offset:9216
  ds_write_addtid_b32 v213 offset:9472
  v_mfma_f32_16x16x32_bf16 v[252:255], v[44:47], a[192:195], v[252:255]
  ds_write_addtid_b32 v214 offset:9728
  v_mfma_f32_16x16x32_bf16 v[252:255], v[60:63], a[212:215], v[252:255]
  ds_write_addtid_b32 v215 offset:9984
  ds_write_addtid_b32 v232 offset:14336
  ds_write_addtid_b32 v233 offset:14592
  ds_write_addtid_b32 v234 offset:14848
  ds_write_addtid_b32 v235 offset:15104
  s_nop 2
  ds_write_addtid_b32 v252 offset:19456
  ds_write_addtid_b32 v253 offset:19712
  ds_write_addtid_b32 v254 offset:19968
  ds_write_addtid_b32 v255 offset:20224
  s_waitcnt lgkmcnt(0)
  s_barrier
  ds_read_b128 v[176:179], v23 offset:0
  ds_read_b128 v[180:183], v23 offset:20480
  ds_read_b128 v[184:187], v24 offset:0
  ds_read_b128 v[188:191], v24 offset:20480
  ds_read_b128 v[192:195], v23 offset:1024
  ds_read_b128 v[196:199], v23 offset:21504
  ds_read_b128 v[200:203], v24 offset:1024
  ds_read_b128 v[204:207], v24 offset:21504
  ds_read_b128 v[208:211], v23 offset:2048
  ds_read_b128 v[212:215], v23 offset:22528
  ds_read_b128 v[216:219], v24 offset:2048
  ds_read_b128 v[220:223], v24 offset:22528
  ds_read_b128 v[224:227], v23 offset:3072
  ds_read_b128 v[228:231], v23 offset:23552
  ds_read_b128 v[232:235], v24 offset:3072
  ds_read_b128 v[236:239], v24 offset:23552
  ds_read_b128 v[240:243], v23 offset:4096
  ds_read_b128 v[244:247], v23 offset:24576
  ds_read_b128 v[248:251], v24 offset:4096
  ds_read_b128 v[252:255], v24 offset:24576
  s_waitcnt vmcnt(0)
  v_cmp_ne_u32 vcc, s96, v9
  s_cbranch_vccz C3_ok
  s_mov_b32 s7, 0x40000
C3_l:
  s_xor_b32 s31, s95, 4
  s_lshl_b32 s31, s31, 7
  s_add_u32 s31, s31, 524288
  v_min_u32 v9, 0, v1
  v_lshlrev_b32 v9, 7, v9
  buffer_load_dword v9, v9, s[8:11], s31 offen sc1
  s_waitcnt vmcnt(0)
  v_cmp_ne_u32 vcc, s96, v9
  s_sub_u32 s7, s7, 1
  s_cbranch_scc1 C3_ok
  s_cbranch_vccnz C3_l
C3_ok:
  buffer_load_dwordx4 v[108:111], v28, s[8:11], s5 offen offset:0 sc1
  buffer_load_dwordx4 v[124:127], v28, s[8:11], s5 offen offset:1024 sc1
  buffer_load_dwordx4 v[140:143], v28, s[8:11], s5 offen offset:2048 sc1
  buffer_load_dwordx4 v[156:159], v28, s[8:11], s5 offen offset:3072 sc1
  buffer_load_dwordx4 v[172:175], v29, s[8:11], s5 offen offset:0 sc1
  s_waitcnt lgkmcnt(0)
  v_pk_add_f32 v[176:177], v[176:177], v[180:181] op_sel_hi:[1,1]
  v_pk_add_f32 v[184:185], v[184:185], v[188:189] op_sel_hi:[1,1]
  v_pk_add_f32 v[178:179], v[178:179], v[182:183] op_sel_hi:[1,1]
  v_pk_add_f32 v[186:187], v[186:187], v[190:191] op_sel_hi:[1,1]
  v_pk_add_f32 v[104:105], v[104:105], v[176:177] op_sel_hi:[1,1]
  v_pk_add_f32 v[106:107], v[106:107], v[178:179] op_sel_hi:[1,1]
  v_pk_add_f32 v[104:105], v[104:105], v[184:185] op_sel_hi:[1,1]
  v_pk_add_f32 v[106:107], v[106:107], v[186:187] op_sel_hi:[1,1]
  v_pk_add_f32 v[192:193], v[192:193], v[196:197] op_sel_hi:[1,1]
  v_pk_add_f32 v[200:201], v[200:201], v[204:205] op_sel_hi:[1,1]
  v_pk_add_f32 v[194:195], v[194:195], v[198:199] op_sel_hi:[1,1]
  v_pk_add_f32 v[202:203], v[202:203], v[206:207] op_sel_hi:[1,1]
  v_pk_add_f32 v[120:121], v[120:121], v[192:193] op_sel_hi:[1,1]
  v_pk_add_f32 v[122:123], v[122:123], v[194:195] op_sel_hi:[1,1]
  v_pk_add_f32 v[120:121], v[120:121], v[200:201] op_sel_hi:[1,1]
  v_pk_add_f32 v[122:123], v[122:123], v[202:203] op_sel_hi:[1,1]
  v_pk_add_f32 v[208:209], v[208:209], v[212:213] op_sel_hi:[1,1]
  v_pk_add_f32 v[216:217], v[216:217], v[220:221] op_sel_hi:[1,1]
  v_pk_add_f32 v[210:211], v[210:211], v[214:215] op_sel_hi:[1,1]
  v_pk_add_f32 v[218:219], v[218:219], v[222:223] op_sel_hi:[1,1]
  v_pk_add_f32 v[136:137], v[136:137], v[208:209] op_sel_hi:[1,1]
  v_pk_add_f32 v[138:139], v[138:139], v[210:211] op_sel_hi:[1,1]
  v_pk_add_f32 v[136:137], v[136:137], v[216:217] op_sel_hi:[1,1]
  v_pk_add_f32 v[138:139], v[138:139], v[218:219] op_sel_hi:[1,1]
  v_pk_add_f32 v[224:225], v[224:225], v[228:229] op_sel_hi:[1,1]
  v_pk_add_f32 v[232:233], v[232:233], v[236:237] op_sel_hi:[1,1]
  v_pk_add_f32 v[226:227], v[226:227], v[230:231] op_sel_hi:[1,1]
  v_pk_add_f32 v[234:235], v[234:235], v[238:239] op_sel_hi:[1,1]
  v_pk_add_f32 v[152:153], v[152:153], v[224:225] op_sel_hi:[1,1]
  v_pk_add_f32 v[154:155], v[154:155], v[226:227] op_sel_hi:[1,1]
  v_pk_add_f32 v[152:153], v[152:153], v[232:233] op_sel_hi:[1,1]
  v_pk_add_f32 v[154:155], v[154:155], v[234:235] op_sel_hi:[1,1]
  v_pk_add_f32 v[240:241], v[240:241], v[244:245] op_sel_hi:[1,1]
  v_pk_add_f32 v[248:249], v[248:249], v[252:253] op_sel_hi:[1,1]
  v_pk_add_f32 v[242:243], v[242:243], v[246:247] op_sel_hi:[1,1]
  v_pk_add_f32 v[250:251], v[250:251], v[254:255] op_sel_hi:[1,1]
  v_pk_add_f32 v[168:169], v[168:169], v[240:241] op_sel_hi:[1,1]
  v_pk_add_f32 v[170:171], v[170:171], v[242:243] op_sel_hi:[1,1]
  v_pk_add_f32 v[168:169], v[168:169], v[248:249] op_sel_hi:[1,1]
  v_pk_add_f32 v[170:171], v[170:171], v[250:251] op_sel_hi:[1,1]
  s_waitcnt vmcnt(4)
  v_pk_add_f32 v[104:105], v[104:105], v[108:109] op_sel_hi:[1,1]
  v_pk_add_f32 v[106:107], v[106:107], v[110:111] op_sel_hi:[1,1]
  buffer_store_dwordx4 v[104:107], v13, s[20:23], 0 offen offset:0
  s_waitcnt vmcnt(4)
  v_pk_add_f32 v[120:121], v[120:121], v[124:125] op_sel_hi:[1,1]
  v_pk_add_f32 v[122:123], v[122:123], v[126:127] op_sel_hi:[1,1]
  buffer_store_dwordx4 v[120:123], v13, s[20:23], 0 offen offset:64
  s_waitcnt vmcnt(4)
  v_pk_add_f32 v[136:137], v[136:137], v[140:141] op_sel_hi:[1,1]
  v_pk_add_f32 v[138:139], v[138:139], v[142:143] op_sel_hi:[1,1]
  buffer_store_dwordx4 v[136:139], v13, s[20:23], 0 offen offset:128
  s_waitcnt vmcnt(4)
  v_pk_add_f32 v[152:153], v[152:153], v[156:157] op_sel_hi:[1,1]
  v_pk_add_f32 v[154:155], v[154:155], v[158:159] op_sel_hi:[1,1]
  buffer_store_dwordx4 v[152:155], v13, s[20:23], 0 offen offset:192
  s_waitcnt vmcnt(4)
  v_pk_add_f32 v[168:169], v[168:169], v[172:173] op_sel_hi:[1,1]
  v_pk_add_f32 v[170:171], v[170:171], v[174:175] op_sel_hi:[1,1]
  buffer_store_dwordx4 v[168:171], v13, s[20:23], 0 offen offset:256
K_end:
  s_endpgm
.section .rodata,"a"
.p2align 6
.amdhsa_kernel parallel_sum__ssm_conv_s5__glu_gated_swiglu__prompt_kernel
  .amdhsa_next_free_vgpr 512
  .amdhsa_next_free_sgpr 102
  .amdhsa_accum_offset 256
  .amdhsa_group_segment_fixed_size 0
  .amdhsa_kernarg_size 128
  .amdhsa_user_sgpr_count 2
  .amdhsa_user_sgpr_kernarg_segment_ptr 1
  .amdhsa_system_sgpr_workgroup_id_x 1
  .amdhsa_float_denorm_mode_32 3
.end_amdhsa_kernel
```
